```python
import torch

def _softmax(x, axis=-1):
    return torch.softmax(x, dim=axis)
def _gelu(x):
    return torch.nn.functional.gelu(x, approximate="tanh")
def _silu(x):
    return torch.nn.functional.silu(x)
def _sigmoid(x):
    return torch.sigmoid(x)
def _layernorm(x, axis=-1, eps=1e-5):
    m = x.mean(dim=axis, keepdim=True)
    v = x.var(dim=axis, keepdim=True, unbiased=False)
    return (x - m) / torch.sqrt(v + eps)
def _scatter_add(tgt, idx, src, axis=0):
    return tgt.clone().index_add_(axis, idx, src)
def _segment_sum(src, seg, n):
    out = torch.zeros((n,) + src.shape[1:], dtype=src.dtype)
    return out.index_add_(0, seg, src)
def _pad(x, pw):
    flat = tuple(v for pair in reversed(pw) for v in pair)
    return torch.nn.functional.pad(x, flat)

kernel_name = 'concat_heads__gqa_block_cached__mha_block_cached__near_ridge'

def setup_inputs():

    _w = (lambda a: (lambda t: t.to(torch.bfloat16) if t.is_floating_point() else t)(torch.as_tensor(a)))
    def _A_setup():
        B, Sq, D = 8, 96, 512
        Hq, Hkv, Sk, Dh = 32, 32, 512, 128
        assert Hq % Hkv == 0, (Hq, Hkv)
        return {
            "x": _w((lambda *s: torch.randn(*s, dtype=torch.bfloat16) * 0.8)(B, Sq, D)),
            "k_cache": _w((lambda *s: torch.randn(*s, dtype=torch.bfloat16) * 0.8)(B, Hkv, Sk, Dh)),
            "v_cache": _w((lambda *s: torch.randn(*s, dtype=torch.bfloat16) * 0.05)(B, Hkv, Sk, Dh)),
            "wq": _w((lambda *s: torch.randn(*s, dtype=torch.bfloat16) * 0.8)(D, Hq * Dh) * (D ** -0.5)),
            "wo": _w((lambda *s: torch.randn(*s, dtype=torch.bfloat16) * 0.05)(Hq * Dh, D) * ((Hq * Dh) ** -0.5)),
        }
    _A_in = _A_setup()

    def _B_setup():
        B, Sq, D = 8, 96, 512
        H, Sk, Dh = 32, 512, 128
        return {
            "x": _w((lambda *s: torch.randn(*s, dtype=torch.bfloat16) * 0.8)(B, Sq, D)),
            "k_cache": _w((lambda *s: torch.randn(*s, dtype=torch.bfloat16) * 0.8)(B, H, Sk, Dh)),
            "v_cache": _w((lambda *s: torch.randn(*s, dtype=torch.bfloat16) * 0.05)(B, H, Sk, Dh)),
            "wq": _w((lambda *s: torch.randn(*s, dtype=torch.bfloat16) * 0.8)(D, H * Dh) * (D ** -0.5)),
            "wo": _w((lambda *s: torch.randn(*s, dtype=torch.bfloat16) * 0.05)(H * Dh, D) * ((H * Dh) ** -0.5)),
        }
    _B_in = _B_setup()

    return {
        "A_x": _A_in["x"],
        "A_k_cache": _A_in["k_cache"],
        "A_v_cache": _A_in["v_cache"],
        "A_wq": _A_in["wq"],
        "A_wo": _A_in["wo"],
        "B_x": _B_in["x"],
        "B_k_cache": _B_in["k_cache"],
        "B_v_cache": _B_in["v_cache"],
        "B_wq": _B_in["wq"],
        "B_wo": _B_in["wo"],
    }

def reference(A_x, A_k_cache, A_v_cache, A_wq, A_wo, B_x, B_k_cache, B_v_cache, B_wq, B_wo):
    def _A_ref(x, k_cache, v_cache, wq, wo):
        B, Sq, D = x.shape
        Hq, Dh = 32, 128
        Hkv = k_cache.shape[1]
        rep = Hq // Hkv
        q = (lambda x, *d: x.permute(*d))((x @ wq).reshape(B, Sq, Hq, Dh), 0, 2, 1, 3)
        k = (lambda x, n, axis: torch.repeat_interleave(x, n, dim=axis))(k_cache, rep, axis=1)
        v = (lambda x, n, axis: torch.repeat_interleave(x, n, dim=axis))(v_cache, rep, axis=1)
        scores = torch.einsum("bhqd,bhkd->bhqk", q, k) * (Dh ** -0.5)
        p = _softmax(scores, axis=-1)
        o = torch.einsum("bhqk,bhkd->bhqd", p, v)
        return (lambda x, *d: x.permute(*d))(o, 0, 2, 1, 3).reshape(B, Sq, Hq * Dh) @ wo

    def _B_ref(x, k_cache, v_cache, wq, wo):
        B, Sq, D = x.shape
        H, Dh = 32, 128
        q = (lambda x, *d: x.permute(*d))((x @ wq).reshape(B, Sq, H, Dh), 0, 2, 1, 3)
        scores = torch.einsum("bhqd,bhkd->bhqk", q, k_cache) * (Dh ** -0.5)
        p = _softmax(scores, axis=-1)
        o = torch.einsum("bhqk,bhkd->bhqd", p, v_cache)
        return (lambda x, *d: x.permute(*d))(o, 0, 2, 1, 3).reshape(B, Sq, H * Dh) @ wo

    a = _A_ref(A_x, A_k_cache, A_v_cache, A_wq, A_wo)
    b = _B_ref(B_x, B_k_cache, B_v_cache, B_wq, B_wo)
    return torch.concatenate([a, b], axis=-1)
```

```asm
; @launch grid=(256,1,1) block=(256,1,1) lds=163840
.amdgcn_target "amdgcn-amd-amdhsa--gfx950"
.text
.globl concat_heads__gqa_block_cached__mha_block_cached__near_ridge_kernel
.p2align 8
.type concat_heads__gqa_block_cached__mha_block_cached__near_ridge_kernel,@function
concat_heads__gqa_block_cached__mha_block_cached__near_ridge_kernel:
L_start:
    s_cmp_ge_u32 s2, 256
    s_cbranch_scc1 L_end
    s_and_b32 s3, s2, 7
    s_lshr_b32 s43, s3, 2
    s_mul_i32 s4, s43, 40
    s_add_u32 s4, s0, s4
    s_addc_u32 s5, s1, 0
    s_load_dwordx8 s[72:79], s[4:5], 0
    s_load_dwordx2 s[80:81], s[4:5], 32
    s_load_dwordx4 s[84:87], s[0:1], 80
    s_load_dwordx2 s[88:89], s[0:1], 96
    v_lshrrev_b32 v1, 6, v0
    v_and_b32 v0, 63, v0
    v_readfirstlane_b32 s40, v1
    v_lshlrev_b32 v248, 4, v0
    s_lshr_b32 s6, s2, 3
    s_lshl_b32 s59, s40, 12
    s_mul_i32 s61, s40, 3072
    s_and_b32 s41, s40, 1
    s_lshr_b32 s42, s40, 1
    s_getpc_b64 s[92:93]
L_pc:
    s_sub_u32 s92, s92, L_pc - L_start
    s_subb_u32 s93, s93, 0
    s_mov_b32 s94, 91624
    s_mov_b32 s95, 0x20000
    s_lshl_b32 s48, s6, 12
    s_lshl_b32 s49, s40, 20
    s_add_u32 s48, s48, s49
    v_lshlrev_b32 v16, 6, v0
    v_add_u32 v16, s48, v16
    buffer_load_dword v17, v16, s[92:95], 0 offen
    s_and_b32 s7, s3, 3
    s_lshr_b32 s44, s6, 2
    s_and_b32 s56, s6, 3
    s_lshl_b32 s45, s7, 3
    s_lshl_b32 s49, s56, 1
    s_add_u32 s45, s45, s49
    s_add_u32 s53, s44, s49
    s_and_b32 s53, s53, 7
    s_lshl_b32 s54, s40, 17
    s_lshl_b32 s49, s45, 8
    s_add_u32 s54, s54, s49
    s_mul_i32 s55, s44, 98304
    s_mul_i32 s49, s40, 24576
    s_add_u32 s55, s55, s49
    v_lshrrev_b32 v2, 3, v0
    v_and_b32 v3, 7, v0
    v_lshrrev_b32 v5, 1, v2
    s_add_u32 s48, s40, 0
    s_and_b32 s48, s48, 1
    s_lshl_b32 s48, s48, 2
    v_add_u32 v4, s48, v5
    v_xor_b32 v4, v4, v3
    v_lshlrev_b32 v4, 4, v4
    v_lshl_add_u32 v4, v2, 10, v4
    v_add_u32 v96, 0, v4
    s_add_u32 s48, s40, 1
    s_and_b32 s48, s48, 1
    s_lshl_b32 s48, s48, 2
    v_add_u32 v4, s48, v5
    v_xor_b32 v4, v4, v3
    v_lshlrev_b32 v4, 4, v4
    v_lshl_add_u32 v4, v2, 10, v4
    v_add_u32 v97, 7168, v4
    s_add_u32 s48, s40, 2
    s_and_b32 s48, s48, 1
    s_lshl_b32 s48, s48, 2
    v_add_u32 v4, s48, v5
    v_xor_b32 v4, v4, v3
    v_lshlrev_b32 v4, 4, v4
    v_lshl_add_u32 v4, v2, 10, v4
    v_add_u32 v98, 14336, v4
    v_lshrrev_b32 v2, 4, v0
    v_and_b32 v3, 0xf0, v248
    v_lshlrev_b32 v4, 5, v2
    v_xor_b32 v4, v4, v3
    v_lshl_add_u32 v242, v2, 13, v4
    s_memrealtime s[64:65]
    s_lshl_b32 s48, s2, 14
    s_add_u32 s48, s48, s59
    s_add_u32 s48, s48, 4
    v_lshl_add_u32 v239, v248, 4, s48
    s_waitcnt lgkmcnt(0)
    s_mov_b32 s8, s72
    s_mov_b32 s9, s73
    s_mov_b32 s10, 786432
    s_mov_b32 s11, 0x20000
    s_mov_b32 s20, s78
    s_mov_b32 s21, s79
    s_mov_b32 s22, 4194304
    s_mov_b32 s23, 0x20000
    s_mov_b32 s36, s86
    s_mov_b32 s37, s87
    s_mov_b32 s38, 256
    s_mov_b32 s39, 0x20000
    s_or_b32 s49, s64, 1
    v_mov_b32 v238, s49
    buffer_store_dword v238, v239, s[36:39], 0 offen sc1
    s_bitcmp1_b32 s6, 2
    s_cbranch_scc1 L_cls_Y
    s_add_u32 s69, s53, 0
    s_and_b32 s69, s69, 7
    s_add_u32 m0, s61, 65536
    s_lshl_b32 s68, s69, 7
    s_add_u32 s68, s68, s55
    buffer_load_dwordx4 v96, s[8:11], s68 offen offset:0 lds
    buffer_load_dwordx4 v97, s[8:11], s68 offen offset:1024 lds
    buffer_load_dwordx4 v98, s[8:11], s68 offen offset:2048 lds
    s_add_u32 m0, s59, 114688
    s_add_u32 s69, s53, 0
    s_and_b32 s69, s69, 7
    s_lshl_b32 s68, s69, 19
    s_add_u32 s68, s68, s54
    buffer_load_dwordx4 v242, s[20:23], s68 offen offset:0  lds
    s_add_u32 s68, s68, 31744
    buffer_load_dwordx4 v242, s[20:23], s68 offen offset:1024  lds
    s_add_u32 s68, s68, 31744
    v_xor_b32 v244, 128, v242
    buffer_load_dwordx4 v244, s[20:23], s68 offen offset:2048  lds
    s_add_u32 s68, s68, 31744
    buffer_load_dwordx4 v244, s[20:23], s68 offen offset:3072  lds
    s_add_u32 s69, s53, 1
    s_and_b32 s69, s69, 7
    s_add_u32 m0, s61, 77824
    s_lshl_b32 s68, s69, 7
    s_add_u32 s68, s68, s55
    buffer_load_dwordx4 v96, s[8:11], s68 offen offset:0 lds
    buffer_load_dwordx4 v97, s[8:11], s68 offen offset:1024 lds
    buffer_load_dwordx4 v98, s[8:11], s68 offen offset:2048 lds
    v_lshl_add_u32 v241, v2, 8, v4
    v_lshl_add_u32 v243, v2, 10, v4
    v_lshlrev_b32 v4, 4, v2
    v_xor_b32 v4, v4, v3
    v_lshl_add_u32 v240, v2, 8, v4
    v_bfe_u32 v5, v0, 2, 2
    v_and_b32 v6, 3, v0
    v_and_b32 v7, 15, v0
    s_lshl_b32 s48, s42, 7
    s_lshl_b32 s49, s42, 13
    s_mul_i32 s60, s41, 6144
    v_lshl_add_u32 v8, v2, 3, v5
    v_lshlrev_b32 v8, 8, v8
    v_and_b32 v9, 1, v2
    v_lshl_add_u32 v9, v9, 2, v5
    v_lshl_add_u32 v8, v9, 5, v8
    v_lshl_add_u32 v8, v6, 3, v8
    v_xor_b32 v245, s48, v8
    v_lshrrev_b32 v8, 2, v0
    v_and_b32 v9, 7, v8
    v_lshlrev_b32 v9, 5, v9
    v_lshl_add_u32 v9, v8, 8, v9
    v_lshl_add_u32 v9, v6, 3, v9
    v_add_u32 v9, s49, v9
    v_xor_b32 v247, s48, v9
    v_xor_b32 v8, v2, v7
    v_lshlrev_b32 v8, 4, v8
    v_lshl_add_u32 v8, v7, 8, v8
    v_add_u32 v246, s49, v8
    v_lshrrev_b32 v8, 1, v7
    v_xor_b32 v8, v8, v2
    v_lshlrev_b32 v8, 4, v8
    v_lshl_add_u32 v8, v7, 7, v8
    s_add_u32 s48, s60, 65536
    v_add_u32 v100, s48, v8
    v_xor_b32 v101, 64, v100
    s_add_u32 m0, s59, 131072
    s_add_u32 s69, s53, 1
    s_and_b32 s69, s69, 7
    s_lshl_b32 s68, s69, 19
    s_add_u32 s68, s68, s54
    buffer_load_dwordx4 v242, s[20:23], s68 offen offset:0  lds
    s_add_u32 s68, s68, 31744
    buffer_load_dwordx4 v242, s[20:23], s68 offen offset:1024  lds
    s_add_u32 s68, s68, 31744
    v_xor_b32 v244, 128, v242
    buffer_load_dwordx4 v244, s[20:23], s68 offen offset:2048  lds
    s_add_u32 s68, s68, 31744
    buffer_load_dwordx4 v244, s[20:23], s68 offen offset:3072  lds
    s_add_u32 s69, s53, 2
    s_and_b32 s69, s69, 7
    s_add_u32 m0, s61, 90112
    s_lshl_b32 s68, s69, 7
    s_add_u32 s68, s68, s55
    buffer_load_dwordx4 v96, s[8:11], s68 offen offset:0 lds
    buffer_load_dwordx4 v97, s[8:11], s68 offen offset:1024 lds
    buffer_load_dwordx4 v98, s[8:11], s68 offen offset:2048 lds
    s_add_u32 m0, s59, 147456
    s_add_u32 s69, s53, 2
    s_and_b32 s69, s69, 7
    s_lshl_b32 s68, s69, 19
    s_add_u32 s68, s68, s54
    buffer_load_dwordx4 v242, s[20:23], s68 offen offset:0  lds
    s_add_u32 s68, s68, 31744
    buffer_load_dwordx4 v242, s[20:23], s68 offen offset:1024  lds
    s_add_u32 s68, s68, 31744
    v_xor_b32 v244, 128, v242
    buffer_load_dwordx4 v244, s[20:23], s68 offen offset:2048  lds
    s_add_u32 s68, s68, 31744
    buffer_load_dwordx4 v244, s[20:23], s68 offen offset:3072  lds
    s_mov_b32 s12, s74
    s_mov_b32 s13, s75
    s_mov_b32 s14, 33554432
    s_mov_b32 s15, 0x20000
    s_mov_b32 s16, s76
    s_mov_b32 s17, s77
    s_mov_b32 s18, 33554432
    s_mov_b32 s19, 0x20000
    s_mov_b32 s24, s80
    s_mov_b32 s25, s81
    s_mov_b32 s26, 4194304
    s_mov_b32 s27, 0x20000
    s_mov_b32 s28, s84
    s_mov_b32 s29, s85
    s_mov_b32 s30, 1572864
    s_mov_b32 s31, 0x20000
    s_mov_b32 s32, s88
    s_mov_b32 s33, s89
    s_mov_b32 s34, 268435456
    s_mov_b32 s35, 0x20000
    s_lshl_b32 s46, s44, 5
    s_add_u32 s46, s46, s45
    s_lshl_b32 s46, s46, 17
    s_lshl_b32 s49, s40, 10
    s_add_u32 s46, s46, s49
    s_lshl_b32 s51, s43, 3
    s_add_u32 s51, s51, s44
    s_lshl_b32 s63, s51, 7
    s_lshl_b32 s49, s7, 4
    s_add_u32 s63, s63, s49
    s_add_u32 s63, s63, 16777216
    s_lshl_b32 s49, s56, 2
    s_add_u32 s47, s63, s49
    s_add_u32 s90, s56, s44
    s_and_b32 s90, s90, 3
    s_lshl_b32 s62, s51, 5
    s_add_u32 s62, s62, s45
    s_mul_i32 s62, s62, 24576
    s_mul_i32 s49, s42, 12288
    s_add_u32 s62, s62, s49
    s_add_u32 s62, s62, s60
    s_mov_b32 s52, 0x3e0293ee
    s_lshl_b32 s48, s7, 20
    s_lshl_b32 s49, s40, 14
    s_add_u32 s48, s48, s49
    s_lshl_b32 s49, s90, 8
    s_add_u32 s48, s48, s49
    s_lshl_b32 s50, s51, 2
    s_add_u32 s50, s50, s7
    s_mul_i32 s50, s50, 196608
    s_add_u32 s50, s50, s61
    s_add_u32 s49, s56, 0
    s_and_b32 s49, s49, 3
    s_lshl_b32 s72, s49, 18
    s_add_u32 s72, s72, s48
    s_mul_i32 s80, s49, 49152
    s_add_u32 s80, s80, s50
    s_add_u32 s49, s56, 1
    s_and_b32 s49, s49, 3
    s_lshl_b32 s73, s49, 18
    s_add_u32 s73, s73, s48
    s_mul_i32 s81, s49, 49152
    s_add_u32 s81, s81, s50
    s_add_u32 s49, s56, 2
    s_and_b32 s49, s49, 3
    s_lshl_b32 s74, s49, 18
    s_add_u32 s74, s74, s48
    s_mul_i32 s82, s49, 49152
    s_add_u32 s82, s82, s50
    s_add_u32 s49, s56, 3
    s_and_b32 s49, s49, 3
    s_lshl_b32 s75, s49, 18
    s_add_u32 s75, s75, s48
    s_mul_i32 s83, s49, 49152
    s_add_u32 s83, s83, s50
    s_lshl_b32 s58, s51, 2
    s_add_u32 s58, s58, s56
    s_mov_b32 s57, s7
    v_add_u32 v224, 114688, v245
    v_xor_b32 v225, 32, v224
    v_xor_b32 v226, 64, v224
    v_xor_b32 v227, 96, v224
    s_waitcnt vmcnt(14)
    s_barrier
    ds_read_b64_tr_b16 v[192:193], v224 offset:0
    ds_read_b64_tr_b16 v[194:195], v224 offset:1024
    ds_read_b128 a[0:3], v100 offset:0
    ds_read_b128 a[4:7], v100 offset:2048
    ds_read_b128 a[8:11], v100 offset:4096
    ds_read_b64_tr_b16 v[196:197], v225 offset:0
    ds_read_b64_tr_b16 v[198:199], v225 offset:1024
    ds_read_b64_tr_b16 v[200:201], v226 offset:0
    ds_read_b64_tr_b16 v[202:203], v226 offset:1024
    ds_read_b128 a[12:15], v101 offset:0
    ds_read_b128 a[16:19], v101 offset:2048
    ds_read_b128 a[20:23], v101 offset:4096
    ds_read_b64_tr_b16 v[204:205], v227 offset:0
    ds_read_b64_tr_b16 v[206:207], v227 offset:1024
    ds_read_b64_tr_b16 v[208:209], v224 offset:8192
    ds_read_b64_tr_b16 v[210:211], v224 offset:9216
    s_waitcnt lgkmcnt(11)
    v_mfma_f32_16x16x32_bf16 v[0:3], v[192:195], a[0:3], 0
    v_mfma_f32_16x16x32_bf16 v[4:7], v[192:195], a[4:7], 0
    ds_read_b64_tr_b16 v[212:213], v225 offset:8192
    ds_read_b64_tr_b16 v[214:215], v225 offset:9216
    v_mfma_f32_16x16x32_bf16 v[8:11], v[192:195], a[8:11], 0
    s_waitcnt lgkmcnt(11)
    v_mfma_f32_16x16x32_bf16 v[12:15], v[196:199], a[0:3], 0
    v_mfma_f32_16x16x32_bf16 v[16:19], v[196:199], a[4:7], 0
    ds_read_b64_tr_b16 v[216:217], v226 offset:8192
    ds_read_b64_tr_b16 v[218:219], v226 offset:9216
    v_mfma_f32_16x16x32_bf16 v[20:23], v[196:199], a[8:11], 0
    s_waitcnt lgkmcnt(11)
    v_mfma_f32_16x16x32_bf16 v[24:27], v[200:203], a[0:3], 0
    v_mfma_f32_16x16x32_bf16 v[28:31], v[200:203], a[4:7], 0
    ds_read_b64_tr_b16 v[220:221], v227 offset:8192
    ds_read_b64_tr_b16 v[222:223], v227 offset:9216
    v_mfma_f32_16x16x32_bf16 v[32:35], v[200:203], a[8:11], 0
    s_waitcnt lgkmcnt(8)
    v_mfma_f32_16x16x32_bf16 v[36:39], v[204:207], a[0:3], 0
    v_add_u32 v224, 131072, v245
    v_xor_b32 v225, 32, v224
    v_mfma_f32_16x16x32_bf16 v[40:43], v[204:207], a[4:7], 0
    v_xor_b32 v226, 64, v224
    v_xor_b32 v227, 96, v224
    v_mfma_f32_16x16x32_bf16 v[44:47], v[204:207], a[8:11], 0
    s_waitcnt lgkmcnt(6)
    v_mfma_f32_16x16x32_bf16 v[0:3], v[208:211], a[12:15], v[0:3]
    v_mfma_f32_16x16x32_bf16 v[4:7], v[208:211], a[16:19], v[4:7]
    v_mfma_f32_16x16x32_bf16 v[8:11], v[208:211], a[20:23], v[8:11]
    s_waitcnt vmcnt(7) lgkmcnt(0)
    s_barrier
    v_mfma_f32_16x16x32_bf16 v[12:15], v[212:215], a[12:15], v[12:15]
    ds_read_b64_tr_b16 v[192:193], v224 offset:0
    ds_read_b64_tr_b16 v[194:195], v224 offset:1024
    s_add_u32 s69, s53, 3
    s_and_b32 s69, s69, 7
    s_add_u32 m0, s61, 102400
    s_lshl_b32 s68, s69, 7
    s_add_u32 s68, s68, s55
    buffer_load_dwordx4 v96, s[8:11], s68 offen offset:0 lds
    v_mfma_f32_16x16x32_bf16 v[16:19], v[212:215], a[16:19], v[16:19]
    ds_read_b128 a[24:27], v100 offset:12288
    ds_read_b128 a[28:31], v100 offset:14336
    v_mfma_f32_16x16x32_bf16 v[20:23], v[212:215], a[20:23], v[20:23]
    ds_read_b128 a[32:35], v100 offset:16384
    ds_read_b64_tr_b16 v[196:197], v225 offset:0
    v_mfma_f32_16x16x32_bf16 v[24:27], v[216:219], a[12:15], v[24:27]
    ds_read_b64_tr_b16 v[198:199], v225 offset:1024
    ds_read_b64_tr_b16 v[200:201], v226 offset:0
    buffer_load_dwordx4 v97, s[8:11], s68 offen offset:1024 lds
    v_mfma_f32_16x16x32_bf16 v[28:31], v[216:219], a[16:19], v[28:31]
    ds_read_b64_tr_b16 v[202:203], v226 offset:1024
    ds_read_b128 a[36:39], v101 offset:12288
    v_mfma_f32_16x16x32_bf16 v[32:35], v[216:219], a[20:23], v[32:35]
    ds_read_b128 a[40:43], v101 offset:14336
    ds_read_b128 a[44:47], v101 offset:16384
    v_mfma_f32_16x16x32_bf16 v[36:39], v[220:223], a[12:15], v[36:39]
    ds_read_b64_tr_b16 v[204:205], v227 offset:0
    ds_read_b64_tr_b16 v[206:207], v227 offset:1024
    buffer_load_dwordx4 v98, s[8:11], s68 offen offset:2048 lds
    v_mfma_f32_16x16x32_bf16 v[40:43], v[220:223], a[16:19], v[40:43]
    ds_read_b64_tr_b16 v[208:209], v224 offset:8192
    ds_read_b64_tr_b16 v[210:211], v224 offset:9216
    v_mfma_f32_16x16x32_bf16 v[44:47], v[220:223], a[20:23], v[44:47]
    s_waitcnt lgkmcnt(11)
    v_mfma_f32_16x16x32_bf16 v[0:3], v[192:195], a[24:27], v[0:3]
    s_add_u32 m0, s59, 114688
    s_add_u32 s69, s53, 3
    s_and_b32 s69, s69, 7
    s_lshl_b32 s68, s69, 19
    s_add_u32 s68, s68, s54
    buffer_load_dwordx4 v242, s[20:23], s68 offen offset:0  lds
    v_mfma_f32_16x16x32_bf16 v[4:7], v[192:195], a[28:31], v[4:7]
    ds_read_b64_tr_b16 v[212:213], v225 offset:8192
    ds_read_b64_tr_b16 v[214:215], v225 offset:9216
    v_mfma_f32_16x16x32_bf16 v[8:11], v[192:195], a[32:35], v[8:11]
    s_waitcnt lgkmcnt(11)
    v_mfma_f32_16x16x32_bf16 v[12:15], v[196:199], a[24:27], v[12:15]
    s_add_u32 s68, s68, 31744
    buffer_load_dwordx4 v242, s[20:23], s68 offen offset:1024  lds
    v_mfma_f32_16x16x32_bf16 v[16:19], v[196:199], a[28:31], v[16:19]
    ds_read_b64_tr_b16 v[216:217], v226 offset:8192
    ds_read_b64_tr_b16 v[218:219], v226 offset:9216
    v_mfma_f32_16x16x32_bf16 v[20:23], v[196:199], a[32:35], v[20:23]
    s_waitcnt lgkmcnt(11)
    v_mfma_f32_16x16x32_bf16 v[24:27], v[200:203], a[24:27], v[24:27]
    s_add_u32 s68, s68, 31744
    v_xor_b32 v244, 128, v242
    buffer_load_dwordx4 v244, s[20:23], s68 offen offset:2048  lds
    v_mfma_f32_16x16x32_bf16 v[28:31], v[200:203], a[28:31], v[28:31]
    ds_read_b64_tr_b16 v[220:221], v227 offset:8192
    ds_read_b64_tr_b16 v[222:223], v227 offset:9216
    v_mfma_f32_16x16x32_bf16 v[32:35], v[200:203], a[32:35], v[32:35]
    s_waitcnt lgkmcnt(8)
    v_mfma_f32_16x16x32_bf16 v[36:39], v[204:207], a[24:27], v[36:39]
    v_add_u32 v224, 147456, v245
    s_add_u32 s68, s68, 31744
    buffer_load_dwordx4 v244, s[20:23], s68 offen offset:3072  lds
    v_xor_b32 v225, 32, v224
    v_mfma_f32_16x16x32_bf16 v[40:43], v[204:207], a[28:31], v[40:43]
    v_xor_b32 v226, 64, v224
    v_xor_b32 v227, 96, v224
    v_mfma_f32_16x16x32_bf16 v[44:47], v[204:207], a[32:35], v[44:47]
    s_waitcnt lgkmcnt(6)
    v_mfma_f32_16x16x32_bf16 v[0:3], v[208:211], a[36:39], v[0:3]
    v_mfma_f32_16x16x32_bf16 v[4:7], v[208:211], a[40:43], v[4:7]
    v_mfma_f32_16x16x32_bf16 v[8:11], v[208:211], a[44:47], v[8:11]
    s_waitcnt vmcnt(7) lgkmcnt(0)
    s_barrier
    v_mfma_f32_16x16x32_bf16 v[12:15], v[212:215], a[36:39], v[12:15]
    ds_read_b64_tr_b16 v[192:193], v224 offset:0
    ds_read_b64_tr_b16 v[194:195], v224 offset:1024
    s_add_u32 s69, s53, 4
    s_and_b32 s69, s69, 7
    s_add_u32 m0, s61, 65536
    s_lshl_b32 s68, s69, 7
    s_add_u32 s68, s68, s55
    buffer_load_dwordx4 v96, s[8:11], s68 offen offset:0 lds
    v_mfma_f32_16x16x32_bf16 v[16:19], v[212:215], a[40:43], v[16:19]
    ds_read_b128 a[48:51], v100 offset:24576
    ds_read_b128 a[52:55], v100 offset:26624
    v_mfma_f32_16x16x32_bf16 v[20:23], v[212:215], a[44:47], v[20:23]
    ds_read_b128 a[56:59], v100 offset:28672
    ds_read_b64_tr_b16 v[196:197], v225 offset:0
    v_mfma_f32_16x16x32_bf16 v[24:27], v[216:219], a[36:39], v[24:27]
    ds_read_b64_tr_b16 v[198:199], v225 offset:1024
    ds_read_b64_tr_b16 v[200:201], v226 offset:0
    buffer_load_dwordx4 v97, s[8:11], s68 offen offset:1024 lds
    v_mfma_f32_16x16x32_bf16 v[28:31], v[216:219], a[40:43], v[28:31]
    ds_read_b64_tr_b16 v[202:203], v226 offset:1024
    ds_read_b128 a[60:63], v101 offset:24576
    v_mfma_f32_16x16x32_bf16 v[32:35], v[216:219], a[44:47], v[32:35]
    ds_read_b128 a[64:67], v101 offset:26624
    ds_read_b128 a[68:71], v101 offset:28672
    v_mfma_f32_16x16x32_bf16 v[36:39], v[220:223], a[36:39], v[36:39]
    ds_read_b64_tr_b16 v[204:205], v227 offset:0
    ds_read_b64_tr_b16 v[206:207], v227 offset:1024
    buffer_load_dwordx4 v98, s[8:11], s68 offen offset:2048 lds
    v_mfma_f32_16x16x32_bf16 v[40:43], v[220:223], a[40:43], v[40:43]
    ds_read_b64_tr_b16 v[208:209], v224 offset:8192
    ds_read_b64_tr_b16 v[210:211], v224 offset:9216
    v_mfma_f32_16x16x32_bf16 v[44:47], v[220:223], a[44:47], v[44:47]
    s_waitcnt lgkmcnt(11)
    v_mfma_f32_16x16x32_bf16 v[0:3], v[192:195], a[48:51], v[0:3]
    s_add_u32 m0, s59, 131072
    s_add_u32 s69, s53, 4
    s_and_b32 s69, s69, 7
    s_lshl_b32 s68, s69, 19
    s_add_u32 s68, s68, s54
    buffer_load_dwordx4 v242, s[20:23], s68 offen offset:0  lds
    v_mfma_f32_16x16x32_bf16 v[4:7], v[192:195], a[52:55], v[4:7]
    ds_read_b64_tr_b16 v[212:213], v225 offset:8192
    ds_read_b64_tr_b16 v[214:215], v225 offset:9216
    v_mfma_f32_16x16x32_bf16 v[8:11], v[192:195], a[56:59], v[8:11]
    s_waitcnt lgkmcnt(11)
    v_mfma_f32_16x16x32_bf16 v[12:15], v[196:199], a[48:51], v[12:15]
    s_add_u32 s68, s68, 31744
    buffer_load_dwordx4 v242, s[20:23], s68 offen offset:1024  lds
    v_mfma_f32_16x16x32_bf16 v[16:19], v[196:199], a[52:55], v[16:19]
    ds_read_b64_tr_b16 v[216:217], v226 offset:8192
    ds_read_b64_tr_b16 v[218:219], v226 offset:9216
    v_mfma_f32_16x16x32_bf16 v[20:23], v[196:199], a[56:59], v[20:23]
    s_waitcnt lgkmcnt(11)
    v_mfma_f32_16x16x32_bf16 v[24:27], v[200:203], a[48:51], v[24:27]
    s_add_u32 s68, s68, 31744
    v_xor_b32 v244, 128, v242
    buffer_load_dwordx4 v244, s[20:23], s68 offen offset:2048  lds
    v_mfma_f32_16x16x32_bf16 v[28:31], v[200:203], a[52:55], v[28:31]
    ds_read_b64_tr_b16 v[220:221], v227 offset:8192
    ds_read_b64_tr_b16 v[222:223], v227 offset:9216
    v_mfma_f32_16x16x32_bf16 v[32:35], v[200:203], a[56:59], v[32:35]
    s_waitcnt lgkmcnt(8)
    v_mfma_f32_16x16x32_bf16 v[36:39], v[204:207], a[48:51], v[36:39]
    v_add_u32 v224, 114688, v245
    s_add_u32 s68, s68, 31744
    buffer_load_dwordx4 v244, s[20:23], s68 offen offset:3072  lds
    v_xor_b32 v225, 32, v224
    v_mfma_f32_16x16x32_bf16 v[40:43], v[204:207], a[52:55], v[40:43]
    v_xor_b32 v226, 64, v224
    v_xor_b32 v227, 96, v224
    v_mfma_f32_16x16x32_bf16 v[44:47], v[204:207], a[56:59], v[44:47]
    s_waitcnt lgkmcnt(6)
    v_mfma_f32_16x16x32_bf16 v[0:3], v[208:211], a[60:63], v[0:3]
    v_mfma_f32_16x16x32_bf16 v[4:7], v[208:211], a[64:67], v[4:7]
    v_mfma_f32_16x16x32_bf16 v[8:11], v[208:211], a[68:71], v[8:11]
    s_waitcnt vmcnt(7) lgkmcnt(0)
    s_barrier
    v_mfma_f32_16x16x32_bf16 v[12:15], v[212:215], a[60:63], v[12:15]
    ds_read_b64_tr_b16 v[192:193], v224 offset:0
    ds_read_b64_tr_b16 v[194:195], v224 offset:1024
    s_add_u32 s69, s53, 5
    s_and_b32 s69, s69, 7
    s_add_u32 m0, s61, 77824
    s_lshl_b32 s68, s69, 7
    s_add_u32 s68, s68, s55
    buffer_load_dwordx4 v96, s[8:11], s68 offen offset:0 lds
    v_mfma_f32_16x16x32_bf16 v[16:19], v[212:215], a[64:67], v[16:19]
    ds_read_b128 a[72:75], v100 offset:36864
    ds_read_b128 a[76:79], v100 offset:38912
    v_mfma_f32_16x16x32_bf16 v[20:23], v[212:215], a[68:71], v[20:23]
    ds_read_b128 a[80:83], v100 offset:40960
    ds_read_b64_tr_b16 v[196:197], v225 offset:0
    v_mfma_f32_16x16x32_bf16 v[24:27], v[216:219], a[60:63], v[24:27]
    ds_read_b64_tr_b16 v[198:199], v225 offset:1024
    ds_read_b64_tr_b16 v[200:201], v226 offset:0
    buffer_load_dwordx4 v97, s[8:11], s68 offen offset:1024 lds
    v_mfma_f32_16x16x32_bf16 v[28:31], v[216:219], a[64:67], v[28:31]
    ds_read_b64_tr_b16 v[202:203], v226 offset:1024
    ds_read_b128 a[84:87], v101 offset:36864
    v_mfma_f32_16x16x32_bf16 v[32:35], v[216:219], a[68:71], v[32:35]
    ds_read_b128 a[88:91], v101 offset:38912
    ds_read_b128 a[92:95], v101 offset:40960
    v_mfma_f32_16x16x32_bf16 v[36:39], v[220:223], a[60:63], v[36:39]
    ds_read_b64_tr_b16 v[204:205], v227 offset:0
    ds_read_b64_tr_b16 v[206:207], v227 offset:1024
    buffer_load_dwordx4 v98, s[8:11], s68 offen offset:2048 lds
    v_mfma_f32_16x16x32_bf16 v[40:43], v[220:223], a[64:67], v[40:43]
    ds_read_b64_tr_b16 v[208:209], v224 offset:8192
    ds_read_b64_tr_b16 v[210:211], v224 offset:9216
    v_mfma_f32_16x16x32_bf16 v[44:47], v[220:223], a[68:71], v[44:47]
    s_waitcnt lgkmcnt(11)
    v_mfma_f32_16x16x32_bf16 v[0:3], v[192:195], a[72:75], v[0:3]
    s_add_u32 m0, s59, 147456
    s_add_u32 s69, s53, 5
    s_and_b32 s69, s69, 7
    s_lshl_b32 s68, s69, 19
    s_add_u32 s68, s68, s54
    buffer_load_dwordx4 v242, s[20:23], s68 offen offset:0  lds
    v_mfma_f32_16x16x32_bf16 v[4:7], v[192:195], a[76:79], v[4:7]
    ds_read_b64_tr_b16 v[212:213], v225 offset:8192
    ds_read_b64_tr_b16 v[214:215], v225 offset:9216
    v_mfma_f32_16x16x32_bf16 v[8:11], v[192:195], a[80:83], v[8:11]
    s_waitcnt lgkmcnt(11)
    v_mfma_f32_16x16x32_bf16 v[12:15], v[196:199], a[72:75], v[12:15]
    s_add_u32 s68, s68, 31744
    buffer_load_dwordx4 v242, s[20:23], s68 offen offset:1024  lds
    v_mfma_f32_16x16x32_bf16 v[16:19], v[196:199], a[76:79], v[16:19]
    ds_read_b64_tr_b16 v[216:217], v226 offset:8192
    ds_read_b64_tr_b16 v[218:219], v226 offset:9216
    v_mfma_f32_16x16x32_bf16 v[20:23], v[196:199], a[80:83], v[20:23]
    s_waitcnt lgkmcnt(11)
    v_mfma_f32_16x16x32_bf16 v[24:27], v[200:203], a[72:75], v[24:27]
    s_add_u32 s68, s68, 31744
    v_xor_b32 v244, 128, v242
    buffer_load_dwordx4 v244, s[20:23], s68 offen offset:2048  lds
    v_mfma_f32_16x16x32_bf16 v[28:31], v[200:203], a[76:79], v[28:31]
    ds_read_b64_tr_b16 v[220:221], v227 offset:8192
    ds_read_b64_tr_b16 v[222:223], v227 offset:9216
    v_mfma_f32_16x16x32_bf16 v[32:35], v[200:203], a[80:83], v[32:35]
    s_waitcnt lgkmcnt(8)
    v_mfma_f32_16x16x32_bf16 v[36:39], v[204:207], a[72:75], v[36:39]
    v_add_u32 v224, 131072, v245
    s_add_u32 s68, s68, 31744
    buffer_load_dwordx4 v244, s[20:23], s68 offen offset:3072  lds
    v_xor_b32 v225, 32, v224
    v_mfma_f32_16x16x32_bf16 v[40:43], v[204:207], a[76:79], v[40:43]
    v_xor_b32 v226, 64, v224
    v_xor_b32 v227, 96, v224
    v_mfma_f32_16x16x32_bf16 v[44:47], v[204:207], a[80:83], v[44:47]
    s_waitcnt lgkmcnt(6)
    v_mfma_f32_16x16x32_bf16 v[0:3], v[208:211], a[84:87], v[0:3]
    v_mfma_f32_16x16x32_bf16 v[4:7], v[208:211], a[88:91], v[4:7]
    v_mfma_f32_16x16x32_bf16 v[8:11], v[208:211], a[92:95], v[8:11]
    s_waitcnt vmcnt(7) lgkmcnt(0)
    s_barrier
    v_mfma_f32_16x16x32_bf16 v[12:15], v[212:215], a[84:87], v[12:15]
    ds_read_b64_tr_b16 v[192:193], v224 offset:0
    ds_read_b64_tr_b16 v[194:195], v224 offset:1024
    s_add_u32 s69, s53, 6
    s_and_b32 s69, s69, 7
    s_add_u32 m0, s61, 90112
    s_lshl_b32 s68, s69, 7
    s_add_u32 s68, s68, s55
    buffer_load_dwordx4 v96, s[8:11], s68 offen offset:0 lds
    v_mfma_f32_16x16x32_bf16 v[16:19], v[212:215], a[88:91], v[16:19]
    ds_read_b128 a[144:147], v100 offset:0
    ds_read_b128 a[148:151], v100 offset:2048
    v_mfma_f32_16x16x32_bf16 v[20:23], v[212:215], a[92:95], v[20:23]
    ds_read_b128 a[152:155], v100 offset:4096
    ds_read_b64_tr_b16 v[196:197], v225 offset:0
    v_mfma_f32_16x16x32_bf16 v[24:27], v[216:219], a[84:87], v[24:27]
    ds_read_b64_tr_b16 v[198:199], v225 offset:1024
    ds_read_b64_tr_b16 v[200:201], v226 offset:0
    buffer_load_dwordx4 v97, s[8:11], s68 offen offset:1024 lds
    v_mfma_f32_16x16x32_bf16 v[28:31], v[216:219], a[88:91], v[28:31]
    ds_read_b64_tr_b16 v[202:203], v226 offset:1024
    ds_read_b128 a[156:159], v101 offset:0
    v_mfma_f32_16x16x32_bf16 v[32:35], v[216:219], a[92:95], v[32:35]
    ds_read_b128 a[160:163], v101 offset:2048
    ds_read_b128 a[164:167], v101 offset:4096
    v_mfma_f32_16x16x32_bf16 v[36:39], v[220:223], a[84:87], v[36:39]
    ds_read_b64_tr_b16 v[204:205], v227 offset:0
    ds_read_b64_tr_b16 v[206:207], v227 offset:1024
    buffer_load_dwordx4 v98, s[8:11], s68 offen offset:2048 lds
    v_mfma_f32_16x16x32_bf16 v[40:43], v[220:223], a[88:91], v[40:43]
    ds_read_b64_tr_b16 v[208:209], v224 offset:8192
    ds_read_b64_tr_b16 v[210:211], v224 offset:9216
    v_mfma_f32_16x16x32_bf16 v[44:47], v[220:223], a[92:95], v[44:47]
    s_waitcnt lgkmcnt(11)
    v_mfma_f32_16x16x32_bf16 v[0:3], v[192:195], a[144:147], v[0:3]
    s_add_u32 m0, s59, 114688
    s_add_u32 s69, s53, 6
    s_and_b32 s69, s69, 7
    s_lshl_b32 s68, s69, 19
    s_add_u32 s68, s68, s54
    buffer_load_dwordx4 v242, s[20:23], s68 offen offset:0  lds
    v_mfma_f32_16x16x32_bf16 v[4:7], v[192:195], a[148:151], v[4:7]
    ds_read_b64_tr_b16 v[212:213], v225 offset:8192
    ds_read_b64_tr_b16 v[214:215], v225 offset:9216
    v_mfma_f32_16x16x32_bf16 v[8:11], v[192:195], a[152:155], v[8:11]
    s_waitcnt lgkmcnt(11)
    v_mfma_f32_16x16x32_bf16 v[12:15], v[196:199], a[144:147], v[12:15]
    s_add_u32 s68, s68, 31744
    buffer_load_dwordx4 v242, s[20:23], s68 offen offset:1024  lds
    v_mfma_f32_16x16x32_bf16 v[16:19], v[196:199], a[148:151], v[16:19]
    ds_read_b64_tr_b16 v[216:217], v226 offset:8192
    ds_read_b64_tr_b16 v[218:219], v226 offset:9216
    v_mfma_f32_16x16x32_bf16 v[20:23], v[196:199], a[152:155], v[20:23]
    s_waitcnt lgkmcnt(11)
    v_mfma_f32_16x16x32_bf16 v[24:27], v[200:203], a[144:147], v[24:27]
    s_add_u32 s68, s68, 31744
    v_xor_b32 v244, 128, v242
    buffer_load_dwordx4 v244, s[20:23], s68 offen offset:2048  lds
    v_mfma_f32_16x16x32_bf16 v[28:31], v[200:203], a[148:151], v[28:31]
    ds_read_b64_tr_b16 v[220:221], v227 offset:8192
    ds_read_b64_tr_b16 v[222:223], v227 offset:9216
    v_mfma_f32_16x16x32_bf16 v[32:35], v[200:203], a[152:155], v[32:35]
    s_waitcnt lgkmcnt(8)
    v_mfma_f32_16x16x32_bf16 v[36:39], v[204:207], a[144:147], v[36:39]
    v_add_u32 v224, 147456, v245
    s_add_u32 s68, s68, 31744
    buffer_load_dwordx4 v244, s[20:23], s68 offen offset:3072  lds
    v_xor_b32 v225, 32, v224
    v_mfma_f32_16x16x32_bf16 v[40:43], v[204:207], a[148:151], v[40:43]
    v_xor_b32 v226, 64, v224
    v_xor_b32 v227, 96, v224
    v_mfma_f32_16x16x32_bf16 v[44:47], v[204:207], a[152:155], v[44:47]
    s_waitcnt lgkmcnt(6)
    v_mfma_f32_16x16x32_bf16 v[0:3], v[208:211], a[156:159], v[0:3]
    v_mfma_f32_16x16x32_bf16 v[4:7], v[208:211], a[160:163], v[4:7]
    v_mfma_f32_16x16x32_bf16 v[8:11], v[208:211], a[164:167], v[8:11]
    s_waitcnt vmcnt(7) lgkmcnt(0)
    s_barrier
    v_mfma_f32_16x16x32_bf16 v[12:15], v[212:215], a[156:159], v[12:15]
    ds_read_b64_tr_b16 v[192:193], v224 offset:0
    ds_read_b64_tr_b16 v[194:195], v224 offset:1024
    s_add_u32 s69, s53, 7
    s_and_b32 s69, s69, 7
    s_add_u32 m0, s61, 102400
    s_lshl_b32 s68, s69, 7
    s_add_u32 s68, s68, s55
    buffer_load_dwordx4 v96, s[8:11], s68 offen offset:0 lds
    v_mfma_f32_16x16x32_bf16 v[16:19], v[212:215], a[160:163], v[16:19]
    ds_read_b128 a[168:171], v100 offset:12288
    ds_read_b128 a[172:175], v100 offset:14336
    v_mfma_f32_16x16x32_bf16 v[20:23], v[212:215], a[164:167], v[20:23]
    ds_read_b128 a[176:179], v100 offset:16384
    ds_read_b64_tr_b16 v[196:197], v225 offset:0
    v_mfma_f32_16x16x32_bf16 v[24:27], v[216:219], a[156:159], v[24:27]
    ds_read_b64_tr_b16 v[198:199], v225 offset:1024
    ds_read_b64_tr_b16 v[200:201], v226 offset:0
    buffer_load_dwordx4 v97, s[8:11], s68 offen offset:1024 lds
    v_mfma_f32_16x16x32_bf16 v[28:31], v[216:219], a[160:163], v[28:31]
    ds_read_b64_tr_b16 v[202:203], v226 offset:1024
    ds_read_b128 a[180:183], v101 offset:12288
    v_mfma_f32_16x16x32_bf16 v[32:35], v[216:219], a[164:167], v[32:35]
    ds_read_b128 a[184:187], v101 offset:14336
    ds_read_b128 a[188:191], v101 offset:16384
    v_mfma_f32_16x16x32_bf16 v[36:39], v[220:223], a[156:159], v[36:39]
    ds_read_b64_tr_b16 v[204:205], v227 offset:0
    ds_read_b64_tr_b16 v[206:207], v227 offset:1024
    buffer_load_dwordx4 v98, s[8:11], s68 offen offset:2048 lds
    v_mfma_f32_16x16x32_bf16 v[40:43], v[220:223], a[160:163], v[40:43]
    ds_read_b64_tr_b16 v[208:209], v224 offset:8192
    ds_read_b64_tr_b16 v[210:211], v224 offset:9216
    v_mfma_f32_16x16x32_bf16 v[44:47], v[220:223], a[164:167], v[44:47]
    s_waitcnt lgkmcnt(11)
    v_mfma_f32_16x16x32_bf16 v[0:3], v[192:195], a[168:171], v[0:3]
    s_add_u32 m0, s59, 131072
    s_add_u32 s69, s53, 7
    s_and_b32 s69, s69, 7
    s_lshl_b32 s68, s69, 19
    s_add_u32 s68, s68, s54
    buffer_load_dwordx4 v242, s[20:23], s68 offen offset:0  lds
    v_mfma_f32_16x16x32_bf16 v[4:7], v[192:195], a[172:175], v[4:7]
    ds_read_b64_tr_b16 v[212:213], v225 offset:8192
    ds_read_b64_tr_b16 v[214:215], v225 offset:9216
    v_mfma_f32_16x16x32_bf16 v[8:11], v[192:195], a[176:179], v[8:11]
    s_waitcnt lgkmcnt(11)
    v_mfma_f32_16x16x32_bf16 v[12:15], v[196:199], a[168:171], v[12:15]
    s_add_u32 s68, s68, 31744
    buffer_load_dwordx4 v242, s[20:23], s68 offen offset:1024  lds
    v_mfma_f32_16x16x32_bf16 v[16:19], v[196:199], a[172:175], v[16:19]
    ds_read_b64_tr_b16 v[216:217], v226 offset:8192
    ds_read_b64_tr_b16 v[218:219], v226 offset:9216
    v_mfma_f32_16x16x32_bf16 v[20:23], v[196:199], a[176:179], v[20:23]
    s_waitcnt lgkmcnt(11)
    v_mfma_f32_16x16x32_bf16 v[24:27], v[200:203], a[168:171], v[24:27]
    s_add_u32 s68, s68, 31744
    v_xor_b32 v244, 128, v242
    buffer_load_dwordx4 v244, s[20:23], s68 offen offset:2048  lds
    v_mfma_f32_16x16x32_bf16 v[28:31], v[200:203], a[172:175], v[28:31]
    ds_read_b64_tr_b16 v[220:221], v227 offset:8192
    ds_read_b64_tr_b16 v[222:223], v227 offset:9216
    v_mfma_f32_16x16x32_bf16 v[32:35], v[200:203], a[176:179], v[32:35]
    s_waitcnt lgkmcnt(8)
    v_mfma_f32_16x16x32_bf16 v[36:39], v[204:207], a[168:171], v[36:39]
    v_add_u32 v224, 114688, v245
    s_add_u32 s68, s68, 31744
    buffer_load_dwordx4 v244, s[20:23], s68 offen offset:3072  lds
    v_xor_b32 v225, 32, v224
    v_mfma_f32_16x16x32_bf16 v[40:43], v[204:207], a[172:175], v[40:43]
    v_xor_b32 v226, 64, v224
    v_xor_b32 v227, 96, v224
    v_mfma_f32_16x16x32_bf16 v[44:47], v[204:207], a[176:179], v[44:47]
    s_waitcnt lgkmcnt(6)
    v_mfma_f32_16x16x32_bf16 v[0:3], v[208:211], a[180:183], v[0:3]
    v_mfma_f32_16x16x32_bf16 v[4:7], v[208:211], a[184:187], v[4:7]
    v_mfma_f32_16x16x32_bf16 v[8:11], v[208:211], a[188:191], v[8:11]
    s_waitcnt vmcnt(7) lgkmcnt(0)
    s_barrier
    v_mfma_f32_16x16x32_bf16 v[12:15], v[212:215], a[180:183], v[12:15]
    ds_read_b64_tr_b16 v[192:193], v224 offset:0
    ds_read_b64_tr_b16 v[194:195], v224 offset:1024
    s_add_u32 m0, s59, 0
    s_add_u32 s68, s46, 0
    buffer_load_dwordx4 v240, s[12:15], s68 offen offset:0 nt lds
    v_mfma_f32_16x16x32_bf16 v[16:19], v[212:215], a[184:187], v[16:19]
    ds_read_b128 a[192:195], v100 offset:24576
    ds_read_b128 a[196:199], v100 offset:26624
    v_mfma_f32_16x16x32_bf16 v[20:23], v[212:215], a[188:191], v[20:23]
    ds_read_b128 a[200:203], v100 offset:28672
    ds_read_b64_tr_b16 v[196:197], v225 offset:0
    v_mfma_f32_16x16x32_bf16 v[24:27], v[216:219], a[180:183], v[24:27]
    ds_read_b64_tr_b16 v[198:199], v225 offset:1024
    ds_read_b64_tr_b16 v[200:201], v226 offset:0
    v_mfma_f32_16x16x32_bf16 v[28:31], v[216:219], a[184:187], v[28:31]
    ds_read_b64_tr_b16 v[202:203], v226 offset:1024
    ds_read_b128 a[204:207], v101 offset:24576
    s_add_u32 s68, s68, 3072
    v_xor_b32 v244, 64, v240
    buffer_load_dwordx4 v244, s[12:15], s68 offen offset:1024 nt lds
    v_mfma_f32_16x16x32_bf16 v[32:35], v[216:219], a[188:191], v[32:35]
    ds_read_b128 a[208:211], v101 offset:26624
    ds_read_b128 a[212:215], v101 offset:28672
    v_mfma_f32_16x16x32_bf16 v[36:39], v[220:223], a[180:183], v[36:39]
    ds_read_b64_tr_b16 v[204:205], v227 offset:0
    ds_read_b64_tr_b16 v[206:207], v227 offset:1024
    v_mfma_f32_16x16x32_bf16 v[40:43], v[220:223], a[184:187], v[40:43]
    ds_read_b64_tr_b16 v[208:209], v224 offset:8192
    ds_read_b64_tr_b16 v[210:211], v224 offset:9216
    v_mfma_f32_16x16x32_bf16 v[44:47], v[220:223], a[188:191], v[44:47]
    s_add_u32 s68, s68, 3072
    v_xor_b32 v244, 128, v240
    buffer_load_dwordx4 v244, s[12:15], s68 offen offset:2048 nt lds
    s_waitcnt lgkmcnt(11)
    v_mfma_f32_16x16x32_bf16 v[0:3], v[192:195], a[192:195], v[0:3]
    v_mfma_f32_16x16x32_bf16 v[4:7], v[192:195], a[196:199], v[4:7]
    ds_read_b64_tr_b16 v[212:213], v225 offset:8192
    ds_read_b64_tr_b16 v[214:215], v225 offset:9216
    v_mfma_f32_16x16x32_bf16 v[8:11], v[192:195], a[200:203], v[8:11]
    s_waitcnt lgkmcnt(11)
    v_mfma_f32_16x16x32_bf16 v[12:15], v[196:199], a[192:195], v[12:15]
    s_add_u32 s68, s68, 3072
    v_xor_b32 v244, 192, v240
    buffer_load_dwordx4 v244, s[12:15], s68 offen offset:3072 nt lds
    v_mfma_f32_16x16x32_bf16 v[16:19], v[196:199], a[196:199], v[16:19]
    ds_read_b64_tr_b16 v[216:217], v226 offset:8192
    ds_read_b64_tr_b16 v[218:219], v226 offset:9216
    v_mfma_f32_16x16x32_bf16 v[20:23], v[196:199], a[200:203], v[20:23]
    s_waitcnt lgkmcnt(11)
    v_mfma_f32_16x16x32_bf16 v[24:27], v[200:203], a[192:195], v[24:27]
    v_mfma_f32_16x16x32_bf16 v[28:31], v[200:203], a[196:199], v[28:31]
    ds_read_b64_tr_b16 v[220:221], v227 offset:8192
    ds_read_b64_tr_b16 v[222:223], v227 offset:9216
    s_add_u32 m0, s59, 16384
    s_add_u32 s68, s46, 16384
    buffer_load_dwordx4 v240, s[12:15], s68 offen offset:0 nt lds
    v_mfma_f32_16x16x32_bf16 v[32:35], v[200:203], a[200:203], v[32:35]
    s_waitcnt lgkmcnt(8)
    v_mfma_f32_16x16x32_bf16 v[36:39], v[204:207], a[192:195], v[36:39]
    v_add_u32 v224, 131072, v245
    v_xor_b32 v225, 32, v224
    v_mfma_f32_16x16x32_bf16 v[40:43], v[204:207], a[196:199], v[40:43]
    v_xor_b32 v226, 64, v224
    v_xor_b32 v227, 96, v224
    s_add_u32 s68, s68, 3072
    v_xor_b32 v244, 64, v240
    buffer_load_dwordx4 v244, s[12:15], s68 offen offset:1024 nt lds
    v_mfma_f32_16x16x32_bf16 v[44:47], v[204:207], a[200:203], v[44:47]
    s_waitcnt lgkmcnt(6)
    v_mfma_f32_16x16x32_bf16 v[0:3], v[208:211], a[204:207], v[0:3]
    v_mfma_f32_16x16x32_bf16 v[4:7], v[208:211], a[208:211], v[4:7]
    v_mfma_f32_16x16x32_bf16 v[8:11], v[208:211], a[212:215], v[8:11]
    s_add_u32 s68, s68, 3072
    v_xor_b32 v244, 128, v240
    buffer_load_dwordx4 v244, s[12:15], s68 offen offset:2048 nt lds
    s_waitcnt vmcnt(7) lgkmcnt(0)
    s_barrier
    v_mfma_f32_16x16x32_bf16 v[12:15], v[212:215], a[204:207], v[12:15]
    ds_read_b64_tr_b16 v[192:193], v224 offset:0
    ds_read_b64_tr_b16 v[194:195], v224 offset:1024
    s_add_u32 s68, s68, 3072
    v_xor_b32 v244, 192, v240
    buffer_load_dwordx4 v244, s[12:15], s68 offen offset:3072 nt lds
    v_mfma_f32_16x16x32_bf16 v[16:19], v[212:215], a[208:211], v[16:19]
    ds_read_b128 a[216:219], v100 offset:36864
    ds_read_b128 a[220:223], v100 offset:38912
    v_mfma_f32_16x16x32_bf16 v[20:23], v[212:215], a[212:215], v[20:23]
    ds_read_b128 a[224:227], v100 offset:40960
    ds_read_b64_tr_b16 v[196:197], v225 offset:0
    v_mfma_f32_16x16x32_bf16 v[24:27], v[216:219], a[204:207], v[24:27]
    ds_read_b64_tr_b16 v[198:199], v225 offset:1024
    ds_read_b64_tr_b16 v[200:201], v226 offset:0
    v_mfma_f32_16x16x32_bf16 v[28:31], v[216:219], a[208:211], v[28:31]
    ds_read_b64_tr_b16 v[202:203], v226 offset:1024
    ds_read_b128 a[228:231], v101 offset:36864
    s_add_u32 m0, s59, 32768
    s_add_u32 s68, s46, 32768
    buffer_load_dwordx4 v240, s[12:15], s68 offen offset:0 nt lds
    v_mfma_f32_16x16x32_bf16 v[32:35], v[216:219], a[212:215], v[32:35]
    ds_read_b128 a[232:235], v101 offset:38912
    ds_read_b128 a[236:239], v101 offset:40960
    v_mfma_f32_16x16x32_bf16 v[36:39], v[220:223], a[204:207], v[36:39]
    ds_read_b64_tr_b16 v[204:205], v227 offset:0
    ds_read_b64_tr_b16 v[206:207], v227 offset:1024
    v_mfma_f32_16x16x32_bf16 v[40:43], v[220:223], a[208:211], v[40:43]
    ds_read_b64_tr_b16 v[208:209], v224 offset:8192
    ds_read_b64_tr_b16 v[210:211], v224 offset:9216
    v_mfma_f32_16x16x32_bf16 v[44:47], v[220:223], a[212:215], v[44:47]
    s_add_u32 s68, s68, 3072
    v_xor_b32 v244, 64, v240
    buffer_load_dwordx4 v244, s[12:15], s68 offen offset:1024 nt lds
    s_waitcnt lgkmcnt(11)
    v_mfma_f32_16x16x32_bf16 v[0:3], v[192:195], a[216:219], v[0:3]
    v_mfma_f32_16x16x32_bf16 v[4:7], v[192:195], a[220:223], v[4:7]
    ds_read_b64_tr_b16 v[212:213], v225 offset:8192
    ds_read_b64_tr_b16 v[214:215], v225 offset:9216
    v_mfma_f32_16x16x32_bf16 v[8:11], v[192:195], a[224:227], v[8:11]
    s_waitcnt lgkmcnt(11)
    v_mfma_f32_16x16x32_bf16 v[12:15], v[196:199], a[216:219], v[12:15]
    s_add_u32 s68, s68, 3072
    v_xor_b32 v244, 128, v240
    buffer_load_dwordx4 v244, s[12:15], s68 offen offset:2048 nt lds
    v_mfma_f32_16x16x32_bf16 v[16:19], v[196:199], a[220:223], v[16:19]
    ds_read_b64_tr_b16 v[216:217], v226 offset:8192
    ds_read_b64_tr_b16 v[218:219], v226 offset:9216
    v_mfma_f32_16x16x32_bf16 v[20:23], v[196:199], a[224:227], v[20:23]
    s_waitcnt lgkmcnt(11)
    v_mfma_f32_16x16x32_bf16 v[24:27], v[200:203], a[216:219], v[24:27]
    v_mfma_f32_16x16x32_bf16 v[28:31], v[200:203], a[220:223], v[28:31]
    ds_read_b64_tr_b16 v[220:221], v227 offset:8192
    ds_read_b64_tr_b16 v[222:223], v227 offset:9216
    s_add_u32 s68, s68, 3072
    v_xor_b32 v244, 192, v240
    buffer_load_dwordx4 v244, s[12:15], s68 offen offset:3072 nt lds
    v_mfma_f32_16x16x32_bf16 v[32:35], v[200:203], a[224:227], v[32:35]
    s_waitcnt lgkmcnt(8)
    v_mfma_f32_16x16x32_bf16 v[36:39], v[204:207], a[216:219], v[36:39]
    v_mfma_f32_16x16x32_bf16 v[40:43], v[204:207], a[220:223], v[40:43]
    v_mfma_f32_16x16x32_bf16 v[44:47], v[204:207], a[224:227], v[44:47]
    s_waitcnt lgkmcnt(6)
    v_mfma_f32_16x16x32_bf16 v[0:3], v[208:211], a[228:231], v[0:3]
    v_mfma_f32_16x16x32_bf16 v[4:7], v[208:211], a[232:235], v[4:7]
    v_mfma_f32_16x16x32_bf16 v[8:11], v[208:211], a[236:239], v[8:11]
    s_waitcnt lgkmcnt(4)
    v_mfma_f32_16x16x32_bf16 v[12:15], v[212:215], a[228:231], v[12:15]
    v_mfma_f32_16x16x32_bf16 v[16:19], v[212:215], a[232:235], v[16:19]
    v_mfma_f32_16x16x32_bf16 v[20:23], v[212:215], a[236:239], v[20:23]
    s_waitcnt lgkmcnt(2)
    v_mfma_f32_16x16x32_bf16 v[24:27], v[216:219], a[228:231], v[24:27]
    v_mfma_f32_16x16x32_bf16 v[28:31], v[216:219], a[232:235], v[28:31]
    v_mfma_f32_16x16x32_bf16 v[32:35], v[216:219], a[236:239], v[32:35]
    s_waitcnt lgkmcnt(0)
    v_mfma_f32_16x16x32_bf16 v[36:39], v[220:223], a[228:231], v[36:39]
    v_mfma_f32_16x16x32_bf16 v[40:43], v[220:223], a[232:235], v[40:43]
    v_mfma_f32_16x16x32_bf16 v[44:47], v[220:223], a[236:239], v[44:47]
    v_lshrrev_b32 v228, 8, v248
    v_bfe_u32 v229, v248, 4, 4
    v_lshrrev_b32 v230, 1, v228
    v_xor_b32 v230, v230, v229
    v_lshlrev_b32 v230, 4, v230
    v_lshl_add_u32 v230, v229, 8, v230
    v_and_b32 v231, 1, v228
    v_lshl_add_u32 v230, v231, 3, v230
    s_mul_i32 s48, s41, 12288
    s_add_u32 s48, s48, 114688
    s_lshl_b32 s49, s42, 7
    v_xor_b32 v192, s49, v230
    v_add_u32 v192, s48, v192
    v_xor_b32 v193, 32, v192
    v_xor_b32 v194, 64, v192
    v_xor_b32 v195, 96, v192
    v_xor_b32 v230, v228, v229
    v_lshlrev_b32 v230, 4, v230
    v_lshl_add_u32 v230, v229, 8, v230
    v_add_u32 v196, s48, v230
    v_xor_b32 v197, 64, v196
    v_xor_b32 v198, 128, v196
    v_xor_b32 v199, 192, v196
    v_cvt_pk_bf16_f32 v200, v0, v1
    v_cvt_pk_bf16_f32 v201, v2, v3
    v_cvt_pk_bf16_f32 v202, v4, v5
    v_cvt_pk_bf16_f32 v203, v6, v7
    v_cvt_pk_bf16_f32 v204, v8, v9
    v_cvt_pk_bf16_f32 v205, v10, v11
    v_cvt_pk_bf16_f32 v206, v12, v13
    v_cvt_pk_bf16_f32 v207, v14, v15
    v_cvt_pk_bf16_f32 v208, v16, v17
    v_cvt_pk_bf16_f32 v209, v18, v19
    v_cvt_pk_bf16_f32 v210, v20, v21
    v_cvt_pk_bf16_f32 v211, v22, v23
    v_cvt_pk_bf16_f32 v212, v24, v25
    v_cvt_pk_bf16_f32 v213, v26, v27
    v_cvt_pk_bf16_f32 v214, v28, v29
    v_cvt_pk_bf16_f32 v215, v30, v31
    v_cvt_pk_bf16_f32 v216, v32, v33
    v_cvt_pk_bf16_f32 v217, v34, v35
    v_cvt_pk_bf16_f32 v218, v36, v37
    v_cvt_pk_bf16_f32 v219, v38, v39
    v_cvt_pk_bf16_f32 v220, v40, v41
    v_cvt_pk_bf16_f32 v221, v42, v43
    v_cvt_pk_bf16_f32 v222, v44, v45
    v_cvt_pk_bf16_f32 v223, v46, v47
    s_barrier
    ds_write_b64 v192, v[200:201] offset:0
    ds_write_b64 v192, v[202:203] offset:4096
    ds_write_b64 v192, v[204:205] offset:8192
    ds_write_b64 v193, v[206:207] offset:0
    ds_write_b64 v193, v[208:209] offset:4096
    ds_write_b64 v193, v[210:211] offset:8192
    ds_write_b64 v194, v[212:213] offset:0
    ds_write_b64 v194, v[214:215] offset:4096
    ds_write_b64 v194, v[216:217] offset:8192
    ds_write_b64 v195, v[218:219] offset:0
    ds_write_b64 v195, v[220:221] offset:4096
    ds_write_b64 v195, v[222:223] offset:8192
    s_waitcnt lgkmcnt(0)
    s_barrier
    ds_read_b128 a[96:99], v196 offset:0
    ds_read_b128 a[100:103], v197 offset:0
    ds_read_b128 a[104:107], v198 offset:0
    ds_read_b128 a[108:111], v199 offset:0
    ds_read_b128 a[112:115], v196 offset:4096
    ds_read_b128 a[116:119], v197 offset:4096
    ds_read_b128 a[120:123], v198 offset:4096
    ds_read_b128 a[124:127], v199 offset:4096
    ds_read_b128 a[128:131], v196 offset:8192
    ds_read_b128 a[132:135], v197 offset:8192
    ds_read_b128 a[136:139], v198 offset:8192
    ds_read_b128 a[140:143], v199 offset:8192
    v_add_u32 v224, 0, v246
    s_add_u32 m0, s59, 49152
    s_add_u32 s68, s46, 49152
    buffer_load_dwordx4 v240, s[12:15], s68 offen offset:0 nt lds
    v_xor_b32 v225, 64, v224
    v_xor_b32 v226, 128, v224
    v_xor_b32 v227, 192, v224
    s_waitcnt vmcnt(9) lgkmcnt(0)
    s_barrier
    ds_read_b128 v[192:195], v224 offset:0
    ds_read_b128 v[196:199], v225 offset:0
    ds_read_b128 v[200:203], v226 offset:0
    ds_read_b128 v[204:207], v227 offset:0
    ds_read_b128 v[208:211], v224 offset:4096
    s_waitcnt lgkmcnt(4)
    v_mfma_f32_16x16x32_bf16 v[0:3], v[192:195], a[96:99], 0
    s_add_u32 s68, s68, 3072
    v_xor_b32 v244, 64, v240
    buffer_load_dwordx4 v244, s[12:15], s68 offen offset:1024 nt lds
    v_mfma_f32_16x16x32_bf16 v[8:11], v[192:195], a[112:115], 0
    ds_read_b128 v[212:215], v225 offset:4096
    v_mfma_f32_16x16x32_bf16 v[16:19], v[192:195], a[128:131], 0
    s_waitcnt lgkmcnt(4)
    v_mfma_f32_16x16x32_bf16 v[0:3], v[196:199], a[100:103], v[0:3]
    v_mfma_f32_16x16x32_bf16 v[8:11], v[196:199], a[116:119], v[8:11]
    ds_read_b128 v[216:219], v226 offset:4096
    s_add_u32 s68, s68, 3072
    v_xor_b32 v244, 128, v240
    buffer_load_dwordx4 v244, s[12:15], s68 offen offset:2048 nt lds
    v_mfma_f32_16x16x32_bf16 v[16:19], v[196:199], a[132:135], v[16:19]
    s_waitcnt lgkmcnt(4)
    v_mfma_f32_16x16x32_bf16 v[0:3], v[200:203], a[104:107], v[0:3]
    v_mfma_f32_16x16x32_bf16 v[8:11], v[200:203], a[120:123], v[8:11]
    ds_read_b128 v[220:223], v227 offset:4096
    v_mfma_f32_16x16x32_bf16 v[16:19], v[200:203], a[136:139], v[16:19]
    s_add_u32 s68, s68, 3072
    v_xor_b32 v244, 192, v240
    buffer_load_dwordx4 v244, s[12:15], s68 offen offset:3072 nt lds
    s_waitcnt lgkmcnt(4)
    v_mfma_f32_16x16x32_bf16 v[0:3], v[204:207], a[108:111], v[0:3]
    v_add_u32 v224, 16384, v246
    v_xor_b32 v225, 64, v224
    v_mfma_f32_16x16x32_bf16 v[8:11], v[204:207], a[124:127], v[8:11]
    v_xor_b32 v226, 128, v224
    v_xor_b32 v227, 192, v224
    v_mfma_f32_16x16x32_bf16 v[16:19], v[204:207], a[140:143], v[16:19]
    s_add_u32 m0, s59, 65536
    s_add_u32 s68, s46, 65536
    buffer_load_dwordx4 v240, s[12:15], s68 offen offset:0 nt lds
    s_waitcnt lgkmcnt(3)
    v_mfma_f32_16x16x32_bf16 v[4:7], v[208:211], a[96:99], 0
    v_mfma_f32_16x16x32_bf16 v[12:15], v[208:211], a[112:115], 0
    v_mfma_f32_16x16x32_bf16 v[20:23], v[208:211], a[128:131], 0
    s_waitcnt vmcnt(9) lgkmcnt(0)
    s_barrier
    v_mfma_f32_16x16x32_bf16 v[4:7], v[212:215], a[100:103], v[4:7]
    ds_read_b128 v[192:195], v224 offset:0
    ds_read_b128 v[196:199], v225 offset:0
    s_add_u32 s68, s68, 3072
    v_xor_b32 v244, 64, v240
    buffer_load_dwordx4 v244, s[12:15], s68 offen offset:1024 nt lds
    v_mfma_f32_16x16x32_bf16 v[12:15], v[212:215], a[116:119], v[12:15]
    ds_read_b128 v[200:203], v226 offset:0
    ds_read_b128 v[204:207], v227 offset:0
    v_mfma_f32_16x16x32_bf16 v[20:23], v[212:215], a[132:135], v[20:23]
    ds_read_b128 v[208:211], v224 offset:4096
    v_mfma_f32_16x16x32_bf16 v[4:7], v[216:219], a[104:107], v[4:7]
    v_mfma_f32_16x16x32_bf16 v[12:15], v[216:219], a[120:123], v[12:15]
    s_add_u32 s68, s68, 3072
    v_xor_b32 v244, 128, v240
    buffer_load_dwordx4 v244, s[12:15], s68 offen offset:2048 nt lds
    v_mfma_f32_16x16x32_bf16 v[20:23], v[216:219], a[136:139], v[20:23]
    v_mfma_f32_16x16x32_bf16 v[4:7], v[220:223], a[108:111], v[4:7]
    v_mfma_f32_16x16x32_bf16 v[12:15], v[220:223], a[124:127], v[12:15]
    v_mfma_f32_16x16x32_bf16 v[20:23], v[220:223], a[140:143], v[20:23]
    s_add_u32 s68, s68, 3072
    v_xor_b32 v244, 192, v240
    buffer_load_dwordx4 v244, s[12:15], s68 offen offset:3072 nt lds
    s_waitcnt lgkmcnt(4)
    v_mfma_f32_16x16x32_bf16 v[24:27], v[192:195], a[96:99], 0
    v_max_f32 v232, v0, v1
    v_max_f32 v233, v8, v9
    v_mfma_f32_16x16x32_bf16 v[32:35], v[192:195], a[112:115], 0
    ds_read_b128 v[212:215], v225 offset:4096
    v_max_f32 v234, v16, v17
    v_mfma_f32_16x16x32_bf16 v[40:43], v[192:195], a[128:131], 0
    v_max3_f32 v232, v232, v2, v3
    v_max3_f32 v233, v233, v10, v11
    s_waitcnt lgkmcnt(4)
    v_mfma_f32_16x16x32_bf16 v[24:27], v[196:199], a[100:103], v[24:27]
    v_max3_f32 v234, v234, v18, v19
    v_max3_f32 v232, v232, v4, v5
    v_mfma_f32_16x16x32_bf16 v[32:35], v[196:199], a[116:119], v[32:35]
    ds_read_b128 v[216:219], v226 offset:4096
    v_max3_f32 v233, v233, v12, v13
    v_mfma_f32_16x16x32_bf16 v[40:43], v[196:199], a[132:135], v[40:43]
    v_max3_f32 v234, v234, v20, v21
    v_max3_f32 v232, v232, v6, v7
    s_waitcnt lgkmcnt(4)
    v_mfma_f32_16x16x32_bf16 v[24:27], v[200:203], a[104:107], v[24:27]
    v_max3_f32 v233, v233, v14, v15
    v_max3_f32 v234, v234, v22, v23
    v_mfma_f32_16x16x32_bf16 v[32:35], v[200:203], a[120:123], v[32:35]
    ds_read_b128 v[220:223], v227 offset:4096
    v_mfma_f32_16x16x32_bf16 v[40:43], v[200:203], a[136:139], v[40:43]
    s_waitcnt lgkmcnt(4)
    v_mfma_f32_16x16x32_bf16 v[24:27], v[204:207], a[108:111], v[24:27]
    v_add_u32 v224, 32768, v246
    v_xor_b32 v225, 64, v224
    v_mfma_f32_16x16x32_bf16 v[32:35], v[204:207], a[124:127], v[32:35]
    v_xor_b32 v226, 128, v224
    v_xor_b32 v227, 192, v224
    v_mfma_f32_16x16x32_bf16 v[40:43], v[204:207], a[140:143], v[40:43]
    s_waitcnt lgkmcnt(3)
    v_mfma_f32_16x16x32_bf16 v[28:31], v[208:211], a[96:99], 0
    v_mfma_f32_16x16x32_bf16 v[36:39], v[208:211], a[112:115], 0
    v_mfma_f32_16x16x32_bf16 v[44:47], v[208:211], a[128:131], 0
    s_waitcnt vmcnt(8) lgkmcnt(0)
    s_barrier
    v_mfma_f32_16x16x32_bf16 v[28:31], v[212:215], a[100:103], v[28:31]
    ds_read_b128 v[192:195], v224 offset:0
    ds_read_b128 v[196:199], v225 offset:0
    s_add_u32 m0, s59, 81920
    s_add_u32 s68, s46, 81920
    buffer_load_dwordx4 v240, s[12:15], s68 offen offset:0 nt lds
    v_mfma_f32_16x16x32_bf16 v[36:39], v[212:215], a[116:119], v[36:39]
    ds_read_b128 v[200:203], v226 offset:0
    ds_read_b128 v[204:207], v227 offset:0
    v_mfma_f32_16x16x32_bf16 v[44:47], v[212:215], a[132:135], v[44:47]
    ds_read_b128 v[208:211], v224 offset:4096
    v_mfma_f32_16x16x32_bf16 v[28:31], v[216:219], a[104:107], v[28:31]
    v_mfma_f32_16x16x32_bf16 v[36:39], v[216:219], a[120:123], v[36:39]
    s_add_u32 s68, s68, 3072
    v_xor_b32 v244, 64, v240
    buffer_load_dwordx4 v244, s[12:15], s68 offen offset:1024 nt lds
    v_mfma_f32_16x16x32_bf16 v[44:47], v[216:219], a[136:139], v[44:47]
    v_mfma_f32_16x16x32_bf16 v[28:31], v[220:223], a[108:111], v[28:31]
    v_mfma_f32_16x16x32_bf16 v[36:39], v[220:223], a[124:127], v[36:39]
    v_mfma_f32_16x16x32_bf16 v[44:47], v[220:223], a[140:143], v[44:47]
    s_add_u32 s68, s68, 3072
    v_xor_b32 v244, 128, v240
    buffer_load_dwordx4 v244, s[12:15], s68 offen offset:2048 nt lds
    s_waitcnt lgkmcnt(4)
    v_mfma_f32_16x16x32_bf16 v[48:51], v[192:195], a[96:99], 0
    v_max3_f32 v232, v232, v24, v25
    v_max3_f32 v233, v233, v32, v33
    v_mfma_f32_16x16x32_bf16 v[56:59], v[192:195], a[112:115], 0
    ds_read_b128 v[212:215], v225 offset:4096
    v_max3_f32 v234, v234, v40, v41
    v_mfma_f32_16x16x32_bf16 v[64:67], v[192:195], a[128:131], 0
    v_max3_f32 v232, v232, v26, v27
    s_add_u32 s68, s68, 3072
    v_xor_b32 v244, 192, v240
    buffer_load_dwordx4 v244, s[12:15], s68 offen offset:3072 nt lds
    v_max3_f32 v233, v233, v34, v35
    s_waitcnt lgkmcnt(4)
    v_mfma_f32_16x16x32_bf16 v[48:51], v[196:199], a[100:103], v[48:51]
    v_max3_f32 v234, v234, v42, v43
    v_max3_f32 v232, v232, v28, v29
    v_mfma_f32_16x16x32_bf16 v[56:59], v[196:199], a[116:119], v[56:59]
    ds_read_b128 v[216:219], v226 offset:4096
    v_max3_f32 v233, v233, v36, v37
    v_mfma_f32_16x16x32_bf16 v[64:67], v[196:199], a[132:135], v[64:67]
    v_max3_f32 v234, v234, v44, v45
    v_max3_f32 v232, v232, v30, v31
    s_waitcnt lgkmcnt(4)
    v_mfma_f32_16x16x32_bf16 v[48:51], v[200:203], a[104:107], v[48:51]
    v_max3_f32 v233, v233, v38, v39
    v_max3_f32 v234, v234, v46, v47
    v_mfma_f32_16x16x32_bf16 v[56:59], v[200:203], a[120:123], v[56:59]
    ds_read_b128 v[220:223], v227 offset:4096
    v_mfma_f32_16x16x32_bf16 v[64:67], v[200:203], a[136:139], v[64:67]
    s_waitcnt lgkmcnt(4)
    v_mfma_f32_16x16x32_bf16 v[48:51], v[204:207], a[108:111], v[48:51]
    v_add_u32 v224, 49152, v246
    v_xor_b32 v225, 64, v224
    v_mfma_f32_16x16x32_bf16 v[56:59], v[204:207], a[124:127], v[56:59]
    v_xor_b32 v226, 128, v224
    v_xor_b32 v227, 192, v224
    v_mfma_f32_16x16x32_bf16 v[64:67], v[204:207], a[140:143], v[64:67]
    s_waitcnt lgkmcnt(3)
    v_mfma_f32_16x16x32_bf16 v[52:55], v[208:211], a[96:99], 0
    v_mfma_f32_16x16x32_bf16 v[60:63], v[208:211], a[112:115], 0
    v_mfma_f32_16x16x32_bf16 v[68:71], v[208:211], a[128:131], 0
    s_waitcnt vmcnt(8) lgkmcnt(0)
    s_barrier
    v_mfma_f32_16x16x32_bf16 v[52:55], v[212:215], a[100:103], v[52:55]
    ds_read_b128 v[192:195], v224 offset:0
    ds_read_b128 v[196:199], v225 offset:0
    s_add_u32 m0, s59, 98304
    s_add_u32 s68, s46, 98304
    buffer_load_dwordx4 v240, s[12:15], s68 offen offset:0 nt lds
    v_mfma_f32_16x16x32_bf16 v[60:63], v[212:215], a[116:119], v[60:63]
    ds_read_b128 v[200:203], v226 offset:0
    ds_read_b128 v[204:207], v227 offset:0
    v_mfma_f32_16x16x32_bf16 v[68:71], v[212:215], a[132:135], v[68:71]
    ds_read_b128 v[208:211], v224 offset:4096
    v_mfma_f32_16x16x32_bf16 v[52:55], v[216:219], a[104:107], v[52:55]
    v_mfma_f32_16x16x32_bf16 v[60:63], v[216:219], a[120:123], v[60:63]
    s_add_u32 s68, s68, 3072
    v_xor_b32 v244, 64, v240
    buffer_load_dwordx4 v244, s[12:15], s68 offen offset:1024 nt lds
    v_mfma_f32_16x16x32_bf16 v[68:71], v[216:219], a[136:139], v[68:71]
    v_mfma_f32_16x16x32_bf16 v[52:55], v[220:223], a[108:111], v[52:55]
    v_mfma_f32_16x16x32_bf16 v[60:63], v[220:223], a[124:127], v[60:63]
    v_mfma_f32_16x16x32_bf16 v[68:71], v[220:223], a[140:143], v[68:71]
    s_add_u32 s68, s68, 3072
    v_xor_b32 v244, 128, v240
    buffer_load_dwordx4 v244, s[12:15], s68 offen offset:2048 nt lds
    s_waitcnt lgkmcnt(4)
    v_mfma_f32_16x16x32_bf16 v[72:75], v[192:195], a[96:99], 0
    v_max3_f32 v232, v232, v48, v49
    v_max3_f32 v233, v233, v56, v57
    v_mfma_f32_16x16x32_bf16 v[80:83], v[192:195], a[112:115], 0
    ds_read_b128 v[212:215], v225 offset:4096
    v_max3_f32 v234, v234, v64, v65
    v_mfma_f32_16x16x32_bf16 v[88:91], v[192:195], a[128:131], 0
    v_max3_f32 v232, v232, v50, v51
    s_add_u32 s68, s68, 3072
    v_xor_b32 v244, 192, v240
    buffer_load_dwordx4 v244, s[12:15], s68 offen offset:3072 nt lds
    v_max3_f32 v233, v233, v58, v59
    s_waitcnt lgkmcnt(4)
    v_mfma_f32_16x16x32_bf16 v[72:75], v[196:199], a[100:103], v[72:75]
    v_max3_f32 v234, v234, v66, v67
    v_max3_f32 v232, v232, v52, v53
    v_mfma_f32_16x16x32_bf16 v[80:83], v[196:199], a[116:119], v[80:83]
    ds_read_b128 v[216:219], v226 offset:4096
    v_max3_f32 v233, v233, v60, v61
    v_mfma_f32_16x16x32_bf16 v[88:91], v[196:199], a[132:135], v[88:91]
    v_max3_f32 v234, v234, v68, v69
    v_max3_f32 v232, v232, v54, v55
    s_waitcnt lgkmcnt(4)
    v_mfma_f32_16x16x32_bf16 v[72:75], v[200:203], a[104:107], v[72:75]
    v_max3_f32 v233, v233, v62, v63
    v_max3_f32 v234, v234, v70, v71
    v_mfma_f32_16x16x32_bf16 v[80:83], v[200:203], a[120:123], v[80:83]
    ds_read_b128 v[220:223], v227 offset:4096
    v_mfma_f32_16x16x32_bf16 v[88:91], v[200:203], a[136:139], v[88:91]
    s_waitcnt lgkmcnt(4)
    v_mfma_f32_16x16x32_bf16 v[72:75], v[204:207], a[108:111], v[72:75]
    v_add_u32 v224, 65536, v246
    v_xor_b32 v225, 64, v224
    v_mfma_f32_16x16x32_bf16 v[80:83], v[204:207], a[124:127], v[80:83]
    v_xor_b32 v226, 128, v224
    v_xor_b32 v227, 192, v224
    v_mfma_f32_16x16x32_bf16 v[88:91], v[204:207], a[140:143], v[88:91]
    s_waitcnt lgkmcnt(3)
    v_mfma_f32_16x16x32_bf16 v[76:79], v[208:211], a[96:99], 0
    v_mfma_f32_16x16x32_bf16 v[84:87], v[208:211], a[112:115], 0
    v_mfma_f32_16x16x32_bf16 v[92:95], v[208:211], a[128:131], 0
    s_waitcnt vmcnt(8) lgkmcnt(0)
    s_barrier
    v_mfma_f32_16x16x32_bf16 v[76:79], v[212:215], a[100:103], v[76:79]
    ds_read_b128 v[192:195], v224 offset:0
    ds_read_b128 v[196:199], v225 offset:0
    s_add_u32 m0, s59, 0
    s_add_u32 s68, s46, 114688
    buffer_load_dwordx4 v240, s[12:15], s68 offen offset:0 nt lds
    v_mfma_f32_16x16x32_bf16 v[84:87], v[212:215], a[116:119], v[84:87]
    ds_read_b128 v[200:203], v226 offset:0
    ds_read_b128 v[204:207], v227 offset:0
    v_mfma_f32_16x16x32_bf16 v[92:95], v[212:215], a[132:135], v[92:95]
    ds_read_b128 v[208:211], v224 offset:4096
    v_mfma_f32_16x16x32_bf16 v[76:79], v[216:219], a[104:107], v[76:79]
    v_mfma_f32_16x16x32_bf16 v[84:87], v[216:219], a[120:123], v[84:87]
    s_add_u32 s68, s68, 3072
    v_xor_b32 v244, 64, v240
    buffer_load_dwordx4 v244, s[12:15], s68 offen offset:1024 nt lds
    v_mfma_f32_16x16x32_bf16 v[92:95], v[216:219], a[136:139], v[92:95]
    v_mfma_f32_16x16x32_bf16 v[76:79], v[220:223], a[108:111], v[76:79]
    v_mfma_f32_16x16x32_bf16 v[84:87], v[220:223], a[124:127], v[84:87]
    v_mfma_f32_16x16x32_bf16 v[92:95], v[220:223], a[140:143], v[92:95]
    s_add_u32 s68, s68, 3072
    v_xor_b32 v244, 128, v240
    buffer_load_dwordx4 v244, s[12:15], s68 offen offset:2048 nt lds
    s_waitcnt lgkmcnt(4)
    v_mfma_f32_16x16x32_bf16 v[96:99], v[192:195], a[96:99], 0
    v_max3_f32 v232, v232, v72, v73
    v_max3_f32 v233, v233, v80, v81
    v_mfma_f32_16x16x32_bf16 v[104:107], v[192:195], a[112:115], 0
    ds_read_b128 v[212:215], v225 offset:4096
    v_max3_f32 v234, v234, v88, v89
    v_mfma_f32_16x16x32_bf16 v[112:115], v[192:195], a[128:131], 0
    v_max3_f32 v232, v232, v74, v75
    s_add_u32 s68, s68, 3072
    v_xor_b32 v244, 192, v240
    buffer_load_dwordx4 v244, s[12:15], s68 offen offset:3072 nt lds
    v_max3_f32 v233, v233, v82, v83
    s_waitcnt lgkmcnt(4)
    v_mfma_f32_16x16x32_bf16 v[96:99], v[196:199], a[100:103], v[96:99]
    v_max3_f32 v234, v234, v90, v91
    v_max3_f32 v232, v232, v76, v77
    v_mfma_f32_16x16x32_bf16 v[104:107], v[196:199], a[116:119], v[104:107]
    ds_read_b128 v[216:219], v226 offset:4096
    v_max3_f32 v233, v233, v84, v85
    v_mfma_f32_16x16x32_bf16 v[112:115], v[196:199], a[132:135], v[112:115]
    v_max3_f32 v234, v234, v92, v93
    v_max3_f32 v232, v232, v78, v79
    s_waitcnt lgkmcnt(4)
    v_mfma_f32_16x16x32_bf16 v[96:99], v[200:203], a[104:107], v[96:99]
    v_max3_f32 v233, v233, v86, v87
    v_max3_f32 v234, v234, v94, v95
    v_mfma_f32_16x16x32_bf16 v[104:107], v[200:203], a[120:123], v[104:107]
    ds_read_b128 v[220:223], v227 offset:4096
    v_mfma_f32_16x16x32_bf16 v[112:115], v[200:203], a[136:139], v[112:115]
    s_waitcnt lgkmcnt(4)
    v_mfma_f32_16x16x32_bf16 v[96:99], v[204:207], a[108:111], v[96:99]
    v_add_u32 v224, 81920, v246
    v_xor_b32 v225, 64, v224
    v_mfma_f32_16x16x32_bf16 v[104:107], v[204:207], a[124:127], v[104:107]
    v_xor_b32 v226, 128, v224
    v_xor_b32 v227, 192, v224
    v_mfma_f32_16x16x32_bf16 v[112:115], v[204:207], a[140:143], v[112:115]
    s_waitcnt lgkmcnt(3)
    v_mfma_f32_16x16x32_bf16 v[100:103], v[208:211], a[96:99], 0
    v_mfma_f32_16x16x32_bf16 v[108:111], v[208:211], a[112:115], 0
    v_mfma_f32_16x16x32_bf16 v[116:119], v[208:211], a[128:131], 0
    s_waitcnt vmcnt(8) lgkmcnt(0)
    s_barrier
    v_mfma_f32_16x16x32_bf16 v[100:103], v[212:215], a[100:103], v[100:103]
    ds_read_b128 v[192:195], v224 offset:0
    ds_read_b128 v[196:199], v225 offset:0
    s_add_u32 m0, s59, 16384
    s_add_u32 s68, s46, 0
    buffer_load_dwordx4 v241, s[16:19], s68 offen offset:0 nt lds
    v_mfma_f32_16x16x32_bf16 v[108:111], v[212:215], a[116:119], v[108:111]
    ds_read_b128 v[200:203], v226 offset:0
    ds_read_b128 v[204:207], v227 offset:0
    v_mfma_f32_16x16x32_bf16 v[116:119], v[212:215], a[132:135], v[116:119]
    ds_read_b128 v[208:211], v224 offset:4096
    v_mfma_f32_16x16x32_bf16 v[100:103], v[216:219], a[104:107], v[100:103]
    v_mfma_f32_16x16x32_bf16 v[108:111], v[216:219], a[120:123], v[108:111]
    s_add_u32 s68, s68, 3072
    v_xor_b32 v244, 128, v241
    buffer_load_dwordx4 v244, s[16:19], s68 offen offset:1024 nt lds
    v_mfma_f32_16x16x32_bf16 v[116:119], v[216:219], a[136:139], v[116:119]
    v_mfma_f32_16x16x32_bf16 v[100:103], v[220:223], a[108:111], v[100:103]
    v_mfma_f32_16x16x32_bf16 v[108:111], v[220:223], a[124:127], v[108:111]
    v_mfma_f32_16x16x32_bf16 v[116:119], v[220:223], a[140:143], v[116:119]
    s_add_u32 s68, s68, 3072
    buffer_load_dwordx4 v241, s[16:19], s68 offen offset:2048 nt lds
    s_waitcnt lgkmcnt(4)
    v_mfma_f32_16x16x32_bf16 v[120:123], v[192:195], a[96:99], 0
    v_max3_f32 v232, v232, v96, v97
    v_max3_f32 v233, v233, v104, v105
    v_mfma_f32_16x16x32_bf16 v[128:131], v[192:195], a[112:115], 0
    ds_read_b128 v[212:215], v225 offset:4096
    v_max3_f32 v234, v234, v112, v113
    v_mfma_f32_16x16x32_bf16 v[136:139], v[192:195], a[128:131], 0
    v_max3_f32 v232, v232, v98, v99
    s_add_u32 s68, s68, 3072
    buffer_load_dwordx4 v244, s[16:19], s68 offen offset:3072 nt lds
    v_max3_f32 v233, v233, v106, v107
    s_waitcnt lgkmcnt(4)
    v_mfma_f32_16x16x32_bf16 v[120:123], v[196:199], a[100:103], v[120:123]
    v_max3_f32 v234, v234, v114, v115
    v_max3_f32 v232, v232, v100, v101
    v_mfma_f32_16x16x32_bf16 v[128:131], v[196:199], a[116:119], v[128:131]
    ds_read_b128 v[216:219], v226 offset:4096
    v_max3_f32 v233, v233, v108, v109
    v_mfma_f32_16x16x32_bf16 v[136:139], v[196:199], a[132:135], v[136:139]
    v_max3_f32 v234, v234, v116, v117
    v_max3_f32 v232, v232, v102, v103
    s_waitcnt lgkmcnt(4)
    v_mfma_f32_16x16x32_bf16 v[120:123], v[200:203], a[104:107], v[120:123]
    v_max3_f32 v233, v233, v110, v111
    v_max3_f32 v234, v234, v118, v119
    v_mfma_f32_16x16x32_bf16 v[128:131], v[200:203], a[120:123], v[128:131]
    ds_read_b128 v[220:223], v227 offset:4096
    v_mfma_f32_16x16x32_bf16 v[136:139], v[200:203], a[136:139], v[136:139]
    s_waitcnt lgkmcnt(4)
    v_mfma_f32_16x16x32_bf16 v[120:123], v[204:207], a[108:111], v[120:123]
    v_add_u32 v224, 98304, v246
    v_xor_b32 v225, 64, v224
    v_mfma_f32_16x16x32_bf16 v[128:131], v[204:207], a[124:127], v[128:131]
    v_xor_b32 v226, 128, v224
    v_xor_b32 v227, 192, v224
    v_mfma_f32_16x16x32_bf16 v[136:139], v[204:207], a[140:143], v[136:139]
    s_waitcnt lgkmcnt(3)
    v_mfma_f32_16x16x32_bf16 v[124:127], v[208:211], a[96:99], 0
    v_mfma_f32_16x16x32_bf16 v[132:135], v[208:211], a[112:115], 0
    v_mfma_f32_16x16x32_bf16 v[140:143], v[208:211], a[128:131], 0
    s_waitcnt vmcnt(8) lgkmcnt(0)
    s_barrier
    v_mfma_f32_16x16x32_bf16 v[124:127], v[212:215], a[100:103], v[124:127]
    ds_read_b128 v[192:195], v224 offset:0
    ds_read_b128 v[196:199], v225 offset:0
    s_add_u32 m0, s59, 32768
    s_add_u32 s68, s46, 16384
    buffer_load_dwordx4 v241, s[16:19], s68 offen offset:0 nt lds
    v_mfma_f32_16x16x32_bf16 v[132:135], v[212:215], a[116:119], v[132:135]
    ds_read_b128 v[200:203], v226 offset:0
    ds_read_b128 v[204:207], v227 offset:0
    v_mfma_f32_16x16x32_bf16 v[140:143], v[212:215], a[132:135], v[140:143]
    ds_read_b128 v[208:211], v224 offset:4096
    v_mfma_f32_16x16x32_bf16 v[124:127], v[216:219], a[104:107], v[124:127]
    v_mfma_f32_16x16x32_bf16 v[132:135], v[216:219], a[120:123], v[132:135]
    s_add_u32 s68, s68, 3072
    v_xor_b32 v244, 128, v241
    buffer_load_dwordx4 v244, s[16:19], s68 offen offset:1024 nt lds
    v_mfma_f32_16x16x32_bf16 v[140:143], v[216:219], a[136:139], v[140:143]
    v_mfma_f32_16x16x32_bf16 v[124:127], v[220:223], a[108:111], v[124:127]
    v_mfma_f32_16x16x32_bf16 v[132:135], v[220:223], a[124:127], v[132:135]
    v_mfma_f32_16x16x32_bf16 v[140:143], v[220:223], a[140:143], v[140:143]
    s_add_u32 s68, s68, 3072
    buffer_load_dwordx4 v241, s[16:19], s68 offen offset:2048 nt lds
    s_waitcnt lgkmcnt(4)
    v_mfma_f32_16x16x32_bf16 v[144:147], v[192:195], a[96:99], 0
    v_max3_f32 v232, v232, v120, v121
    v_max3_f32 v233, v233, v128, v129
    v_mfma_f32_16x16x32_bf16 v[152:155], v[192:195], a[112:115], 0
    ds_read_b128 v[212:215], v225 offset:4096
    v_max3_f32 v234, v234, v136, v137
    v_mfma_f32_16x16x32_bf16 v[160:163], v[192:195], a[128:131], 0
    v_max3_f32 v232, v232, v122, v123
    s_add_u32 s68, s68, 3072
    buffer_load_dwordx4 v244, s[16:19], s68 offen offset:3072 nt lds
    v_max3_f32 v233, v233, v130, v131
    s_waitcnt lgkmcnt(4)
    v_mfma_f32_16x16x32_bf16 v[144:147], v[196:199], a[100:103], v[144:147]
    v_max3_f32 v234, v234, v138, v139
    v_max3_f32 v232, v232, v124, v125
    v_mfma_f32_16x16x32_bf16 v[152:155], v[196:199], a[116:119], v[152:155]
    ds_read_b128 v[216:219], v226 offset:4096
    v_max3_f32 v233, v233, v132, v133
    v_mfma_f32_16x16x32_bf16 v[160:163], v[196:199], a[132:135], v[160:163]
    v_max3_f32 v234, v234, v140, v141
    v_max3_f32 v232, v232, v126, v127
    s_waitcnt lgkmcnt(4)
    v_mfma_f32_16x16x32_bf16 v[144:147], v[200:203], a[104:107], v[144:147]
    v_max3_f32 v233, v233, v134, v135
    v_max3_f32 v234, v234, v142, v143
    v_mfma_f32_16x16x32_bf16 v[152:155], v[200:203], a[120:123], v[152:155]
    ds_read_b128 v[220:223], v227 offset:4096
    v_mfma_f32_16x16x32_bf16 v[160:163], v[200:203], a[136:139], v[160:163]
    s_waitcnt lgkmcnt(4)
    v_mfma_f32_16x16x32_bf16 v[144:147], v[204:207], a[108:111], v[144:147]
    v_add_u32 v224, 0, v246
    v_xor_b32 v225, 64, v224
    v_mfma_f32_16x16x32_bf16 v[152:155], v[204:207], a[124:127], v[152:155]
    v_xor_b32 v226, 128, v224
    v_xor_b32 v227, 192, v224
    v_mfma_f32_16x16x32_bf16 v[160:163], v[204:207], a[140:143], v[160:163]
    s_waitcnt lgkmcnt(3)
    v_mfma_f32_16x16x32_bf16 v[148:151], v[208:211], a[96:99], 0
    v_mfma_f32_16x16x32_bf16 v[156:159], v[208:211], a[112:115], 0
    v_mfma_f32_16x16x32_bf16 v[164:167], v[208:211], a[128:131], 0
    s_waitcnt vmcnt(8) lgkmcnt(0)
    s_barrier
    v_mfma_f32_16x16x32_bf16 v[148:151], v[212:215], a[100:103], v[148:151]
    ds_read_b128 v[192:195], v224 offset:0
    ds_read_b128 v[196:199], v225 offset:0
    s_add_u32 m0, s59, 49152
    s_add_u32 s68, s46, 32768
    buffer_load_dwordx4 v241, s[16:19], s68 offen offset:0 nt lds
    v_mfma_f32_16x16x32_bf16 v[156:159], v[212:215], a[116:119], v[156:159]
    ds_read_b128 v[200:203], v226 offset:0
    ds_read_b128 v[204:207], v227 offset:0
    v_mfma_f32_16x16x32_bf16 v[164:167], v[212:215], a[132:135], v[164:167]
    ds_read_b128 v[208:211], v224 offset:4096
    v_mfma_f32_16x16x32_bf16 v[148:151], v[216:219], a[104:107], v[148:151]
    v_mfma_f32_16x16x32_bf16 v[156:159], v[216:219], a[120:123], v[156:159]
    s_add_u32 s68, s68, 3072
    v_xor_b32 v244, 128, v241
    buffer_load_dwordx4 v244, s[16:19], s68 offen offset:1024 nt lds
    v_mfma_f32_16x16x32_bf16 v[164:167], v[216:219], a[136:139], v[164:167]
    v_mfma_f32_16x16x32_bf16 v[148:151], v[220:223], a[108:111], v[148:151]
    v_mfma_f32_16x16x32_bf16 v[156:159], v[220:223], a[124:127], v[156:159]
    v_mfma_f32_16x16x32_bf16 v[164:167], v[220:223], a[140:143], v[164:167]
    s_add_u32 s68, s68, 3072
    buffer_load_dwordx4 v241, s[16:19], s68 offen offset:2048 nt lds
    s_waitcnt lgkmcnt(4)
    v_mfma_f32_16x16x32_bf16 v[168:171], v[192:195], a[96:99], 0
    v_max3_f32 v232, v232, v144, v145
    v_max3_f32 v233, v233, v152, v153
    v_mfma_f32_16x16x32_bf16 v[176:179], v[192:195], a[112:115], 0
    ds_read_b128 v[212:215], v225 offset:4096
    v_max3_f32 v234, v234, v160, v161
    v_mfma_f32_16x16x32_bf16 v[184:187], v[192:195], a[128:131], 0
    v_max3_f32 v232, v232, v146, v147
    s_add_u32 s68, s68, 3072
    buffer_load_dwordx4 v244, s[16:19], s68 offen offset:3072 nt lds
    v_max3_f32 v233, v233, v154, v155
    s_waitcnt lgkmcnt(4)
    v_mfma_f32_16x16x32_bf16 v[168:171], v[196:199], a[100:103], v[168:171]
    v_max3_f32 v234, v234, v162, v163
    v_max3_f32 v232, v232, v148, v149
    v_mfma_f32_16x16x32_bf16 v[176:179], v[196:199], a[116:119], v[176:179]
    ds_read_b128 v[216:219], v226 offset:4096
    v_max3_f32 v233, v233, v156, v157
    v_mfma_f32_16x16x32_bf16 v[184:187], v[196:199], a[132:135], v[184:187]
    v_max3_f32 v234, v234, v164, v165
    v_max3_f32 v232, v232, v150, v151
    s_waitcnt lgkmcnt(4)
    v_mfma_f32_16x16x32_bf16 v[168:171], v[200:203], a[104:107], v[168:171]
    v_max3_f32 v233, v233, v158, v159
    v_max3_f32 v234, v234, v166, v167
    v_mfma_f32_16x16x32_bf16 v[176:179], v[200:203], a[120:123], v[176:179]
    ds_read_b128 v[220:223], v227 offset:4096
    v_mfma_f32_16x16x32_bf16 v[184:187], v[200:203], a[136:139], v[184:187]
    s_waitcnt lgkmcnt(4)
    v_mfma_f32_16x16x32_bf16 v[168:171], v[204:207], a[108:111], v[168:171]
    v_mfma_f32_16x16x32_bf16 v[176:179], v[204:207], a[124:127], v[176:179]
    v_mfma_f32_16x16x32_bf16 v[184:187], v[204:207], a[140:143], v[184:187]
    s_waitcnt lgkmcnt(3)
    v_mfma_f32_16x16x32_bf16 v[172:175], v[208:211], a[96:99], 0
    v_mfma_f32_16x16x32_bf16 v[180:183], v[208:211], a[112:115], 0
    v_mfma_f32_16x16x32_bf16 v[188:191], v[208:211], a[128:131], 0
    s_waitcnt lgkmcnt(2)
    v_mfma_f32_16x16x32_bf16 v[172:175], v[212:215], a[100:103], v[172:175]
    v_mfma_f32_16x16x32_bf16 v[180:183], v[212:215], a[116:119], v[180:183]
    v_mfma_f32_16x16x32_bf16 v[188:191], v[212:215], a[132:135], v[188:191]
    s_waitcnt lgkmcnt(1)
    v_mfma_f32_16x16x32_bf16 v[172:175], v[216:219], a[104:107], v[172:175]
    v_mfma_f32_16x16x32_bf16 v[180:183], v[216:219], a[120:123], v[180:183]
    v_mfma_f32_16x16x32_bf16 v[188:191], v[216:219], a[136:139], v[188:191]
    s_waitcnt lgkmcnt(0)
    v_mfma_f32_16x16x32_bf16 v[172:175], v[220:223], a[108:111], v[172:175]
    v_mfma_f32_16x16x32_bf16 v[180:183], v[220:223], a[124:127], v[180:183]
    v_mfma_f32_16x16x32_bf16 v[188:191], v[220:223], a[140:143], v[188:191]
    buffer_load_dword a247, off, s[36:39], 0 offset:4 sc1
    v_max3_f32 v232, v232, v168, v169
    s_add_u32 m0, s59, 147456
    s_add_u32 s69, s53, 0
    s_and_b32 s69, s69, 7
    s_lshl_b32 s68, s69, 19
    s_add_u32 s68, s68, s54
    s_add_u32 s68, s68, 256
    buffer_load_dwordx4 v242, s[20:23], s68 offen offset:0  lds
    v_max3_f32 v233, v233, v176, v177
    v_max3_f32 v234, v234, v184, v185
    v_max3_f32 v232, v232, v170, v171
    v_max3_f32 v233, v233, v178, v179
    v_max3_f32 v234, v234, v186, v187
    v_max3_f32 v232, v232, v172, v173
    v_max3_f32 v233, v233, v180, v181
    v_max3_f32 v234, v234, v188, v189
    v_max3_f32 v232, v232, v174, v175
    v_max3_f32 v233, v233, v182, v183
    v_max3_f32 v234, v234, v190, v191
    v_mov_b32 v228, v232
    v_mov_b32 v229, v233
    v_mov_b32 v230, v234
    v_permlane32_swap_b32 v228, v232
    v_permlane32_swap_b32 v229, v233
    v_permlane32_swap_b32 v230, v234
    v_max_f32 v232, v228, v232
    v_max_f32 v233, v229, v233
    v_max_f32 v234, v230, v234
    v_mov_b32 v228, v232
    v_mov_b32 v229, v233
    v_mov_b32 v230, v234
    v_permlane16_swap_b32 v228, v232
    v_permlane16_swap_b32 v229, v233
    v_permlane16_swap_b32 v230, v234
    v_max_f32 v232, v228, v232
    v_max_f32 v233, v229, v233
    v_max_f32 v234, v230, v234
    v_mul_f32 v232, s52, v232
    v_mul_f32 v233, s52, v233
    v_mul_f32 v234, s52, v234
    v_mov_b32 v230, v233
    v_pk_fma_f32 v[0:1], v[0:1], s[52:53], v[232:233] op_sel_hi:[1,0,0] neg_lo:[0,0,1] neg_hi:[0,0,1]
    v_pk_fma_f32 v[2:3], v[2:3], s[52:53], v[232:233] op_sel_hi:[1,0,0] neg_lo:[0,0,1] neg_hi:[0,0,1]
    v_pk_fma_f32 v[4:5], v[4:5], s[52:53], v[232:233] op_sel_hi:[1,0,0] neg_lo:[0,0,1] neg_hi:[0,0,1]
    v_pk_fma_f32 v[6:7], v[6:7], s[52:53], v[232:233] op_sel_hi:[1,0,0] neg_lo:[0,0,1] neg_hi:[0,0,1]
    v_exp_f32 v0, v0
    v_exp_f32 v1, v1
    v_exp_f32 v2, v2
    v_exp_f32 v3, v3
    v_exp_f32 v4, v4
    v_exp_f32 v5, v5
    v_exp_f32 v6, v6
    s_add_u32 s68, s68, 31744
    buffer_load_dwordx4 v242, s[20:23], s68 offen offset:1024  lds
    v_exp_f32 v7, v7
    v_pk_add_f32 v[250:251], v[0:1], v[2:3]
    v_pk_add_f32 v[250:251], v[250:251], v[4:5]
    v_pk_add_f32 v[250:251], v[250:251], v[6:7]
    v_cvt_pk_bf16_f32 v0, v0, v1
    v_cvt_pk_bf16_f32 v1, v2, v3
    v_cvt_pk_bf16_f32 v2, v4, v5
    v_cvt_pk_bf16_f32 v3, v6, v7
    v_pk_fma_f32 v[8:9], v[8:9], s[52:53], v[230:231] op_sel_hi:[1,0,0] neg_lo:[0,0,1] neg_hi:[0,0,1]
    v_pk_fma_f32 v[10:11], v[10:11], s[52:53], v[230:231] op_sel_hi:[1,0,0] neg_lo:[0,0,1] neg_hi:[0,0,1]
    v_pk_fma_f32 v[12:13], v[12:13], s[52:53], v[230:231] op_sel_hi:[1,0,0] neg_lo:[0,0,1] neg_hi:[0,0,1]
    v_pk_fma_f32 v[14:15], v[14:15], s[52:53], v[230:231] op_sel_hi:[1,0,0] neg_lo:[0,0,1] neg_hi:[0,0,1]
    v_exp_f32 v8, v8
    v_exp_f32 v9, v9
    v_exp_f32 v10, v10
    v_exp_f32 v11, v11
    v_exp_f32 v12, v12
    v_exp_f32 v13, v13
    v_exp_f32 v14, v14
    v_exp_f32 v15, v15
    v_pk_add_f32 v[252:253], v[8:9], v[10:11]
    v_pk_add_f32 v[252:253], v[252:253], v[12:13]
    v_pk_add_f32 v[252:253], v[252:253], v[14:15]
    v_cvt_pk_bf16_f32 v4, v8, v9
    v_cvt_pk_bf16_f32 v5, v10, v11
    v_cvt_pk_bf16_f32 v6, v12, v13
    v_cvt_pk_bf16_f32 v7, v14, v15
    v_pk_fma_f32 v[16:17], v[16:17], s[52:53], v[234:235] op_sel_hi:[1,0,0] neg_lo:[0,0,1] neg_hi:[0,0,1]
    v_pk_fma_f32 v[18:19], v[18:19], s[52:53], v[234:235] op_sel_hi:[1,0,0] neg_lo:[0,0,1] neg_hi:[0,0,1]
    v_pk_fma_f32 v[20:21], v[20:21], s[52:53], v[234:235] op_sel_hi:[1,0,0] neg_lo:[0,0,1] neg_hi:[0,0,1]
    v_pk_fma_f32 v[22:23], v[22:23], s[52:53], v[234:235] op_sel_hi:[1,0,0] neg_lo:[0,0,1] neg_hi:[0,0,1]
    v_exp_f32 v16, v16
    v_exp_f32 v17, v17
    v_exp_f32 v18, v18
    v_exp_f32 v19, v19
    v_exp_f32 v20, v20
    s_add_u32 s68, s68, 31744
    v_xor_b32 v244, 128, v242
    buffer_load_dwordx4 v244, s[20:23], s68 offen offset:2048  lds
    v_exp_f32 v21, v21
    v_exp_f32 v22, v22
    v_exp_f32 v23, v23
    v_pk_add_f32 v[238:239], v[16:17], v[18:19]
    v_pk_add_f32 v[238:239], v[238:239], v[20:21]
    v_pk_add_f32 v[238:239], v[238:239], v[22:23]
    v_cvt_pk_bf16_f32 v8, v16, v17
    v_cvt_pk_bf16_f32 v9, v18, v19
    v_cvt_pk_bf16_f32 v10, v20, v21
    v_cvt_pk_bf16_f32 v11, v22, v23
    v_pk_fma_f32 v[24:25], v[24:25], s[52:53], v[232:233] op_sel_hi:[1,0,0] neg_lo:[0,0,1] neg_hi:[0,0,1]
    v_pk_fma_f32 v[26:27], v[26:27], s[52:53], v[232:233] op_sel_hi:[1,0,0] neg_lo:[0,0,1] neg_hi:[0,0,1]
    v_pk_fma_f32 v[28:29], v[28:29], s[52:53], v[232:233] op_sel_hi:[1,0,0] neg_lo:[0,0,1] neg_hi:[0,0,1]
    v_pk_fma_f32 v[30:31], v[30:31], s[52:53], v[232:233] op_sel_hi:[1,0,0] neg_lo:[0,0,1] neg_hi:[0,0,1]
    v_exp_f32 v24, v24
    v_exp_f32 v25, v25
    v_exp_f32 v26, v26
    v_exp_f32 v27, v27
    v_exp_f32 v28, v28
    v_exp_f32 v29, v29
    v_exp_f32 v30, v30
    v_exp_f32 v31, v31
    v_pk_add_f32 v[250:251], v[250:251], v[24:25]
    v_pk_add_f32 v[250:251], v[250:251], v[26:27]
    v_pk_add_f32 v[250:251], v[250:251], v[28:29]
    v_pk_add_f32 v[250:251], v[250:251], v[30:31]
    v_cvt_pk_bf16_f32 v12, v24, v25
    v_cvt_pk_bf16_f32 v13, v26, v27
    v_cvt_pk_bf16_f32 v14, v28, v29
    v_cvt_pk_bf16_f32 v15, v30, v31
    v_pk_fma_f32 v[32:33], v[32:33], s[52:53], v[230:231] op_sel_hi:[1,0,0] neg_lo:[0,0,1] neg_hi:[0,0,1]
    v_pk_fma_f32 v[34:35], v[34:35], s[52:53], v[230:231] op_sel_hi:[1,0,0] neg_lo:[0,0,1] neg_hi:[0,0,1]
    v_pk_fma_f32 v[36:37], v[36:37], s[52:53], v[230:231] op_sel_hi:[1,0,0] neg_lo:[0,0,1] neg_hi:[0,0,1]
    v_pk_fma_f32 v[38:39], v[38:39], s[52:53], v[230:231] op_sel_hi:[1,0,0] neg_lo:[0,0,1] neg_hi:[0,0,1]
    v_exp_f32 v32, v32
    v_exp_f32 v33, v33
    v_exp_f32 v34, v34
    s_add_u32 s68, s68, 31744
    buffer_load_dwordx4 v244, s[20:23], s68 offen offset:3072  lds
    v_exp_f32 v35, v35
    v_exp_f32 v36, v36
    v_exp_f32 v37, v37
    v_exp_f32 v38, v38
    v_exp_f32 v39, v39
    v_pk_add_f32 v[252:253], v[252:253], v[32:33]
    v_pk_add_f32 v[252:253], v[252:253], v[34:35]
    v_pk_add_f32 v[252:253], v[252:253], v[36:37]
    v_pk_add_f32 v[252:253], v[252:253], v[38:39]
    v_cvt_pk_bf16_f32 v16, v32, v33
    v_cvt_pk_bf16_f32 v17, v34, v35
    v_cvt_pk_bf16_f32 v18, v36, v37
    v_cvt_pk_bf16_f32 v19, v38, v39
    v_pk_fma_f32 v[40:41], v[40:41], s[52:53], v[234:235] op_sel_hi:[1,0,0] neg_lo:[0,0,1] neg_hi:[0,0,1]
    v_pk_fma_f32 v[42:43], v[42:43], s[52:53], v[234:235] op_sel_hi:[1,0,0] neg_lo:[0,0,1] neg_hi:[0,0,1]
    v_pk_fma_f32 v[44:45], v[44:45], s[52:53], v[234:235] op_sel_hi:[1,0,0] neg_lo:[0,0,1] neg_hi:[0,0,1]
    v_pk_fma_f32 v[46:47], v[46:47], s[52:53], v[234:235] op_sel_hi:[1,0,0] neg_lo:[0,0,1] neg_hi:[0,0,1]
    v_exp_f32 v40, v40
    v_exp_f32 v41, v41
    v_exp_f32 v42, v42
    v_exp_f32 v43, v43
    v_exp_f32 v44, v44
    v_exp_f32 v45, v45
    v_exp_f32 v46, v46
    v_exp_f32 v47, v47
    v_pk_add_f32 v[238:239], v[238:239], v[40:41]
    v_pk_add_f32 v[238:239], v[238:239], v[42:43]
    v_pk_add_f32 v[238:239], v[238:239], v[44:45]
    v_pk_add_f32 v[238:239], v[238:239], v[46:47]
    v_cvt_pk_bf16_f32 v20, v40, v41
    v_cvt_pk_bf16_f32 v21, v42, v43
    v_cvt_pk_bf16_f32 v22, v44, v45
    v_cvt_pk_bf16_f32 v23, v46, v47
    v_pk_fma_f32 v[48:49], v[48:49], s[52:53], v[232:233] op_sel_hi:[1,0,0] neg_lo:[0,0,1] neg_hi:[0,0,1]
    v_pk_fma_f32 v[50:51], v[50:51], s[52:53], v[232:233] op_sel_hi:[1,0,0] neg_lo:[0,0,1] neg_hi:[0,0,1]
    v_pk_fma_f32 v[52:53], v[52:53], s[52:53], v[232:233] op_sel_hi:[1,0,0] neg_lo:[0,0,1] neg_hi:[0,0,1]
    v_pk_fma_f32 v[54:55], v[54:55], s[52:53], v[232:233] op_sel_hi:[1,0,0] neg_lo:[0,0,1] neg_hi:[0,0,1]
    s_add_u32 m0, s59, 65536
    s_add_u32 s68, s46, 49152
    buffer_load_dwordx4 v241, s[16:19], s68 offen offset:0 nt lds
    v_exp_f32 v48, v48
    v_exp_f32 v49, v49
    v_exp_f32 v50, v50
    v_exp_f32 v51, v51
    v_exp_f32 v52, v52
    v_exp_f32 v53, v53
    v_exp_f32 v54, v54
    v_exp_f32 v55, v55
    v_pk_add_f32 v[250:251], v[250:251], v[48:49]
    v_pk_add_f32 v[250:251], v[250:251], v[50:51]
    v_pk_add_f32 v[250:251], v[250:251], v[52:53]
    v_pk_add_f32 v[250:251], v[250:251], v[54:55]
    v_cvt_pk_bf16_f32 v24, v48, v49
    v_cvt_pk_bf16_f32 v25, v50, v51
    v_cvt_pk_bf16_f32 v26, v52, v53
    v_cvt_pk_bf16_f32 v27, v54, v55
    v_pk_fma_f32 v[56:57], v[56:57], s[52:53], v[230:231] op_sel_hi:[1,0,0] neg_lo:[0,0,1] neg_hi:[0,0,1]
    v_pk_fma_f32 v[58:59], v[58:59], s[52:53], v[230:231] op_sel_hi:[1,0,0] neg_lo:[0,0,1] neg_hi:[0,0,1]
    v_pk_fma_f32 v[60:61], v[60:61], s[52:53], v[230:231] op_sel_hi:[1,0,0] neg_lo:[0,0,1] neg_hi:[0,0,1]
    v_pk_fma_f32 v[62:63], v[62:63], s[52:53], v[230:231] op_sel_hi:[1,0,0] neg_lo:[0,0,1] neg_hi:[0,0,1]
    v_exp_f32 v56, v56
    v_exp_f32 v57, v57
    v_exp_f32 v58, v58
    v_exp_f32 v59, v59
    v_exp_f32 v60, v60
    v_exp_f32 v61, v61
    v_exp_f32 v62, v62
    v_exp_f32 v63, v63
    v_pk_add_f32 v[252:253], v[252:253], v[56:57]
    v_pk_add_f32 v[252:253], v[252:253], v[58:59]
    v_pk_add_f32 v[252:253], v[252:253], v[60:61]
    v_pk_add_f32 v[252:253], v[252:253], v[62:63]
    v_cvt_pk_bf16_f32 v28, v56, v57
    v_cvt_pk_bf16_f32 v29, v58, v59
    s_add_u32 s68, s68, 3072
    v_xor_b32 v244, 128, v241
    buffer_load_dwordx4 v244, s[16:19], s68 offen offset:1024 nt lds
    v_cvt_pk_bf16_f32 v30, v60, v61
    v_cvt_pk_bf16_f32 v31, v62, v63
    v_pk_fma_f32 v[64:65], v[64:65], s[52:53], v[234:235] op_sel_hi:[1,0,0] neg_lo:[0,0,1] neg_hi:[0,0,1]
    v_pk_fma_f32 v[66:67], v[66:67], s[52:53], v[234:235] op_sel_hi:[1,0,0] neg_lo:[0,0,1] neg_hi:[0,0,1]
    v_pk_fma_f32 v[68:69], v[68:69], s[52:53], v[234:235] op_sel_hi:[1,0,0] neg_lo:[0,0,1] neg_hi:[0,0,1]
    v_pk_fma_f32 v[70:71], v[70:71], s[52:53], v[234:235] op_sel_hi:[1,0,0] neg_lo:[0,0,1] neg_hi:[0,0,1]
    v_exp_f32 v64, v64
    v_exp_f32 v65, v65
    v_exp_f32 v66, v66
    v_exp_f32 v67, v67
    v_exp_f32 v68, v68
    v_exp_f32 v69, v69
    v_exp_f32 v70, v70
    v_exp_f32 v71, v71
    v_pk_add_f32 v[238:239], v[238:239], v[64:65]
    v_pk_add_f32 v[238:239], v[238:239], v[66:67]
    v_pk_add_f32 v[238:239], v[238:239], v[68:69]
    v_pk_add_f32 v[238:239], v[238:239], v[70:71]
    v_cvt_pk_bf16_f32 v32, v64, v65
    v_cvt_pk_bf16_f32 v33, v66, v67
    v_cvt_pk_bf16_f32 v34, v68, v69
    v_cvt_pk_bf16_f32 v35, v70, v71
    v_pk_fma_f32 v[72:73], v[72:73], s[52:53], v[232:233] op_sel_hi:[1,0,0] neg_lo:[0,0,1] neg_hi:[0,0,1]
    v_pk_fma_f32 v[74:75], v[74:75], s[52:53], v[232:233] op_sel_hi:[1,0,0] neg_lo:[0,0,1] neg_hi:[0,0,1]
    v_pk_fma_f32 v[76:77], v[76:77], s[52:53], v[232:233] op_sel_hi:[1,0,0] neg_lo:[0,0,1] neg_hi:[0,0,1]
    v_pk_fma_f32 v[78:79], v[78:79], s[52:53], v[232:233] op_sel_hi:[1,0,0] neg_lo:[0,0,1] neg_hi:[0,0,1]
    v_exp_f32 v72, v72
    v_exp_f32 v73, v73
    v_exp_f32 v74, v74
    v_exp_f32 v75, v75
    v_exp_f32 v76, v76
    v_exp_f32 v77, v77
    v_exp_f32 v78, v78
    v_exp_f32 v79, v79
    s_add_u32 s68, s68, 3072
    buffer_load_dwordx4 v241, s[16:19], s68 offen offset:2048 nt lds
    v_pk_add_f32 v[250:251], v[250:251], v[72:73]
    v_pk_add_f32 v[250:251], v[250:251], v[74:75]
    v_pk_add_f32 v[250:251], v[250:251], v[76:77]
    v_pk_add_f32 v[250:251], v[250:251], v[78:79]
    v_cvt_pk_bf16_f32 v36, v72, v73
    v_cvt_pk_bf16_f32 v37, v74, v75
    v_cvt_pk_bf16_f32 v38, v76, v77
    v_cvt_pk_bf16_f32 v39, v78, v79
    v_pk_fma_f32 v[80:81], v[80:81], s[52:53], v[230:231] op_sel_hi:[1,0,0] neg_lo:[0,0,1] neg_hi:[0,0,1]
    v_pk_fma_f32 v[82:83], v[82:83], s[52:53], v[230:231] op_sel_hi:[1,0,0] neg_lo:[0,0,1] neg_hi:[0,0,1]
    v_pk_fma_f32 v[84:85], v[84:85], s[52:53], v[230:231] op_sel_hi:[1,0,0] neg_lo:[0,0,1] neg_hi:[0,0,1]
    v_pk_fma_f32 v[86:87], v[86:87], s[52:53], v[230:231] op_sel_hi:[1,0,0] neg_lo:[0,0,1] neg_hi:[0,0,1]
    v_exp_f32 v80, v80
    v_exp_f32 v81, v81
    v_exp_f32 v82, v82
    v_exp_f32 v83, v83
    v_exp_f32 v84, v84
    v_exp_f32 v85, v85
    v_exp_f32 v86, v86
    v_exp_f32 v87, v87
    v_pk_add_f32 v[252:253], v[252:253], v[80:81]
    v_pk_add_f32 v[252:253], v[252:253], v[82:83]
    v_pk_add_f32 v[252:253], v[252:253], v[84:85]
    v_pk_add_f32 v[252:253], v[252:253], v[86:87]
    v_cvt_pk_bf16_f32 v40, v80, v81
    v_cvt_pk_bf16_f32 v41, v82, v83
    v_cvt_pk_bf16_f32 v42, v84, v85
    v_cvt_pk_bf16_f32 v43, v86, v87
    v_pk_fma_f32 v[88:89], v[88:89], s[52:53], v[234:235] op_sel_hi:[1,0,0] neg_lo:[0,0,1] neg_hi:[0,0,1]
    v_pk_fma_f32 v[90:91], v[90:91], s[52:53], v[234:235] op_sel_hi:[1,0,0] neg_lo:[0,0,1] neg_hi:[0,0,1]
    v_pk_fma_f32 v[92:93], v[92:93], s[52:53], v[234:235] op_sel_hi:[1,0,0] neg_lo:[0,0,1] neg_hi:[0,0,1]
    v_pk_fma_f32 v[94:95], v[94:95], s[52:53], v[234:235] op_sel_hi:[1,0,0] neg_lo:[0,0,1] neg_hi:[0,0,1]
    v_exp_f32 v88, v88
    v_exp_f32 v89, v89
    v_exp_f32 v90, v90
    v_exp_f32 v91, v91
    v_exp_f32 v92, v92
    s_add_u32 s68, s68, 3072
    buffer_load_dwordx4 v244, s[16:19], s68 offen offset:3072 nt lds
    v_exp_f32 v93, v93
    v_exp_f32 v94, v94
    v_exp_f32 v95, v95
    v_pk_add_f32 v[238:239], v[238:239], v[88:89]
    v_pk_add_f32 v[238:239], v[238:239], v[90:91]
    v_pk_add_f32 v[238:239], v[238:239], v[92:93]
    v_pk_add_f32 v[238:239], v[238:239], v[94:95]
    v_cvt_pk_bf16_f32 v44, v88, v89
    v_cvt_pk_bf16_f32 v45, v90, v91
    v_cvt_pk_bf16_f32 v46, v92, v93
    v_cvt_pk_bf16_f32 v47, v94, v95
    v_pk_fma_f32 v[96:97], v[96:97], s[52:53], v[232:233] op_sel_hi:[1,0,0] neg_lo:[0,0,1] neg_hi:[0,0,1]
    v_pk_fma_f32 v[98:99], v[98:99], s[52:53], v[232:233] op_sel_hi:[1,0,0] neg_lo:[0,0,1] neg_hi:[0,0,1]
    v_pk_fma_f32 v[100:101], v[100:101], s[52:53], v[232:233] op_sel_hi:[1,0,0] neg_lo:[0,0,1] neg_hi:[0,0,1]
    v_pk_fma_f32 v[102:103], v[102:103], s[52:53], v[232:233] op_sel_hi:[1,0,0] neg_lo:[0,0,1] neg_hi:[0,0,1]
    v_exp_f32 v96, v96
    v_exp_f32 v97, v97
    v_exp_f32 v98, v98
    v_exp_f32 v99, v99
    v_exp_f32 v100, v100
    v_exp_f32 v101, v101
    v_exp_f32 v102, v102
    v_exp_f32 v103, v103
    v_pk_add_f32 v[250:251], v[250:251], v[96:97]
    v_pk_add_f32 v[250:251], v[250:251], v[98:99]
    v_pk_add_f32 v[250:251], v[250:251], v[100:101]
    v_pk_add_f32 v[250:251], v[250:251], v[102:103]
    v_cvt_pk_bf16_f32 v48, v96, v97
    v_cvt_pk_bf16_f32 v49, v98, v99
    v_cvt_pk_bf16_f32 v50, v100, v101
    v_cvt_pk_bf16_f32 v51, v102, v103
    v_pk_fma_f32 v[104:105], v[104:105], s[52:53], v[230:231] op_sel_hi:[1,0,0] neg_lo:[0,0,1] neg_hi:[0,0,1]
    v_pk_fma_f32 v[106:107], v[106:107], s[52:53], v[230:231] op_sel_hi:[1,0,0] neg_lo:[0,0,1] neg_hi:[0,0,1]
    v_pk_fma_f32 v[108:109], v[108:109], s[52:53], v[230:231] op_sel_hi:[1,0,0] neg_lo:[0,0,1] neg_hi:[0,0,1]
    v_pk_fma_f32 v[110:111], v[110:111], s[52:53], v[230:231] op_sel_hi:[1,0,0] neg_lo:[0,0,1] neg_hi:[0,0,1]
    v_exp_f32 v104, v104
    v_exp_f32 v105, v105
    s_add_u32 m0, s59, 131072
    s_add_u32 s69, s53, 1
    s_and_b32 s69, s69, 7
    s_lshl_b32 s68, s69, 19
    s_add_u32 s68, s68, s54
    s_add_u32 s68, s68, 256
    buffer_load_dwordx4 v242, s[20:23], s68 offen offset:0  lds
    v_exp_f32 v106, v106
    v_exp_f32 v107, v107
    v_exp_f32 v108, v108
    v_exp_f32 v109, v109
    v_exp_f32 v110, v110
    v_exp_f32 v111, v111
    v_pk_add_f32 v[252:253], v[252:253], v[104:105]
    v_pk_add_f32 v[252:253], v[252:253], v[106:107]
    v_pk_add_f32 v[252:253], v[252:253], v[108:109]
    v_pk_add_f32 v[252:253], v[252:253], v[110:111]
    v_cvt_pk_bf16_f32 v52, v104, v105
    v_cvt_pk_bf16_f32 v53, v106, v107
    v_cvt_pk_bf16_f32 v54, v108, v109
    v_cvt_pk_bf16_f32 v55, v110, v111
    v_pk_fma_f32 v[112:113], v[112:113], s[52:53], v[234:235] op_sel_hi:[1,0,0] neg_lo:[0,0,1] neg_hi:[0,0,1]
    v_pk_fma_f32 v[114:115], v[114:115], s[52:53], v[234:235] op_sel_hi:[1,0,0] neg_lo:[0,0,1] neg_hi:[0,0,1]
    v_pk_fma_f32 v[116:117], v[116:117], s[52:53], v[234:235] op_sel_hi:[1,0,0] neg_lo:[0,0,1] neg_hi:[0,0,1]
    v_pk_fma_f32 v[118:119], v[118:119], s[52:53], v[234:235] op_sel_hi:[1,0,0] neg_lo:[0,0,1] neg_hi:[0,0,1]
    v_exp_f32 v112, v112
    v_exp_f32 v113, v113
    v_exp_f32 v114, v114
    v_exp_f32 v115, v115
    v_exp_f32 v116, v116
    v_exp_f32 v117, v117
    v_exp_f32 v118, v118
    v_exp_f32 v119, v119
    v_pk_add_f32 v[238:239], v[238:239], v[112:113]
    v_pk_add_f32 v[238:239], v[238:239], v[114:115]
    v_pk_add_f32 v[238:239], v[238:239], v[116:117]
    v_pk_add_f32 v[238:239], v[238:239], v[118:119]
    v_cvt_pk_bf16_f32 v56, v112, v113
    v_cvt_pk_bf16_f32 v57, v114, v115
    v_cvt_pk_bf16_f32 v58, v116, v117
    v_cvt_pk_bf16_f32 v59, v118, v119
    v_pk_fma_f32 v[120:121], v[120:121], s[52:53], v[232:233] op_sel_hi:[1,0,0] neg_lo:[0,0,1] neg_hi:[0,0,1]
    v_pk_fma_f32 v[122:123], v[122:123], s[52:53], v[232:233] op_sel_hi:[1,0,0] neg_lo:[0,0,1] neg_hi:[0,0,1]
    s_add_u32 s68, s68, 31744
    buffer_load_dwordx4 v242, s[20:23], s68 offen offset:1024  lds
    v_pk_fma_f32 v[124:125], v[124:125], s[52:53], v[232:233] op_sel_hi:[1,0,0] neg_lo:[0,0,1] neg_hi:[0,0,1]
    v_pk_fma_f32 v[126:127], v[126:127], s[52:53], v[232:233] op_sel_hi:[1,0,0] neg_lo:[0,0,1] neg_hi:[0,0,1]
    v_exp_f32 v120, v120
    v_exp_f32 v121, v121
    v_exp_f32 v122, v122
    v_exp_f32 v123, v123
    v_exp_f32 v124, v124
    v_exp_f32 v125, v125
    v_exp_f32 v126, v126
    v_exp_f32 v127, v127
    v_pk_add_f32 v[250:251], v[250:251], v[120:121]
    v_pk_add_f32 v[250:251], v[250:251], v[122:123]
    v_pk_add_f32 v[250:251], v[250:251], v[124:125]
    v_pk_add_f32 v[250:251], v[250:251], v[126:127]
    v_cvt_pk_bf16_f32 v60, v120, v121
    v_cvt_pk_bf16_f32 v61, v122, v123
    v_cvt_pk_bf16_f32 v62, v124, v125
    v_cvt_pk_bf16_f32 v63, v126, v127
    v_pk_fma_f32 v[128:129], v[128:129], s[52:53], v[230:231] op_sel_hi:[1,0,0] neg_lo:[0,0,1] neg_hi:[0,0,1]
    v_pk_fma_f32 v[130:131], v[130:131], s[52:53], v[230:231] op_sel_hi:[1,0,0] neg_lo:[0,0,1] neg_hi:[0,0,1]
    v_pk_fma_f32 v[132:133], v[132:133], s[52:53], v[230:231] op_sel_hi:[1,0,0] neg_lo:[0,0,1] neg_hi:[0,0,1]
    v_pk_fma_f32 v[134:135], v[134:135], s[52:53], v[230:231] op_sel_hi:[1,0,0] neg_lo:[0,0,1] neg_hi:[0,0,1]
    v_exp_f32 v128, v128
    v_exp_f32 v129, v129
    v_exp_f32 v130, v130
    v_exp_f32 v131, v131
    v_exp_f32 v132, v132
    v_exp_f32 v133, v133
    v_exp_f32 v134, v134
    v_exp_f32 v135, v135
    v_pk_add_f32 v[252:253], v[252:253], v[128:129]
    v_pk_add_f32 v[252:253], v[252:253], v[130:131]
    v_pk_add_f32 v[252:253], v[252:253], v[132:133]
    v_pk_add_f32 v[252:253], v[252:253], v[134:135]
    s_add_u32 s68, s68, 31744
    v_xor_b32 v244, 128, v242
    buffer_load_dwordx4 v244, s[20:23], s68 offen offset:2048  lds
    v_cvt_pk_bf16_f32 v64, v128, v129
    v_cvt_pk_bf16_f32 v65, v130, v131
    v_cvt_pk_bf16_f32 v66, v132, v133
    v_cvt_pk_bf16_f32 v67, v134, v135
    v_pk_fma_f32 v[136:137], v[136:137], s[52:53], v[234:235] op_sel_hi:[1,0,0] neg_lo:[0,0,1] neg_hi:[0,0,1]
    v_pk_fma_f32 v[138:139], v[138:139], s[52:53], v[234:235] op_sel_hi:[1,0,0] neg_lo:[0,0,1] neg_hi:[0,0,1]
    v_pk_fma_f32 v[140:141], v[140:141], s[52:53], v[234:235] op_sel_hi:[1,0,0] neg_lo:[0,0,1] neg_hi:[0,0,1]
    v_pk_fma_f32 v[142:143], v[142:143], s[52:53], v[234:235] op_sel_hi:[1,0,0] neg_lo:[0,0,1] neg_hi:[0,0,1]
    v_exp_f32 v136, v136
    v_exp_f32 v137, v137
    v_exp_f32 v138, v138
    v_exp_f32 v139, v139
    v_exp_f32 v140, v140
    v_exp_f32 v141, v141
    v_exp_f32 v142, v142
    v_exp_f32 v143, v143
    v_pk_add_f32 v[238:239], v[238:239], v[136:137]
    v_pk_add_f32 v[238:239], v[238:239], v[138:139]
    v_pk_add_f32 v[238:239], v[238:239], v[140:141]
    v_pk_add_f32 v[238:239], v[238:239], v[142:143]
    v_cvt_pk_bf16_f32 v68, v136, v137
    v_cvt_pk_bf16_f32 v69, v138, v139
    v_cvt_pk_bf16_f32 v70, v140, v141
    v_cvt_pk_bf16_f32 v71, v142, v143
    v_pk_fma_f32 v[144:145], v[144:145], s[52:53], v[232:233] op_sel_hi:[1,0,0] neg_lo:[0,0,1] neg_hi:[0,0,1]
    v_pk_fma_f32 v[146:147], v[146:147], s[52:53], v[232:233] op_sel_hi:[1,0,0] neg_lo:[0,0,1] neg_hi:[0,0,1]
    v_pk_fma_f32 v[148:149], v[148:149], s[52:53], v[232:233] op_sel_hi:[1,0,0] neg_lo:[0,0,1] neg_hi:[0,0,1]
    v_pk_fma_f32 v[150:151], v[150:151], s[52:53], v[232:233] op_sel_hi:[1,0,0] neg_lo:[0,0,1] neg_hi:[0,0,1]
    v_exp_f32 v144, v144
    v_exp_f32 v145, v145
    v_exp_f32 v146, v146
    v_exp_f32 v147, v147
    v_exp_f32 v148, v148
    v_exp_f32 v149, v149
    v_exp_f32 v150, v150
    s_add_u32 s68, s68, 31744
    buffer_load_dwordx4 v244, s[20:23], s68 offen offset:3072  lds
    v_exp_f32 v151, v151
    v_pk_add_f32 v[250:251], v[250:251], v[144:145]
    v_pk_add_f32 v[250:251], v[250:251], v[146:147]
    v_pk_add_f32 v[250:251], v[250:251], v[148:149]
    v_pk_add_f32 v[250:251], v[250:251], v[150:151]
    v_cvt_pk_bf16_f32 v72, v144, v145
    v_cvt_pk_bf16_f32 v73, v146, v147
    v_cvt_pk_bf16_f32 v74, v148, v149
    v_cvt_pk_bf16_f32 v75, v150, v151
    v_pk_fma_f32 v[152:153], v[152:153], s[52:53], v[230:231] op_sel_hi:[1,0,0] neg_lo:[0,0,1] neg_hi:[0,0,1]
    v_pk_fma_f32 v[154:155], v[154:155], s[52:53], v[230:231] op_sel_hi:[1,0,0] neg_lo:[0,0,1] neg_hi:[0,0,1]
    v_pk_fma_f32 v[156:157], v[156:157], s[52:53], v[230:231] op_sel_hi:[1,0,0] neg_lo:[0,0,1] neg_hi:[0,0,1]
    v_pk_fma_f32 v[158:159], v[158:159], s[52:53], v[230:231] op_sel_hi:[1,0,0] neg_lo:[0,0,1] neg_hi:[0,0,1]
    v_exp_f32 v152, v152
    v_exp_f32 v153, v153
    v_exp_f32 v154, v154
    v_exp_f32 v155, v155
    v_exp_f32 v156, v156
    v_exp_f32 v157, v157
    v_exp_f32 v158, v158
    v_exp_f32 v159, v159
    v_pk_add_f32 v[252:253], v[252:253], v[152:153]
    v_pk_add_f32 v[252:253], v[252:253], v[154:155]
    v_pk_add_f32 v[252:253], v[252:253], v[156:157]
    v_pk_add_f32 v[252:253], v[252:253], v[158:159]
    v_cvt_pk_bf16_f32 v76, v152, v153
    v_cvt_pk_bf16_f32 v77, v154, v155
    v_cvt_pk_bf16_f32 v78, v156, v157
    v_cvt_pk_bf16_f32 v79, v158, v159
    v_pk_fma_f32 v[160:161], v[160:161], s[52:53], v[234:235] op_sel_hi:[1,0,0] neg_lo:[0,0,1] neg_hi:[0,0,1]
    v_pk_fma_f32 v[162:163], v[162:163], s[52:53], v[234:235] op_sel_hi:[1,0,0] neg_lo:[0,0,1] neg_hi:[0,0,1]
    v_pk_fma_f32 v[164:165], v[164:165], s[52:53], v[234:235] op_sel_hi:[1,0,0] neg_lo:[0,0,1] neg_hi:[0,0,1]
    v_pk_fma_f32 v[166:167], v[166:167], s[52:53], v[234:235] op_sel_hi:[1,0,0] neg_lo:[0,0,1] neg_hi:[0,0,1]
    v_exp_f32 v160, v160
    v_exp_f32 v161, v161
    v_exp_f32 v162, v162
    v_exp_f32 v163, v163
    s_add_u32 m0, s59, 81920
    s_add_u32 s68, s46, 65536
    buffer_load_dwordx4 v241, s[16:19], s68 offen offset:0 nt lds
    v_exp_f32 v164, v164
    v_exp_f32 v165, v165
    v_exp_f32 v166, v166
    v_exp_f32 v167, v167
    v_pk_add_f32 v[238:239], v[238:239], v[160:161]
    v_pk_add_f32 v[238:239], v[238:239], v[162:163]
    v_pk_add_f32 v[238:239], v[238:239], v[164:165]
    v_pk_add_f32 v[238:239], v[238:239], v[166:167]
    v_cvt_pk_bf16_f32 v80, v160, v161
    v_cvt_pk_bf16_f32 v81, v162, v163
    v_cvt_pk_bf16_f32 v82, v164, v165
    v_cvt_pk_bf16_f32 v83, v166, v167
    v_pk_fma_f32 v[168:169], v[168:169], s[52:53], v[232:233] op_sel_hi:[1,0,0] neg_lo:[0,0,1] neg_hi:[0,0,1]
    v_pk_fma_f32 v[170:171], v[170:171], s[52:53], v[232:233] op_sel_hi:[1,0,0] neg_lo:[0,0,1] neg_hi:[0,0,1]
    v_pk_fma_f32 v[172:173], v[172:173], s[52:53], v[232:233] op_sel_hi:[1,0,0] neg_lo:[0,0,1] neg_hi:[0,0,1]
    v_pk_fma_f32 v[174:175], v[174:175], s[52:53], v[232:233] op_sel_hi:[1,0,0] neg_lo:[0,0,1] neg_hi:[0,0,1]
    v_exp_f32 v168, v168
    v_exp_f32 v169, v169
    v_exp_f32 v170, v170
    v_exp_f32 v171, v171
    v_exp_f32 v172, v172
    v_exp_f32 v173, v173
    v_exp_f32 v174, v174
    v_exp_f32 v175, v175
    v_pk_add_f32 v[250:251], v[250:251], v[168:169]
    v_pk_add_f32 v[250:251], v[250:251], v[170:171]
    v_pk_add_f32 v[250:251], v[250:251], v[172:173]
    v_pk_add_f32 v[250:251], v[250:251], v[174:175]
    v_cvt_pk_bf16_f32 v84, v168, v169
    v_cvt_pk_bf16_f32 v85, v170, v171
    v_cvt_pk_bf16_f32 v86, v172, v173
    v_cvt_pk_bf16_f32 v87, v174, v175
    v_pk_fma_f32 v[176:177], v[176:177], s[52:53], v[230:231] op_sel_hi:[1,0,0] neg_lo:[0,0,1] neg_hi:[0,0,1]
    v_pk_fma_f32 v[178:179], v[178:179], s[52:53], v[230:231] op_sel_hi:[1,0,0] neg_lo:[0,0,1] neg_hi:[0,0,1]
    v_pk_fma_f32 v[180:181], v[180:181], s[52:53], v[230:231] op_sel_hi:[1,0,0] neg_lo:[0,0,1] neg_hi:[0,0,1]
    v_pk_fma_f32 v[182:183], v[182:183], s[52:53], v[230:231] op_sel_hi:[1,0,0] neg_lo:[0,0,1] neg_hi:[0,0,1]
    v_exp_f32 v176, v176
    s_add_u32 s68, s68, 3072
    v_xor_b32 v244, 128, v241
    buffer_load_dwordx4 v244, s[16:19], s68 offen offset:1024 nt lds
    v_exp_f32 v177, v177
    v_exp_f32 v178, v178
    v_exp_f32 v179, v179
    v_exp_f32 v180, v180
    v_exp_f32 v181, v181
    v_exp_f32 v182, v182
    v_exp_f32 v183, v183
    v_pk_add_f32 v[252:253], v[252:253], v[176:177]
    v_pk_add_f32 v[252:253], v[252:253], v[178:179]
    v_pk_add_f32 v[252:253], v[252:253], v[180:181]
    v_pk_add_f32 v[252:253], v[252:253], v[182:183]
    v_cvt_pk_bf16_f32 v88, v176, v177
    v_cvt_pk_bf16_f32 v89, v178, v179
    v_cvt_pk_bf16_f32 v90, v180, v181
    v_cvt_pk_bf16_f32 v91, v182, v183
    v_pk_fma_f32 v[184:185], v[184:185], s[52:53], v[234:235] op_sel_hi:[1,0,0] neg_lo:[0,0,1] neg_hi:[0,0,1]
    v_pk_fma_f32 v[186:187], v[186:187], s[52:53], v[234:235] op_sel_hi:[1,0,0] neg_lo:[0,0,1] neg_hi:[0,0,1]
    v_pk_fma_f32 v[188:189], v[188:189], s[52:53], v[234:235] op_sel_hi:[1,0,0] neg_lo:[0,0,1] neg_hi:[0,0,1]
    v_pk_fma_f32 v[190:191], v[190:191], s[52:53], v[234:235] op_sel_hi:[1,0,0] neg_lo:[0,0,1] neg_hi:[0,0,1]
    v_exp_f32 v184, v184
    v_exp_f32 v185, v185
    v_exp_f32 v186, v186
    v_exp_f32 v187, v187
    v_exp_f32 v188, v188
    v_exp_f32 v189, v189
    v_exp_f32 v190, v190
    v_exp_f32 v191, v191
    v_pk_add_f32 v[238:239], v[238:239], v[184:185]
    v_pk_add_f32 v[238:239], v[238:239], v[186:187]
    v_pk_add_f32 v[238:239], v[238:239], v[188:189]
    v_pk_add_f32 v[238:239], v[238:239], v[190:191]
    v_cvt_pk_bf16_f32 v92, v184, v185
    v_cvt_pk_bf16_f32 v93, v186, v187
    v_cvt_pk_bf16_f32 v94, v188, v189
    v_cvt_pk_bf16_f32 v95, v190, v191
    s_add_u32 s68, s68, 3072
    buffer_load_dwordx4 v241, s[16:19], s68 offen offset:2048 nt lds
    v_add_f32 v235, v250, v251
    v_add_f32 v236, v252, v253
    v_add_f32 v237, v238, v239
    v_mov_b32 v228, v235
    v_mov_b32 v229, v236
    v_mov_b32 v230, v237
    v_permlane32_swap_b32 v228, v235
    v_permlane32_swap_b32 v229, v236
    v_permlane32_swap_b32 v230, v237
    v_add_f32 v235, v228, v235
    v_add_f32 v236, v229, v236
    v_add_f32 v237, v230, v237
    v_mov_b32 v228, v235
    v_mov_b32 v229, v236
    v_mov_b32 v230, v237
    v_permlane16_swap_b32 v228, v235
    v_permlane16_swap_b32 v229, v236
    v_permlane16_swap_b32 v230, v237
    v_add_f32 v235, v228, v235
    v_add_f32 v236, v229, v236
    v_add_f32 v237, v230, v237
    s_lshl_b32 s48, s40, 11
    s_add_u32 s48, s48, 114688
    v_add_u32 v228, s48, v248
    v_xor_b32 v238, 4096, v228
    ds_write_b128 v228, v[232:235]
    ds_write_b64 v228, v[236:237] offset:1024
    v_add_u32 v224, 16384, v247
    v_xor_b32 v225, 32, v224
    v_xor_b32 v226, 64, v224
    v_xor_b32 v227, 96, v224
    v_xor_b32 v228, 128, v224
    v_xor_b32 v229, 160, v224
    v_xor_b32 v230, 192, v224
    v_xor_b32 v231, 224, v224
    s_waitcnt vmcnt(24) lgkmcnt(0)
    s_barrier
    ds_read_b64_tr_b16 v[192:193], v224 offset:0
    ds_read_b64_tr_b16 v[194:195], v224 offset:4096
    ds_read_b128 a[240:243], v238
    ds_read_b64 a[244:245], v238 offset:1024
    ds_read_b64_tr_b16 v[196:197], v225 offset:0
    ds_read_b64_tr_b16 v[198:199], v225 offset:4096
    ds_read_b64_tr_b16 v[200:201], v226 offset:0
    ds_read_b64_tr_b16 v[202:203], v226 offset:4096
    ds_read_b64_tr_b16 v[204:205], v227 offset:0
    ds_read_b64_tr_b16 v[206:207], v227 offset:4096
    ds_read_b64_tr_b16 v[208:209], v228 offset:0
    ds_read_b64_tr_b16 v[210:211], v228 offset:4096
    s_waitcnt lgkmcnt(8)
    v_mfma_f32_16x16x32_bf16 v[96:99], v[192:195], v[0:3], 0
    s_add_u32 s68, s68, 3072
    buffer_load_dwordx4 v244, s[16:19], s68 offen offset:3072 nt lds
    v_mfma_f32_16x16x32_bf16 v[100:103], v[192:195], v[4:7], 0
    ds_read_b64_tr_b16 v[212:213], v229 offset:0
    ds_read_b64_tr_b16 v[214:215], v229 offset:4096
    v_mfma_f32_16x16x32_bf16 v[104:107], v[192:195], v[8:11], 0
    s_waitcnt lgkmcnt(8)
    v_mfma_f32_16x16x32_bf16 v[108:111], v[196:199], v[0:3], 0
    v_mfma_f32_16x16x32_bf16 v[112:115], v[196:199], v[4:7], 0
    ds_read_b64_tr_b16 v[216:217], v230 offset:0
    ds_read_b64_tr_b16 v[218:219], v230 offset:4096
    v_mfma_f32_16x16x32_bf16 v[116:119], v[196:199], v[8:11], 0
    s_waitcnt lgkmcnt(8)
    v_mfma_f32_16x16x32_bf16 v[120:123], v[200:203], v[0:3], 0
    v_mfma_f32_16x16x32_bf16 v[124:127], v[200:203], v[4:7], 0
    ds_read_b64_tr_b16 v[220:221], v231 offset:0
    ds_read_b64_tr_b16 v[222:223], v231 offset:4096
    v_mfma_f32_16x16x32_bf16 v[128:131], v[200:203], v[8:11], 0
    s_waitcnt lgkmcnt(8)
    v_mfma_f32_16x16x32_bf16 v[132:135], v[204:207], v[0:3], 0
    v_add_u32 v224, 147456, v245
    v_xor_b32 v225, 32, v224
    v_mfma_f32_16x16x32_bf16 v[136:139], v[204:207], v[4:7], 0
    v_xor_b32 v226, 64, v224
    v_xor_b32 v227, 96, v224
    v_mfma_f32_16x16x32_bf16 v[140:143], v[204:207], v[8:11], 0
    s_add_u32 m0, s59, 98304
    s_add_u32 s69, s53, 2
    s_and_b32 s69, s69, 7
    s_lshl_b32 s68, s69, 19
    s_add_u32 s68, s68, s54
    s_add_u32 s68, s68, 256
    buffer_load_dwordx4 v242, s[20:23], s68 offen offset:0  lds
    s_waitcnt lgkmcnt(6)
    v_mfma_f32_16x16x32_bf16 v[144:147], v[208:211], v[0:3], 0
    v_mfma_f32_16x16x32_bf16 v[148:151], v[208:211], v[4:7], 0
    v_mfma_f32_16x16x32_bf16 v[152:155], v[208:211], v[8:11], 0
    s_waitcnt vmcnt(13) lgkmcnt(0)
    s_barrier
    v_mfma_f32_16x16x32_bf16 v[156:159], v[212:215], v[0:3], 0
    ds_read_b64_tr_b16 v[192:193], v224 offset:0
    ds_read_b64_tr_b16 v[194:195], v224 offset:1024
    v_mfma_f32_16x16x32_bf16 v[160:163], v[212:215], v[4:7], 0
    ds_read_b64_tr_b16 v[196:197], v225 offset:0
    ds_read_b64_tr_b16 v[198:199], v225 offset:1024
    v_mfma_f32_16x16x32_bf16 v[164:167], v[212:215], v[8:11], 0
    ds_read_b64_tr_b16 v[200:201], v226 offset:0
    ds_read_b64_tr_b16 v[202:203], v226 offset:1024
    v_mfma_f32_16x16x32_bf16 v[168:171], v[216:219], v[0:3], 0
    ds_read_b64_tr_b16 v[204:205], v227 offset:0
    ds_read_b64_tr_b16 v[206:207], v227 offset:1024
    v_mfma_f32_16x16x32_bf16 v[172:175], v[216:219], v[4:7], 0
    ds_read_b64_tr_b16 v[208:209], v224 offset:8192
    ds_read_b64_tr_b16 v[210:211], v224 offset:9216
    v_mfma_f32_16x16x32_bf16 v[176:179], v[216:219], v[8:11], 0
    s_add_u32 s68, s68, 31744
    buffer_load_dwordx4 v242, s[20:23], s68 offen offset:1024  lds
    v_mfma_f32_16x16x32_bf16 v[180:183], v[220:223], v[0:3], 0
    v_mfma_f32_16x16x32_bf16 v[184:187], v[220:223], v[4:7], 0
    v_mfma_f32_16x16x32_bf16 v[188:191], v[220:223], v[8:11], 0
    v_accvgpr_read_b32 v238, a240
    v_accvgpr_read_b32 v239, a243
    v_max_f32 v249, v238, v232
    v_sub_f32 v252, v238, v249
    v_sub_f32 v249, v232, v249
    v_exp_f32 v252, v252
    v_exp_f32 v249, v249
    v_mul_f32 v239, v239, v252
    v_fma_f32 v239, v235, v249, v239
    v_rcp_f32 v239, v239
    s_nop 0
    v_mul_f32 v249, v249, v239
    v_mul_f32 v252, v252, v239
    v_accvgpr_read_b32 v238, a241
    v_accvgpr_read_b32 v239, a244
    v_max_f32 v250, v238, v233
    v_sub_f32 v253, v238, v250
    v_sub_f32 v250, v233, v250
    v_exp_f32 v253, v253
    v_exp_f32 v250, v250
    v_mul_f32 v239, v239, v253
    v_fma_f32 v239, v236, v250, v239
    v_rcp_f32 v239, v239
    s_nop 0
    v_mul_f32 v250, v250, v239
    v_mul_f32 v253, v253, v239
    v_accvgpr_read_b32 v238, a242
    v_accvgpr_read_b32 v239, a245
    v_max_f32 v251, v238, v234
    v_sub_f32 v254, v238, v251
    v_sub_f32 v251, v234, v251
    v_exp_f32 v254, v254
    v_exp_f32 v251, v251
    s_add_u32 s68, s68, 31744
    v_xor_b32 v244, 128, v242
    buffer_load_dwordx4 v244, s[20:23], s68 offen offset:2048  lds
    v_mul_f32 v239, v239, v254
    v_fma_f32 v239, v237, v251, v239
    v_rcp_f32 v239, v239
    s_nop 0
    v_mul_f32 v251, v251, v239
    v_mul_f32 v254, v254, v239
    s_waitcnt lgkmcnt(8)
    v_mfma_f32_16x16x32_bf16 a[96:99], v[192:195], a[0:3], 0
    v_mfma_f32_16x16x32_bf16 a[100:103], v[192:195], a[4:7], 0
    ds_read_b64_tr_b16 v[212:213], v225 offset:8192
    ds_read_b64_tr_b16 v[214:215], v225 offset:9216
    v_mfma_f32_16x16x32_bf16 a[104:107], v[192:195], a[8:11], 0
    s_waitcnt lgkmcnt(8)
    v_mfma_f32_16x16x32_bf16 a[108:111], v[196:199], a[0:3], 0
    v_mfma_f32_16x16x32_bf16 a[112:115], v[196:199], a[4:7], 0
    ds_read_b64_tr_b16 v[216:217], v226 offset:8192
    ds_read_b64_tr_b16 v[218:219], v226 offset:9216
    v_mfma_f32_16x16x32_bf16 a[116:119], v[196:199], a[8:11], 0
    s_waitcnt lgkmcnt(8)
    v_mfma_f32_16x16x32_bf16 a[120:123], v[200:203], a[0:3], 0
    v_mfma_f32_16x16x32_bf16 a[124:127], v[200:203], a[4:7], 0
    ds_read_b64_tr_b16 v[220:221], v227 offset:8192
    ds_read_b64_tr_b16 v[222:223], v227 offset:9216
    v_mfma_f32_16x16x32_bf16 a[128:131], v[200:203], a[8:11], 0
    s_waitcnt lgkmcnt(8)
    v_mfma_f32_16x16x32_bf16 a[132:135], v[204:207], a[0:3], 0
    v_add_u32 v224, 32768, v247
    s_add_u32 s68, s68, 31744
    buffer_load_dwordx4 v244, s[20:23], s68 offen offset:3072  lds
    v_xor_b32 v225, 32, v224
    v_mfma_f32_16x16x32_bf16 a[136:139], v[204:207], a[4:7], 0
    v_xor_b32 v226, 64, v224
    v_xor_b32 v227, 96, v224
    v_mfma_f32_16x16x32_bf16 a[140:143], v[204:207], a[8:11], 0
    v_xor_b32 v228, 128, v224
    v_xor_b32 v229, 160, v224
    s_waitcnt lgkmcnt(6)
    v_mfma_f32_16x16x32_bf16 a[96:99], v[208:211], a[12:15], a[96:99]
    v_xor_b32 v230, 192, v224
    v_xor_b32 v231, 224, v224
    v_mfma_f32_16x16x32_bf16 a[100:103], v[208:211], a[16:19], a[100:103]
    v_mfma_f32_16x16x32_bf16 a[104:107], v[208:211], a[20:23], a[104:107]
    s_waitcnt lgkmcnt(0)
    s_barrier
    v_mfma_f32_16x16x32_bf16 a[108:111], v[212:215], a[12:15], a[108:111]
    ds_read_b64_tr_b16 v[192:193], v224 offset:0
    ds_read_b64_tr_b16 v[194:195], v224 offset:4096
    s_add_u32 m0, s59, 0
    s_add_u32 s68, s46, 81920
    buffer_load_dwordx4 v241, s[16:19], s68 offen offset:0 nt lds
    v_mfma_f32_16x16x32_bf16 a[112:115], v[212:215], a[16:19], a[112:115]
    ds_read_b64_tr_b16 v[196:197], v225 offset:0
    ds_read_b64_tr_b16 v[198:199], v225 offset:4096
    v_mfma_f32_16x16x32_bf16 a[116:119], v[212:215], a[20:23], a[116:119]
    ds_read_b64_tr_b16 v[200:201], v226 offset:0
    ds_read_b64_tr_b16 v[202:203], v226 offset:4096
    v_mfma_f32_16x16x32_bf16 a[120:123], v[216:219], a[12:15], a[120:123]
    ds_read_b64_tr_b16 v[204:205], v227 offset:0
    ds_read_b64_tr_b16 v[206:207], v227 offset:4096
    v_mfma_f32_16x16x32_bf16 a[124:127], v[216:219], a[16:19], a[124:127]
    ds_read_b64_tr_b16 v[208:209], v228 offset:0
    ds_read_b64_tr_b16 v[210:211], v228 offset:4096
    s_add_u32 s68, s68, 3072
    v_xor_b32 v244, 128, v241
    buffer_load_dwordx4 v244, s[16:19], s68 offen offset:1024 nt lds
    v_mfma_f32_16x16x32_bf16 a[128:131], v[216:219], a[20:23], a[128:131]
    v_mfma_f32_16x16x32_bf16 a[132:135], v[220:223], a[12:15], a[132:135]
    v_mfma_f32_16x16x32_bf16 a[136:139], v[220:223], a[16:19], a[136:139]
    v_mfma_f32_16x16x32_bf16 a[140:143], v[220:223], a[20:23], a[140:143]
    s_add_u32 s68, s68, 3072
    buffer_load_dwordx4 v241, s[16:19], s68 offen offset:2048 nt lds
    s_waitcnt lgkmcnt(8)
    v_mfma_f32_16x16x32_bf16 v[96:99], v[192:195], v[12:15], v[96:99]
    v_mfma_f32_16x16x32_bf16 v[100:103], v[192:195], v[16:19], v[100:103]
    ds_read_b64_tr_b16 v[212:213], v229 offset:0
    ds_read_b64_tr_b16 v[214:215], v229 offset:4096
    v_mfma_f32_16x16x32_bf16 v[104:107], v[192:195], v[20:23], v[104:107]
    s_waitcnt lgkmcnt(8)
    v_mfma_f32_16x16x32_bf16 v[108:111], v[196:199], v[12:15], v[108:111]
    s_add_u32 s68, s68, 3072
    buffer_load_dwordx4 v244, s[16:19], s68 offen offset:3072 nt lds
    v_mfma_f32_16x16x32_bf16 v[112:115], v[196:199], v[16:19], v[112:115]
    ds_read_b64_tr_b16 v[216:217], v230 offset:0
    ds_read_b64_tr_b16 v[218:219], v230 offset:4096
    v_mfma_f32_16x16x32_bf16 v[116:119], v[196:199], v[20:23], v[116:119]
    s_waitcnt lgkmcnt(8)
    v_mfma_f32_16x16x32_bf16 v[120:123], v[200:203], v[12:15], v[120:123]
    v_mfma_f32_16x16x32_bf16 v[124:127], v[200:203], v[16:19], v[124:127]
    ds_read_b64_tr_b16 v[220:221], v231 offset:0
    ds_read_b64_tr_b16 v[222:223], v231 offset:4096
    v_mfma_f32_16x16x32_bf16 v[128:131], v[200:203], v[20:23], v[128:131]
    s_waitcnt lgkmcnt(8)
    v_mfma_f32_16x16x32_bf16 v[132:135], v[204:207], v[12:15], v[132:135]
    v_add_u32 v224, 131072, v245
    v_xor_b32 v225, 32, v224
    v_mfma_f32_16x16x32_bf16 v[136:139], v[204:207], v[16:19], v[136:139]
    v_xor_b32 v226, 64, v224
    v_xor_b32 v227, 96, v224
    v_mfma_f32_16x16x32_bf16 v[140:143], v[204:207], v[20:23], v[140:143]
    s_waitcnt lgkmcnt(6)
    v_mfma_f32_16x16x32_bf16 v[144:147], v[208:211], v[12:15], v[144:147]
    v_mfma_f32_16x16x32_bf16 v[148:151], v[208:211], v[16:19], v[148:151]
    v_mfma_f32_16x16x32_bf16 v[152:155], v[208:211], v[20:23], v[152:155]
    s_waitcnt vmcnt(12) lgkmcnt(0)
    s_barrier
    v_mfma_f32_16x16x32_bf16 v[156:159], v[212:215], v[12:15], v[156:159]
    ds_read_b64_tr_b16 v[192:193], v224 offset:0
    ds_read_b64_tr_b16 v[194:195], v224 offset:1024
    s_add_u32 m0, s59, 147456
    s_add_u32 s69, s53, 3
    s_and_b32 s69, s69, 7
    s_lshl_b32 s68, s69, 19
    s_add_u32 s68, s68, s54
    s_add_u32 s68, s68, 256
    buffer_load_dwordx4 v242, s[20:23], s68 offen offset:0  lds
    v_mfma_f32_16x16x32_bf16 v[160:163], v[212:215], v[16:19], v[160:163]
    ds_read_b64_tr_b16 v[196:197], v225 offset:0
    ds_read_b64_tr_b16 v[198:199], v225 offset:1024
    v_mfma_f32_16x16x32_bf16 v[164:167], v[212:215], v[20:23], v[164:167]
    ds_read_b64_tr_b16 v[200:201], v226 offset:0
    ds_read_b64_tr_b16 v[202:203], v226 offset:1024
    v_mfma_f32_16x16x32_bf16 v[168:171], v[216:219], v[12:15], v[168:171]
    ds_read_b64_tr_b16 v[204:205], v227 offset:0
    ds_read_b64_tr_b16 v[206:207], v227 offset:1024
    s_add_u32 s68, s68, 31744
    buffer_load_dwordx4 v242, s[20:23], s68 offen offset:1024  lds
    v_mfma_f32_16x16x32_bf16 v[172:175], v[216:219], v[16:19], v[172:175]
    ds_read_b64_tr_b16 v[208:209], v224 offset:8192
    ds_read_b64_tr_b16 v[210:211], v224 offset:9216
    v_mfma_f32_16x16x32_bf16 v[176:179], v[216:219], v[20:23], v[176:179]
    v_mfma_f32_16x16x32_bf16 v[180:183], v[220:223], v[12:15], v[180:183]
    s_add_u32 s68, s68, 31744
    v_xor_b32 v244, 128, v242
    buffer_load_dwordx4 v244, s[20:23], s68 offen offset:2048  lds
    v_mfma_f32_16x16x32_bf16 v[184:187], v[220:223], v[16:19], v[184:187]
    v_mfma_f32_16x16x32_bf16 v[188:191], v[220:223], v[20:23], v[188:191]
    s_waitcnt lgkmcnt(8)
    v_mfma_f32_16x16x32_bf16 a[96:99], v[192:195], a[24:27], a[96:99]
    v_mfma_f32_16x16x32_bf16 a[100:103], v[192:195], a[28:31], a[100:103]
    ds_read_b64_tr_b16 v[212:213], v225 offset:8192
    ds_read_b64_tr_b16 v[214:215], v225 offset:9216
    s_add_u32 s68, s68, 31744
    buffer_load_dwordx4 v244, s[20:23], s68 offen offset:3072  lds
    v_mfma_f32_16x16x32_bf16 a[104:107], v[192:195], a[32:35], a[104:107]
    s_waitcnt lgkmcnt(8)
    v_mfma_f32_16x16x32_bf16 a[108:111], v[196:199], a[24:27], a[108:111]
    v_mfma_f32_16x16x32_bf16 a[112:115], v[196:199], a[28:31], a[112:115]
    ds_read_b64_tr_b16 v[216:217], v226 offset:8192
    ds_read_b64_tr_b16 v[218:219], v226 offset:9216
    v_mfma_f32_16x16x32_bf16 a[116:119], v[196:199], a[32:35], a[116:119]
    s_waitcnt lgkmcnt(8)
    v_mfma_f32_16x16x32_bf16 a[120:123], v[200:203], a[24:27], a[120:123]
    v_mfma_f32_16x16x32_bf16 a[124:127], v[200:203], a[28:31], a[124:127]
    ds_read_b64_tr_b16 v[220:221], v227 offset:8192
    ds_read_b64_tr_b16 v[222:223], v227 offset:9216
    v_mfma_f32_16x16x32_bf16 a[128:131], v[200:203], a[32:35], a[128:131]
    s_waitcnt lgkmcnt(8)
    v_mfma_f32_16x16x32_bf16 a[132:135], v[204:207], a[24:27], a[132:135]
    v_add_u32 v224, 49152, v247
    v_xor_b32 v225, 32, v224
    v_mfma_f32_16x16x32_bf16 a[136:139], v[204:207], a[28:31], a[136:139]
    v_xor_b32 v226, 64, v224
    v_xor_b32 v227, 96, v224
    v_mfma_f32_16x16x32_bf16 a[140:143], v[204:207], a[32:35], a[140:143]
    v_xor_b32 v228, 128, v224
    v_xor_b32 v229, 160, v224
    s_waitcnt lgkmcnt(6)
    v_mfma_f32_16x16x32_bf16 a[96:99], v[208:211], a[36:39], a[96:99]
    v_xor_b32 v230, 192, v224
    v_xor_b32 v231, 224, v224
    v_mfma_f32_16x16x32_bf16 a[100:103], v[208:211], a[40:43], a[100:103]
    v_mfma_f32_16x16x32_bf16 a[104:107], v[208:211], a[44:47], a[104:107]
    s_waitcnt lgkmcnt(0)
    s_barrier
    v_mfma_f32_16x16x32_bf16 a[108:111], v[212:215], a[36:39], a[108:111]
    ds_read_b64_tr_b16 v[192:193], v224 offset:0
    ds_read_b64_tr_b16 v[194:195], v224 offset:4096
    s_add_u32 m0, s59, 16384
    s_add_u32 s68, s46, 98304
    buffer_load_dwordx4 v241, s[16:19], s68 offen offset:0 nt lds
    v_mfma_f32_16x16x32_bf16 a[112:115], v[212:215], a[40:43], a[112:115]
    ds_read_b64_tr_b16 v[196:197], v225 offset:0
    ds_read_b64_tr_b16 v[198:199], v225 offset:4096
    v_mfma_f32_16x16x32_bf16 a[116:119], v[212:215], a[44:47], a[116:119]
    ds_read_b64_tr_b16 v[200:201], v226 offset:0
    ds_read_b64_tr_b16 v[202:203], v226 offset:4096
    v_mfma_f32_16x16x32_bf16 a[120:123], v[216:219], a[36:39], a[120:123]
    ds_read_b64_tr_b16 v[204:205], v227 offset:0
    ds_read_b64_tr_b16 v[206:207], v227 offset:4096
    v_mfma_f32_16x16x32_bf16 a[124:127], v[216:219], a[40:43], a[124:127]
    ds_read_b64_tr_b16 v[208:209], v228 offset:0
    ds_read_b64_tr_b16 v[210:211], v228 offset:4096
    s_add_u32 s68, s68, 3072
    v_xor_b32 v244, 128, v241
    buffer_load_dwordx4 v244, s[16:19], s68 offen offset:1024 nt lds
    v_mfma_f32_16x16x32_bf16 a[128:131], v[216:219], a[44:47], a[128:131]
    v_mfma_f32_16x16x32_bf16 a[132:135], v[220:223], a[36:39], a[132:135]
    v_mfma_f32_16x16x32_bf16 a[136:139], v[220:223], a[40:43], a[136:139]
    v_mfma_f32_16x16x32_bf16 a[140:143], v[220:223], a[44:47], a[140:143]
    s_add_u32 s68, s68, 3072
    buffer_load_dwordx4 v241, s[16:19], s68 offen offset:2048 nt lds
    s_waitcnt lgkmcnt(8)
    v_mfma_f32_16x16x32_bf16 v[96:99], v[192:195], v[24:27], v[96:99]
    v_mfma_f32_16x16x32_bf16 v[100:103], v[192:195], v[28:31], v[100:103]
    ds_read_b64_tr_b16 v[212:213], v229 offset:0
    ds_read_b64_tr_b16 v[214:215], v229 offset:4096
    v_mfma_f32_16x16x32_bf16 v[104:107], v[192:195], v[32:35], v[104:107]
    s_waitcnt lgkmcnt(8)
    v_mfma_f32_16x16x32_bf16 v[108:111], v[196:199], v[24:27], v[108:111]
    s_add_u32 s68, s68, 3072
    buffer_load_dwordx4 v244, s[16:19], s68 offen offset:3072 nt lds
    v_mfma_f32_16x16x32_bf16 v[112:115], v[196:199], v[28:31], v[112:115]
    ds_read_b64_tr_b16 v[216:217], v230 offset:0
    ds_read_b64_tr_b16 v[218:219], v230 offset:4096
    v_mfma_f32_16x16x32_bf16 v[116:119], v[196:199], v[32:35], v[116:119]
    s_waitcnt lgkmcnt(8)
    v_mfma_f32_16x16x32_bf16 v[120:123], v[200:203], v[24:27], v[120:123]
    v_mfma_f32_16x16x32_bf16 v[124:127], v[200:203], v[28:31], v[124:127]
    ds_read_b64_tr_b16 v[220:221], v231 offset:0
    ds_read_b64_tr_b16 v[222:223], v231 offset:4096
    v_mfma_f32_16x16x32_bf16 v[128:131], v[200:203], v[32:35], v[128:131]
    s_waitcnt lgkmcnt(8)
    v_mfma_f32_16x16x32_bf16 v[132:135], v[204:207], v[24:27], v[132:135]
    v_add_u32 v224, 98304, v245
    v_xor_b32 v225, 32, v224
    v_mfma_f32_16x16x32_bf16 v[136:139], v[204:207], v[28:31], v[136:139]
    v_xor_b32 v226, 64, v224
    v_xor_b32 v227, 96, v224
    v_mfma_f32_16x16x32_bf16 v[140:143], v[204:207], v[32:35], v[140:143]
    s_waitcnt lgkmcnt(6)
    v_mfma_f32_16x16x32_bf16 v[144:147], v[208:211], v[24:27], v[144:147]
    v_mfma_f32_16x16x32_bf16 v[148:151], v[208:211], v[28:31], v[148:151]
    v_mfma_f32_16x16x32_bf16 v[152:155], v[208:211], v[32:35], v[152:155]
    s_waitcnt vmcnt(12) lgkmcnt(0)
    s_barrier
    v_mfma_f32_16x16x32_bf16 v[156:159], v[212:215], v[24:27], v[156:159]
    ds_read_b64_tr_b16 v[192:193], v224 offset:0
    ds_read_b64_tr_b16 v[194:195], v224 offset:1024
    s_add_u32 m0, s59, 131072
    s_add_u32 s69, s53, 4
    s_and_b32 s69, s69, 7
    s_lshl_b32 s68, s69, 19
    s_add_u32 s68, s68, s54
    s_add_u32 s68, s68, 256
    buffer_load_dwordx4 v242, s[20:23], s68 offen offset:0  lds
    v_mfma_f32_16x16x32_bf16 v[160:163], v[212:215], v[28:31], v[160:163]
    ds_read_b64_tr_b16 v[196:197], v225 offset:0
    ds_read_b64_tr_b16 v[198:199], v225 offset:1024
    v_mfma_f32_16x16x32_bf16 v[164:167], v[212:215], v[32:35], v[164:167]
    ds_read_b64_tr_b16 v[200:201], v226 offset:0
    ds_read_b64_tr_b16 v[202:203], v226 offset:1024
    v_mfma_f32_16x16x32_bf16 v[168:171], v[216:219], v[24:27], v[168:171]
    ds_read_b64_tr_b16 v[204:205], v227 offset:0
    ds_read_b64_tr_b16 v[206:207], v227 offset:1024
    s_add_u32 s68, s68, 31744
    buffer_load_dwordx4 v242, s[20:23], s68 offen offset:1024  lds
    v_mfma_f32_16x16x32_bf16 v[172:175], v[216:219], v[28:31], v[172:175]
    ds_read_b64_tr_b16 v[208:209], v224 offset:8192
    ds_read_b64_tr_b16 v[210:211], v224 offset:9216
    v_mfma_f32_16x16x32_bf16 v[176:179], v[216:219], v[32:35], v[176:179]
    v_mfma_f32_16x16x32_bf16 v[180:183], v[220:223], v[24:27], v[180:183]
    s_add_u32 s68, s68, 31744
    v_xor_b32 v244, 128, v242
    buffer_load_dwordx4 v244, s[20:23], s68 offen offset:2048  lds
    v_mfma_f32_16x16x32_bf16 v[184:187], v[220:223], v[28:31], v[184:187]
    v_mfma_f32_16x16x32_bf16 v[188:191], v[220:223], v[32:35], v[188:191]
    s_waitcnt lgkmcnt(8)
    v_mfma_f32_16x16x32_bf16 a[96:99], v[192:195], a[48:51], a[96:99]
    v_mfma_f32_16x16x32_bf16 a[100:103], v[192:195], a[52:55], a[100:103]
    ds_read_b64_tr_b16 v[212:213], v225 offset:8192
    ds_read_b64_tr_b16 v[214:215], v225 offset:9216
    s_add_u32 s68, s68, 31744
    buffer_load_dwordx4 v244, s[20:23], s68 offen offset:3072  lds
    v_mfma_f32_16x16x32_bf16 a[104:107], v[192:195], a[56:59], a[104:107]
    s_waitcnt lgkmcnt(8)
    v_mfma_f32_16x16x32_bf16 a[108:111], v[196:199], a[48:51], a[108:111]
    v_mfma_f32_16x16x32_bf16 a[112:115], v[196:199], a[52:55], a[112:115]
    ds_read_b64_tr_b16 v[216:217], v226 offset:8192
    ds_read_b64_tr_b16 v[218:219], v226 offset:9216
    v_mfma_f32_16x16x32_bf16 a[116:119], v[196:199], a[56:59], a[116:119]
    s_waitcnt lgkmcnt(8)
    v_mfma_f32_16x16x32_bf16 a[120:123], v[200:203], a[48:51], a[120:123]
    v_mfma_f32_16x16x32_bf16 a[124:127], v[200:203], a[52:55], a[124:127]
    ds_read_b64_tr_b16 v[220:221], v227 offset:8192
    ds_read_b64_tr_b16 v[222:223], v227 offset:9216
    v_mfma_f32_16x16x32_bf16 a[128:131], v[200:203], a[56:59], a[128:131]
    s_waitcnt lgkmcnt(8)
    v_mfma_f32_16x16x32_bf16 a[132:135], v[204:207], a[48:51], a[132:135]
    v_add_u32 v224, 65536, v247
    v_xor_b32 v225, 32, v224
    v_mfma_f32_16x16x32_bf16 a[136:139], v[204:207], a[52:55], a[136:139]
    v_xor_b32 v226, 64, v224
    v_xor_b32 v227, 96, v224
    v_mfma_f32_16x16x32_bf16 a[140:143], v[204:207], a[56:59], a[140:143]
    v_xor_b32 v228, 128, v224
    v_xor_b32 v229, 160, v224
    s_waitcnt lgkmcnt(6)
    v_mfma_f32_16x16x32_bf16 a[96:99], v[208:211], a[60:63], a[96:99]
    v_xor_b32 v230, 192, v224
    v_xor_b32 v231, 224, v224
    v_mfma_f32_16x16x32_bf16 a[100:103], v[208:211], a[64:67], a[100:103]
    v_mfma_f32_16x16x32_bf16 a[104:107], v[208:211], a[68:71], a[104:107]
    s_waitcnt lgkmcnt(0)
    s_barrier
    v_mfma_f32_16x16x32_bf16 a[108:111], v[212:215], a[60:63], a[108:111]
    ds_read_b64_tr_b16 v[192:193], v224 offset:0
    ds_read_b64_tr_b16 v[194:195], v224 offset:4096
    s_add_u32 m0, s59, 32768
    s_add_u32 s68, s46, 114688
    buffer_load_dwordx4 v241, s[16:19], s68 offen offset:0 nt lds
    v_mfma_f32_16x16x32_bf16 a[112:115], v[212:215], a[64:67], a[112:115]
    ds_read_b64_tr_b16 v[196:197], v225 offset:0
    ds_read_b64_tr_b16 v[198:199], v225 offset:4096
    v_mfma_f32_16x16x32_bf16 a[116:119], v[212:215], a[68:71], a[116:119]
    ds_read_b64_tr_b16 v[200:201], v226 offset:0
    ds_read_b64_tr_b16 v[202:203], v226 offset:4096
    v_mfma_f32_16x16x32_bf16 a[120:123], v[216:219], a[60:63], a[120:123]
    ds_read_b64_tr_b16 v[204:205], v227 offset:0
    ds_read_b64_tr_b16 v[206:207], v227 offset:4096
    v_mfma_f32_16x16x32_bf16 a[124:127], v[216:219], a[64:67], a[124:127]
    ds_read_b64_tr_b16 v[208:209], v228 offset:0
    ds_read_b64_tr_b16 v[210:211], v228 offset:4096
    s_add_u32 s68, s68, 3072
    v_xor_b32 v244, 128, v241
    buffer_load_dwordx4 v244, s[16:19], s68 offen offset:1024 nt lds
    v_mfma_f32_16x16x32_bf16 a[128:131], v[216:219], a[68:71], a[128:131]
    v_mfma_f32_16x16x32_bf16 a[132:135], v[220:223], a[60:63], a[132:135]
    v_mfma_f32_16x16x32_bf16 a[136:139], v[220:223], a[64:67], a[136:139]
    v_mfma_f32_16x16x32_bf16 a[140:143], v[220:223], a[68:71], a[140:143]
    s_add_u32 s68, s68, 3072
    buffer_load_dwordx4 v241, s[16:19], s68 offen offset:2048 nt lds
    s_waitcnt lgkmcnt(8)
    v_mfma_f32_16x16x32_bf16 v[96:99], v[192:195], v[36:39], v[96:99]
    v_mfma_f32_16x16x32_bf16 v[100:103], v[192:195], v[40:43], v[100:103]
    ds_read_b64_tr_b16 v[212:213], v229 offset:0
    ds_read_b64_tr_b16 v[214:215], v229 offset:4096
    v_mfma_f32_16x16x32_bf16 v[104:107], v[192:195], v[44:47], v[104:107]
    s_waitcnt lgkmcnt(8)
    v_mfma_f32_16x16x32_bf16 v[108:111], v[196:199], v[36:39], v[108:111]
    s_add_u32 s68, s68, 3072
    buffer_load_dwordx4 v244, s[16:19], s68 offen offset:3072 nt lds
    v_mfma_f32_16x16x32_bf16 v[112:115], v[196:199], v[40:43], v[112:115]
    ds_read_b64_tr_b16 v[216:217], v230 offset:0
    ds_read_b64_tr_b16 v[218:219], v230 offset:4096
    v_mfma_f32_16x16x32_bf16 v[116:119], v[196:199], v[44:47], v[116:119]
    s_waitcnt lgkmcnt(8)
    v_mfma_f32_16x16x32_bf16 v[120:123], v[200:203], v[36:39], v[120:123]
    v_mfma_f32_16x16x32_bf16 v[124:127], v[200:203], v[40:43], v[124:127]
    ds_read_b64_tr_b16 v[220:221], v231 offset:0
    ds_read_b64_tr_b16 v[222:223], v231 offset:4096
    v_mfma_f32_16x16x32_bf16 v[128:131], v[200:203], v[44:47], v[128:131]
    s_waitcnt lgkmcnt(8)
    v_mfma_f32_16x16x32_bf16 v[132:135], v[204:207], v[36:39], v[132:135]
    v_add_u32 v224, 147456, v245
    v_xor_b32 v225, 32, v224
    v_mfma_f32_16x16x32_bf16 v[136:139], v[204:207], v[40:43], v[136:139]
    v_xor_b32 v226, 64, v224
    v_xor_b32 v227, 96, v224
    v_mfma_f32_16x16x32_bf16 v[140:143], v[204:207], v[44:47], v[140:143]
    s_waitcnt lgkmcnt(6)
    v_mfma_f32_16x16x32_bf16 v[144:147], v[208:211], v[36:39], v[144:147]
    v_mfma_f32_16x16x32_bf16 v[148:151], v[208:211], v[40:43], v[148:151]
    v_mfma_f32_16x16x32_bf16 v[152:155], v[208:211], v[44:47], v[152:155]
    s_waitcnt vmcnt(12) lgkmcnt(0)
    s_barrier
    v_mfma_f32_16x16x32_bf16 v[156:159], v[212:215], v[36:39], v[156:159]
    ds_read_b64_tr_b16 v[192:193], v224 offset:0
    ds_read_b64_tr_b16 v[194:195], v224 offset:1024
    s_add_u32 m0, s59, 49152
    s_add_u32 s69, s53, 5
    s_and_b32 s69, s69, 7
    s_lshl_b32 s68, s69, 19
    s_add_u32 s68, s68, s54
    s_add_u32 s68, s68, 256
    buffer_load_dwordx4 v242, s[20:23], s68 offen offset:0  lds
    v_mfma_f32_16x16x32_bf16 v[160:163], v[212:215], v[40:43], v[160:163]
    ds_read_b64_tr_b16 v[196:197], v225 offset:0
    ds_read_b64_tr_b16 v[198:199], v225 offset:1024
    v_mfma_f32_16x16x32_bf16 v[164:167], v[212:215], v[44:47], v[164:167]
    ds_read_b64_tr_b16 v[200:201], v226 offset:0
    ds_read_b64_tr_b16 v[202:203], v226 offset:1024
    v_mfma_f32_16x16x32_bf16 v[168:171], v[216:219], v[36:39], v[168:171]
    ds_read_b64_tr_b16 v[204:205], v227 offset:0
    ds_read_b64_tr_b16 v[206:207], v227 offset:1024
    s_add_u32 s68, s68, 31744
    buffer_load_dwordx4 v242, s[20:23], s68 offen offset:1024  lds
    v_mfma_f32_16x16x32_bf16 v[172:175], v[216:219], v[40:43], v[172:175]
    ds_read_b64_tr_b16 v[208:209], v224 offset:8192
    ds_read_b64_tr_b16 v[210:211], v224 offset:9216
    v_mfma_f32_16x16x32_bf16 v[176:179], v[216:219], v[44:47], v[176:179]
    v_mfma_f32_16x16x32_bf16 v[180:183], v[220:223], v[36:39], v[180:183]
    s_add_u32 s68, s68, 31744
    v_xor_b32 v244, 128, v242
    buffer_load_dwordx4 v244, s[20:23], s68 offen offset:2048  lds
    v_mfma_f32_16x16x32_bf16 v[184:187], v[220:223], v[40:43], v[184:187]
    v_mfma_f32_16x16x32_bf16 v[188:191], v[220:223], v[44:47], v[188:191]
    s_waitcnt lgkmcnt(8)
    v_mfma_f32_16x16x32_bf16 a[96:99], v[192:195], a[72:75], a[96:99]
    v_mfma_f32_16x16x32_bf16 a[100:103], v[192:195], a[76:79], a[100:103]
    ds_read_b64_tr_b16 v[212:213], v225 offset:8192
    ds_read_b64_tr_b16 v[214:215], v225 offset:9216
    s_add_u32 s68, s68, 31744
    buffer_load_dwordx4 v244, s[20:23], s68 offen offset:3072  lds
    v_mfma_f32_16x16x32_bf16 a[104:107], v[192:195], a[80:83], a[104:107]
    s_waitcnt lgkmcnt(8)
    v_mfma_f32_16x16x32_bf16 a[108:111], v[196:199], a[72:75], a[108:111]
    v_mfma_f32_16x16x32_bf16 a[112:115], v[196:199], a[76:79], a[112:115]
    ds_read_b64_tr_b16 v[216:217], v226 offset:8192
    ds_read_b64_tr_b16 v[218:219], v226 offset:9216
    v_mfma_f32_16x16x32_bf16 a[116:119], v[196:199], a[80:83], a[116:119]
    s_waitcnt lgkmcnt(8)
    v_mfma_f32_16x16x32_bf16 a[120:123], v[200:203], a[72:75], a[120:123]
    v_mfma_f32_16x16x32_bf16 a[124:127], v[200:203], a[76:79], a[124:127]
    ds_read_b64_tr_b16 v[220:221], v227 offset:8192
    ds_read_b64_tr_b16 v[222:223], v227 offset:9216
    v_mfma_f32_16x16x32_bf16 a[128:131], v[200:203], a[80:83], a[128:131]
    s_waitcnt lgkmcnt(8)
    v_mfma_f32_16x16x32_bf16 a[132:135], v[204:207], a[72:75], a[132:135]
    v_add_u32 v224, 81920, v247
    v_xor_b32 v225, 32, v224
    v_mfma_f32_16x16x32_bf16 a[136:139], v[204:207], a[76:79], a[136:139]
    v_xor_b32 v226, 64, v224
    v_xor_b32 v227, 96, v224
    v_mfma_f32_16x16x32_bf16 a[140:143], v[204:207], a[80:83], a[140:143]
    v_xor_b32 v228, 128, v224
    v_xor_b32 v229, 160, v224
    s_waitcnt lgkmcnt(6)
    v_mfma_f32_16x16x32_bf16 a[96:99], v[208:211], a[84:87], a[96:99]
    v_xor_b32 v230, 192, v224
    v_xor_b32 v231, 224, v224
    v_mfma_f32_16x16x32_bf16 a[100:103], v[208:211], a[88:91], a[100:103]
    v_mfma_f32_16x16x32_bf16 a[104:107], v[208:211], a[92:95], a[104:107]
    s_waitcnt lgkmcnt(0)
    s_barrier
    v_mfma_f32_16x16x32_bf16 a[108:111], v[212:215], a[84:87], a[108:111]
    ds_read_b64_tr_b16 v[192:193], v224 offset:0
    ds_read_b64_tr_b16 v[194:195], v224 offset:4096
    s_add_u32 m0, s59, 98304
    s_add_u32 s68, s46, 131072
    buffer_load_dwordx4 v240, s[12:15], s68 offen offset:0 nt lds
    v_mfma_f32_16x16x32_bf16 a[112:115], v[212:215], a[88:91], a[112:115]
    ds_read_b64_tr_b16 v[196:197], v225 offset:0
    ds_read_b64_tr_b16 v[198:199], v225 offset:4096
    v_mfma_f32_16x16x32_bf16 a[116:119], v[212:215], a[92:95], a[116:119]
    ds_read_b64_tr_b16 v[200:201], v226 offset:0
    ds_read_b64_tr_b16 v[202:203], v226 offset:4096
    v_mfma_f32_16x16x32_bf16 a[120:123], v[216:219], a[84:87], a[120:123]
    ds_read_b64_tr_b16 v[204:205], v227 offset:0
    ds_read_b64_tr_b16 v[206:207], v227 offset:4096
    v_mfma_f32_16x16x32_bf16 a[124:127], v[216:219], a[88:91], a[124:127]
    ds_read_b64_tr_b16 v[208:209], v228 offset:0
    ds_read_b64_tr_b16 v[210:211], v228 offset:4096
    s_add_u32 s68, s68, 3072
    v_xor_b32 v244, 64, v240
    buffer_load_dwordx4 v244, s[12:15], s68 offen offset:1024 nt lds
    v_mfma_f32_16x16x32_bf16 a[128:131], v[216:219], a[92:95], a[128:131]
    v_mfma_f32_16x16x32_bf16 a[132:135], v[220:223], a[84:87], a[132:135]
    v_mfma_f32_16x16x32_bf16 a[136:139], v[220:223], a[88:91], a[136:139]
    v_mfma_f32_16x16x32_bf16 a[140:143], v[220:223], a[92:95], a[140:143]
    s_add_u32 s68, s68, 3072
    v_xor_b32 v244, 128, v240
    buffer_load_dwordx4 v244, s[12:15], s68 offen offset:2048 nt lds
    s_waitcnt lgkmcnt(8)
    v_mfma_f32_16x16x32_bf16 v[96:99], v[192:195], v[48:51], v[96:99]
    v_mfma_f32_16x16x32_bf16 v[100:103], v[192:195], v[52:55], v[100:103]
    ds_read_b64_tr_b16 v[212:213], v229 offset:0
    ds_read_b64_tr_b16 v[214:215], v229 offset:4096
    v_mfma_f32_16x16x32_bf16 v[104:107], v[192:195], v[56:59], v[104:107]
    s_waitcnt lgkmcnt(8)
    v_mfma_f32_16x16x32_bf16 v[108:111], v[196:199], v[48:51], v[108:111]
    s_add_u32 s68, s68, 3072
    v_xor_b32 v244, 192, v240
    buffer_load_dwordx4 v244, s[12:15], s68 offen offset:3072 nt lds
    v_mfma_f32_16x16x32_bf16 v[112:115], v[196:199], v[52:55], v[112:115]
    ds_read_b64_tr_b16 v[216:217], v230 offset:0
    ds_read_b64_tr_b16 v[218:219], v230 offset:4096
    v_mfma_f32_16x16x32_bf16 v[116:119], v[196:199], v[56:59], v[116:119]
    s_waitcnt lgkmcnt(8)
    v_mfma_f32_16x16x32_bf16 v[120:123], v[200:203], v[48:51], v[120:123]
    v_mfma_f32_16x16x32_bf16 v[124:127], v[200:203], v[52:55], v[124:127]
    ds_read_b64_tr_b16 v[220:221], v231 offset:0
    ds_read_b64_tr_b16 v[222:223], v231 offset:4096
    v_mfma_f32_16x16x32_bf16 v[128:131], v[200:203], v[56:59], v[128:131]
    s_waitcnt lgkmcnt(8)
    v_mfma_f32_16x16x32_bf16 v[132:135], v[204:207], v[48:51], v[132:135]
    v_add_u32 v224, 131072, v245
    v_xor_b32 v225, 32, v224
    v_mfma_f32_16x16x32_bf16 v[136:139], v[204:207], v[52:55], v[136:139]
    v_xor_b32 v226, 64, v224
    v_xor_b32 v227, 96, v224
    v_mfma_f32_16x16x32_bf16 v[140:143], v[204:207], v[56:59], v[140:143]
    s_waitcnt lgkmcnt(6)
    v_mfma_f32_16x16x32_bf16 v[144:147], v[208:211], v[48:51], v[144:147]
    v_mfma_f32_16x16x32_bf16 v[148:151], v[208:211], v[52:55], v[148:151]
    v_mfma_f32_16x16x32_bf16 v[152:155], v[208:211], v[56:59], v[152:155]
    s_waitcnt vmcnt(12) lgkmcnt(0)
    s_barrier
    v_mfma_f32_16x16x32_bf16 v[156:159], v[212:215], v[48:51], v[156:159]
    ds_read_b64_tr_b16 v[192:193], v224 offset:0
    ds_read_b64_tr_b16 v[194:195], v224 offset:1024
    s_add_u32 m0, s59, 147456
    s_add_u32 s69, s53, 6
    s_and_b32 s69, s69, 7
    s_lshl_b32 s68, s69, 19
    s_add_u32 s68, s68, s54
    s_add_u32 s68, s68, 256
    buffer_load_dwordx4 v242, s[20:23], s68 offen offset:0  lds
    v_mfma_f32_16x16x32_bf16 v[160:163], v[212:215], v[52:55], v[160:163]
    ds_read_b64_tr_b16 v[196:197], v225 offset:0
    ds_read_b64_tr_b16 v[198:199], v225 offset:1024
    v_mfma_f32_16x16x32_bf16 v[164:167], v[212:215], v[56:59], v[164:167]
    ds_read_b64_tr_b16 v[200:201], v226 offset:0
    ds_read_b64_tr_b16 v[202:203], v226 offset:1024
    v_mfma_f32_16x16x32_bf16 v[168:171], v[216:219], v[48:51], v[168:171]
    ds_read_b64_tr_b16 v[204:205], v227 offset:0
    ds_read_b64_tr_b16 v[206:207], v227 offset:1024
    s_add_u32 s68, s68, 31744
    buffer_load_dwordx4 v242, s[20:23], s68 offen offset:1024  lds
    v_mfma_f32_16x16x32_bf16 v[172:175], v[216:219], v[52:55], v[172:175]
    ds_read_b64_tr_b16 v[208:209], v224 offset:8192
    ds_read_b64_tr_b16 v[210:211], v224 offset:9216
    v_mfma_f32_16x16x32_bf16 v[176:179], v[216:219], v[56:59], v[176:179]
    v_mfma_f32_16x16x32_bf16 v[180:183], v[220:223], v[48:51], v[180:183]
    s_add_u32 s68, s68, 31744
    v_xor_b32 v244, 128, v242
    buffer_load_dwordx4 v244, s[20:23], s68 offen offset:2048  lds
    v_mfma_f32_16x16x32_bf16 v[184:187], v[220:223], v[52:55], v[184:187]
    v_mfma_f32_16x16x32_bf16 v[188:191], v[220:223], v[56:59], v[188:191]
    s_waitcnt lgkmcnt(8)
    v_mfma_f32_16x16x32_bf16 a[96:99], v[192:195], a[144:147], a[96:99]
    v_mfma_f32_16x16x32_bf16 a[100:103], v[192:195], a[148:151], a[100:103]
    ds_read_b64_tr_b16 v[212:213], v225 offset:8192
    ds_read_b64_tr_b16 v[214:215], v225 offset:9216
    s_add_u32 s68, s68, 31744
    buffer_load_dwordx4 v244, s[20:23], s68 offen offset:3072  lds
    v_mfma_f32_16x16x32_bf16 a[104:107], v[192:195], a[152:155], a[104:107]
    s_waitcnt lgkmcnt(8)
    v_mfma_f32_16x16x32_bf16 a[108:111], v[196:199], a[144:147], a[108:111]
    v_mfma_f32_16x16x32_bf16 a[112:115], v[196:199], a[148:151], a[112:115]
    ds_read_b64_tr_b16 v[216:217], v226 offset:8192
    ds_read_b64_tr_b16 v[218:219], v226 offset:9216
    v_mfma_f32_16x16x32_bf16 a[116:119], v[196:199], a[152:155], a[116:119]
    s_waitcnt lgkmcnt(8)
    v_mfma_f32_16x16x32_bf16 a[120:123], v[200:203], a[144:147], a[120:123]
    v_mfma_f32_16x16x32_bf16 a[124:127], v[200:203], a[148:151], a[124:127]
    ds_read_b64_tr_b16 v[220:221], v227 offset:8192
    ds_read_b64_tr_b16 v[222:223], v227 offset:9216
    v_mfma_f32_16x16x32_bf16 a[128:131], v[200:203], a[152:155], a[128:131]
    s_waitcnt lgkmcnt(8)
    v_mfma_f32_16x16x32_bf16 a[132:135], v[204:207], a[144:147], a[132:135]
    v_add_u32 v224, 0, v247
    v_xor_b32 v225, 32, v224
    v_mfma_f32_16x16x32_bf16 a[136:139], v[204:207], a[148:151], a[136:139]
    v_xor_b32 v226, 64, v224
    v_xor_b32 v227, 96, v224
    v_mfma_f32_16x16x32_bf16 a[140:143], v[204:207], a[152:155], a[140:143]
    v_xor_b32 v228, 128, v224
    v_xor_b32 v229, 160, v224
    s_waitcnt lgkmcnt(6)
    v_mfma_f32_16x16x32_bf16 a[96:99], v[208:211], a[156:159], a[96:99]
    v_xor_b32 v230, 192, v224
    v_xor_b32 v231, 224, v224
    v_mfma_f32_16x16x32_bf16 a[100:103], v[208:211], a[160:163], a[100:103]
    v_mfma_f32_16x16x32_bf16 a[104:107], v[208:211], a[164:167], a[104:107]
    s_waitcnt lgkmcnt(0)
    s_barrier
    v_mfma_f32_16x16x32_bf16 a[108:111], v[212:215], a[156:159], a[108:111]
    ds_read_b64_tr_b16 v[192:193], v224 offset:0
    ds_read_b64_tr_b16 v[194:195], v224 offset:4096
    s_add_u32 m0, s59, 65536
    s_add_u32 s68, s46, 147456
    buffer_load_dwordx4 v240, s[12:15], s68 offen offset:0 nt lds
    v_mfma_f32_16x16x32_bf16 a[112:115], v[212:215], a[160:163], a[112:115]
    ds_read_b64_tr_b16 v[196:197], v225 offset:0
    ds_read_b64_tr_b16 v[198:199], v225 offset:4096
    v_mfma_f32_16x16x32_bf16 a[116:119], v[212:215], a[164:167], a[116:119]
    ds_read_b64_tr_b16 v[200:201], v226 offset:0
    ds_read_b64_tr_b16 v[202:203], v226 offset:4096
    v_mfma_f32_16x16x32_bf16 a[120:123], v[216:219], a[156:159], a[120:123]
    ds_read_b64_tr_b16 v[204:205], v227 offset:0
    ds_read_b64_tr_b16 v[206:207], v227 offset:4096
    v_mfma_f32_16x16x32_bf16 a[124:127], v[216:219], a[160:163], a[124:127]
    ds_read_b64_tr_b16 v[208:209], v228 offset:0
    ds_read_b64_tr_b16 v[210:211], v228 offset:4096
    s_add_u32 s68, s68, 3072
    v_xor_b32 v244, 64, v240
    buffer_load_dwordx4 v244, s[12:15], s68 offen offset:1024 nt lds
    v_mfma_f32_16x16x32_bf16 a[128:131], v[216:219], a[164:167], a[128:131]
    v_mfma_f32_16x16x32_bf16 a[132:135], v[220:223], a[156:159], a[132:135]
    v_mfma_f32_16x16x32_bf16 a[136:139], v[220:223], a[160:163], a[136:139]
    v_mfma_f32_16x16x32_bf16 a[140:143], v[220:223], a[164:167], a[140:143]
    s_add_u32 s68, s68, 3072
    v_xor_b32 v244, 128, v240
    buffer_load_dwordx4 v244, s[12:15], s68 offen offset:2048 nt lds
    s_waitcnt lgkmcnt(8)
    v_mfma_f32_16x16x32_bf16 v[96:99], v[192:195], v[60:63], v[96:99]
    v_mfma_f32_16x16x32_bf16 v[100:103], v[192:195], v[64:67], v[100:103]
    ds_read_b64_tr_b16 v[212:213], v229 offset:0
    ds_read_b64_tr_b16 v[214:215], v229 offset:4096
    v_mfma_f32_16x16x32_bf16 v[104:107], v[192:195], v[68:71], v[104:107]
    s_waitcnt lgkmcnt(8)
    v_mfma_f32_16x16x32_bf16 v[108:111], v[196:199], v[60:63], v[108:111]
    s_add_u32 s68, s68, 3072
    v_xor_b32 v244, 192, v240
    buffer_load_dwordx4 v244, s[12:15], s68 offen offset:3072 nt lds
    v_mfma_f32_16x16x32_bf16 v[112:115], v[196:199], v[64:67], v[112:115]
    ds_read_b64_tr_b16 v[216:217], v230 offset:0
    ds_read_b64_tr_b16 v[218:219], v230 offset:4096
    v_mfma_f32_16x16x32_bf16 v[116:119], v[196:199], v[68:71], v[116:119]
    s_waitcnt lgkmcnt(8)
    v_mfma_f32_16x16x32_bf16 v[120:123], v[200:203], v[60:63], v[120:123]
    v_mfma_f32_16x16x32_bf16 v[124:127], v[200:203], v[64:67], v[124:127]
    ds_read_b64_tr_b16 v[220:221], v231 offset:0
    ds_read_b64_tr_b16 v[222:223], v231 offset:4096
    v_mfma_f32_16x16x32_bf16 v[128:131], v[200:203], v[68:71], v[128:131]
    s_waitcnt lgkmcnt(8)
    v_mfma_f32_16x16x32_bf16 v[132:135], v[204:207], v[60:63], v[132:135]
    v_add_u32 v224, 49152, v245
    v_xor_b32 v225, 32, v224
    v_mfma_f32_16x16x32_bf16 v[136:139], v[204:207], v[64:67], v[136:139]
    v_xor_b32 v226, 64, v224
    v_xor_b32 v227, 96, v224
    v_mfma_f32_16x16x32_bf16 v[140:143], v[204:207], v[68:71], v[140:143]
    s_waitcnt lgkmcnt(6)
    v_mfma_f32_16x16x32_bf16 v[144:147], v[208:211], v[60:63], v[144:147]
    v_mfma_f32_16x16x32_bf16 v[148:151], v[208:211], v[64:67], v[148:151]
    v_mfma_f32_16x16x32_bf16 v[152:155], v[208:211], v[68:71], v[152:155]
    s_waitcnt vmcnt(12) lgkmcnt(0)
    s_barrier
    v_mfma_f32_16x16x32_bf16 v[156:159], v[212:215], v[60:63], v[156:159]
    ds_read_b64_tr_b16 v[192:193], v224 offset:0
    ds_read_b64_tr_b16 v[194:195], v224 offset:1024
    s_add_u32 m0, s59, 81920
    s_add_u32 s69, s53, 7
    s_and_b32 s69, s69, 7
    s_lshl_b32 s68, s69, 19
    s_add_u32 s68, s68, s54
    s_add_u32 s68, s68, 256
    buffer_load_dwordx4 v242, s[20:23], s68 offen offset:0  lds
    v_mfma_f32_16x16x32_bf16 v[160:163], v[212:215], v[64:67], v[160:163]
    ds_read_b64_tr_b16 v[196:197], v225 offset:0
    ds_read_b64_tr_b16 v[198:199], v225 offset:1024
    v_mfma_f32_16x16x32_bf16 v[164:167], v[212:215], v[68:71], v[164:167]
    ds_read_b64_tr_b16 v[200:201], v226 offset:0
    ds_read_b64_tr_b16 v[202:203], v226 offset:1024
    v_mfma_f32_16x16x32_bf16 v[168:171], v[216:219], v[60:63], v[168:171]
    ds_read_b64_tr_b16 v[204:205], v227 offset:0
    ds_read_b64_tr_b16 v[206:207], v227 offset:1024
    s_add_u32 s68, s68, 31744
    buffer_load_dwordx4 v242, s[20:23], s68 offen offset:1024  lds
    v_mfma_f32_16x16x32_bf16 v[172:175], v[216:219], v[64:67], v[172:175]
    ds_read_b64_tr_b16 v[208:209], v224 offset:8192
    ds_read_b64_tr_b16 v[210:211], v224 offset:9216
    v_mfma_f32_16x16x32_bf16 v[176:179], v[216:219], v[68:71], v[176:179]
    v_mfma_f32_16x16x32_bf16 v[180:183], v[220:223], v[60:63], v[180:183]
    s_add_u32 s68, s68, 31744
    v_xor_b32 v244, 128, v242
    buffer_load_dwordx4 v244, s[20:23], s68 offen offset:2048  lds
    v_mfma_f32_16x16x32_bf16 v[184:187], v[220:223], v[64:67], v[184:187]
    v_mfma_f32_16x16x32_bf16 v[188:191], v[220:223], v[68:71], v[188:191]
    s_waitcnt lgkmcnt(8)
    v_mfma_f32_16x16x32_bf16 a[96:99], v[192:195], a[168:171], a[96:99]
    v_mfma_f32_16x16x32_bf16 a[100:103], v[192:195], a[172:175], a[100:103]
    ds_read_b64_tr_b16 v[212:213], v225 offset:8192
    ds_read_b64_tr_b16 v[214:215], v225 offset:9216
    s_add_u32 s68, s68, 31744
    buffer_load_dwordx4 v244, s[20:23], s68 offen offset:3072  lds
    v_mfma_f32_16x16x32_bf16 a[104:107], v[192:195], a[176:179], a[104:107]
    s_waitcnt lgkmcnt(8)
    v_mfma_f32_16x16x32_bf16 a[108:111], v[196:199], a[168:171], a[108:111]
    v_mfma_f32_16x16x32_bf16 a[112:115], v[196:199], a[172:175], a[112:115]
    ds_read_b64_tr_b16 v[216:217], v226 offset:8192
    ds_read_b64_tr_b16 v[218:219], v226 offset:9216
    v_mfma_f32_16x16x32_bf16 a[116:119], v[196:199], a[176:179], a[116:119]
    s_waitcnt lgkmcnt(8)
    v_mfma_f32_16x16x32_bf16 a[120:123], v[200:203], a[168:171], a[120:123]
    v_mfma_f32_16x16x32_bf16 a[124:127], v[200:203], a[172:175], a[124:127]
    ds_read_b64_tr_b16 v[220:221], v227 offset:8192
    ds_read_b64_tr_b16 v[222:223], v227 offset:9216
    v_mfma_f32_16x16x32_bf16 a[128:131], v[200:203], a[176:179], a[128:131]
    s_waitcnt lgkmcnt(8)
    v_mfma_f32_16x16x32_bf16 a[132:135], v[204:207], a[168:171], a[132:135]
    v_add_u32 v224, 16384, v247
    v_xor_b32 v225, 32, v224
    v_mfma_f32_16x16x32_bf16 a[136:139], v[204:207], a[172:175], a[136:139]
    v_xor_b32 v226, 64, v224
    v_xor_b32 v227, 96, v224
    v_mfma_f32_16x16x32_bf16 a[140:143], v[204:207], a[176:179], a[140:143]
    v_xor_b32 v228, 128, v224
    v_xor_b32 v229, 160, v224
    s_waitcnt lgkmcnt(6)
    v_mfma_f32_16x16x32_bf16 a[96:99], v[208:211], a[180:183], a[96:99]
    v_xor_b32 v230, 192, v224
    v_xor_b32 v231, 224, v224
    v_mfma_f32_16x16x32_bf16 a[100:103], v[208:211], a[184:187], a[100:103]
    v_mfma_f32_16x16x32_bf16 a[104:107], v[208:211], a[188:191], a[104:107]
    s_waitcnt lgkmcnt(0)
    s_barrier
    v_mfma_f32_16x16x32_bf16 a[108:111], v[212:215], a[180:183], a[108:111]
    ds_read_b64_tr_b16 v[192:193], v224 offset:0
    ds_read_b64_tr_b16 v[194:195], v224 offset:4096
    s_add_u32 m0, s59, 0
    s_add_u32 s68, s46, 163840
    buffer_load_dwordx4 v240, s[12:15], s68 offen offset:0 nt lds
    v_mfma_f32_16x16x32_bf16 a[112:115], v[212:215], a[184:187], a[112:115]
    ds_read_b64_tr_b16 v[196:197], v225 offset:0
    ds_read_b64_tr_b16 v[198:199], v225 offset:4096
    v_mfma_f32_16x16x32_bf16 a[116:119], v[212:215], a[188:191], a[116:119]
    ds_read_b64_tr_b16 v[200:201], v226 offset:0
    ds_read_b64_tr_b16 v[202:203], v226 offset:4096
    v_mfma_f32_16x16x32_bf16 a[120:123], v[216:219], a[180:183], a[120:123]
    ds_read_b64_tr_b16 v[204:205], v227 offset:0
    ds_read_b64_tr_b16 v[206:207], v227 offset:4096
    v_mfma_f32_16x16x32_bf16 a[124:127], v[216:219], a[184:187], a[124:127]
    ds_read_b64_tr_b16 v[208:209], v228 offset:0
    ds_read_b64_tr_b16 v[210:211], v228 offset:4096
    s_add_u32 s68, s68, 3072
    v_xor_b32 v244, 64, v240
    buffer_load_dwordx4 v244, s[12:15], s68 offen offset:1024 nt lds
    v_mfma_f32_16x16x32_bf16 a[128:131], v[216:219], a[188:191], a[128:131]
    v_mfma_f32_16x16x32_bf16 a[132:135], v[220:223], a[180:183], a[132:135]
    v_mfma_f32_16x16x32_bf16 a[136:139], v[220:223], a[184:187], a[136:139]
    v_mfma_f32_16x16x32_bf16 a[140:143], v[220:223], a[188:191], a[140:143]
    s_add_u32 s68, s68, 3072
    v_xor_b32 v244, 128, v240
    buffer_load_dwordx4 v244, s[12:15], s68 offen offset:2048 nt lds
    s_waitcnt lgkmcnt(8)
    v_mfma_f32_16x16x32_bf16 v[96:99], v[192:195], v[72:75], v[96:99]
    v_mfma_f32_16x16x32_bf16 v[100:103], v[192:195], v[76:79], v[100:103]
    ds_read_b64_tr_b16 v[212:213], v229 offset:0
    ds_read_b64_tr_b16 v[214:215], v229 offset:4096
    v_mfma_f32_16x16x32_bf16 v[104:107], v[192:195], v[80:83], v[104:107]
    s_waitcnt lgkmcnt(8)
    v_mfma_f32_16x16x32_bf16 v[108:111], v[196:199], v[72:75], v[108:111]
    s_add_u32 s68, s68, 3072
    v_xor_b32 v244, 192, v240
    buffer_load_dwordx4 v244, s[12:15], s68 offen offset:3072 nt lds
    v_mfma_f32_16x16x32_bf16 v[112:115], v[196:199], v[76:79], v[112:115]
    ds_read_b64_tr_b16 v[216:217], v230 offset:0
    ds_read_b64_tr_b16 v[218:219], v230 offset:4096
    v_mfma_f32_16x16x32_bf16 v[116:119], v[196:199], v[80:83], v[116:119]
    s_waitcnt lgkmcnt(8)
    v_mfma_f32_16x16x32_bf16 v[120:123], v[200:203], v[72:75], v[120:123]
    v_mfma_f32_16x16x32_bf16 v[124:127], v[200:203], v[76:79], v[124:127]
    ds_read_b64_tr_b16 v[220:221], v231 offset:0
    ds_read_b64_tr_b16 v[222:223], v231 offset:4096
    v_mfma_f32_16x16x32_bf16 v[128:131], v[200:203], v[80:83], v[128:131]
    s_waitcnt lgkmcnt(8)
    v_mfma_f32_16x16x32_bf16 v[132:135], v[204:207], v[72:75], v[132:135]
    v_add_u32 v224, 147456, v245
    v_xor_b32 v225, 32, v224
    v_mfma_f32_16x16x32_bf16 v[136:139], v[204:207], v[76:79], v[136:139]
    v_xor_b32 v226, 64, v224
    v_xor_b32 v227, 96, v224
    v_mfma_f32_16x16x32_bf16 v[140:143], v[204:207], v[80:83], v[140:143]
    s_waitcnt lgkmcnt(6)
    v_mfma_f32_16x16x32_bf16 v[144:147], v[208:211], v[72:75], v[144:147]
    v_mfma_f32_16x16x32_bf16 v[148:151], v[208:211], v[76:79], v[148:151]
    v_mfma_f32_16x16x32_bf16 v[152:155], v[208:211], v[80:83], v[152:155]
    s_waitcnt vmcnt(12) lgkmcnt(0)
    s_barrier
    v_mfma_f32_16x16x32_bf16 v[156:159], v[212:215], v[72:75], v[156:159]
    ds_read_b64_tr_b16 v[192:193], v224 offset:0
    ds_read_b64_tr_b16 v[194:195], v224 offset:1024
    s_add_u32 m0, s59, 49152
    s_add_u32 s68, s46, 180224
    buffer_load_dwordx4 v240, s[12:15], s68 offen offset:0 nt lds
    v_mfma_f32_16x16x32_bf16 v[160:163], v[212:215], v[76:79], v[160:163]
    ds_read_b64_tr_b16 v[196:197], v225 offset:0
    ds_read_b64_tr_b16 v[198:199], v225 offset:1024
    v_mfma_f32_16x16x32_bf16 v[164:167], v[212:215], v[80:83], v[164:167]
    ds_read_b64_tr_b16 v[200:201], v226 offset:0
    ds_read_b64_tr_b16 v[202:203], v226 offset:1024
    v_mfma_f32_16x16x32_bf16 v[168:171], v[216:219], v[72:75], v[168:171]
    ds_read_b64_tr_b16 v[204:205], v227 offset:0
    ds_read_b64_tr_b16 v[206:207], v227 offset:1024
    v_mfma_f32_16x16x32_bf16 v[172:175], v[216:219], v[76:79], v[172:175]
    ds_read_b64_tr_b16 v[208:209], v224 offset:8192
    ds_read_b64_tr_b16 v[210:211], v224 offset:9216
    s_add_u32 s68, s68, 3072
    v_xor_b32 v244, 64, v240
    buffer_load_dwordx4 v244, s[12:15], s68 offen offset:1024 nt lds
    v_mfma_f32_16x16x32_bf16 v[176:179], v[216:219], v[80:83], v[176:179]
    v_mfma_f32_16x16x32_bf16 v[180:183], v[220:223], v[72:75], v[180:183]
    v_mfma_f32_16x16x32_bf16 v[184:187], v[220:223], v[76:79], v[184:187]
    v_mfma_f32_16x16x32_bf16 v[188:191], v[220:223], v[80:83], v[188:191]
    s_add_u32 s68, s68, 3072
    v_xor_b32 v244, 128, v240
    buffer_load_dwordx4 v244, s[12:15], s68 offen offset:2048 nt lds
    s_waitcnt lgkmcnt(8)
    v_mfma_f32_16x16x32_bf16 a[96:99], v[192:195], a[192:195], a[96:99]
    v_mfma_f32_16x16x32_bf16 a[100:103], v[192:195], a[196:199], a[100:103]
    ds_read_b64_tr_b16 v[212:213], v225 offset:8192
    ds_read_b64_tr_b16 v[214:215], v225 offset:9216
    v_mfma_f32_16x16x32_bf16 a[104:107], v[192:195], a[200:203], a[104:107]
    s_waitcnt lgkmcnt(8)
    v_mfma_f32_16x16x32_bf16 a[108:111], v[196:199], a[192:195], a[108:111]
    s_add_u32 s68, s68, 3072
    v_xor_b32 v244, 192, v240
    buffer_load_dwordx4 v244, s[12:15], s68 offen offset:3072 nt lds
    v_mfma_f32_16x16x32_bf16 a[112:115], v[196:199], a[196:199], a[112:115]
    ds_read_b64_tr_b16 v[216:217], v226 offset:8192
    ds_read_b64_tr_b16 v[218:219], v226 offset:9216
    v_mfma_f32_16x16x32_bf16 a[116:119], v[196:199], a[200:203], a[116:119]
    s_waitcnt lgkmcnt(8)
    v_mfma_f32_16x16x32_bf16 a[120:123], v[200:203], a[192:195], a[120:123]
    v_mfma_f32_16x16x32_bf16 a[124:127], v[200:203], a[196:199], a[124:127]
    ds_read_b64_tr_b16 v[220:221], v227 offset:8192
    ds_read_b64_tr_b16 v[222:223], v227 offset:9216
    v_mfma_f32_16x16x32_bf16 a[128:131], v[200:203], a[200:203], a[128:131]
    s_waitcnt lgkmcnt(8)
    v_mfma_f32_16x16x32_bf16 a[132:135], v[204:207], a[192:195], a[132:135]
    v_add_u32 v224, 81920, v245
    v_xor_b32 v225, 32, v224
    v_mfma_f32_16x16x32_bf16 a[136:139], v[204:207], a[196:199], a[136:139]
    v_xor_b32 v226, 64, v224
    v_xor_b32 v227, 96, v224
    v_mfma_f32_16x16x32_bf16 a[140:143], v[204:207], a[200:203], a[140:143]
    s_waitcnt lgkmcnt(6)
    v_mfma_f32_16x16x32_bf16 a[96:99], v[208:211], a[204:207], a[96:99]
    v_mfma_f32_16x16x32_bf16 a[100:103], v[208:211], a[208:211], a[100:103]
    v_mfma_f32_16x16x32_bf16 a[104:107], v[208:211], a[212:215], a[104:107]
    s_waitcnt vmcnt(8) lgkmcnt(0)
    s_barrier
    v_mfma_f32_16x16x32_bf16 a[108:111], v[212:215], a[204:207], a[108:111]
    ds_read_b64_tr_b16 v[192:193], v224 offset:0
    ds_read_b64_tr_b16 v[194:195], v224 offset:1024
    s_add_u32 m0, s59, 16384
    s_add_u32 s68, s46, 196608
    buffer_load_dwordx4 v240, s[12:15], s68 offen offset:0 nt lds
    v_mfma_f32_16x16x32_bf16 a[112:115], v[212:215], a[208:211], a[112:115]
    ds_read_b64_tr_b16 v[196:197], v225 offset:0
    ds_read_b64_tr_b16 v[198:199], v225 offset:1024
    v_mfma_f32_16x16x32_bf16 a[116:119], v[212:215], a[212:215], a[116:119]
    ds_read_b64_tr_b16 v[200:201], v226 offset:0
    ds_read_b64_tr_b16 v[202:203], v226 offset:1024
    v_mfma_f32_16x16x32_bf16 a[120:123], v[216:219], a[204:207], a[120:123]
    ds_read_b64_tr_b16 v[204:205], v227 offset:0
    ds_read_b64_tr_b16 v[206:207], v227 offset:1024
    v_mfma_f32_16x16x32_bf16 a[124:127], v[216:219], a[208:211], a[124:127]
    ds_read_b64_tr_b16 v[208:209], v224 offset:8192
    ds_read_b64_tr_b16 v[210:211], v224 offset:9216
    s_add_u32 s68, s68, 3072
    v_xor_b32 v244, 64, v240
    buffer_load_dwordx4 v244, s[12:15], s68 offen offset:1024 nt lds
    v_mfma_f32_16x16x32_bf16 a[128:131], v[216:219], a[212:215], a[128:131]
    v_mfma_f32_16x16x32_bf16 a[132:135], v[220:223], a[204:207], a[132:135]
    v_mfma_f32_16x16x32_bf16 a[136:139], v[220:223], a[208:211], a[136:139]
    v_mfma_f32_16x16x32_bf16 a[140:143], v[220:223], a[212:215], a[140:143]
    s_add_u32 s68, s68, 3072
    v_xor_b32 v244, 128, v240
    buffer_load_dwordx4 v244, s[12:15], s68 offen offset:2048 nt lds
    s_waitcnt lgkmcnt(8)
    v_mfma_f32_16x16x32_bf16 a[96:99], v[192:195], a[216:219], a[96:99]
    v_mfma_f32_16x16x32_bf16 a[100:103], v[192:195], a[220:223], a[100:103]
    ds_read_b64_tr_b16 v[212:213], v225 offset:8192
    ds_read_b64_tr_b16 v[214:215], v225 offset:9216
    v_mfma_f32_16x16x32_bf16 a[104:107], v[192:195], a[224:227], a[104:107]
    s_waitcnt lgkmcnt(8)
    v_mfma_f32_16x16x32_bf16 a[108:111], v[196:199], a[216:219], a[108:111]
    s_add_u32 s68, s68, 3072
    v_xor_b32 v244, 192, v240
    buffer_load_dwordx4 v244, s[12:15], s68 offen offset:3072 nt lds
    v_mfma_f32_16x16x32_bf16 a[112:115], v[196:199], a[220:223], a[112:115]
    ds_read_b64_tr_b16 v[216:217], v226 offset:8192
    ds_read_b64_tr_b16 v[218:219], v226 offset:9216
    v_mfma_f32_16x16x32_bf16 a[116:119], v[196:199], a[224:227], a[116:119]
    s_waitcnt lgkmcnt(8)
    v_mfma_f32_16x16x32_bf16 a[120:123], v[200:203], a[216:219], a[120:123]
    v_mfma_f32_16x16x32_bf16 a[124:127], v[200:203], a[220:223], a[124:127]
    ds_read_b64_tr_b16 v[220:221], v227 offset:8192
    ds_read_b64_tr_b16 v[222:223], v227 offset:9216
    v_mfma_f32_16x16x32_bf16 a[128:131], v[200:203], a[224:227], a[128:131]
    s_waitcnt lgkmcnt(8)
    v_mfma_f32_16x16x32_bf16 a[132:135], v[204:207], a[216:219], a[132:135]
    v_add_u32 v224, 32768, v247
    v_xor_b32 v225, 32, v224
    v_mfma_f32_16x16x32_bf16 a[136:139], v[204:207], a[220:223], a[136:139]
    v_xor_b32 v226, 64, v224
    v_xor_b32 v227, 96, v224
    v_mfma_f32_16x16x32_bf16 a[140:143], v[204:207], a[224:227], a[140:143]
    v_xor_b32 v228, 128, v224
    v_xor_b32 v229, 160, v224
    s_waitcnt lgkmcnt(6)
    v_mfma_f32_16x16x32_bf16 a[96:99], v[208:211], a[228:231], a[96:99]
    v_xor_b32 v230, 192, v224
    v_xor_b32 v231, 224, v224
    v_mfma_f32_16x16x32_bf16 a[100:103], v[208:211], a[232:235], a[100:103]
    v_mfma_f32_16x16x32_bf16 a[104:107], v[208:211], a[236:239], a[104:107]
    s_waitcnt lgkmcnt(0)
    s_barrier
    v_mfma_f32_16x16x32_bf16 a[108:111], v[212:215], a[228:231], a[108:111]
    ds_read_b64_tr_b16 v[192:193], v224 offset:0
    ds_read_b64_tr_b16 v[194:195], v224 offset:4096
    s_add_u32 m0, s59, 81920
    s_add_u32 s68, s46, 212992
    buffer_load_dwordx4 v240, s[12:15], s68 offen offset:0 nt lds
    v_mfma_f32_16x16x32_bf16 a[112:115], v[212:215], a[232:235], a[112:115]
    ds_read_b64_tr_b16 v[196:197], v225 offset:0
    ds_read_b64_tr_b16 v[198:199], v225 offset:4096
    v_mfma_f32_16x16x32_bf16 a[116:119], v[212:215], a[236:239], a[116:119]
    ds_read_b64_tr_b16 v[200:201], v226 offset:0
    ds_read_b64_tr_b16 v[202:203], v226 offset:4096
    v_mfma_f32_16x16x32_bf16 a[120:123], v[216:219], a[228:231], a[120:123]
    ds_read_b64_tr_b16 v[204:205], v227 offset:0
    ds_read_b64_tr_b16 v[206:207], v227 offset:4096
    v_mfma_f32_16x16x32_bf16 a[124:127], v[216:219], a[232:235], a[124:127]
    ds_read_b64_tr_b16 v[208:209], v228 offset:0
    ds_read_b64_tr_b16 v[210:211], v228 offset:4096
    s_add_u32 s68, s68, 3072
    v_xor_b32 v244, 64, v240
    buffer_load_dwordx4 v244, s[12:15], s68 offen offset:1024 nt lds
    v_mfma_f32_16x16x32_bf16 a[128:131], v[216:219], a[236:239], a[128:131]
    v_mfma_f32_16x16x32_bf16 a[132:135], v[220:223], a[228:231], a[132:135]
    v_mfma_f32_16x16x32_bf16 a[136:139], v[220:223], a[232:235], a[136:139]
    v_mfma_f32_16x16x32_bf16 a[140:143], v[220:223], a[236:239], a[140:143]
    s_add_u32 s68, s68, 3072
    v_xor_b32 v244, 128, v240
    buffer_load_dwordx4 v244, s[12:15], s68 offen offset:2048 nt lds
    s_waitcnt lgkmcnt(8)
    v_mfma_f32_16x16x32_bf16 v[96:99], v[192:195], v[84:87], v[96:99]
    v_mfma_f32_16x16x32_bf16 v[100:103], v[192:195], v[88:91], v[100:103]
    ds_read_b64_tr_b16 v[212:213], v229 offset:0
    ds_read_b64_tr_b16 v[214:215], v229 offset:4096
    v_mfma_f32_16x16x32_bf16 v[104:107], v[192:195], v[92:95], v[104:107]
    s_waitcnt lgkmcnt(8)
    v_mfma_f32_16x16x32_bf16 v[108:111], v[196:199], v[84:87], v[108:111]
    s_add_u32 s68, s68, 3072
    v_xor_b32 v244, 192, v240
    buffer_load_dwordx4 v244, s[12:15], s68 offen offset:3072 nt lds
    v_mfma_f32_16x16x32_bf16 v[112:115], v[196:199], v[88:91], v[112:115]
    ds_read_b64_tr_b16 v[216:217], v230 offset:0
    ds_read_b64_tr_b16 v[218:219], v230 offset:4096
    v_mfma_f32_16x16x32_bf16 v[116:119], v[196:199], v[92:95], v[116:119]
    s_waitcnt lgkmcnt(8)
    v_mfma_f32_16x16x32_bf16 v[120:123], v[200:203], v[84:87], v[120:123]
    v_mfma_f32_16x16x32_bf16 v[124:127], v[200:203], v[88:91], v[124:127]
    ds_read_b64_tr_b16 v[220:221], v231 offset:0
    ds_read_b64_tr_b16 v[222:223], v231 offset:4096
    v_mfma_f32_16x16x32_bf16 v[128:131], v[200:203], v[92:95], v[128:131]
    s_waitcnt lgkmcnt(8)
    v_mfma_f32_16x16x32_bf16 v[132:135], v[204:207], v[84:87], v[132:135]
    v_mfma_f32_16x16x32_bf16 v[136:139], v[204:207], v[88:91], v[136:139]
    v_mfma_f32_16x16x32_bf16 v[140:143], v[204:207], v[92:95], v[140:143]
    s_waitcnt lgkmcnt(6)
    v_mfma_f32_16x16x32_bf16 v[144:147], v[208:211], v[84:87], v[144:147]
    v_mfma_f32_16x16x32_bf16 v[148:151], v[208:211], v[88:91], v[148:151]
    v_mfma_f32_16x16x32_bf16 v[152:155], v[208:211], v[92:95], v[152:155]
    s_waitcnt lgkmcnt(4)
    v_mfma_f32_16x16x32_bf16 v[156:159], v[212:215], v[84:87], v[156:159]
    v_mfma_f32_16x16x32_bf16 v[160:163], v[212:215], v[88:91], v[160:163]
    v_mfma_f32_16x16x32_bf16 v[164:167], v[212:215], v[92:95], v[164:167]
    s_waitcnt lgkmcnt(2)
    v_mfma_f32_16x16x32_bf16 v[168:171], v[216:219], v[84:87], v[168:171]
    v_mfma_f32_16x16x32_bf16 v[172:175], v[216:219], v[88:91], v[172:175]
    v_mfma_f32_16x16x32_bf16 v[176:179], v[216:219], v[92:95], v[176:179]
    s_waitcnt lgkmcnt(0)
    v_mfma_f32_16x16x32_bf16 v[180:183], v[220:223], v[84:87], v[180:183]
    v_mfma_f32_16x16x32_bf16 v[184:187], v[220:223], v[88:91], v[184:187]
    v_mfma_f32_16x16x32_bf16 v[188:191], v[220:223], v[92:95], v[188:191]
    s_mul_i32 s48, s40, 12288
    s_add_u32 s48, s48, 114688
    v_add_u32 v192, s48, v248
    s_xor_b32 s49, s40, 2
    s_mul_i32 s49, s49, 12288
    s_add_u32 s49, s49, 114688
    v_add_u32 v193, s49, v248
    ds_write_b128 v192, v[144:147] offset:0
    v_mul_f32 v96, v96, v249
    v_mul_f32 v97, v97, v249
    v_mul_f32 v98, v98, v249
    v_mul_f32 v99, v99, v249
    ds_write_b128 v192, v[148:151] offset:1024
    v_mul_f32 v100, v100, v250
    v_mul_f32 v101, v101, v250
    v_mul_f32 v102, v102, v250
    v_mul_f32 v103, v103, v250
    ds_write_b128 v192, v[152:155] offset:2048
    v_mul_f32 v104, v104, v251
    v_mul_f32 v105, v105, v251
    v_mul_f32 v106, v106, v251
    v_mul_f32 v107, v107, v251
    ds_write_b128 v192, v[156:159] offset:3072
    v_mul_f32 v108, v108, v249
    v_mul_f32 v109, v109, v249
    v_mul_f32 v110, v110, v249
    v_mul_f32 v111, v111, v249
    ds_write_b128 v192, v[160:163] offset:4096
    v_mul_f32 v112, v112, v250
    v_mul_f32 v113, v113, v250
    v_mul_f32 v114, v114, v250
    v_mul_f32 v115, v115, v250
    ds_write_b128 v192, v[164:167] offset:5120
    v_mul_f32 v116, v116, v251
    v_mul_f32 v117, v117, v251
    v_mul_f32 v118, v118, v251
    v_mul_f32 v119, v119, v251
    ds_write_b128 v192, v[168:171] offset:6144
    v_mul_f32 v120, v120, v249
    v_mul_f32 v121, v121, v249
    v_mul_f32 v122, v122, v249
    v_mul_f32 v123, v123, v249
    ds_write_b128 v192, v[172:175] offset:7168
    v_mul_f32 v124, v124, v250
    v_mul_f32 v125, v125, v250
    v_mul_f32 v126, v126, v250
    v_mul_f32 v127, v127, v250
    ds_write_b128 v192, v[176:179] offset:8192
    v_mul_f32 v128, v128, v251
    v_mul_f32 v129, v129, v251
    v_mul_f32 v130, v130, v251
    v_mul_f32 v131, v131, v251
    ds_write_b128 v192, v[180:183] offset:9216
    v_mul_f32 v132, v132, v249
    v_mul_f32 v133, v133, v249
    v_mul_f32 v134, v134, v249
    v_mul_f32 v135, v135, v249
    ds_write_b128 v192, v[184:187] offset:10240
    v_mul_f32 v136, v136, v250
    v_mul_f32 v137, v137, v250
    v_mul_f32 v138, v138, v250
    v_mul_f32 v139, v139, v250
    ds_write_b128 v192, v[188:191] offset:11264
    v_mul_f32 v140, v140, v251
    v_mul_f32 v141, v141, v251
    v_mul_f32 v142, v142, v251
    v_mul_f32 v143, v143, v251
    s_waitcnt lgkmcnt(0)
    s_barrier
    ds_read_b128 v[0:3], v193 offset:0
    ds_read_b128 v[12:15], v193 offset:3072
    ds_read_b128 v[4:7], v193 offset:1024
    ds_read_b128 v[16:19], v193 offset:4096
    ds_read_b128 v[8:11], v193 offset:2048
    ds_read_b128 v[20:23], v193 offset:5120
    ds_read_b128 v[24:27], v193 offset:6144
    ds_read_b128 v[36:39], v193 offset:9216
    ds_read_b128 v[28:31], v193 offset:7168
    ds_read_b128 v[40:43], v193 offset:10240
    ds_read_b128 v[32:35], v193 offset:8192
    ds_read_b128 v[44:47], v193 offset:11264
    s_add_u32 s48, s62, 0
    s_add_u32 s49, s48, 2048
    s_add_u32 s50, s48, 4096
    s_waitcnt lgkmcnt(11)
    v_fma_f32 v96, v0, v252, v96
    v_fma_f32 v97, v1, v252, v97
    v_fma_f32 v98, v2, v252, v98
    v_fma_f32 v99, v3, v252, v99
    v_cvt_pk_bf16_f32 v48, v96, v97
    v_cvt_pk_bf16_f32 v49, v98, v99
    s_waitcnt lgkmcnt(10)
    v_fma_f32 v108, v12, v252, v108
    v_fma_f32 v109, v13, v252, v109
    v_fma_f32 v110, v14, v252, v110
    v_fma_f32 v111, v15, v252, v111
    v_cvt_pk_bf16_f32 v50, v108, v109
    v_cvt_pk_bf16_f32 v51, v110, v111
    buffer_store_dwordx4 v[48:51], v248, s[32:35], s48 offen offset:0 sc1
    v_accvgpr_write_b32 a48, v48
    v_accvgpr_write_b32 a49, v49
    v_accvgpr_write_b32 a50, v50
    v_accvgpr_write_b32 a51, v51
    s_waitcnt lgkmcnt(9)
    v_fma_f32 v100, v4, v253, v100
    v_fma_f32 v101, v5, v253, v101
    v_fma_f32 v102, v6, v253, v102
    v_fma_f32 v103, v7, v253, v103
    v_cvt_pk_bf16_f32 v52, v100, v101
    v_cvt_pk_bf16_f32 v53, v102, v103
    s_waitcnt lgkmcnt(8)
    v_fma_f32 v112, v16, v253, v112
    v_fma_f32 v113, v17, v253, v113
    v_fma_f32 v114, v18, v253, v114
    v_fma_f32 v115, v19, v253, v115
    v_cvt_pk_bf16_f32 v54, v112, v113
    v_cvt_pk_bf16_f32 v55, v114, v115
    buffer_store_dwordx4 v[52:55], v248, s[32:35], s49 offen offset:0 sc1
    v_accvgpr_write_b32 a52, v52
    v_accvgpr_write_b32 a53, v53
    v_accvgpr_write_b32 a54, v54
    v_accvgpr_write_b32 a55, v55
    s_waitcnt lgkmcnt(7)
    v_fma_f32 v104, v8, v254, v104
    v_fma_f32 v105, v9, v254, v105
    v_fma_f32 v106, v10, v254, v106
    v_fma_f32 v107, v11, v254, v107
    v_cvt_pk_bf16_f32 v56, v104, v105
    v_cvt_pk_bf16_f32 v57, v106, v107
    s_waitcnt lgkmcnt(6)
    v_fma_f32 v116, v20, v254, v116
    v_fma_f32 v117, v21, v254, v117
    v_fma_f32 v118, v22, v254, v118
    v_fma_f32 v119, v23, v254, v119
    v_cvt_pk_bf16_f32 v58, v116, v117
    v_cvt_pk_bf16_f32 v59, v118, v119
    buffer_store_dwordx4 v[56:59], v248, s[32:35], s50 offen offset:0 sc1
    v_accvgpr_write_b32 a56, v56
    v_accvgpr_write_b32 a57, v57
    v_accvgpr_write_b32 a58, v58
    v_accvgpr_write_b32 a59, v59
    s_waitcnt lgkmcnt(5)
    v_fma_f32 v120, v24, v252, v120
    v_fma_f32 v121, v25, v252, v121
    v_fma_f32 v122, v26, v252, v122
    v_fma_f32 v123, v27, v252, v123
    v_cvt_pk_bf16_f32 v60, v120, v121
    v_cvt_pk_bf16_f32 v61, v122, v123
    s_waitcnt lgkmcnt(4)
    v_fma_f32 v132, v36, v252, v132
    v_fma_f32 v133, v37, v252, v133
    v_fma_f32 v134, v38, v252, v134
    v_fma_f32 v135, v39, v252, v135
    v_cvt_pk_bf16_f32 v62, v132, v133
    v_cvt_pk_bf16_f32 v63, v134, v135
    buffer_store_dwordx4 v[60:63], v248, s[32:35], s48 offen offset:1024 sc1
    v_accvgpr_write_b32 a60, v60
    v_accvgpr_write_b32 a61, v61
    v_accvgpr_write_b32 a62, v62
    v_accvgpr_write_b32 a63, v63
    s_waitcnt lgkmcnt(3)
    v_fma_f32 v124, v28, v253, v124
    v_fma_f32 v125, v29, v253, v125
    v_fma_f32 v126, v30, v253, v126
    v_fma_f32 v127, v31, v253, v127
    v_cvt_pk_bf16_f32 v64, v124, v125
    v_cvt_pk_bf16_f32 v65, v126, v127
    s_waitcnt lgkmcnt(2)
    v_fma_f32 v136, v40, v253, v136
    v_fma_f32 v137, v41, v253, v137
    v_fma_f32 v138, v42, v253, v138
    v_fma_f32 v139, v43, v253, v139
    v_cvt_pk_bf16_f32 v66, v136, v137
    v_cvt_pk_bf16_f32 v67, v138, v139
    buffer_store_dwordx4 v[64:67], v248, s[32:35], s49 offen offset:1024 sc1
    v_accvgpr_write_b32 a64, v64
    v_accvgpr_write_b32 a65, v65
    v_accvgpr_write_b32 a66, v66
    v_accvgpr_write_b32 a67, v67
    s_waitcnt lgkmcnt(1)
    v_fma_f32 v128, v32, v254, v128
    v_fma_f32 v129, v33, v254, v129
    v_fma_f32 v130, v34, v254, v130
    v_fma_f32 v131, v35, v254, v131
    v_cvt_pk_bf16_f32 v68, v128, v129
    v_cvt_pk_bf16_f32 v69, v130, v131
    s_waitcnt lgkmcnt(0)
    v_fma_f32 v140, v44, v254, v140
    v_fma_f32 v141, v45, v254, v141
    v_fma_f32 v142, v46, v254, v142
    v_fma_f32 v143, v47, v254, v143
    v_cvt_pk_bf16_f32 v70, v140, v141
    v_cvt_pk_bf16_f32 v71, v142, v143
    buffer_store_dwordx4 v[68:71], v248, s[32:35], s50 offen offset:1024 sc1
    v_accvgpr_write_b32 a68, v68
    v_accvgpr_write_b32 a69, v69
    v_accvgpr_write_b32 a70, v70
    v_accvgpr_write_b32 a71, v71
    v_accvgpr_read_b32 v239, a247
    s_mov_b32 s70, 0
L_nonce_X:
    v_readfirstlane_b32 s71, v239
    s_nop 0
    s_cmp_lg_u32 s71, 0
    s_cbranch_scc1 L_nonce_ok_X
    s_add_u32 s70, s70, 1
    s_cmp_gt_u32 s70, 20000
    s_cbranch_scc1 L_nonce_ok_X
    s_sleep 2
    buffer_load_dword v239, off, s[36:39], 0 offset:4 sc1
    s_waitcnt vmcnt(0)
    s_branch L_nonce_X
L_nonce_ok_X:
    v_lshrrev_b32 v228, 8, v248
    v_bfe_u32 v229, v248, 4, 4
    v_lshrrev_b32 v230, 1, v228
    v_xor_b32 v230, v230, v229
    v_lshlrev_b32 v230, 4, v230
    v_lshl_add_u32 v230, v229, 8, v230
    v_and_b32 v231, 1, v228
    v_lshl_add_u32 v230, v231, 3, v230
    s_mul_i32 s48, s41, 12288
    s_add_u32 s48, s48, 114688
    s_lshl_b32 s49, s42, 7
    v_xor_b32 v192, s49, v230
    v_add_u32 v192, s48, v192
    v_xor_b32 v193, 32, v192
    v_xor_b32 v194, 64, v192
    v_xor_b32 v195, 96, v192
    v_xor_b32 v230, v228, v229
    v_lshlrev_b32 v230, 4, v230
    v_lshl_add_u32 v230, v229, 8, v230
    v_add_u32 v196, s48, v230
    v_xor_b32 v197, 64, v196
    v_xor_b32 v198, 128, v196
    v_xor_b32 v199, 192, v196
    v_accvgpr_read_b32 v224, a96
    v_accvgpr_read_b32 v225, a97
    v_accvgpr_read_b32 v226, a98
    v_accvgpr_read_b32 v227, a99
    v_cvt_pk_bf16_f32 v200, v224, v225
    v_cvt_pk_bf16_f32 v201, v226, v227
    v_accvgpr_read_b32 v224, a100
    v_accvgpr_read_b32 v225, a101
    v_accvgpr_read_b32 v226, a102
    v_accvgpr_read_b32 v227, a103
    v_cvt_pk_bf16_f32 v202, v224, v225
    v_cvt_pk_bf16_f32 v203, v226, v227
    v_accvgpr_read_b32 v224, a104
    v_accvgpr_read_b32 v225, a105
    v_accvgpr_read_b32 v226, a106
    v_accvgpr_read_b32 v227, a107
    v_cvt_pk_bf16_f32 v204, v224, v225
    v_cvt_pk_bf16_f32 v205, v226, v227
    v_accvgpr_read_b32 v224, a108
    v_accvgpr_read_b32 v225, a109
    v_accvgpr_read_b32 v226, a110
    v_accvgpr_read_b32 v227, a111
    v_cvt_pk_bf16_f32 v206, v224, v225
    v_cvt_pk_bf16_f32 v207, v226, v227
    v_accvgpr_read_b32 v224, a112
    v_accvgpr_read_b32 v225, a113
    v_accvgpr_read_b32 v226, a114
    v_accvgpr_read_b32 v227, a115
    v_cvt_pk_bf16_f32 v208, v224, v225
    v_cvt_pk_bf16_f32 v209, v226, v227
    v_accvgpr_read_b32 v224, a116
    v_accvgpr_read_b32 v225, a117
    v_accvgpr_read_b32 v226, a118
    v_accvgpr_read_b32 v227, a119
    v_cvt_pk_bf16_f32 v210, v224, v225
    v_cvt_pk_bf16_f32 v211, v226, v227
    v_accvgpr_read_b32 v224, a120
    v_accvgpr_read_b32 v225, a121
    v_accvgpr_read_b32 v226, a122
    v_accvgpr_read_b32 v227, a123
    v_cvt_pk_bf16_f32 v212, v224, v225
    v_cvt_pk_bf16_f32 v213, v226, v227
    v_accvgpr_read_b32 v224, a124
    v_accvgpr_read_b32 v225, a125
    v_accvgpr_read_b32 v226, a126
    v_accvgpr_read_b32 v227, a127
    v_cvt_pk_bf16_f32 v214, v224, v225
    v_cvt_pk_bf16_f32 v215, v226, v227
    v_accvgpr_read_b32 v224, a128
    v_accvgpr_read_b32 v225, a129
    v_accvgpr_read_b32 v226, a130
    v_accvgpr_read_b32 v227, a131
    v_cvt_pk_bf16_f32 v216, v224, v225
    v_cvt_pk_bf16_f32 v217, v226, v227
    v_accvgpr_read_b32 v224, a132
    v_accvgpr_read_b32 v225, a133
    v_accvgpr_read_b32 v226, a134
    v_accvgpr_read_b32 v227, a135
    v_cvt_pk_bf16_f32 v218, v224, v225
    v_cvt_pk_bf16_f32 v219, v226, v227
    v_accvgpr_read_b32 v224, a136
    v_accvgpr_read_b32 v225, a137
    v_accvgpr_read_b32 v226, a138
    v_accvgpr_read_b32 v227, a139
    v_cvt_pk_bf16_f32 v220, v224, v225
    v_cvt_pk_bf16_f32 v221, v226, v227
    v_accvgpr_read_b32 v224, a140
    v_accvgpr_read_b32 v225, a141
    v_accvgpr_read_b32 v226, a142
    v_accvgpr_read_b32 v227, a143
    v_cvt_pk_bf16_f32 v222, v224, v225
    v_cvt_pk_bf16_f32 v223, v226, v227
    s_barrier
    ds_write_b64 v192, v[200:201] offset:0
    ds_write_b64 v192, v[202:203] offset:4096
    ds_write_b64 v192, v[204:205] offset:8192
    ds_write_b64 v193, v[206:207] offset:0
    ds_write_b64 v193, v[208:209] offset:4096
    ds_write_b64 v193, v[210:211] offset:8192
    ds_write_b64 v194, v[212:213] offset:0
    ds_write_b64 v194, v[214:215] offset:4096
    ds_write_b64 v194, v[216:217] offset:8192
    ds_write_b64 v195, v[218:219] offset:0
    ds_write_b64 v195, v[220:221] offset:4096
    ds_write_b64 v195, v[222:223] offset:8192
    s_waitcnt lgkmcnt(0)
    s_barrier
    ds_read_b128 a[144:147], v196 offset:0
    ds_read_b128 a[148:151], v197 offset:0
    ds_read_b128 a[152:155], v198 offset:0
    ds_read_b128 a[156:159], v199 offset:0
    ds_read_b128 a[160:163], v196 offset:4096
    ds_read_b128 a[164:167], v197 offset:4096
    ds_read_b128 a[168:171], v198 offset:4096
    ds_read_b128 a[172:175], v199 offset:4096
    ds_read_b128 a[176:179], v196 offset:8192
    ds_read_b128 a[180:183], v197 offset:8192
    ds_read_b128 a[184:187], v198 offset:8192
    ds_read_b128 a[188:191], v199 offset:8192
    v_add_u32 v224, 98304, v246
    s_add_u32 m0, s59, 32768
    s_add_u32 s68, s46, 229376
    buffer_load_dwordx4 v240, s[12:15], s68 offen offset:0 nt lds
    v_xor_b32 v225, 64, v224
    v_xor_b32 v226, 128, v224
    v_xor_b32 v227, 192, v224
    s_waitcnt lgkmcnt(0)
    s_barrier
    ds_read_b128 v[192:195], v224 offset:0
    ds_read_b128 v[196:199], v225 offset:0
    ds_read_b128 v[200:203], v226 offset:0
    ds_read_b128 v[204:207], v227 offset:0
    ds_read_b128 v[208:211], v224 offset:4096
    s_waitcnt lgkmcnt(4)
    v_mfma_f32_16x16x32_bf16 v[0:3], v[192:195], a[144:147], 0
    s_add_u32 s68, s68, 3072
    v_xor_b32 v244, 64, v240
    buffer_load_dwordx4 v244, s[12:15], s68 offen offset:1024 nt lds
    v_mfma_f32_16x16x32_bf16 v[8:11], v[192:195], a[160:163], 0
    ds_read_b128 v[212:215], v225 offset:4096
    v_mfma_f32_16x16x32_bf16 v[16:19], v[192:195], a[176:179], 0
    s_waitcnt lgkmcnt(4)
    v_mfma_f32_16x16x32_bf16 v[0:3], v[196:199], a[148:151], v[0:3]
    v_mfma_f32_16x16x32_bf16 v[8:11], v[196:199], a[164:167], v[8:11]
    ds_read_b128 v[216:219], v226 offset:4096
    s_add_u32 s68, s68, 3072
    v_xor_b32 v244, 128, v240
    buffer_load_dwordx4 v244, s[12:15], s68 offen offset:2048 nt lds
    v_mfma_f32_16x16x32_bf16 v[16:19], v[196:199], a[180:183], v[16:19]
    s_waitcnt lgkmcnt(4)
    v_mfma_f32_16x16x32_bf16 v[0:3], v[200:203], a[152:155], v[0:3]
    v_mfma_f32_16x16x32_bf16 v[8:11], v[200:203], a[168:171], v[8:11]
    ds_read_b128 v[220:223], v227 offset:4096
    v_mfma_f32_16x16x32_bf16 v[16:19], v[200:203], a[184:187], v[16:19]
    s_add_u32 s68, s68, 3072
    v_xor_b32 v244, 192, v240
    buffer_load_dwordx4 v244, s[12:15], s68 offen offset:3072 nt lds
    s_waitcnt lgkmcnt(4)
    v_mfma_f32_16x16x32_bf16 v[0:3], v[204:207], a[156:159], v[0:3]
    v_add_u32 v224, 65536, v246
    v_xor_b32 v225, 64, v224
    v_mfma_f32_16x16x32_bf16 v[8:11], v[204:207], a[172:175], v[8:11]
    v_xor_b32 v226, 128, v224
    v_xor_b32 v227, 192, v224
    v_mfma_f32_16x16x32_bf16 v[16:19], v[204:207], a[188:191], v[16:19]
    s_waitcnt lgkmcnt(3)
    v_mfma_f32_16x16x32_bf16 v[4:7], v[208:211], a[144:147], 0
    v_mfma_f32_16x16x32_bf16 v[12:15], v[208:211], a[160:163], 0
    v_mfma_f32_16x16x32_bf16 v[20:23], v[208:211], a[176:179], 0
    s_waitcnt lgkmcnt(0)
    s_barrier
    v_mfma_f32_16x16x32_bf16 v[4:7], v[212:215], a[148:151], v[4:7]
    ds_read_b128 v[192:195], v224 offset:0
    ds_read_b128 v[196:199], v225 offset:0
    v_mfma_f32_16x16x32_bf16 v[12:15], v[212:215], a[164:167], v[12:15]
    ds_read_b128 v[200:203], v226 offset:0
    ds_read_b128 v[204:207], v227 offset:0
    v_mfma_f32_16x16x32_bf16 v[20:23], v[212:215], a[180:183], v[20:23]
    ds_read_b128 v[208:211], v224 offset:4096
    v_mfma_f32_16x16x32_bf16 v[4:7], v[216:219], a[152:155], v[4:7]
    v_mfma_f32_16x16x32_bf16 v[12:15], v[216:219], a[168:171], v[12:15]
    v_mfma_f32_16x16x32_bf16 v[20:23], v[216:219], a[184:187], v[20:23]
    v_mfma_f32_16x16x32_bf16 v[4:7], v[220:223], a[156:159], v[4:7]
    v_mfma_f32_16x16x32_bf16 v[12:15], v[220:223], a[172:175], v[12:15]
    v_mfma_f32_16x16x32_bf16 v[20:23], v[220:223], a[188:191], v[20:23]
    s_waitcnt lgkmcnt(4)
    v_mfma_f32_16x16x32_bf16 v[24:27], v[192:195], a[144:147], 0
    v_max_f32 v232, v0, v1
    v_max_f32 v233, v8, v9
    v_mfma_f32_16x16x32_bf16 v[32:35], v[192:195], a[160:163], 0
    ds_read_b128 v[212:215], v225 offset:4096
    v_max_f32 v234, v16, v17
    v_mfma_f32_16x16x32_bf16 v[40:43], v[192:195], a[176:179], 0
    v_max3_f32 v232, v232, v2, v3
    v_max3_f32 v233, v233, v10, v11
    s_waitcnt lgkmcnt(4)
    v_mfma_f32_16x16x32_bf16 v[24:27], v[196:199], a[148:151], v[24:27]
    v_max3_f32 v234, v234, v18, v19
    v_max3_f32 v232, v232, v4, v5
    v_mfma_f32_16x16x32_bf16 v[32:35], v[196:199], a[164:167], v[32:35]
    ds_read_b128 v[216:219], v226 offset:4096
    v_max3_f32 v233, v233, v12, v13
    v_mfma_f32_16x16x32_bf16 v[40:43], v[196:199], a[180:183], v[40:43]
    v_max3_f32 v234, v234, v20, v21
    v_max3_f32 v232, v232, v6, v7
    s_waitcnt lgkmcnt(4)
    v_mfma_f32_16x16x32_bf16 v[24:27], v[200:203], a[152:155], v[24:27]
    v_max3_f32 v233, v233, v14, v15
    v_max3_f32 v234, v234, v22, v23
    v_mfma_f32_16x16x32_bf16 v[32:35], v[200:203], a[168:171], v[32:35]
    ds_read_b128 v[220:223], v227 offset:4096
    v_mfma_f32_16x16x32_bf16 v[40:43], v[200:203], a[184:187], v[40:43]
    s_waitcnt lgkmcnt(4)
    v_mfma_f32_16x16x32_bf16 v[24:27], v[204:207], a[156:159], v[24:27]
    v_add_u32 v224, 0, v246
    v_xor_b32 v225, 64, v224
    v_mfma_f32_16x16x32_bf16 v[32:35], v[204:207], a[172:175], v[32:35]
    v_xor_b32 v226, 128, v224
    v_xor_b32 v227, 192, v224
    v_mfma_f32_16x16x32_bf16 v[40:43], v[204:207], a[188:191], v[40:43]
    s_waitcnt lgkmcnt(3)
    v_mfma_f32_16x16x32_bf16 v[28:31], v[208:211], a[144:147], 0
    v_mfma_f32_16x16x32_bf16 v[36:39], v[208:211], a[160:163], 0
    v_mfma_f32_16x16x32_bf16 v[44:47], v[208:211], a[176:179], 0
    s_waitcnt vmcnt(22) lgkmcnt(0)
    s_barrier
    v_mfma_f32_16x16x32_bf16 v[28:31], v[212:215], a[148:151], v[28:31]
    ds_read_b128 v[192:195], v224 offset:0
    ds_read_b128 v[196:199], v225 offset:0
    v_mfma_f32_16x16x32_bf16 v[36:39], v[212:215], a[164:167], v[36:39]
    ds_read_b128 v[200:203], v226 offset:0
    ds_read_b128 v[204:207], v227 offset:0
    v_mfma_f32_16x16x32_bf16 v[44:47], v[212:215], a[180:183], v[44:47]
    ds_read_b128 v[208:211], v224 offset:4096
    v_mfma_f32_16x16x32_bf16 v[28:31], v[216:219], a[152:155], v[28:31]
    v_mfma_f32_16x16x32_bf16 v[36:39], v[216:219], a[168:171], v[36:39]
    v_mfma_f32_16x16x32_bf16 v[44:47], v[216:219], a[184:187], v[44:47]
    v_mfma_f32_16x16x32_bf16 v[28:31], v[220:223], a[156:159], v[28:31]
    v_mfma_f32_16x16x32_bf16 v[36:39], v[220:223], a[172:175], v[36:39]
    v_mfma_f32_16x16x32_bf16 v[44:47], v[220:223], a[188:191], v[44:47]
    s_waitcnt lgkmcnt(4)
    v_mfma_f32_16x16x32_bf16 v[48:51], v[192:195], a[144:147], 0
    v_max3_f32 v232, v232, v24, v25
    v_max3_f32 v233, v233, v32, v33
    v_mfma_f32_16x16x32_bf16 v[56:59], v[192:195], a[160:163], 0
    ds_read_b128 v[212:215], v225 offset:4096
    v_max3_f32 v234, v234, v40, v41
    v_mfma_f32_16x16x32_bf16 v[64:67], v[192:195], a[176:179], 0
    v_max3_f32 v232, v232, v26, v27
    v_max3_f32 v233, v233, v34, v35
    s_waitcnt lgkmcnt(4)
    v_mfma_f32_16x16x32_bf16 v[48:51], v[196:199], a[148:151], v[48:51]
    v_max3_f32 v234, v234, v42, v43
    v_max3_f32 v232, v232, v28, v29
    v_mfma_f32_16x16x32_bf16 v[56:59], v[196:199], a[164:167], v[56:59]
    ds_read_b128 v[216:219], v226 offset:4096
    v_max3_f32 v233, v233, v36, v37
    v_mfma_f32_16x16x32_bf16 v[64:67], v[196:199], a[180:183], v[64:67]
    v_max3_f32 v234, v234, v44, v45
    v_max3_f32 v232, v232, v30, v31
    s_waitcnt lgkmcnt(4)
    v_mfma_f32_16x16x32_bf16 v[48:51], v[200:203], a[152:155], v[48:51]
    v_max3_f32 v233, v233, v38, v39
    v_max3_f32 v234, v234, v46, v47
    v_mfma_f32_16x16x32_bf16 v[56:59], v[200:203], a[168:171], v[56:59]
    ds_read_b128 v[220:223], v227 offset:4096
    v_mfma_f32_16x16x32_bf16 v[64:67], v[200:203], a[184:187], v[64:67]
    s_waitcnt lgkmcnt(4)
    v_mfma_f32_16x16x32_bf16 v[48:51], v[204:207], a[156:159], v[48:51]
    v_add_u32 v224, 49152, v246
    v_xor_b32 v225, 64, v224
    v_mfma_f32_16x16x32_bf16 v[56:59], v[204:207], a[172:175], v[56:59]
    v_xor_b32 v226, 128, v224
    v_xor_b32 v227, 192, v224
    v_mfma_f32_16x16x32_bf16 v[64:67], v[204:207], a[188:191], v[64:67]
    s_waitcnt lgkmcnt(3)
    v_mfma_f32_16x16x32_bf16 v[52:55], v[208:211], a[144:147], 0
    v_mfma_f32_16x16x32_bf16 v[60:63], v[208:211], a[160:163], 0
    v_mfma_f32_16x16x32_bf16 v[68:71], v[208:211], a[176:179], 0
    s_waitcnt vmcnt(18) lgkmcnt(0)
    s_barrier
    v_mfma_f32_16x16x32_bf16 v[52:55], v[212:215], a[148:151], v[52:55]
    ds_read_b128 v[192:195], v224 offset:0
    ds_read_b128 v[196:199], v225 offset:0
    v_mfma_f32_16x16x32_bf16 v[60:63], v[212:215], a[164:167], v[60:63]
    ds_read_b128 v[200:203], v226 offset:0
    ds_read_b128 v[204:207], v227 offset:0
    v_mfma_f32_16x16x32_bf16 v[68:71], v[212:215], a[180:183], v[68:71]
    ds_read_b128 v[208:211], v224 offset:4096
    v_mfma_f32_16x16x32_bf16 v[52:55], v[216:219], a[152:155], v[52:55]
    v_mfma_f32_16x16x32_bf16 v[60:63], v[216:219], a[168:171], v[60:63]
    v_mfma_f32_16x16x32_bf16 v[68:71], v[216:219], a[184:187], v[68:71]
    v_mfma_f32_16x16x32_bf16 v[52:55], v[220:223], a[156:159], v[52:55]
    v_mfma_f32_16x16x32_bf16 v[60:63], v[220:223], a[172:175], v[60:63]
    v_mfma_f32_16x16x32_bf16 v[68:71], v[220:223], a[188:191], v[68:71]
    s_waitcnt lgkmcnt(4)
    v_mfma_f32_16x16x32_bf16 v[72:75], v[192:195], a[144:147], 0
    v_max3_f32 v232, v232, v48, v49
    v_max3_f32 v233, v233, v56, v57
    v_mfma_f32_16x16x32_bf16 v[80:83], v[192:195], a[160:163], 0
    ds_read_b128 v[212:215], v225 offset:4096
    v_max3_f32 v234, v234, v64, v65
    v_mfma_f32_16x16x32_bf16 v[88:91], v[192:195], a[176:179], 0
    v_max3_f32 v232, v232, v50, v51
    v_max3_f32 v233, v233, v58, v59
    s_waitcnt lgkmcnt(4)
    v_mfma_f32_16x16x32_bf16 v[72:75], v[196:199], a[148:151], v[72:75]
    v_max3_f32 v234, v234, v66, v67
    v_max3_f32 v232, v232, v52, v53
    v_mfma_f32_16x16x32_bf16 v[80:83], v[196:199], a[164:167], v[80:83]
    ds_read_b128 v[216:219], v226 offset:4096
    v_max3_f32 v233, v233, v60, v61
    v_mfma_f32_16x16x32_bf16 v[88:91], v[196:199], a[180:183], v[88:91]
    v_max3_f32 v234, v234, v68, v69
    v_max3_f32 v232, v232, v54, v55
    s_waitcnt lgkmcnt(4)
    v_mfma_f32_16x16x32_bf16 v[72:75], v[200:203], a[152:155], v[72:75]
    v_max3_f32 v233, v233, v62, v63
    v_max3_f32 v234, v234, v70, v71
    v_mfma_f32_16x16x32_bf16 v[80:83], v[200:203], a[168:171], v[80:83]
    ds_read_b128 v[220:223], v227 offset:4096
    v_mfma_f32_16x16x32_bf16 v[88:91], v[200:203], a[184:187], v[88:91]
    s_waitcnt lgkmcnt(4)
    v_mfma_f32_16x16x32_bf16 v[72:75], v[204:207], a[156:159], v[72:75]
    v_add_u32 v224, 16384, v246
    v_xor_b32 v225, 64, v224
    v_mfma_f32_16x16x32_bf16 v[80:83], v[204:207], a[172:175], v[80:83]
    v_xor_b32 v226, 128, v224
    v_xor_b32 v227, 192, v224
    v_mfma_f32_16x16x32_bf16 v[88:91], v[204:207], a[188:191], v[88:91]
    s_waitcnt lgkmcnt(3)
    v_mfma_f32_16x16x32_bf16 v[76:79], v[208:211], a[144:147], 0
    v_mfma_f32_16x16x32_bf16 v[84:87], v[208:211], a[160:163], 0
    v_mfma_f32_16x16x32_bf16 v[92:95], v[208:211], a[176:179], 0
    s_waitcnt vmcnt(14) lgkmcnt(0)
    s_barrier
    v_mfma_f32_16x16x32_bf16 v[76:79], v[212:215], a[148:151], v[76:79]
    ds_read_b128 v[192:195], v224 offset:0
    ds_read_b128 v[196:199], v225 offset:0
    s_add_u32 m0, s59, 98304
    s_add_u32 s68, s46, 245760
    buffer_load_dwordx4 v240, s[12:15], s68 offen offset:0 nt lds
    v_mfma_f32_16x16x32_bf16 v[84:87], v[212:215], a[164:167], v[84:87]
    ds_read_b128 v[200:203], v226 offset:0
    ds_read_b128 v[204:207], v227 offset:0
    v_mfma_f32_16x16x32_bf16 v[92:95], v[212:215], a[180:183], v[92:95]
    ds_read_b128 v[208:211], v224 offset:4096
    v_mfma_f32_16x16x32_bf16 v[76:79], v[216:219], a[152:155], v[76:79]
    v_mfma_f32_16x16x32_bf16 v[84:87], v[216:219], a[168:171], v[84:87]
    s_add_u32 s68, s68, 3072
    v_xor_b32 v244, 64, v240
    buffer_load_dwordx4 v244, s[12:15], s68 offen offset:1024 nt lds
    v_mfma_f32_16x16x32_bf16 v[92:95], v[216:219], a[184:187], v[92:95]
    v_mfma_f32_16x16x32_bf16 v[76:79], v[220:223], a[156:159], v[76:79]
    v_mfma_f32_16x16x32_bf16 v[84:87], v[220:223], a[172:175], v[84:87]
    v_mfma_f32_16x16x32_bf16 v[92:95], v[220:223], a[188:191], v[92:95]
    s_add_u32 s68, s68, 3072
    v_xor_b32 v244, 128, v240
    buffer_load_dwordx4 v244, s[12:15], s68 offen offset:2048 nt lds
    s_waitcnt lgkmcnt(4)
    v_mfma_f32_16x16x32_bf16 v[96:99], v[192:195], a[144:147], 0
    v_max3_f32 v232, v232, v72, v73
    v_max3_f32 v233, v233, v80, v81
    v_mfma_f32_16x16x32_bf16 v[104:107], v[192:195], a[160:163], 0
    ds_read_b128 v[212:215], v225 offset:4096
    v_max3_f32 v234, v234, v88, v89
    v_mfma_f32_16x16x32_bf16 v[112:115], v[192:195], a[176:179], 0
    v_max3_f32 v232, v232, v74, v75
    s_add_u32 s68, s68, 3072
    v_xor_b32 v244, 192, v240
    buffer_load_dwordx4 v244, s[12:15], s68 offen offset:3072 nt lds
    v_max3_f32 v233, v233, v82, v83
    s_waitcnt lgkmcnt(4)
    v_mfma_f32_16x16x32_bf16 v[96:99], v[196:199], a[148:151], v[96:99]
    v_max3_f32 v234, v234, v90, v91
    v_max3_f32 v232, v232, v76, v77
    v_mfma_f32_16x16x32_bf16 v[104:107], v[196:199], a[164:167], v[104:107]
    ds_read_b128 v[216:219], v226 offset:4096
    v_max3_f32 v233, v233, v84, v85
    v_mfma_f32_16x16x32_bf16 v[112:115], v[196:199], a[180:183], v[112:115]
    v_max3_f32 v234, v234, v92, v93
    v_max3_f32 v232, v232, v78, v79
    s_waitcnt lgkmcnt(4)
    v_mfma_f32_16x16x32_bf16 v[96:99], v[200:203], a[152:155], v[96:99]
    v_max3_f32 v233, v233, v86, v87
    v_max3_f32 v234, v234, v94, v95
    v_mfma_f32_16x16x32_bf16 v[104:107], v[200:203], a[168:171], v[104:107]
    ds_read_b128 v[220:223], v227 offset:4096
    v_mfma_f32_16x16x32_bf16 v[112:115], v[200:203], a[184:187], v[112:115]
    s_waitcnt lgkmcnt(4)
    v_mfma_f32_16x16x32_bf16 v[96:99], v[204:207], a[156:159], v[96:99]
    v_add_u32 v224, 81920, v246
    v_xor_b32 v225, 64, v224
    v_mfma_f32_16x16x32_bf16 v[104:107], v[204:207], a[172:175], v[104:107]
    v_xor_b32 v226, 128, v224
    v_xor_b32 v227, 192, v224
    v_mfma_f32_16x16x32_bf16 v[112:115], v[204:207], a[188:191], v[112:115]
    s_waitcnt lgkmcnt(3)
    v_mfma_f32_16x16x32_bf16 v[100:103], v[208:211], a[144:147], 0
    v_mfma_f32_16x16x32_bf16 v[108:111], v[208:211], a[160:163], 0
    v_mfma_f32_16x16x32_bf16 v[116:119], v[208:211], a[176:179], 0
    s_waitcnt vmcnt(14) lgkmcnt(0)
    s_barrier
    v_mfma_f32_16x16x32_bf16 v[100:103], v[212:215], a[148:151], v[100:103]
    ds_read_b128 v[192:195], v224 offset:0
    ds_read_b128 v[196:199], v225 offset:0
    s_add_u32 m0, s59, 65536
    s_add_u32 s68, s46, 131072
    buffer_load_dwordx4 v241, s[16:19], s68 offen offset:0 nt lds
    v_mfma_f32_16x16x32_bf16 v[108:111], v[212:215], a[164:167], v[108:111]
    ds_read_b128 v[200:203], v226 offset:0
    ds_read_b128 v[204:207], v227 offset:0
    v_mfma_f32_16x16x32_bf16 v[116:119], v[212:215], a[180:183], v[116:119]
    ds_read_b128 v[208:211], v224 offset:4096
    v_mfma_f32_16x16x32_bf16 v[100:103], v[216:219], a[152:155], v[100:103]
    v_mfma_f32_16x16x32_bf16 v[108:111], v[216:219], a[168:171], v[108:111]
    s_add_u32 s68, s68, 3072
    v_xor_b32 v244, 128, v241
    buffer_load_dwordx4 v244, s[16:19], s68 offen offset:1024 nt lds
    v_mfma_f32_16x16x32_bf16 v[116:119], v[216:219], a[184:187], v[116:119]
    v_mfma_f32_16x16x32_bf16 v[100:103], v[220:223], a[156:159], v[100:103]
    v_mfma_f32_16x16x32_bf16 v[108:111], v[220:223], a[172:175], v[108:111]
    v_mfma_f32_16x16x32_bf16 v[116:119], v[220:223], a[188:191], v[116:119]
    s_add_u32 s68, s68, 3072
    buffer_load_dwordx4 v241, s[16:19], s68 offen offset:2048 nt lds
    s_waitcnt lgkmcnt(4)
    v_mfma_f32_16x16x32_bf16 v[120:123], v[192:195], a[144:147], 0
    v_max3_f32 v232, v232, v96, v97
    v_max3_f32 v233, v233, v104, v105
    v_mfma_f32_16x16x32_bf16 v[128:131], v[192:195], a[160:163], 0
    ds_read_b128 v[212:215], v225 offset:4096
    v_max3_f32 v234, v234, v112, v113
    v_mfma_f32_16x16x32_bf16 v[136:139], v[192:195], a[176:179], 0
    v_max3_f32 v232, v232, v98, v99
    s_add_u32 s68, s68, 3072
    buffer_load_dwordx4 v244, s[16:19], s68 offen offset:3072 nt lds
    v_max3_f32 v233, v233, v106, v107
    s_waitcnt lgkmcnt(4)
    v_mfma_f32_16x16x32_bf16 v[120:123], v[196:199], a[148:151], v[120:123]
    v_max3_f32 v234, v234, v114, v115
    v_max3_f32 v232, v232, v100, v101
    v_mfma_f32_16x16x32_bf16 v[128:131], v[196:199], a[164:167], v[128:131]
    ds_read_b128 v[216:219], v226 offset:4096
    v_max3_f32 v233, v233, v108, v109
    v_mfma_f32_16x16x32_bf16 v[136:139], v[196:199], a[180:183], v[136:139]
    v_max3_f32 v234, v234, v116, v117
    v_max3_f32 v232, v232, v102, v103
    s_waitcnt lgkmcnt(4)
    v_mfma_f32_16x16x32_bf16 v[120:123], v[200:203], a[152:155], v[120:123]
    v_max3_f32 v233, v233, v110, v111
    v_max3_f32 v234, v234, v118, v119
    v_mfma_f32_16x16x32_bf16 v[128:131], v[200:203], a[168:171], v[128:131]
    ds_read_b128 v[220:223], v227 offset:4096
    v_mfma_f32_16x16x32_bf16 v[136:139], v[200:203], a[184:187], v[136:139]
    s_waitcnt lgkmcnt(4)
    v_mfma_f32_16x16x32_bf16 v[120:123], v[204:207], a[156:159], v[120:123]
    v_add_u32 v224, 32768, v246
    v_xor_b32 v225, 64, v224
    v_mfma_f32_16x16x32_bf16 v[128:131], v[204:207], a[172:175], v[128:131]
    v_xor_b32 v226, 128, v224
    v_xor_b32 v227, 192, v224
    v_mfma_f32_16x16x32_bf16 v[136:139], v[204:207], a[188:191], v[136:139]
    s_waitcnt lgkmcnt(3)
    v_mfma_f32_16x16x32_bf16 v[124:127], v[208:211], a[144:147], 0
    v_mfma_f32_16x16x32_bf16 v[132:135], v[208:211], a[160:163], 0
    v_mfma_f32_16x16x32_bf16 v[140:143], v[208:211], a[176:179], 0
    s_waitcnt vmcnt(8) lgkmcnt(0)
    s_barrier
    s_lshl_b32 s48, s40, 28
    s_add_u32 s48, s48, s47
    v_lshlrev_b32 v238, 24, v248
    v_lshrrev_b32 v239, 8, v248
    v_lshl_or_b32 v238, v239, 28, v238
    v_or_b32 v238, s48, v238
    v_mov_b32 v239, s71
    buffer_store_dword v239, v238, s[32:35], 0 offen offset:0 sc1
    v_mfma_f32_16x16x32_bf16 v[124:127], v[212:215], a[148:151], v[124:127]
    ds_read_b128 v[192:195], v224 offset:0
    ds_read_b128 v[196:199], v225 offset:0
    s_add_u32 m0, s59, 0
    s_add_u32 s68, s46, 147456
    buffer_load_dwordx4 v241, s[16:19], s68 offen offset:0 nt lds
    v_mfma_f32_16x16x32_bf16 v[132:135], v[212:215], a[164:167], v[132:135]
    ds_read_b128 v[200:203], v226 offset:0
    ds_read_b128 v[204:207], v227 offset:0
    v_mfma_f32_16x16x32_bf16 v[140:143], v[212:215], a[180:183], v[140:143]
    ds_read_b128 v[208:211], v224 offset:4096
    v_mfma_f32_16x16x32_bf16 v[124:127], v[216:219], a[152:155], v[124:127]
    v_mfma_f32_16x16x32_bf16 v[132:135], v[216:219], a[168:171], v[132:135]
    s_add_u32 s68, s68, 3072
    v_xor_b32 v244, 128, v241
    buffer_load_dwordx4 v244, s[16:19], s68 offen offset:1024 nt lds
    v_mfma_f32_16x16x32_bf16 v[140:143], v[216:219], a[184:187], v[140:143]
    v_mfma_f32_16x16x32_bf16 v[124:127], v[220:223], a[156:159], v[124:127]
    v_mfma_f32_16x16x32_bf16 v[132:135], v[220:223], a[172:175], v[132:135]
    v_mfma_f32_16x16x32_bf16 v[140:143], v[220:223], a[188:191], v[140:143]
    s_add_u32 s68, s68, 3072
    buffer_load_dwordx4 v241, s[16:19], s68 offen offset:2048 nt lds
    s_waitcnt lgkmcnt(4)
    v_mfma_f32_16x16x32_bf16 v[144:147], v[192:195], a[144:147], 0
    v_max3_f32 v232, v232, v120, v121
    v_max3_f32 v233, v233, v128, v129
    v_mfma_f32_16x16x32_bf16 v[152:155], v[192:195], a[160:163], 0
    ds_read_b128 v[212:215], v225 offset:4096
    v_max3_f32 v234, v234, v136, v137
    v_mfma_f32_16x16x32_bf16 v[160:163], v[192:195], a[176:179], 0
    v_max3_f32 v232, v232, v122, v123
    s_add_u32 s68, s68, 3072
    buffer_load_dwordx4 v244, s[16:19], s68 offen offset:3072 nt lds
    v_max3_f32 v233, v233, v130, v131
    s_waitcnt lgkmcnt(4)
    v_mfma_f32_16x16x32_bf16 v[144:147], v[196:199], a[148:151], v[144:147]
    v_max3_f32 v234, v234, v138, v139
    v_max3_f32 v232, v232, v124, v125
    v_mfma_f32_16x16x32_bf16 v[152:155], v[196:199], a[164:167], v[152:155]
    ds_read_b128 v[216:219], v226 offset:4096
    v_max3_f32 v233, v233, v132, v133
    v_mfma_f32_16x16x32_bf16 v[160:163], v[196:199], a[180:183], v[160:163]
    v_max3_f32 v234, v234, v140, v141
    v_max3_f32 v232, v232, v126, v127
    s_waitcnt lgkmcnt(4)
    v_mfma_f32_16x16x32_bf16 v[144:147], v[200:203], a[152:155], v[144:147]
    v_max3_f32 v233, v233, v134, v135
    v_max3_f32 v234, v234, v142, v143
    v_mfma_f32_16x16x32_bf16 v[152:155], v[200:203], a[168:171], v[152:155]
    ds_read_b128 v[220:223], v227 offset:4096
    v_mfma_f32_16x16x32_bf16 v[160:163], v[200:203], a[184:187], v[160:163]
    s_waitcnt lgkmcnt(4)
    v_mfma_f32_16x16x32_bf16 v[144:147], v[204:207], a[156:159], v[144:147]
    v_add_u32 v224, 98304, v246
    v_xor_b32 v225, 64, v224
    v_mfma_f32_16x16x32_bf16 v[152:155], v[204:207], a[172:175], v[152:155]
    v_xor_b32 v226, 128, v224
    v_xor_b32 v227, 192, v224
    v_mfma_f32_16x16x32_bf16 v[160:163], v[204:207], a[188:191], v[160:163]
    s_waitcnt lgkmcnt(3)
    v_mfma_f32_16x16x32_bf16 v[148:151], v[208:211], a[144:147], 0
    v_mfma_f32_16x16x32_bf16 v[156:159], v[208:211], a[160:163], 0
    v_mfma_f32_16x16x32_bf16 v[164:167], v[208:211], a[176:179], 0
    s_waitcnt vmcnt(9) lgkmcnt(0)
    s_barrier
    v_mfma_f32_16x16x32_bf16 v[148:151], v[212:215], a[148:151], v[148:151]
    ds_read_b128 v[192:195], v224 offset:0
    ds_read_b128 v[196:199], v225 offset:0
    s_add_u32 m0, s59, 49152
    s_add_u32 s68, s46, 163840
    buffer_load_dwordx4 v241, s[16:19], s68 offen offset:0 nt lds
    v_mfma_f32_16x16x32_bf16 v[156:159], v[212:215], a[164:167], v[156:159]
    ds_read_b128 v[200:203], v226 offset:0
    ds_read_b128 v[204:207], v227 offset:0
    v_mfma_f32_16x16x32_bf16 v[164:167], v[212:215], a[180:183], v[164:167]
    ds_read_b128 v[208:211], v224 offset:4096
    v_mfma_f32_16x16x32_bf16 v[148:151], v[216:219], a[152:155], v[148:151]
    v_mfma_f32_16x16x32_bf16 v[156:159], v[216:219], a[168:171], v[156:159]
    s_add_u32 s68, s68, 3072
    v_xor_b32 v244, 128, v241
    buffer_load_dwordx4 v244, s[16:19], s68 offen offset:1024 nt lds
    v_mfma_f32_16x16x32_bf16 v[164:167], v[216:219], a[184:187], v[164:167]
    v_mfma_f32_16x16x32_bf16 v[148:151], v[220:223], a[156:159], v[148:151]
    v_mfma_f32_16x16x32_bf16 v[156:159], v[220:223], a[172:175], v[156:159]
    v_mfma_f32_16x16x32_bf16 v[164:167], v[220:223], a[188:191], v[164:167]
    s_add_u32 s68, s68, 3072
    buffer_load_dwordx4 v241, s[16:19], s68 offen offset:2048 nt lds
    s_waitcnt lgkmcnt(4)
    v_mfma_f32_16x16x32_bf16 v[168:171], v[192:195], a[144:147], 0
    v_max3_f32 v232, v232, v144, v145
    v_max3_f32 v233, v233, v152, v153
    v_mfma_f32_16x16x32_bf16 v[176:179], v[192:195], a[160:163], 0
    ds_read_b128 v[212:215], v225 offset:4096
    v_max3_f32 v234, v234, v160, v161
    v_mfma_f32_16x16x32_bf16 v[184:187], v[192:195], a[176:179], 0
    v_max3_f32 v232, v232, v146, v147
    s_add_u32 s68, s68, 3072
    buffer_load_dwordx4 v244, s[16:19], s68 offen offset:3072 nt lds
    v_max3_f32 v233, v233, v154, v155
    s_waitcnt lgkmcnt(4)
    v_mfma_f32_16x16x32_bf16 v[168:171], v[196:199], a[148:151], v[168:171]
    v_max3_f32 v234, v234, v162, v163
    v_max3_f32 v232, v232, v148, v149
    v_mfma_f32_16x16x32_bf16 v[176:179], v[196:199], a[164:167], v[176:179]
    ds_read_b128 v[216:219], v226 offset:4096
    v_max3_f32 v233, v233, v156, v157
    v_mfma_f32_16x16x32_bf16 v[184:187], v[196:199], a[180:183], v[184:187]
    v_max3_f32 v234, v234, v164, v165
    v_max3_f32 v232, v232, v150, v151
    s_waitcnt lgkmcnt(4)
    v_mfma_f32_16x16x32_bf16 v[168:171], v[200:203], a[152:155], v[168:171]
    v_max3_f32 v233, v233, v158, v159
    v_max3_f32 v234, v234, v166, v167
    v_mfma_f32_16x16x32_bf16 v[176:179], v[200:203], a[168:171], v[176:179]
    ds_read_b128 v[220:223], v227 offset:4096
    v_mfma_f32_16x16x32_bf16 v[184:187], v[200:203], a[184:187], v[184:187]
    s_waitcnt lgkmcnt(4)
    v_mfma_f32_16x16x32_bf16 v[168:171], v[204:207], a[156:159], v[168:171]
    v_mfma_f32_16x16x32_bf16 v[176:179], v[204:207], a[172:175], v[176:179]
    v_mfma_f32_16x16x32_bf16 v[184:187], v[204:207], a[188:191], v[184:187]
    s_waitcnt lgkmcnt(3)
    v_mfma_f32_16x16x32_bf16 v[172:175], v[208:211], a[144:147], 0
    v_mfma_f32_16x16x32_bf16 v[180:183], v[208:211], a[160:163], 0
    v_mfma_f32_16x16x32_bf16 v[188:191], v[208:211], a[176:179], 0
    s_waitcnt lgkmcnt(2)
    v_mfma_f32_16x16x32_bf16 v[172:175], v[212:215], a[148:151], v[172:175]
    v_mfma_f32_16x16x32_bf16 v[180:183], v[212:215], a[164:167], v[180:183]
    v_mfma_f32_16x16x32_bf16 v[188:191], v[212:215], a[180:183], v[188:191]
    s_waitcnt lgkmcnt(1)
    v_mfma_f32_16x16x32_bf16 v[172:175], v[216:219], a[152:155], v[172:175]
    v_mfma_f32_16x16x32_bf16 v[180:183], v[216:219], a[168:171], v[180:183]
    v_mfma_f32_16x16x32_bf16 v[188:191], v[216:219], a[184:187], v[188:191]
    s_waitcnt lgkmcnt(0)
    v_mfma_f32_16x16x32_bf16 v[172:175], v[220:223], a[156:159], v[172:175]
    v_mfma_f32_16x16x32_bf16 v[180:183], v[220:223], a[172:175], v[180:183]
    v_mfma_f32_16x16x32_bf16 v[188:191], v[220:223], a[188:191], v[188:191]
    s_lshl_b32 s48, s42, 13
    s_lshl_b32 s49, s57, 5
    v_subrev_u32 v246, s48, v247
    v_xor_b32 v246, s49, v246
    v_max3_f32 v232, v232, v168, v169
    s_add_u32 m0, s59, 16384
    s_add_u32 s68, s46, 180224
    buffer_load_dwordx4 v241, s[16:19], s68 offen offset:0 nt lds
    v_max3_f32 v233, v233, v176, v177
    v_max3_f32 v234, v234, v184, v185
    v_max3_f32 v232, v232, v170, v171
    v_max3_f32 v233, v233, v178, v179
    v_max3_f32 v234, v234, v186, v187
    v_max3_f32 v232, v232, v172, v173
    v_max3_f32 v233, v233, v180, v181
    v_max3_f32 v234, v234, v188, v189
    v_max3_f32 v232, v232, v174, v175
    v_max3_f32 v233, v233, v182, v183
    v_max3_f32 v234, v234, v190, v191
    v_mov_b32 v228, v232
    v_mov_b32 v229, v233
    v_mov_b32 v230, v234
    v_permlane32_swap_b32 v228, v232
    v_permlane32_swap_b32 v229, v233
    v_permlane32_swap_b32 v230, v234
    v_max_f32 v232, v228, v232
    v_max_f32 v233, v229, v233
    v_max_f32 v234, v230, v234
    v_mov_b32 v228, v232
    v_mov_b32 v229, v233
    v_mov_b32 v230, v234
    v_permlane16_swap_b32 v228, v232
    v_permlane16_swap_b32 v229, v233
    v_permlane16_swap_b32 v230, v234
    v_max_f32 v232, v228, v232
    v_max_f32 v233, v229, v233
    v_max_f32 v234, v230, v234
    v_mul_f32 v232, s52, v232
    v_mul_f32 v233, s52, v233
    v_mul_f32 v234, s52, v234
    v_mov_b32 v230, v233
    v_pk_fma_f32 v[0:1], v[0:1], s[52:53], v[232:233] op_sel_hi:[1,0,0] neg_lo:[0,0,1] neg_hi:[0,0,1]
    v_pk_fma_f32 v[2:3], v[2:3], s[52:53], v[232:233] op_sel_hi:[1,0,0] neg_lo:[0,0,1] neg_hi:[0,0,1]
    v_pk_fma_f32 v[4:5], v[4:5], s[52:53], v[232:233] op_sel_hi:[1,0,0] neg_lo:[0,0,1] neg_hi:[0,0,1]
    v_pk_fma_f32 v[6:7], v[6:7], s[52:53], v[232:233] op_sel_hi:[1,0,0] neg_lo:[0,0,1] neg_hi:[0,0,1]
    v_exp_f32 v0, v0
    v_exp_f32 v1, v1
    v_exp_f32 v2, v2
    v_exp_f32 v3, v3
    v_exp_f32 v4, v4
    v_exp_f32 v5, v5
    v_exp_f32 v6, v6
    s_add_u32 s68, s68, 3072
    v_xor_b32 v244, 128, v241
    buffer_load_dwordx4 v244, s[16:19], s68 offen offset:1024 nt lds
    v_exp_f32 v7, v7
    v_pk_add_f32 v[250:251], v[0:1], v[2:3]
    v_pk_add_f32 v[250:251], v[250:251], v[4:5]
    v_pk_add_f32 v[250:251], v[250:251], v[6:7]
    v_cvt_pk_bf16_f32 v0, v0, v1
    v_cvt_pk_bf16_f32 v1, v2, v3
    v_cvt_pk_bf16_f32 v2, v4, v5
    v_cvt_pk_bf16_f32 v3, v6, v7
    v_pk_fma_f32 v[8:9], v[8:9], s[52:53], v[230:231] op_sel_hi:[1,0,0] neg_lo:[0,0,1] neg_hi:[0,0,1]
    v_pk_fma_f32 v[10:11], v[10:11], s[52:53], v[230:231] op_sel_hi:[1,0,0] neg_lo:[0,0,1] neg_hi:[0,0,1]
    v_pk_fma_f32 v[12:13], v[12:13], s[52:53], v[230:231] op_sel_hi:[1,0,0] neg_lo:[0,0,1] neg_hi:[0,0,1]
    v_pk_fma_f32 v[14:15], v[14:15], s[52:53], v[230:231] op_sel_hi:[1,0,0] neg_lo:[0,0,1] neg_hi:[0,0,1]
    v_exp_f32 v8, v8
    v_exp_f32 v9, v9
    v_exp_f32 v10, v10
    v_exp_f32 v11, v11
    v_exp_f32 v12, v12
    v_exp_f32 v13, v13
    v_exp_f32 v14, v14
    v_exp_f32 v15, v15
    v_pk_add_f32 v[252:253], v[8:9], v[10:11]
    v_pk_add_f32 v[252:253], v[252:253], v[12:13]
    v_pk_add_f32 v[252:253], v[252:253], v[14:15]
    v_cvt_pk_bf16_f32 v4, v8, v9
    v_cvt_pk_bf16_f32 v5, v10, v11
    v_cvt_pk_bf16_f32 v6, v12, v13
    v_cvt_pk_bf16_f32 v7, v14, v15
    v_pk_fma_f32 v[16:17], v[16:17], s[52:53], v[234:235] op_sel_hi:[1,0,0] neg_lo:[0,0,1] neg_hi:[0,0,1]
    v_pk_fma_f32 v[18:19], v[18:19], s[52:53], v[234:235] op_sel_hi:[1,0,0] neg_lo:[0,0,1] neg_hi:[0,0,1]
    v_pk_fma_f32 v[20:21], v[20:21], s[52:53], v[234:235] op_sel_hi:[1,0,0] neg_lo:[0,0,1] neg_hi:[0,0,1]
    v_pk_fma_f32 v[22:23], v[22:23], s[52:53], v[234:235] op_sel_hi:[1,0,0] neg_lo:[0,0,1] neg_hi:[0,0,1]
    v_exp_f32 v16, v16
    v_exp_f32 v17, v17
    v_exp_f32 v18, v18
    v_exp_f32 v19, v19
    v_exp_f32 v20, v20
    s_add_u32 s68, s68, 3072
    buffer_load_dwordx4 v241, s[16:19], s68 offen offset:2048 nt lds
    v_exp_f32 v21, v21
    v_exp_f32 v22, v22
    v_exp_f32 v23, v23
    v_pk_add_f32 v[238:239], v[16:17], v[18:19]
    v_pk_add_f32 v[238:239], v[238:239], v[20:21]
    v_pk_add_f32 v[238:239], v[238:239], v[22:23]
    v_cvt_pk_bf16_f32 v8, v16, v17
    v_cvt_pk_bf16_f32 v9, v18, v19
    v_cvt_pk_bf16_f32 v10, v20, v21
    v_cvt_pk_bf16_f32 v11, v22, v23
    v_pk_fma_f32 v[24:25], v[24:25], s[52:53], v[232:233] op_sel_hi:[1,0,0] neg_lo:[0,0,1] neg_hi:[0,0,1]
    v_pk_fma_f32 v[26:27], v[26:27], s[52:53], v[232:233] op_sel_hi:[1,0,0] neg_lo:[0,0,1] neg_hi:[0,0,1]
    v_pk_fma_f32 v[28:29], v[28:29], s[52:53], v[232:233] op_sel_hi:[1,0,0] neg_lo:[0,0,1] neg_hi:[0,0,1]
    v_pk_fma_f32 v[30:31], v[30:31], s[52:53], v[232:233] op_sel_hi:[1,0,0] neg_lo:[0,0,1] neg_hi:[0,0,1]
    v_exp_f32 v24, v24
    v_exp_f32 v25, v25
    v_exp_f32 v26, v26
    v_exp_f32 v27, v27
    v_exp_f32 v28, v28
    v_exp_f32 v29, v29
    v_exp_f32 v30, v30
    v_exp_f32 v31, v31
    v_pk_add_f32 v[250:251], v[250:251], v[24:25]
    v_pk_add_f32 v[250:251], v[250:251], v[26:27]
    v_pk_add_f32 v[250:251], v[250:251], v[28:29]
    v_pk_add_f32 v[250:251], v[250:251], v[30:31]
    v_cvt_pk_bf16_f32 v12, v24, v25
    v_cvt_pk_bf16_f32 v13, v26, v27
    v_cvt_pk_bf16_f32 v14, v28, v29
    v_cvt_pk_bf16_f32 v15, v30, v31
    v_pk_fma_f32 v[32:33], v[32:33], s[52:53], v[230:231] op_sel_hi:[1,0,0] neg_lo:[0,0,1] neg_hi:[0,0,1]
    v_pk_fma_f32 v[34:35], v[34:35], s[52:53], v[230:231] op_sel_hi:[1,0,0] neg_lo:[0,0,1] neg_hi:[0,0,1]
    v_pk_fma_f32 v[36:37], v[36:37], s[52:53], v[230:231] op_sel_hi:[1,0,0] neg_lo:[0,0,1] neg_hi:[0,0,1]
    v_pk_fma_f32 v[38:39], v[38:39], s[52:53], v[230:231] op_sel_hi:[1,0,0] neg_lo:[0,0,1] neg_hi:[0,0,1]
    v_exp_f32 v32, v32
    v_exp_f32 v33, v33
    v_exp_f32 v34, v34
    s_add_u32 s68, s68, 3072
    buffer_load_dwordx4 v244, s[16:19], s68 offen offset:3072 nt lds
    v_exp_f32 v35, v35
    v_exp_f32 v36, v36
    v_exp_f32 v37, v37
    v_exp_f32 v38, v38
    v_exp_f32 v39, v39
    v_pk_add_f32 v[252:253], v[252:253], v[32:33]
    v_pk_add_f32 v[252:253], v[252:253], v[34:35]
    v_pk_add_f32 v[252:253], v[252:253], v[36:37]
    v_pk_add_f32 v[252:253], v[252:253], v[38:39]
    v_cvt_pk_bf16_f32 v16, v32, v33
    v_cvt_pk_bf16_f32 v17, v34, v35
    v_cvt_pk_bf16_f32 v18, v36, v37
    v_cvt_pk_bf16_f32 v19, v38, v39
    v_pk_fma_f32 v[40:41], v[40:41], s[52:53], v[234:235] op_sel_hi:[1,0,0] neg_lo:[0,0,1] neg_hi:[0,0,1]
    v_pk_fma_f32 v[42:43], v[42:43], s[52:53], v[234:235] op_sel_hi:[1,0,0] neg_lo:[0,0,1] neg_hi:[0,0,1]
    v_pk_fma_f32 v[44:45], v[44:45], s[52:53], v[234:235] op_sel_hi:[1,0,0] neg_lo:[0,0,1] neg_hi:[0,0,1]
    v_pk_fma_f32 v[46:47], v[46:47], s[52:53], v[234:235] op_sel_hi:[1,0,0] neg_lo:[0,0,1] neg_hi:[0,0,1]
    v_exp_f32 v40, v40
    v_exp_f32 v41, v41
    v_exp_f32 v42, v42
    v_exp_f32 v43, v43
    v_exp_f32 v44, v44
    v_exp_f32 v45, v45
    v_exp_f32 v46, v46
    v_exp_f32 v47, v47
    v_pk_add_f32 v[238:239], v[238:239], v[40:41]
    v_pk_add_f32 v[238:239], v[238:239], v[42:43]
    v_pk_add_f32 v[238:239], v[238:239], v[44:45]
    v_pk_add_f32 v[238:239], v[238:239], v[46:47]
    v_cvt_pk_bf16_f32 v20, v40, v41
    v_cvt_pk_bf16_f32 v21, v42, v43
    v_cvt_pk_bf16_f32 v22, v44, v45
    v_cvt_pk_bf16_f32 v23, v46, v47
    v_pk_fma_f32 v[48:49], v[48:49], s[52:53], v[232:233] op_sel_hi:[1,0,0] neg_lo:[0,0,1] neg_hi:[0,0,1]
    v_pk_fma_f32 v[50:51], v[50:51], s[52:53], v[232:233] op_sel_hi:[1,0,0] neg_lo:[0,0,1] neg_hi:[0,0,1]
    v_pk_fma_f32 v[52:53], v[52:53], s[52:53], v[232:233] op_sel_hi:[1,0,0] neg_lo:[0,0,1] neg_hi:[0,0,1]
    v_pk_fma_f32 v[54:55], v[54:55], s[52:53], v[232:233] op_sel_hi:[1,0,0] neg_lo:[0,0,1] neg_hi:[0,0,1]
    s_add_u32 m0, s59, 81920
    s_add_u32 s68, s46, 196608
    buffer_load_dwordx4 v241, s[16:19], s68 offen offset:0 nt lds
    v_exp_f32 v48, v48
    v_exp_f32 v49, v49
    v_exp_f32 v50, v50
    v_exp_f32 v51, v51
    v_exp_f32 v52, v52
    v_exp_f32 v53, v53
    v_exp_f32 v54, v54
    v_exp_f32 v55, v55
    v_pk_add_f32 v[250:251], v[250:251], v[48:49]
    v_pk_add_f32 v[250:251], v[250:251], v[50:51]
    v_pk_add_f32 v[250:251], v[250:251], v[52:53]
    v_pk_add_f32 v[250:251], v[250:251], v[54:55]
    v_cvt_pk_bf16_f32 v24, v48, v49
    v_cvt_pk_bf16_f32 v25, v50, v51
    v_cvt_pk_bf16_f32 v26, v52, v53
    v_cvt_pk_bf16_f32 v27, v54, v55
    v_pk_fma_f32 v[56:57], v[56:57], s[52:53], v[230:231] op_sel_hi:[1,0,0] neg_lo:[0,0,1] neg_hi:[0,0,1]
    v_pk_fma_f32 v[58:59], v[58:59], s[52:53], v[230:231] op_sel_hi:[1,0,0] neg_lo:[0,0,1] neg_hi:[0,0,1]
    v_pk_fma_f32 v[60:61], v[60:61], s[52:53], v[230:231] op_sel_hi:[1,0,0] neg_lo:[0,0,1] neg_hi:[0,0,1]
    v_pk_fma_f32 v[62:63], v[62:63], s[52:53], v[230:231] op_sel_hi:[1,0,0] neg_lo:[0,0,1] neg_hi:[0,0,1]
    v_exp_f32 v56, v56
    v_exp_f32 v57, v57
    v_exp_f32 v58, v58
    v_exp_f32 v59, v59
    v_exp_f32 v60, v60
    v_exp_f32 v61, v61
    v_exp_f32 v62, v62
    v_exp_f32 v63, v63
    v_pk_add_f32 v[252:253], v[252:253], v[56:57]
    v_pk_add_f32 v[252:253], v[252:253], v[58:59]
    v_pk_add_f32 v[252:253], v[252:253], v[60:61]
    v_pk_add_f32 v[252:253], v[252:253], v[62:63]
    v_cvt_pk_bf16_f32 v28, v56, v57
    v_cvt_pk_bf16_f32 v29, v58, v59
    s_add_u32 s68, s68, 3072
    v_xor_b32 v244, 128, v241
    buffer_load_dwordx4 v244, s[16:19], s68 offen offset:1024 nt lds
    v_cvt_pk_bf16_f32 v30, v60, v61
    v_cvt_pk_bf16_f32 v31, v62, v63
    v_pk_fma_f32 v[64:65], v[64:65], s[52:53], v[234:235] op_sel_hi:[1,0,0] neg_lo:[0,0,1] neg_hi:[0,0,1]
    v_pk_fma_f32 v[66:67], v[66:67], s[52:53], v[234:235] op_sel_hi:[1,0,0] neg_lo:[0,0,1] neg_hi:[0,0,1]
    v_pk_fma_f32 v[68:69], v[68:69], s[52:53], v[234:235] op_sel_hi:[1,0,0] neg_lo:[0,0,1] neg_hi:[0,0,1]
    v_pk_fma_f32 v[70:71], v[70:71], s[52:53], v[234:235] op_sel_hi:[1,0,0] neg_lo:[0,0,1] neg_hi:[0,0,1]
    v_exp_f32 v64, v64
    v_exp_f32 v65, v65
    v_exp_f32 v66, v66
    v_exp_f32 v67, v67
    v_exp_f32 v68, v68
    v_exp_f32 v69, v69
    v_exp_f32 v70, v70
    v_exp_f32 v71, v71
    v_pk_add_f32 v[238:239], v[238:239], v[64:65]
    v_pk_add_f32 v[238:239], v[238:239], v[66:67]
    v_pk_add_f32 v[238:239], v[238:239], v[68:69]
    v_pk_add_f32 v[238:239], v[238:239], v[70:71]
    v_cvt_pk_bf16_f32 v32, v64, v65
    v_cvt_pk_bf16_f32 v33, v66, v67
    v_cvt_pk_bf16_f32 v34, v68, v69
    v_cvt_pk_bf16_f32 v35, v70, v71
    v_pk_fma_f32 v[72:73], v[72:73], s[52:53], v[232:233] op_sel_hi:[1,0,0] neg_lo:[0,0,1] neg_hi:[0,0,1]
    v_pk_fma_f32 v[74:75], v[74:75], s[52:53], v[232:233] op_sel_hi:[1,0,0] neg_lo:[0,0,1] neg_hi:[0,0,1]
    v_pk_fma_f32 v[76:77], v[76:77], s[52:53], v[232:233] op_sel_hi:[1,0,0] neg_lo:[0,0,1] neg_hi:[0,0,1]
    v_pk_fma_f32 v[78:79], v[78:79], s[52:53], v[232:233] op_sel_hi:[1,0,0] neg_lo:[0,0,1] neg_hi:[0,0,1]
    v_exp_f32 v72, v72
    v_exp_f32 v73, v73
    v_exp_f32 v74, v74
    v_exp_f32 v75, v75
    v_exp_f32 v76, v76
    v_exp_f32 v77, v77
    v_exp_f32 v78, v78
    v_exp_f32 v79, v79
    s_add_u32 s68, s68, 3072
    buffer_load_dwordx4 v241, s[16:19], s68 offen offset:2048 nt lds
    v_pk_add_f32 v[250:251], v[250:251], v[72:73]
    v_pk_add_f32 v[250:251], v[250:251], v[74:75]
    v_pk_add_f32 v[250:251], v[250:251], v[76:77]
    v_pk_add_f32 v[250:251], v[250:251], v[78:79]
    v_cvt_pk_bf16_f32 v36, v72, v73
    v_cvt_pk_bf16_f32 v37, v74, v75
    v_cvt_pk_bf16_f32 v38, v76, v77
    v_cvt_pk_bf16_f32 v39, v78, v79
    v_pk_fma_f32 v[80:81], v[80:81], s[52:53], v[230:231] op_sel_hi:[1,0,0] neg_lo:[0,0,1] neg_hi:[0,0,1]
    v_pk_fma_f32 v[82:83], v[82:83], s[52:53], v[230:231] op_sel_hi:[1,0,0] neg_lo:[0,0,1] neg_hi:[0,0,1]
    v_pk_fma_f32 v[84:85], v[84:85], s[52:53], v[230:231] op_sel_hi:[1,0,0] neg_lo:[0,0,1] neg_hi:[0,0,1]
    v_pk_fma_f32 v[86:87], v[86:87], s[52:53], v[230:231] op_sel_hi:[1,0,0] neg_lo:[0,0,1] neg_hi:[0,0,1]
    v_exp_f32 v80, v80
    v_exp_f32 v81, v81
    v_exp_f32 v82, v82
    v_exp_f32 v83, v83
    v_exp_f32 v84, v84
    v_exp_f32 v85, v85
    v_exp_f32 v86, v86
    v_exp_f32 v87, v87
    v_pk_add_f32 v[252:253], v[252:253], v[80:81]
    v_pk_add_f32 v[252:253], v[252:253], v[82:83]
    v_pk_add_f32 v[252:253], v[252:253], v[84:85]
    v_pk_add_f32 v[252:253], v[252:253], v[86:87]
    v_cvt_pk_bf16_f32 v40, v80, v81
    v_cvt_pk_bf16_f32 v41, v82, v83
    v_cvt_pk_bf16_f32 v42, v84, v85
    v_cvt_pk_bf16_f32 v43, v86, v87
    v_pk_fma_f32 v[88:89], v[88:89], s[52:53], v[234:235] op_sel_hi:[1,0,0] neg_lo:[0,0,1] neg_hi:[0,0,1]
    v_pk_fma_f32 v[90:91], v[90:91], s[52:53], v[234:235] op_sel_hi:[1,0,0] neg_lo:[0,0,1] neg_hi:[0,0,1]
    v_pk_fma_f32 v[92:93], v[92:93], s[52:53], v[234:235] op_sel_hi:[1,0,0] neg_lo:[0,0,1] neg_hi:[0,0,1]
    v_pk_fma_f32 v[94:95], v[94:95], s[52:53], v[234:235] op_sel_hi:[1,0,0] neg_lo:[0,0,1] neg_hi:[0,0,1]
    v_exp_f32 v88, v88
    v_exp_f32 v89, v89
    v_exp_f32 v90, v90
    v_exp_f32 v91, v91
    v_exp_f32 v92, v92
    s_add_u32 s68, s68, 3072
    buffer_load_dwordx4 v244, s[16:19], s68 offen offset:3072 nt lds
    v_exp_f32 v93, v93
    v_exp_f32 v94, v94
    v_exp_f32 v95, v95
    v_pk_add_f32 v[238:239], v[238:239], v[88:89]
    v_pk_add_f32 v[238:239], v[238:239], v[90:91]
    v_pk_add_f32 v[238:239], v[238:239], v[92:93]
    v_pk_add_f32 v[238:239], v[238:239], v[94:95]
    v_cvt_pk_bf16_f32 v44, v88, v89
    v_cvt_pk_bf16_f32 v45, v90, v91
    v_cvt_pk_bf16_f32 v46, v92, v93
    v_cvt_pk_bf16_f32 v47, v94, v95
    v_pk_fma_f32 v[96:97], v[96:97], s[52:53], v[232:233] op_sel_hi:[1,0,0] neg_lo:[0,0,1] neg_hi:[0,0,1]
    v_pk_fma_f32 v[98:99], v[98:99], s[52:53], v[232:233] op_sel_hi:[1,0,0] neg_lo:[0,0,1] neg_hi:[0,0,1]
    v_pk_fma_f32 v[100:101], v[100:101], s[52:53], v[232:233] op_sel_hi:[1,0,0] neg_lo:[0,0,1] neg_hi:[0,0,1]
    v_pk_fma_f32 v[102:103], v[102:103], s[52:53], v[232:233] op_sel_hi:[1,0,0] neg_lo:[0,0,1] neg_hi:[0,0,1]
    v_exp_f32 v96, v96
    v_exp_f32 v97, v97
    v_exp_f32 v98, v98
    v_exp_f32 v99, v99
    v_exp_f32 v100, v100
    v_exp_f32 v101, v101
    v_exp_f32 v102, v102
    v_exp_f32 v103, v103
    v_pk_add_f32 v[250:251], v[250:251], v[96:97]
    v_pk_add_f32 v[250:251], v[250:251], v[98:99]
    v_pk_add_f32 v[250:251], v[250:251], v[100:101]
    v_pk_add_f32 v[250:251], v[250:251], v[102:103]
    v_cvt_pk_bf16_f32 v48, v96, v97
    v_cvt_pk_bf16_f32 v49, v98, v99
    v_cvt_pk_bf16_f32 v50, v100, v101
    v_cvt_pk_bf16_f32 v51, v102, v103
    v_pk_fma_f32 v[104:105], v[104:105], s[52:53], v[230:231] op_sel_hi:[1,0,0] neg_lo:[0,0,1] neg_hi:[0,0,1]
    v_pk_fma_f32 v[106:107], v[106:107], s[52:53], v[230:231] op_sel_hi:[1,0,0] neg_lo:[0,0,1] neg_hi:[0,0,1]
    v_pk_fma_f32 v[108:109], v[108:109], s[52:53], v[230:231] op_sel_hi:[1,0,0] neg_lo:[0,0,1] neg_hi:[0,0,1]
    v_pk_fma_f32 v[110:111], v[110:111], s[52:53], v[230:231] op_sel_hi:[1,0,0] neg_lo:[0,0,1] neg_hi:[0,0,1]
    v_exp_f32 v104, v104
    v_exp_f32 v105, v105
    s_add_u32 m0, s59, 32768
    s_add_u32 s68, s46, 212992
    buffer_load_dwordx4 v241, s[16:19], s68 offen offset:0 nt lds
    v_exp_f32 v106, v106
    v_exp_f32 v107, v107
    v_exp_f32 v108, v108
    v_exp_f32 v109, v109
    v_exp_f32 v110, v110
    v_exp_f32 v111, v111
    v_pk_add_f32 v[252:253], v[252:253], v[104:105]
    v_pk_add_f32 v[252:253], v[252:253], v[106:107]
    v_pk_add_f32 v[252:253], v[252:253], v[108:109]
    v_pk_add_f32 v[252:253], v[252:253], v[110:111]
    v_cvt_pk_bf16_f32 v52, v104, v105
    v_cvt_pk_bf16_f32 v53, v106, v107
    v_cvt_pk_bf16_f32 v54, v108, v109
    v_cvt_pk_bf16_f32 v55, v110, v111
    v_pk_fma_f32 v[112:113], v[112:113], s[52:53], v[234:235] op_sel_hi:[1,0,0] neg_lo:[0,0,1] neg_hi:[0,0,1]
    v_pk_fma_f32 v[114:115], v[114:115], s[52:53], v[234:235] op_sel_hi:[1,0,0] neg_lo:[0,0,1] neg_hi:[0,0,1]
    v_pk_fma_f32 v[116:117], v[116:117], s[52:53], v[234:235] op_sel_hi:[1,0,0] neg_lo:[0,0,1] neg_hi:[0,0,1]
    v_pk_fma_f32 v[118:119], v[118:119], s[52:53], v[234:235] op_sel_hi:[1,0,0] neg_lo:[0,0,1] neg_hi:[0,0,1]
    v_exp_f32 v112, v112
    v_exp_f32 v113, v113
    v_exp_f32 v114, v114
    v_exp_f32 v115, v115
    v_exp_f32 v116, v116
    v_exp_f32 v117, v117
    v_exp_f32 v118, v118
    v_exp_f32 v119, v119
    v_pk_add_f32 v[238:239], v[238:239], v[112:113]
    v_pk_add_f32 v[238:239], v[238:239], v[114:115]
    v_pk_add_f32 v[238:239], v[238:239], v[116:117]
    v_pk_add_f32 v[238:239], v[238:239], v[118:119]
    v_cvt_pk_bf16_f32 v56, v112, v113
    v_cvt_pk_bf16_f32 v57, v114, v115
    v_cvt_pk_bf16_f32 v58, v116, v117
    v_cvt_pk_bf16_f32 v59, v118, v119
    v_pk_fma_f32 v[120:121], v[120:121], s[52:53], v[232:233] op_sel_hi:[1,0,0] neg_lo:[0,0,1] neg_hi:[0,0,1]
    v_pk_fma_f32 v[122:123], v[122:123], s[52:53], v[232:233] op_sel_hi:[1,0,0] neg_lo:[0,0,1] neg_hi:[0,0,1]
    s_add_u32 s68, s68, 3072
    v_xor_b32 v244, 128, v241
    buffer_load_dwordx4 v244, s[16:19], s68 offen offset:1024 nt lds
    v_pk_fma_f32 v[124:125], v[124:125], s[52:53], v[232:233] op_sel_hi:[1,0,0] neg_lo:[0,0,1] neg_hi:[0,0,1]
    v_pk_fma_f32 v[126:127], v[126:127], s[52:53], v[232:233] op_sel_hi:[1,0,0] neg_lo:[0,0,1] neg_hi:[0,0,1]
    v_exp_f32 v120, v120
    v_exp_f32 v121, v121
    v_exp_f32 v122, v122
    v_exp_f32 v123, v123
    v_exp_f32 v124, v124
    v_exp_f32 v125, v125
    v_exp_f32 v126, v126
    v_exp_f32 v127, v127
    v_pk_add_f32 v[250:251], v[250:251], v[120:121]
    v_pk_add_f32 v[250:251], v[250:251], v[122:123]
    v_pk_add_f32 v[250:251], v[250:251], v[124:125]
    v_pk_add_f32 v[250:251], v[250:251], v[126:127]
    v_cvt_pk_bf16_f32 v60, v120, v121
    v_cvt_pk_bf16_f32 v61, v122, v123
    v_cvt_pk_bf16_f32 v62, v124, v125
    v_cvt_pk_bf16_f32 v63, v126, v127
    v_pk_fma_f32 v[128:129], v[128:129], s[52:53], v[230:231] op_sel_hi:[1,0,0] neg_lo:[0,0,1] neg_hi:[0,0,1]
    v_pk_fma_f32 v[130:131], v[130:131], s[52:53], v[230:231] op_sel_hi:[1,0,0] neg_lo:[0,0,1] neg_hi:[0,0,1]
    v_pk_fma_f32 v[132:133], v[132:133], s[52:53], v[230:231] op_sel_hi:[1,0,0] neg_lo:[0,0,1] neg_hi:[0,0,1]
    v_pk_fma_f32 v[134:135], v[134:135], s[52:53], v[230:231] op_sel_hi:[1,0,0] neg_lo:[0,0,1] neg_hi:[0,0,1]
    v_exp_f32 v128, v128
    v_exp_f32 v129, v129
    v_exp_f32 v130, v130
    v_exp_f32 v131, v131
    v_exp_f32 v132, v132
    v_exp_f32 v133, v133
    v_exp_f32 v134, v134
    v_exp_f32 v135, v135
    v_pk_add_f32 v[252:253], v[252:253], v[128:129]
    v_pk_add_f32 v[252:253], v[252:253], v[130:131]
    v_pk_add_f32 v[252:253], v[252:253], v[132:133]
    v_pk_add_f32 v[252:253], v[252:253], v[134:135]
    s_add_u32 s68, s68, 3072
    buffer_load_dwordx4 v241, s[16:19], s68 offen offset:2048 nt lds
    v_cvt_pk_bf16_f32 v64, v128, v129
    v_cvt_pk_bf16_f32 v65, v130, v131
    v_cvt_pk_bf16_f32 v66, v132, v133
    v_cvt_pk_bf16_f32 v67, v134, v135
    v_pk_fma_f32 v[136:137], v[136:137], s[52:53], v[234:235] op_sel_hi:[1,0,0] neg_lo:[0,0,1] neg_hi:[0,0,1]
    v_pk_fma_f32 v[138:139], v[138:139], s[52:53], v[234:235] op_sel_hi:[1,0,0] neg_lo:[0,0,1] neg_hi:[0,0,1]
    v_pk_fma_f32 v[140:141], v[140:141], s[52:53], v[234:235] op_sel_hi:[1,0,0] neg_lo:[0,0,1] neg_hi:[0,0,1]
    v_pk_fma_f32 v[142:143], v[142:143], s[52:53], v[234:235] op_sel_hi:[1,0,0] neg_lo:[0,0,1] neg_hi:[0,0,1]
    v_exp_f32 v136, v136
    v_exp_f32 v137, v137
    v_exp_f32 v138, v138
    v_exp_f32 v139, v139
    v_exp_f32 v140, v140
    v_exp_f32 v141, v141
    v_exp_f32 v142, v142
    v_exp_f32 v143, v143
    v_pk_add_f32 v[238:239], v[238:239], v[136:137]
    v_pk_add_f32 v[238:239], v[238:239], v[138:139]
    v_pk_add_f32 v[238:239], v[238:239], v[140:141]
    v_pk_add_f32 v[238:239], v[238:239], v[142:143]
    v_cvt_pk_bf16_f32 v68, v136, v137
    v_cvt_pk_bf16_f32 v69, v138, v139
    v_cvt_pk_bf16_f32 v70, v140, v141
    v_cvt_pk_bf16_f32 v71, v142, v143
    v_pk_fma_f32 v[144:145], v[144:145], s[52:53], v[232:233] op_sel_hi:[1,0,0] neg_lo:[0,0,1] neg_hi:[0,0,1]
    v_pk_fma_f32 v[146:147], v[146:147], s[52:53], v[232:233] op_sel_hi:[1,0,0] neg_lo:[0,0,1] neg_hi:[0,0,1]
    v_pk_fma_f32 v[148:149], v[148:149], s[52:53], v[232:233] op_sel_hi:[1,0,0] neg_lo:[0,0,1] neg_hi:[0,0,1]
    v_pk_fma_f32 v[150:151], v[150:151], s[52:53], v[232:233] op_sel_hi:[1,0,0] neg_lo:[0,0,1] neg_hi:[0,0,1]
    v_exp_f32 v144, v144
    v_exp_f32 v145, v145
    v_exp_f32 v146, v146
    v_exp_f32 v147, v147
    v_exp_f32 v148, v148
    v_exp_f32 v149, v149
    v_exp_f32 v150, v150
    s_add_u32 s68, s68, 3072
    buffer_load_dwordx4 v244, s[16:19], s68 offen offset:3072 nt lds
    v_exp_f32 v151, v151
    v_pk_add_f32 v[250:251], v[250:251], v[144:145]
    v_pk_add_f32 v[250:251], v[250:251], v[146:147]
    v_pk_add_f32 v[250:251], v[250:251], v[148:149]
    v_pk_add_f32 v[250:251], v[250:251], v[150:151]
    v_cvt_pk_bf16_f32 v72, v144, v145
    v_cvt_pk_bf16_f32 v73, v146, v147
    v_cvt_pk_bf16_f32 v74, v148, v149
    v_cvt_pk_bf16_f32 v75, v150, v151
    v_pk_fma_f32 v[152:153], v[152:153], s[52:53], v[230:231] op_sel_hi:[1,0,0] neg_lo:[0,0,1] neg_hi:[0,0,1]
    v_pk_fma_f32 v[154:155], v[154:155], s[52:53], v[230:231] op_sel_hi:[1,0,0] neg_lo:[0,0,1] neg_hi:[0,0,1]
    v_pk_fma_f32 v[156:157], v[156:157], s[52:53], v[230:231] op_sel_hi:[1,0,0] neg_lo:[0,0,1] neg_hi:[0,0,1]
    v_pk_fma_f32 v[158:159], v[158:159], s[52:53], v[230:231] op_sel_hi:[1,0,0] neg_lo:[0,0,1] neg_hi:[0,0,1]
    v_exp_f32 v152, v152
    v_exp_f32 v153, v153
    v_exp_f32 v154, v154
    v_exp_f32 v155, v155
    v_exp_f32 v156, v156
    v_exp_f32 v157, v157
    v_exp_f32 v158, v158
    v_exp_f32 v159, v159
    v_pk_add_f32 v[252:253], v[252:253], v[152:153]
    v_pk_add_f32 v[252:253], v[252:253], v[154:155]
    v_pk_add_f32 v[252:253], v[252:253], v[156:157]
    v_pk_add_f32 v[252:253], v[252:253], v[158:159]
    v_cvt_pk_bf16_f32 v76, v152, v153
    v_cvt_pk_bf16_f32 v77, v154, v155
    v_cvt_pk_bf16_f32 v78, v156, v157
    v_cvt_pk_bf16_f32 v79, v158, v159
    v_pk_fma_f32 v[160:161], v[160:161], s[52:53], v[234:235] op_sel_hi:[1,0,0] neg_lo:[0,0,1] neg_hi:[0,0,1]
    v_pk_fma_f32 v[162:163], v[162:163], s[52:53], v[234:235] op_sel_hi:[1,0,0] neg_lo:[0,0,1] neg_hi:[0,0,1]
    v_pk_fma_f32 v[164:165], v[164:165], s[52:53], v[234:235] op_sel_hi:[1,0,0] neg_lo:[0,0,1] neg_hi:[0,0,1]
    v_pk_fma_f32 v[166:167], v[166:167], s[52:53], v[234:235] op_sel_hi:[1,0,0] neg_lo:[0,0,1] neg_hi:[0,0,1]
    v_exp_f32 v160, v160
    v_exp_f32 v161, v161
    v_exp_f32 v162, v162
    v_exp_f32 v163, v163
    v_exp_f32 v164, v164
    v_exp_f32 v165, v165
    v_exp_f32 v166, v166
    v_exp_f32 v167, v167
    v_pk_add_f32 v[238:239], v[238:239], v[160:161]
    v_pk_add_f32 v[238:239], v[238:239], v[162:163]
    v_pk_add_f32 v[238:239], v[238:239], v[164:165]
    v_pk_add_f32 v[238:239], v[238:239], v[166:167]
    v_cvt_pk_bf16_f32 v80, v160, v161
    v_cvt_pk_bf16_f32 v81, v162, v163
    v_cvt_pk_bf16_f32 v82, v164, v165
    v_cvt_pk_bf16_f32 v83, v166, v167
    v_pk_fma_f32 v[168:169], v[168:169], s[52:53], v[232:233] op_sel_hi:[1,0,0] neg_lo:[0,0,1] neg_hi:[0,0,1]
    v_pk_fma_f32 v[170:171], v[170:171], s[52:53], v[232:233] op_sel_hi:[1,0,0] neg_lo:[0,0,1] neg_hi:[0,0,1]
    v_pk_fma_f32 v[172:173], v[172:173], s[52:53], v[232:233] op_sel_hi:[1,0,0] neg_lo:[0,0,1] neg_hi:[0,0,1]
    v_pk_fma_f32 v[174:175], v[174:175], s[52:53], v[232:233] op_sel_hi:[1,0,0] neg_lo:[0,0,1] neg_hi:[0,0,1]
    v_exp_f32 v168, v168
    v_exp_f32 v169, v169
    v_exp_f32 v170, v170
    v_exp_f32 v171, v171
    v_exp_f32 v172, v172
    v_exp_f32 v173, v173
    v_exp_f32 v174, v174
    v_exp_f32 v175, v175
    v_pk_add_f32 v[250:251], v[250:251], v[168:169]
    v_pk_add_f32 v[250:251], v[250:251], v[170:171]
    v_pk_add_f32 v[250:251], v[250:251], v[172:173]
    v_pk_add_f32 v[250:251], v[250:251], v[174:175]
    v_cvt_pk_bf16_f32 v84, v168, v169
    v_cvt_pk_bf16_f32 v85, v170, v171
    v_cvt_pk_bf16_f32 v86, v172, v173
    v_cvt_pk_bf16_f32 v87, v174, v175
    v_pk_fma_f32 v[176:177], v[176:177], s[52:53], v[230:231] op_sel_hi:[1,0,0] neg_lo:[0,0,1] neg_hi:[0,0,1]
    v_pk_fma_f32 v[178:179], v[178:179], s[52:53], v[230:231] op_sel_hi:[1,0,0] neg_lo:[0,0,1] neg_hi:[0,0,1]
    v_pk_fma_f32 v[180:181], v[180:181], s[52:53], v[230:231] op_sel_hi:[1,0,0] neg_lo:[0,0,1] neg_hi:[0,0,1]
    v_pk_fma_f32 v[182:183], v[182:183], s[52:53], v[230:231] op_sel_hi:[1,0,0] neg_lo:[0,0,1] neg_hi:[0,0,1]
    v_exp_f32 v176, v176
    v_exp_f32 v177, v177
    v_exp_f32 v178, v178
    v_exp_f32 v179, v179
    v_exp_f32 v180, v180
    v_exp_f32 v181, v181
    v_exp_f32 v182, v182
    v_exp_f32 v183, v183
    v_pk_add_f32 v[252:253], v[252:253], v[176:177]
    v_pk_add_f32 v[252:253], v[252:253], v[178:179]
    v_pk_add_f32 v[252:253], v[252:253], v[180:181]
    v_pk_add_f32 v[252:253], v[252:253], v[182:183]
    v_cvt_pk_bf16_f32 v88, v176, v177
    v_cvt_pk_bf16_f32 v89, v178, v179
    v_cvt_pk_bf16_f32 v90, v180, v181
    v_cvt_pk_bf16_f32 v91, v182, v183
    v_pk_fma_f32 v[184:185], v[184:185], s[52:53], v[234:235] op_sel_hi:[1,0,0] neg_lo:[0,0,1] neg_hi:[0,0,1]
    v_pk_fma_f32 v[186:187], v[186:187], s[52:53], v[234:235] op_sel_hi:[1,0,0] neg_lo:[0,0,1] neg_hi:[0,0,1]
    v_pk_fma_f32 v[188:189], v[188:189], s[52:53], v[234:235] op_sel_hi:[1,0,0] neg_lo:[0,0,1] neg_hi:[0,0,1]
    v_pk_fma_f32 v[190:191], v[190:191], s[52:53], v[234:235] op_sel_hi:[1,0,0] neg_lo:[0,0,1] neg_hi:[0,0,1]
    v_exp_f32 v184, v184
    v_exp_f32 v185, v185
    v_exp_f32 v186, v186
    v_exp_f32 v187, v187
    v_exp_f32 v188, v188
    v_exp_f32 v189, v189
    v_exp_f32 v190, v190
    v_exp_f32 v191, v191
    v_pk_add_f32 v[238:239], v[238:239], v[184:185]
    v_pk_add_f32 v[238:239], v[238:239], v[186:187]
    v_pk_add_f32 v[238:239], v[238:239], v[188:189]
    v_pk_add_f32 v[238:239], v[238:239], v[190:191]
    v_cvt_pk_bf16_f32 v92, v184, v185
    v_cvt_pk_bf16_f32 v93, v186, v187
    v_cvt_pk_bf16_f32 v94, v188, v189
    v_cvt_pk_bf16_f32 v95, v190, v191
    v_add_f32 v235, v250, v251
    v_add_f32 v236, v252, v253
    v_add_f32 v237, v238, v239
    v_mov_b32 v228, v235
    v_mov_b32 v229, v236
    v_mov_b32 v230, v237
    v_permlane32_swap_b32 v228, v235
    v_permlane32_swap_b32 v229, v236
    v_permlane32_swap_b32 v230, v237
    v_add_f32 v235, v228, v235
    v_add_f32 v236, v229, v236
    v_add_f32 v237, v230, v237
    v_mov_b32 v228, v235
    v_mov_b32 v229, v236
    v_mov_b32 v230, v237
    v_permlane16_swap_b32 v228, v235
    v_permlane16_swap_b32 v229, v236
    v_permlane16_swap_b32 v230, v237
    v_add_f32 v235, v228, v235
    v_add_f32 v236, v229, v236
    v_add_f32 v237, v230, v237
    s_lshl_b32 s48, s40, 11
    s_add_u32 s48, s48, 114688
    v_add_u32 v228, s48, v248
    v_xor_b32 v238, 4096, v228
    ds_write_b128 v228, v[232:235]
    ds_write_b64 v228, v[236:237] offset:1024
    v_add_u32 v224, 65536, v247
    v_xor_b32 v225, 32, v224
    v_xor_b32 v226, 64, v224
    v_xor_b32 v227, 96, v224
    v_xor_b32 v228, 128, v224
    v_xor_b32 v229, 160, v224
    v_xor_b32 v230, 192, v224
    v_xor_b32 v231, 224, v224
    s_waitcnt vmcnt(21) lgkmcnt(0)
    s_barrier
    ds_read_b64_tr_b16 v[192:193], v224 offset:0
    ds_read_b64_tr_b16 v[194:195], v224 offset:4096
    ds_read_b128 a[240:243], v238
    ds_read_b64 a[244:245], v238 offset:1024
    ds_read_b64_tr_b16 v[196:197], v225 offset:0
    ds_read_b64_tr_b16 v[198:199], v225 offset:4096
    ds_read_b64_tr_b16 v[200:201], v226 offset:0
    ds_read_b64_tr_b16 v[202:203], v226 offset:4096
    ds_read_b64_tr_b16 v[204:205], v227 offset:0
    ds_read_b64_tr_b16 v[206:207], v227 offset:4096
    ds_read_b64_tr_b16 v[208:209], v228 offset:0
    ds_read_b64_tr_b16 v[210:211], v228 offset:4096
    s_waitcnt lgkmcnt(8)
    v_mfma_f32_16x16x32_bf16 v[96:99], v[192:195], v[0:3], 0
    v_mfma_f32_16x16x32_bf16 v[100:103], v[192:195], v[4:7], 0
    ds_read_b64_tr_b16 v[212:213], v229 offset:0
    ds_read_b64_tr_b16 v[214:215], v229 offset:4096
    v_mfma_f32_16x16x32_bf16 v[104:107], v[192:195], v[8:11], 0
    s_waitcnt lgkmcnt(8)
    v_mfma_f32_16x16x32_bf16 v[108:111], v[196:199], v[0:3], 0
    v_mfma_f32_16x16x32_bf16 v[112:115], v[196:199], v[4:7], 0
    ds_read_b64_tr_b16 v[216:217], v230 offset:0
    ds_read_b64_tr_b16 v[218:219], v230 offset:4096
    v_mfma_f32_16x16x32_bf16 v[116:119], v[196:199], v[8:11], 0
    s_waitcnt lgkmcnt(8)
    v_mfma_f32_16x16x32_bf16 v[120:123], v[200:203], v[0:3], 0
    v_mfma_f32_16x16x32_bf16 v[124:127], v[200:203], v[4:7], 0
    ds_read_b64_tr_b16 v[220:221], v231 offset:0
    ds_read_b64_tr_b16 v[222:223], v231 offset:4096
    v_mfma_f32_16x16x32_bf16 v[128:131], v[200:203], v[8:11], 0
    s_waitcnt lgkmcnt(8)
    v_mfma_f32_16x16x32_bf16 v[132:135], v[204:207], v[0:3], 0
    v_add_u32 v224, 0, v247
    v_xor_b32 v225, 32, v224
    v_mfma_f32_16x16x32_bf16 v[136:139], v[204:207], v[4:7], 0
    v_xor_b32 v226, 64, v224
    v_xor_b32 v227, 96, v224
    v_mfma_f32_16x16x32_bf16 v[140:143], v[204:207], v[8:11], 0
    v_xor_b32 v228, 128, v224
    v_xor_b32 v229, 160, v224
    s_waitcnt lgkmcnt(6)
    v_mfma_f32_16x16x32_bf16 v[144:147], v[208:211], v[0:3], 0
    v_xor_b32 v230, 192, v224
    v_xor_b32 v231, 224, v224
    v_mfma_f32_16x16x32_bf16 v[148:151], v[208:211], v[4:7], 0
    v_mfma_f32_16x16x32_bf16 v[152:155], v[208:211], v[8:11], 0
    s_waitcnt vmcnt(16) lgkmcnt(0)
    s_barrier
    v_mfma_f32_16x16x32_bf16 v[156:159], v[212:215], v[0:3], 0
    ds_read_b64_tr_b16 v[192:193], v224 offset:0
    ds_read_b64_tr_b16 v[194:195], v224 offset:4096
    v_mfma_f32_16x16x32_bf16 v[160:163], v[212:215], v[4:7], 0
    ds_read_b64_tr_b16 v[196:197], v225 offset:0
    ds_read_b64_tr_b16 v[198:199], v225 offset:4096
    v_mfma_f32_16x16x32_bf16 v[164:167], v[212:215], v[8:11], 0
    ds_read_b64_tr_b16 v[200:201], v226 offset:0
    ds_read_b64_tr_b16 v[202:203], v226 offset:4096
    v_mfma_f32_16x16x32_bf16 v[168:171], v[216:219], v[0:3], 0
    ds_read_b64_tr_b16 v[204:205], v227 offset:0
    ds_read_b64_tr_b16 v[206:207], v227 offset:4096
    v_mfma_f32_16x16x32_bf16 v[172:175], v[216:219], v[4:7], 0
    ds_read_b64_tr_b16 v[208:209], v228 offset:0
    ds_read_b64_tr_b16 v[210:211], v228 offset:4096
    v_mfma_f32_16x16x32_bf16 v[176:179], v[216:219], v[8:11], 0
    v_mfma_f32_16x16x32_bf16 v[180:183], v[220:223], v[0:3], 0
    v_mfma_f32_16x16x32_bf16 v[184:187], v[220:223], v[4:7], 0
    v_mfma_f32_16x16x32_bf16 v[188:191], v[220:223], v[8:11], 0
    v_accvgpr_read_b32 v238, a240
    v_accvgpr_read_b32 v239, a243
    v_max_f32 v249, v238, v232
    v_sub_f32 v252, v238, v249
    v_sub_f32 v249, v232, v249
    v_exp_f32 v252, v252
    v_exp_f32 v249, v249
    v_mul_f32 v239, v239, v252
    v_fma_f32 v239, v235, v249, v239
    v_rcp_f32 v239, v239
    s_nop 0
    v_mul_f32 v249, v249, v239
    v_mul_f32 v252, v252, v239
    v_accvgpr_read_b32 v238, a241
    v_accvgpr_read_b32 v239, a244
    v_max_f32 v250, v238, v233
    v_sub_f32 v253, v238, v250
    v_sub_f32 v250, v233, v250
    v_exp_f32 v253, v253
    v_exp_f32 v250, v250
    v_mul_f32 v239, v239, v253
    v_fma_f32 v239, v236, v250, v239
    v_rcp_f32 v239, v239
    s_nop 0
    v_mul_f32 v250, v250, v239
    v_mul_f32 v253, v253, v239
    v_accvgpr_read_b32 v238, a242
    v_accvgpr_read_b32 v239, a245
    v_max_f32 v251, v238, v234
    v_sub_f32 v254, v238, v251
    v_sub_f32 v251, v234, v251
    v_exp_f32 v254, v254
    v_exp_f32 v251, v251
    v_mul_f32 v239, v239, v254
    v_fma_f32 v239, v237, v251, v239
    v_rcp_f32 v239, v239
    s_nop 0
    v_mul_f32 v251, v251, v239
    v_mul_f32 v254, v254, v239
    s_waitcnt lgkmcnt(8)
    v_mfma_f32_16x16x32_bf16 v[96:99], v[192:195], v[12:15], v[96:99]
    v_mfma_f32_16x16x32_bf16 v[100:103], v[192:195], v[16:19], v[100:103]
    ds_read_b64_tr_b16 v[212:213], v229 offset:0
    ds_read_b64_tr_b16 v[214:215], v229 offset:4096
    v_mfma_f32_16x16x32_bf16 v[104:107], v[192:195], v[20:23], v[104:107]
    s_waitcnt lgkmcnt(8)
    v_mfma_f32_16x16x32_bf16 v[108:111], v[196:199], v[12:15], v[108:111]
    v_mfma_f32_16x16x32_bf16 v[112:115], v[196:199], v[16:19], v[112:115]
    ds_read_b64_tr_b16 v[216:217], v230 offset:0
    ds_read_b64_tr_b16 v[218:219], v230 offset:4096
    v_mfma_f32_16x16x32_bf16 v[116:119], v[196:199], v[20:23], v[116:119]
    s_waitcnt lgkmcnt(8)
    v_mfma_f32_16x16x32_bf16 v[120:123], v[200:203], v[12:15], v[120:123]
    v_mfma_f32_16x16x32_bf16 v[124:127], v[200:203], v[16:19], v[124:127]
    ds_read_b64_tr_b16 v[220:221], v231 offset:0
    ds_read_b64_tr_b16 v[222:223], v231 offset:4096
    v_mfma_f32_16x16x32_bf16 v[128:131], v[200:203], v[20:23], v[128:131]
    s_waitcnt lgkmcnt(8)
    v_mfma_f32_16x16x32_bf16 v[132:135], v[204:207], v[12:15], v[132:135]
    v_add_u32 v224, 49152, v247
    v_xor_b32 v225, 32, v224
    v_mfma_f32_16x16x32_bf16 v[136:139], v[204:207], v[16:19], v[136:139]
    v_xor_b32 v226, 64, v224
    v_xor_b32 v227, 96, v224
    v_mfma_f32_16x16x32_bf16 v[140:143], v[204:207], v[20:23], v[140:143]
    v_xor_b32 v228, 128, v224
    v_xor_b32 v229, 160, v224
    s_waitcnt lgkmcnt(6)
    v_mfma_f32_16x16x32_bf16 v[144:147], v[208:211], v[12:15], v[144:147]
    v_xor_b32 v230, 192, v224
    v_xor_b32 v231, 224, v224
    v_mfma_f32_16x16x32_bf16 v[148:151], v[208:211], v[16:19], v[148:151]
    v_mfma_f32_16x16x32_bf16 v[152:155], v[208:211], v[20:23], v[152:155]
    s_waitcnt vmcnt(12) lgkmcnt(0)
    s_barrier
    v_bfe_u32 v238, v248, 4, 2
    v_lshl_add_u32 v238, v238, 2, s63
    buffer_load_dword v237, v238, s[32:35], 0 offen offset:0 sc1
    v_mfma_f32_16x16x32_bf16 v[156:159], v[212:215], v[12:15], v[156:159]
    ds_read_b64_tr_b16 v[192:193], v224 offset:0
    ds_read_b64_tr_b16 v[194:195], v224 offset:4096
    v_mfma_f32_16x16x32_bf16 v[160:163], v[212:215], v[16:19], v[160:163]
    ds_read_b64_tr_b16 v[196:197], v225 offset:0
    ds_read_b64_tr_b16 v[198:199], v225 offset:4096
    v_mfma_f32_16x16x32_bf16 v[164:167], v[212:215], v[20:23], v[164:167]
    ds_read_b64_tr_b16 v[200:201], v226 offset:0
    ds_read_b64_tr_b16 v[202:203], v226 offset:4096
    v_mfma_f32_16x16x32_bf16 v[168:171], v[216:219], v[12:15], v[168:171]
    ds_read_b64_tr_b16 v[204:205], v227 offset:0
    ds_read_b64_tr_b16 v[206:207], v227 offset:4096
    v_mfma_f32_16x16x32_bf16 v[172:175], v[216:219], v[16:19], v[172:175]
    ds_read_b64_tr_b16 v[208:209], v228 offset:0
    ds_read_b64_tr_b16 v[210:211], v228 offset:4096
    v_mfma_f32_16x16x32_bf16 v[176:179], v[216:219], v[20:23], v[176:179]
    v_mfma_f32_16x16x32_bf16 v[180:183], v[220:223], v[12:15], v[180:183]
    v_mfma_f32_16x16x32_bf16 v[184:187], v[220:223], v[16:19], v[184:187]
    v_mfma_f32_16x16x32_bf16 v[188:191], v[220:223], v[20:23], v[188:191]
    s_waitcnt lgkmcnt(8)
    v_mfma_f32_16x16x32_bf16 v[96:99], v[192:195], v[24:27], v[96:99]
    v_mfma_f32_16x16x32_bf16 v[100:103], v[192:195], v[28:31], v[100:103]
    ds_read_b64_tr_b16 v[212:213], v229 offset:0
    ds_read_b64_tr_b16 v[214:215], v229 offset:4096
    v_mfma_f32_16x16x32_bf16 v[104:107], v[192:195], v[32:35], v[104:107]
    s_waitcnt lgkmcnt(8)
    v_mfma_f32_16x16x32_bf16 v[108:111], v[196:199], v[24:27], v[108:111]
    v_mfma_f32_16x16x32_bf16 v[112:115], v[196:199], v[28:31], v[112:115]
    ds_read_b64_tr_b16 v[216:217], v230 offset:0
    ds_read_b64_tr_b16 v[218:219], v230 offset:4096
    v_mfma_f32_16x16x32_bf16 v[116:119], v[196:199], v[32:35], v[116:119]
    s_waitcnt lgkmcnt(8)
    v_mfma_f32_16x16x32_bf16 v[120:123], v[200:203], v[24:27], v[120:123]
    v_mfma_f32_16x16x32_bf16 v[124:127], v[200:203], v[28:31], v[124:127]
    ds_read_b64_tr_b16 v[220:221], v231 offset:0
    ds_read_b64_tr_b16 v[222:223], v231 offset:4096
    v_mfma_f32_16x16x32_bf16 v[128:131], v[200:203], v[32:35], v[128:131]
    s_waitcnt lgkmcnt(8)
    v_mfma_f32_16x16x32_bf16 v[132:135], v[204:207], v[24:27], v[132:135]
    v_add_u32 v224, 16384, v247
    v_xor_b32 v225, 32, v224
    v_mfma_f32_16x16x32_bf16 v[136:139], v[204:207], v[28:31], v[136:139]
    v_xor_b32 v226, 64, v224
    v_xor_b32 v227, 96, v224
    v_mfma_f32_16x16x32_bf16 v[140:143], v[204:207], v[32:35], v[140:143]
    v_xor_b32 v228, 128, v224
    v_xor_b32 v229, 160, v224
    s_waitcnt lgkmcnt(6)
    v_mfma_f32_16x16x32_bf16 v[144:147], v[208:211], v[24:27], v[144:147]
    v_xor_b32 v230, 192, v224
    v_xor_b32 v231, 224, v224
    v_mfma_f32_16x16x32_bf16 v[148:151], v[208:211], v[28:31], v[148:151]
    v_mfma_f32_16x16x32_bf16 v[152:155], v[208:211], v[32:35], v[152:155]
    s_waitcnt vmcnt(9) lgkmcnt(0)
    s_barrier
    v_mfma_f32_16x16x32_bf16 v[156:159], v[212:215], v[24:27], v[156:159]
    ds_read_b64_tr_b16 v[192:193], v224 offset:0
    ds_read_b64_tr_b16 v[194:195], v224 offset:4096
    s_add_u32 m0, s59, 98304
    s_add_u32 s68, s46, 229376
    buffer_load_dwordx4 v241, s[16:19], s68 offen offset:0 nt lds
    v_mfma_f32_16x16x32_bf16 v[160:163], v[212:215], v[28:31], v[160:163]
    ds_read_b64_tr_b16 v[196:197], v225 offset:0
    ds_read_b64_tr_b16 v[198:199], v225 offset:4096
    v_mfma_f32_16x16x32_bf16 v[164:167], v[212:215], v[32:35], v[164:167]
    ds_read_b64_tr_b16 v[200:201], v226 offset:0
    ds_read_b64_tr_b16 v[202:203], v226 offset:4096
    v_mfma_f32_16x16x32_bf16 v[168:171], v[216:219], v[24:27], v[168:171]
    ds_read_b64_tr_b16 v[204:205], v227 offset:0
    ds_read_b64_tr_b16 v[206:207], v227 offset:4096
    v_mfma_f32_16x16x32_bf16 v[172:175], v[216:219], v[28:31], v[172:175]
    ds_read_b64_tr_b16 v[208:209], v228 offset:0
    ds_read_b64_tr_b16 v[210:211], v228 offset:4096
    s_add_u32 s68, s68, 3072
    v_xor_b32 v244, 128, v241
    buffer_load_dwordx4 v244, s[16:19], s68 offen offset:1024 nt lds
    v_mfma_f32_16x16x32_bf16 v[176:179], v[216:219], v[32:35], v[176:179]
    v_mfma_f32_16x16x32_bf16 v[180:183], v[220:223], v[24:27], v[180:183]
    v_mfma_f32_16x16x32_bf16 v[184:187], v[220:223], v[28:31], v[184:187]
    v_mfma_f32_16x16x32_bf16 v[188:191], v[220:223], v[32:35], v[188:191]
    s_add_u32 s68, s68, 3072
    buffer_load_dwordx4 v241, s[16:19], s68 offen offset:2048 nt lds
    s_waitcnt lgkmcnt(8)
    v_mfma_f32_16x16x32_bf16 v[96:99], v[192:195], v[36:39], v[96:99]
    v_mfma_f32_16x16x32_bf16 v[100:103], v[192:195], v[40:43], v[100:103]
    ds_read_b64_tr_b16 v[212:213], v229 offset:0
    ds_read_b64_tr_b16 v[214:215], v229 offset:4096
    v_mfma_f32_16x16x32_bf16 v[104:107], v[192:195], v[44:47], v[104:107]
    s_waitcnt lgkmcnt(8)
    v_mfma_f32_16x16x32_bf16 v[108:111], v[196:199], v[36:39], v[108:111]
    s_add_u32 s68, s68, 3072
    buffer_load_dwordx4 v244, s[16:19], s68 offen offset:3072 nt lds
    v_mfma_f32_16x16x32_bf16 v[112:115], v[196:199], v[40:43], v[112:115]
    ds_read_b64_tr_b16 v[216:217], v230 offset:0
    ds_read_b64_tr_b16 v[218:219], v230 offset:4096
    v_mfma_f32_16x16x32_bf16 v[116:119], v[196:199], v[44:47], v[116:119]
    s_waitcnt lgkmcnt(8)
    v_mfma_f32_16x16x32_bf16 v[120:123], v[200:203], v[36:39], v[120:123]
    v_mfma_f32_16x16x32_bf16 v[124:127], v[200:203], v[40:43], v[124:127]
    ds_read_b64_tr_b16 v[220:221], v231 offset:0
    ds_read_b64_tr_b16 v[222:223], v231 offset:4096
    v_mfma_f32_16x16x32_bf16 v[128:131], v[200:203], v[44:47], v[128:131]
    s_waitcnt lgkmcnt(8)
    v_mfma_f32_16x16x32_bf16 v[132:135], v[204:207], v[36:39], v[132:135]
    v_add_u32 v224, 81920, v247
    v_xor_b32 v225, 32, v224
    v_mfma_f32_16x16x32_bf16 v[136:139], v[204:207], v[40:43], v[136:139]
    v_xor_b32 v226, 64, v224
    v_xor_b32 v227, 96, v224
    v_mfma_f32_16x16x32_bf16 v[140:143], v[204:207], v[44:47], v[140:143]
    v_xor_b32 v228, 128, v224
    v_xor_b32 v229, 160, v224
    s_waitcnt lgkmcnt(6)
    v_mfma_f32_16x16x32_bf16 v[144:147], v[208:211], v[36:39], v[144:147]
    v_xor_b32 v230, 192, v224
    v_xor_b32 v231, 224, v224
    v_mfma_f32_16x16x32_bf16 v[148:151], v[208:211], v[40:43], v[148:151]
    v_mfma_f32_16x16x32_bf16 v[152:155], v[208:211], v[44:47], v[152:155]
    s_waitcnt vmcnt(9) lgkmcnt(0)
    s_barrier
    v_mfma_f32_16x16x32_bf16 v[156:159], v[212:215], v[36:39], v[156:159]
    ds_read_b64_tr_b16 v[192:193], v224 offset:0
    ds_read_b64_tr_b16 v[194:195], v224 offset:4096
    s_add_u32 m0, s59, 65536
    s_add_u32 s68, s46, 245760
    buffer_load_dwordx4 v241, s[16:19], s68 offen offset:0 nt lds
    v_mfma_f32_16x16x32_bf16 v[160:163], v[212:215], v[40:43], v[160:163]
    ds_read_b64_tr_b16 v[196:197], v225 offset:0
    ds_read_b64_tr_b16 v[198:199], v225 offset:4096
    v_mfma_f32_16x16x32_bf16 v[164:167], v[212:215], v[44:47], v[164:167]
    ds_read_b64_tr_b16 v[200:201], v226 offset:0
    ds_read_b64_tr_b16 v[202:203], v226 offset:4096
    v_mfma_f32_16x16x32_bf16 v[168:171], v[216:219], v[36:39], v[168:171]
    ds_read_b64_tr_b16 v[204:205], v227 offset:0
    ds_read_b64_tr_b16 v[206:207], v227 offset:4096
    v_mfma_f32_16x16x32_bf16 v[172:175], v[216:219], v[40:43], v[172:175]
    ds_read_b64_tr_b16 v[208:209], v228 offset:0
    ds_read_b64_tr_b16 v[210:211], v228 offset:4096
    s_add_u32 s68, s68, 3072
    v_xor_b32 v244, 128, v241
    buffer_load_dwordx4 v244, s[16:19], s68 offen offset:1024 nt lds
    v_mfma_f32_16x16x32_bf16 v[176:179], v[216:219], v[44:47], v[176:179]
    v_mfma_f32_16x16x32_bf16 v[180:183], v[220:223], v[36:39], v[180:183]
    v_mfma_f32_16x16x32_bf16 v[184:187], v[220:223], v[40:43], v[184:187]
    v_mfma_f32_16x16x32_bf16 v[188:191], v[220:223], v[44:47], v[188:191]
    s_add_u32 s68, s68, 3072
    buffer_load_dwordx4 v241, s[16:19], s68 offen offset:2048 nt lds
    s_waitcnt lgkmcnt(8)
    v_mfma_f32_16x16x32_bf16 v[96:99], v[192:195], v[48:51], v[96:99]
    v_mfma_f32_16x16x32_bf16 v[100:103], v[192:195], v[52:55], v[100:103]
    ds_read_b64_tr_b16 v[212:213], v229 offset:0
    ds_read_b64_tr_b16 v[214:215], v229 offset:4096
    v_mfma_f32_16x16x32_bf16 v[104:107], v[192:195], v[56:59], v[104:107]
    s_waitcnt lgkmcnt(8)
    v_mfma_f32_16x16x32_bf16 v[108:111], v[196:199], v[48:51], v[108:111]
    s_add_u32 s68, s68, 3072
    buffer_load_dwordx4 v244, s[16:19], s68 offen offset:3072 nt lds
    v_mfma_f32_16x16x32_bf16 v[112:115], v[196:199], v[52:55], v[112:115]
    ds_read_b64_tr_b16 v[216:217], v230 offset:0
    ds_read_b64_tr_b16 v[218:219], v230 offset:4096
    v_mfma_f32_16x16x32_bf16 v[116:119], v[196:199], v[56:59], v[116:119]
    s_waitcnt lgkmcnt(8)
    v_mfma_f32_16x16x32_bf16 v[120:123], v[200:203], v[48:51], v[120:123]
    v_mfma_f32_16x16x32_bf16 v[124:127], v[200:203], v[52:55], v[124:127]
    ds_read_b64_tr_b16 v[220:221], v231 offset:0
    ds_read_b64_tr_b16 v[222:223], v231 offset:4096
    v_mfma_f32_16x16x32_bf16 v[128:131], v[200:203], v[56:59], v[128:131]
    s_waitcnt lgkmcnt(8)
    v_mfma_f32_16x16x32_bf16 v[132:135], v[204:207], v[48:51], v[132:135]
    v_add_u32 v224, 32768, v247
    v_xor_b32 v225, 32, v224
    v_mfma_f32_16x16x32_bf16 v[136:139], v[204:207], v[52:55], v[136:139]
    v_xor_b32 v226, 64, v224
    v_xor_b32 v227, 96, v224
    v_mfma_f32_16x16x32_bf16 v[140:143], v[204:207], v[56:59], v[140:143]
    v_xor_b32 v228, 128, v224
    v_xor_b32 v229, 160, v224
    s_waitcnt lgkmcnt(6)
    v_mfma_f32_16x16x32_bf16 v[144:147], v[208:211], v[48:51], v[144:147]
    v_xor_b32 v230, 192, v224
    v_xor_b32 v231, 224, v224
    v_mfma_f32_16x16x32_bf16 v[148:151], v[208:211], v[52:55], v[148:151]
    v_mfma_f32_16x16x32_bf16 v[152:155], v[208:211], v[56:59], v[152:155]
    s_waitcnt vmcnt(9) lgkmcnt(0)
    s_barrier
    v_mfma_f32_16x16x32_bf16 v[156:159], v[212:215], v[48:51], v[156:159]
    ds_read_b64_tr_b16 v[192:193], v224 offset:0
    ds_read_b64_tr_b16 v[194:195], v224 offset:4096
    v_mfma_f32_16x16x32_bf16 v[160:163], v[212:215], v[52:55], v[160:163]
    ds_read_b64_tr_b16 v[196:197], v225 offset:0
    ds_read_b64_tr_b16 v[198:199], v225 offset:4096
    v_mfma_f32_16x16x32_bf16 v[164:167], v[212:215], v[56:59], v[164:167]
    ds_read_b64_tr_b16 v[200:201], v226 offset:0
    ds_read_b64_tr_b16 v[202:203], v226 offset:4096
    v_mfma_f32_16x16x32_bf16 v[168:171], v[216:219], v[48:51], v[168:171]
    ds_read_b64_tr_b16 v[204:205], v227 offset:0
    ds_read_b64_tr_b16 v[206:207], v227 offset:4096
    v_mfma_f32_16x16x32_bf16 v[172:175], v[216:219], v[52:55], v[172:175]
    ds_read_b64_tr_b16 v[208:209], v228 offset:0
    ds_read_b64_tr_b16 v[210:211], v228 offset:4096
    v_mfma_f32_16x16x32_bf16 v[176:179], v[216:219], v[56:59], v[176:179]
    v_mfma_f32_16x16x32_bf16 v[180:183], v[220:223], v[48:51], v[180:183]
    v_mfma_f32_16x16x32_bf16 v[184:187], v[220:223], v[52:55], v[184:187]
    v_mfma_f32_16x16x32_bf16 v[188:191], v[220:223], v[56:59], v[188:191]
    s_waitcnt lgkmcnt(8)
    v_mfma_f32_16x16x32_bf16 v[96:99], v[192:195], v[60:63], v[96:99]
    v_mfma_f32_16x16x32_bf16 v[100:103], v[192:195], v[64:67], v[100:103]
    ds_read_b64_tr_b16 v[212:213], v229 offset:0
    ds_read_b64_tr_b16 v[214:215], v229 offset:4096
    v_mfma_f32_16x16x32_bf16 v[104:107], v[192:195], v[68:71], v[104:107]
    s_waitcnt lgkmcnt(8)
    v_mfma_f32_16x16x32_bf16 v[108:111], v[196:199], v[60:63], v[108:111]
    v_mfma_f32_16x16x32_bf16 v[112:115], v[196:199], v[64:67], v[112:115]
    ds_read_b64_tr_b16 v[216:217], v230 offset:0
    ds_read_b64_tr_b16 v[218:219], v230 offset:4096
    v_mfma_f32_16x16x32_bf16 v[116:119], v[196:199], v[68:71], v[116:119]
    s_waitcnt lgkmcnt(8)
    v_mfma_f32_16x16x32_bf16 v[120:123], v[200:203], v[60:63], v[120:123]
    v_mfma_f32_16x16x32_bf16 v[124:127], v[200:203], v[64:67], v[124:127]
    ds_read_b64_tr_b16 v[220:221], v231 offset:0
    ds_read_b64_tr_b16 v[222:223], v231 offset:4096
    v_mfma_f32_16x16x32_bf16 v[128:131], v[200:203], v[68:71], v[128:131]
    s_waitcnt lgkmcnt(8)
    v_mfma_f32_16x16x32_bf16 v[132:135], v[204:207], v[60:63], v[132:135]
    v_add_u32 v224, 98304, v247
    v_xor_b32 v225, 32, v224
    v_mfma_f32_16x16x32_bf16 v[136:139], v[204:207], v[64:67], v[136:139]
    v_xor_b32 v226, 64, v224
    v_xor_b32 v227, 96, v224
    v_mfma_f32_16x16x32_bf16 v[140:143], v[204:207], v[68:71], v[140:143]
    v_xor_b32 v228, 128, v224
    v_xor_b32 v229, 160, v224
    s_waitcnt lgkmcnt(6)
    v_mfma_f32_16x16x32_bf16 v[144:147], v[208:211], v[60:63], v[144:147]
    v_xor_b32 v230, 192, v224
    v_xor_b32 v231, 224, v224
    v_mfma_f32_16x16x32_bf16 v[148:151], v[208:211], v[64:67], v[148:151]
    v_mfma_f32_16x16x32_bf16 v[152:155], v[208:211], v[68:71], v[152:155]
    s_waitcnt vmcnt(4) lgkmcnt(0)
    s_barrier
    v_mfma_f32_16x16x32_bf16 v[156:159], v[212:215], v[60:63], v[156:159]
    ds_read_b64_tr_b16 v[192:193], v224 offset:0
    ds_read_b64_tr_b16 v[194:195], v224 offset:4096
    v_mfma_f32_16x16x32_bf16 v[160:163], v[212:215], v[64:67], v[160:163]
    ds_read_b64_tr_b16 v[196:197], v225 offset:0
    ds_read_b64_tr_b16 v[198:199], v225 offset:4096
    v_mfma_f32_16x16x32_bf16 v[164:167], v[212:215], v[68:71], v[164:167]
    ds_read_b64_tr_b16 v[200:201], v226 offset:0
    ds_read_b64_tr_b16 v[202:203], v226 offset:4096
    v_mfma_f32_16x16x32_bf16 v[168:171], v[216:219], v[60:63], v[168:171]
    ds_read_b64_tr_b16 v[204:205], v227 offset:0
    ds_read_b64_tr_b16 v[206:207], v227 offset:4096
    v_mfma_f32_16x16x32_bf16 v[172:175], v[216:219], v[64:67], v[172:175]
    ds_read_b64_tr_b16 v[208:209], v228 offset:0
    ds_read_b64_tr_b16 v[210:211], v228 offset:4096
    v_mfma_f32_16x16x32_bf16 v[176:179], v[216:219], v[68:71], v[176:179]
    v_mfma_f32_16x16x32_bf16 v[180:183], v[220:223], v[60:63], v[180:183]
    v_mfma_f32_16x16x32_bf16 v[184:187], v[220:223], v[64:67], v[184:187]
    v_mfma_f32_16x16x32_bf16 v[188:191], v[220:223], v[68:71], v[188:191]
    s_waitcnt lgkmcnt(8)
    v_mfma_f32_16x16x32_bf16 v[96:99], v[192:195], v[72:75], v[96:99]
    v_mfma_f32_16x16x32_bf16 v[100:103], v[192:195], v[76:79], v[100:103]
    ds_read_b64_tr_b16 v[212:213], v229 offset:0
    ds_read_b64_tr_b16 v[214:215], v229 offset:4096
    v_mfma_f32_16x16x32_bf16 v[104:107], v[192:195], v[80:83], v[104:107]
    s_waitcnt lgkmcnt(8)
    v_mfma_f32_16x16x32_bf16 v[108:111], v[196:199], v[72:75], v[108:111]
    v_mfma_f32_16x16x32_bf16 v[112:115], v[196:199], v[76:79], v[112:115]
    ds_read_b64_tr_b16 v[216:217], v230 offset:0
    ds_read_b64_tr_b16 v[218:219], v230 offset:4096
    v_mfma_f32_16x16x32_bf16 v[116:119], v[196:199], v[80:83], v[116:119]
    s_waitcnt lgkmcnt(8)
    v_mfma_f32_16x16x32_bf16 v[120:123], v[200:203], v[72:75], v[120:123]
    v_mfma_f32_16x16x32_bf16 v[124:127], v[200:203], v[76:79], v[124:127]
    ds_read_b64_tr_b16 v[220:221], v231 offset:0
    ds_read_b64_tr_b16 v[222:223], v231 offset:4096
    v_mfma_f32_16x16x32_bf16 v[128:131], v[200:203], v[80:83], v[128:131]
    s_waitcnt lgkmcnt(8)
    v_mfma_f32_16x16x32_bf16 v[132:135], v[204:207], v[72:75], v[132:135]
    v_add_u32 v224, 65536, v247
    v_xor_b32 v225, 32, v224
    v_mfma_f32_16x16x32_bf16 v[136:139], v[204:207], v[76:79], v[136:139]
    v_xor_b32 v226, 64, v224
    v_xor_b32 v227, 96, v224
    v_mfma_f32_16x16x32_bf16 v[140:143], v[204:207], v[80:83], v[140:143]
    v_xor_b32 v228, 128, v224
    v_xor_b32 v229, 160, v224
    s_waitcnt lgkmcnt(6)
    v_mfma_f32_16x16x32_bf16 v[144:147], v[208:211], v[72:75], v[144:147]
    v_xor_b32 v230, 192, v224
    v_xor_b32 v231, 224, v224
    v_mfma_f32_16x16x32_bf16 v[148:151], v[208:211], v[76:79], v[148:151]
    v_mfma_f32_16x16x32_bf16 v[152:155], v[208:211], v[80:83], v[152:155]
    s_waitcnt vmcnt(0) lgkmcnt(0)
    s_barrier
    v_bfe_u32 v238, v248, 4, 2
    v_lshl_add_u32 v238, v238, 2, s63
    s_mov_b32 s70, 0
L_p0_X:
    v_cmp_eq_u32 vcc, s71, v237
    s_nop 0
    s_cmp_eq_u64 vcc, -1
    s_cbranch_scc1 L_p0ok_X
    s_add_u32 s70, s70, 1
    s_cmp_gt_u32 s70, 20000
    s_cbranch_scc1 L_p0ok_X
    s_sleep 1
    buffer_load_dword v237, v238, s[32:35], 0 offen offset:0 sc1
    s_waitcnt vmcnt(0)
    s_branch L_p0_X
L_p0ok_X:
    s_mul_i32 s48, s42, 49152
    s_add_u32 s48, s48, s60
    s_add_u32 s48, s48, 0
    v_add_u32 v239, s48, v248
    v_mfma_f32_16x16x32_bf16 v[156:159], v[212:215], v[72:75], v[156:159]
    ds_read_b64_tr_b16 v[192:193], v224 offset:0
    ds_read_b64_tr_b16 v[194:195], v224 offset:4096
    s_add_u32 m0, s59, 16384
    s_add_u32 s68, s72, 0
    buffer_load_dwordx4 v243, s[24:27], s68 offen offset:0  lds
    v_mfma_f32_16x16x32_bf16 v[160:163], v[212:215], v[76:79], v[160:163]
    ds_read_b64_tr_b16 v[196:197], v225 offset:0
    ds_read_b64_tr_b16 v[198:199], v225 offset:4096
    v_mfma_f32_16x16x32_bf16 v[164:167], v[212:215], v[80:83], v[164:167]
    ds_read_b64_tr_b16 v[200:201], v226 offset:0
    ds_read_b64_tr_b16 v[202:203], v226 offset:4096
    v_mfma_f32_16x16x32_bf16 v[168:171], v[216:219], v[72:75], v[168:171]
    ds_read_b64_tr_b16 v[204:205], v227 offset:0
    ds_read_b64_tr_b16 v[206:207], v227 offset:4096
    s_add_u32 s68, s68, 3072
    v_xor_b32 v244, 128, v243
    buffer_load_dwordx4 v244, s[24:27], s68 offen offset:1024  lds
    v_mfma_f32_16x16x32_bf16 v[172:175], v[216:219], v[76:79], v[172:175]
    ds_read_b64_tr_b16 v[208:209], v228 offset:0
    ds_read_b64_tr_b16 v[210:211], v228 offset:4096
    v_mfma_f32_16x16x32_bf16 v[176:179], v[216:219], v[80:83], v[176:179]
    ds_write_b128 v239, a[48:51] offset:0
    ds_write_b128 v239, a[52:55] offset:2048
    v_mfma_f32_16x16x32_bf16 v[180:183], v[220:223], v[72:75], v[180:183]
    ds_write_b128 v239, a[56:59] offset:4096
    ds_write_b128 v239, a[60:63] offset:1024
    s_add_u32 s68, s68, 3072
    buffer_load_dwordx4 v243, s[24:27], s68 offen offset:2048  lds
    v_mfma_f32_16x16x32_bf16 v[184:187], v[220:223], v[76:79], v[184:187]
    ds_write_b128 v239, a[64:67] offset:3072
    ds_write_b128 v239, a[68:71] offset:5120
    v_mfma_f32_16x16x32_bf16 v[188:191], v[220:223], v[80:83], v[188:191]
    s_waitcnt lgkmcnt(14)
    v_mfma_f32_16x16x32_bf16 v[96:99], v[192:195], v[84:87], v[96:99]
    s_add_u32 s68, s68, 3072
    buffer_load_dwordx4 v244, s[24:27], s68 offen offset:3072  lds
    v_mfma_f32_16x16x32_bf16 v[100:103], v[192:195], v[88:91], v[100:103]
    ds_read_b64_tr_b16 v[212:213], v229 offset:0
    ds_read_b64_tr_b16 v[214:215], v229 offset:4096
    v_mfma_f32_16x16x32_bf16 v[104:107], v[192:195], v[92:95], v[104:107]
    s_waitcnt lgkmcnt(14)
    v_mfma_f32_16x16x32_bf16 v[108:111], v[196:199], v[84:87], v[108:111]
    s_add_u32 m0, s59, 81920
    s_add_u32 s68, s72, 65536
    buffer_load_dwordx4 v243, s[24:27], s68 offen offset:0  lds
    v_mfma_f32_16x16x32_bf16 v[112:115], v[196:199], v[88:91], v[112:115]
    ds_read_b64_tr_b16 v[216:217], v230 offset:0
    ds_read_b64_tr_b16 v[218:219], v230 offset:4096
    v_mfma_f32_16x16x32_bf16 v[116:119], v[196:199], v[92:95], v[116:119]
    s_waitcnt lgkmcnt(14)
    v_mfma_f32_16x16x32_bf16 v[120:123], v[200:203], v[84:87], v[120:123]
    s_add_u32 s68, s68, 3072
    v_xor_b32 v244, 128, v243
    buffer_load_dwordx4 v244, s[24:27], s68 offen offset:1024  lds
    v_mfma_f32_16x16x32_bf16 v[124:127], v[200:203], v[88:91], v[124:127]
    ds_read_b64_tr_b16 v[220:221], v231 offset:0
    ds_read_b64_tr_b16 v[222:223], v231 offset:4096
    v_mfma_f32_16x16x32_bf16 v[128:131], v[200:203], v[92:95], v[128:131]
    s_waitcnt lgkmcnt(14)
    v_mfma_f32_16x16x32_bf16 v[132:135], v[204:207], v[84:87], v[132:135]
    s_add_u32 s68, s68, 3072
    buffer_load_dwordx4 v243, s[24:27], s68 offen offset:2048  lds
    v_mfma_f32_16x16x32_bf16 v[136:139], v[204:207], v[88:91], v[136:139]
    v_mfma_f32_16x16x32_bf16 v[140:143], v[204:207], v[92:95], v[140:143]
    s_waitcnt lgkmcnt(12)
    v_mfma_f32_16x16x32_bf16 v[144:147], v[208:211], v[84:87], v[144:147]
    v_mfma_f32_16x16x32_bf16 v[148:151], v[208:211], v[88:91], v[148:151]
    s_add_u32 s68, s68, 3072
    buffer_load_dwordx4 v244, s[24:27], s68 offen offset:3072  lds
    v_mfma_f32_16x16x32_bf16 v[152:155], v[208:211], v[92:95], v[152:155]
    s_waitcnt lgkmcnt(4)
    v_mfma_f32_16x16x32_bf16 v[156:159], v[212:215], v[84:87], v[156:159]
    v_mfma_f32_16x16x32_bf16 v[160:163], v[212:215], v[88:91], v[160:163]
    v_mfma_f32_16x16x32_bf16 v[164:167], v[212:215], v[92:95], v[164:167]
    s_add_u32 m0, s59, 32768
    s_add_u32 s68, s72, 131072
    buffer_load_dwordx4 v243, s[24:27], s68 offen offset:0  lds
    s_waitcnt lgkmcnt(2)
    v_mfma_f32_16x16x32_bf16 v[168:171], v[216:219], v[84:87], v[168:171]
    v_mfma_f32_16x16x32_bf16 v[172:175], v[216:219], v[88:91], v[172:175]
    v_mfma_f32_16x16x32_bf16 v[176:179], v[216:219], v[92:95], v[176:179]
    s_waitcnt lgkmcnt(0)
    v_mfma_f32_16x16x32_bf16 v[180:183], v[220:223], v[84:87], v[180:183]
    s_add_u32 s68, s68, 3072
    v_xor_b32 v244, 128, v243
    buffer_load_dwordx4 v244, s[24:27], s68 offen offset:1024  lds
    v_mfma_f32_16x16x32_bf16 v[184:187], v[220:223], v[88:91], v[184:187]
    v_mfma_f32_16x16x32_bf16 v[188:191], v[220:223], v[92:95], v[188:191]
    s_mul_i32 s48, s40, 12288
    s_add_u32 s48, s48, 114688
    v_add_u32 v192, s48, v248
    s_xor_b32 s49, s40, 2
    s_mul_i32 s49, s49, 12288
    s_add_u32 s49, s49, 114688
    v_add_u32 v193, s49, v248
    s_add_u32 s68, s68, 3072
    buffer_load_dwordx4 v243, s[24:27], s68 offen offset:2048  lds
    ds_write_b128 v192, v[144:147] offset:0
    v_mul_f32 v96, v96, v249
    v_mul_f32 v97, v97, v249
    v_mul_f32 v98, v98, v249
    v_mul_f32 v99, v99, v249
    ds_write_b128 v192, v[148:151] offset:1024
    v_mul_f32 v100, v100, v250
    v_mul_f32 v101, v101, v250
    v_mul_f32 v102, v102, v250
    v_mul_f32 v103, v103, v250
    ds_write_b128 v192, v[152:155] offset:2048
    v_mul_f32 v104, v104, v251
    v_mul_f32 v105, v105, v251
    s_add_u32 s68, s68, 3072
    buffer_load_dwordx4 v244, s[24:27], s68 offen offset:3072  lds
    v_mul_f32 v106, v106, v251
    v_mul_f32 v107, v107, v251
    ds_write_b128 v192, v[156:159] offset:3072
    v_mul_f32 v108, v108, v249
    v_mul_f32 v109, v109, v249
    v_mul_f32 v110, v110, v249
    v_mul_f32 v111, v111, v249
    ds_write_b128 v192, v[160:163] offset:4096
    v_mul_f32 v112, v112, v250
    v_mul_f32 v113, v113, v250
    v_mul_f32 v114, v114, v250
    v_mul_f32 v115, v115, v250
    ds_write_b128 v192, v[164:167] offset:5120
    v_mul_f32 v116, v116, v251
    v_mul_f32 v117, v117, v251
    v_mul_f32 v118, v118, v251
    v_mul_f32 v119, v119, v251
    ds_write_b128 v192, v[168:171] offset:6144
    v_mul_f32 v120, v120, v249
    v_mul_f32 v121, v121, v249
    v_mul_f32 v122, v122, v249
    v_mul_f32 v123, v123, v249
    ds_write_b128 v192, v[172:175] offset:7168
    v_mul_f32 v124, v124, v250
    v_mul_f32 v125, v125, v250
    v_mul_f32 v126, v126, v250
    v_mul_f32 v127, v127, v250
    ds_write_b128 v192, v[176:179] offset:8192
    v_mul_f32 v128, v128, v251
    v_mul_f32 v129, v129, v251
    v_mul_f32 v130, v130, v251
    v_mul_f32 v131, v131, v251
    ds_write_b128 v192, v[180:183] offset:9216
    v_mul_f32 v132, v132, v249
    v_mul_f32 v133, v133, v249
    v_mul_f32 v134, v134, v249
    v_mul_f32 v135, v135, v249
    ds_write_b128 v192, v[184:187] offset:10240
    v_mul_f32 v136, v136, v250
    v_mul_f32 v137, v137, v250
    v_mul_f32 v138, v138, v250
    v_mul_f32 v139, v139, v250
    ds_write_b128 v192, v[188:191] offset:11264
    v_mul_f32 v140, v140, v251
    v_mul_f32 v141, v141, v251
    v_mul_f32 v142, v142, v251
    v_mul_f32 v143, v143, v251
    s_waitcnt lgkmcnt(0)
    s_barrier
    ds_read_b128 v[0:3], v193 offset:0
    ds_read_b128 v[12:15], v193 offset:3072
    ds_read_b128 v[4:7], v193 offset:1024
    ds_read_b128 v[16:19], v193 offset:4096
    ds_read_b128 v[8:11], v193 offset:2048
    ds_read_b128 v[20:23], v193 offset:5120
    ds_read_b128 v[24:27], v193 offset:6144
    ds_read_b128 v[36:39], v193 offset:9216
    ds_read_b128 v[28:31], v193 offset:7168
    ds_read_b128 v[40:43], v193 offset:10240
    ds_read_b128 v[32:35], v193 offset:8192
    ds_read_b128 v[44:47], v193 offset:11264
    s_mul_i32 s48, s42, -32768
    s_add_u32 s48, s48, s60
    s_add_u32 s48, s48, 98304
    v_add_u32 v194, s48, v248
    s_add_u32 s48, s62, 24576
    s_add_u32 s49, s48, 2048
    s_add_u32 s50, s48, 4096
    s_waitcnt lgkmcnt(11)
    v_fma_f32 v96, v0, v252, v96
    v_fma_f32 v97, v1, v252, v97
    v_fma_f32 v98, v2, v252, v98
    v_fma_f32 v99, v3, v252, v99
    v_cvt_pk_bf16_f32 v48, v96, v97
    v_cvt_pk_bf16_f32 v49, v98, v99
    s_waitcnt lgkmcnt(10)
    v_fma_f32 v108, v12, v252, v108
    v_fma_f32 v109, v13, v252, v109
    v_fma_f32 v110, v14, v252, v110
    v_fma_f32 v111, v15, v252, v111
    v_cvt_pk_bf16_f32 v50, v108, v109
    v_cvt_pk_bf16_f32 v51, v110, v111
    buffer_store_dwordx4 v[48:51], v248, s[32:35], s48 offen offset:0 sc1
    ds_write_b128 v194, v[48:51] offset:0
    s_waitcnt lgkmcnt(10)
    v_fma_f32 v100, v4, v253, v100
    v_fma_f32 v101, v5, v253, v101
    v_fma_f32 v102, v6, v253, v102
    v_fma_f32 v103, v7, v253, v103
    v_cvt_pk_bf16_f32 v52, v100, v101
    v_cvt_pk_bf16_f32 v53, v102, v103
    s_waitcnt lgkmcnt(9)
    v_fma_f32 v112, v16, v253, v112
    v_fma_f32 v113, v17, v253, v113
    v_fma_f32 v114, v18, v253, v114
    v_fma_f32 v115, v19, v253, v115
    v_cvt_pk_bf16_f32 v54, v112, v113
    v_cvt_pk_bf16_f32 v55, v114, v115
    buffer_store_dwordx4 v[52:55], v248, s[32:35], s49 offen offset:0 sc1
    ds_write_b128 v194, v[52:55] offset:2048
    s_waitcnt lgkmcnt(9)
    v_fma_f32 v104, v8, v254, v104
    v_fma_f32 v105, v9, v254, v105
    v_fma_f32 v106, v10, v254, v106
    v_fma_f32 v107, v11, v254, v107
    v_cvt_pk_bf16_f32 v56, v104, v105
    v_cvt_pk_bf16_f32 v57, v106, v107
    s_waitcnt lgkmcnt(8)
    v_fma_f32 v116, v20, v254, v116
    v_fma_f32 v117, v21, v254, v117
    v_fma_f32 v118, v22, v254, v118
    v_fma_f32 v119, v23, v254, v119
    v_cvt_pk_bf16_f32 v58, v116, v117
    v_cvt_pk_bf16_f32 v59, v118, v119
    buffer_store_dwordx4 v[56:59], v248, s[32:35], s50 offen offset:0 sc1
    ds_write_b128 v194, v[56:59] offset:4096
    s_waitcnt lgkmcnt(8)
    v_fma_f32 v120, v24, v252, v120
    v_fma_f32 v121, v25, v252, v121
    v_fma_f32 v122, v26, v252, v122
    v_fma_f32 v123, v27, v252, v123
    v_cvt_pk_bf16_f32 v60, v120, v121
    v_cvt_pk_bf16_f32 v61, v122, v123
    s_waitcnt lgkmcnt(7)
    v_fma_f32 v132, v36, v252, v132
    v_fma_f32 v133, v37, v252, v133
    v_fma_f32 v134, v38, v252, v134
    v_fma_f32 v135, v39, v252, v135
    v_cvt_pk_bf16_f32 v62, v132, v133
    v_cvt_pk_bf16_f32 v63, v134, v135
    buffer_store_dwordx4 v[60:63], v248, s[32:35], s48 offen offset:1024 sc1
    ds_write_b128 v194, v[60:63] offset:1024
    s_waitcnt lgkmcnt(7)
    v_fma_f32 v124, v28, v253, v124
    v_fma_f32 v125, v29, v253, v125
    v_fma_f32 v126, v30, v253, v126
    v_fma_f32 v127, v31, v253, v127
    v_cvt_pk_bf16_f32 v64, v124, v125
    v_cvt_pk_bf16_f32 v65, v126, v127
    s_waitcnt lgkmcnt(6)
    v_fma_f32 v136, v40, v253, v136
    v_fma_f32 v137, v41, v253, v137
    v_fma_f32 v138, v42, v253, v138
    v_fma_f32 v139, v43, v253, v139
    v_cvt_pk_bf16_f32 v66, v136, v137
    v_cvt_pk_bf16_f32 v67, v138, v139
    buffer_store_dwordx4 v[64:67], v248, s[32:35], s49 offen offset:1024 sc1
    ds_write_b128 v194, v[64:67] offset:3072
    s_waitcnt lgkmcnt(6)
    v_fma_f32 v128, v32, v254, v128
    v_fma_f32 v129, v33, v254, v129
    v_fma_f32 v130, v34, v254, v130
    v_fma_f32 v131, v35, v254, v131
    v_cvt_pk_bf16_f32 v68, v128, v129
    v_cvt_pk_bf16_f32 v69, v130, v131
    s_waitcnt lgkmcnt(5)
    v_fma_f32 v140, v44, v254, v140
    v_fma_f32 v141, v45, v254, v141
    v_fma_f32 v142, v46, v254, v142
    v_fma_f32 v143, v47, v254, v143
    v_cvt_pk_bf16_f32 v70, v140, v141
    v_cvt_pk_bf16_f32 v71, v142, v143
    buffer_store_dwordx4 v[68:71], v248, s[32:35], s50 offen offset:1024 sc1
    ds_write_b128 v194, v[68:71] offset:5120
    s_add_u32 s48, s60, 0
    v_add_u32 v245, s48, v248
    v_add_u32 v224, 16384, v246
    v_xor_b32 v225, 32, v224
    v_xor_b32 v226, 64, v224
    v_xor_b32 v227, 96, v224
    s_waitcnt vmcnt(14) lgkmcnt(0)
    s_barrier
    s_add_u32 m0, s59, 114688
    s_add_u32 s68, s72, 196608
    buffer_load_dwordx4 v243, s[24:27], s68 offen offset:0  lds
    ds_read_b64_tr_b16 v[192:193], v224 offset:0
    ds_read_b64_tr_b16 v[194:195], v224 offset:4096
    ds_read_b128 a[0:3], v245 offset:0
    ds_read_b128 a[4:7], v245 offset:2048
    ds_read_b128 a[8:11], v245 offset:4096
    ds_read_b64_tr_b16 v[196:197], v225 offset:0
    ds_read_b64_tr_b16 v[198:199], v225 offset:4096
    ds_read_b64_tr_b16 v[200:201], v226 offset:0
    ds_read_b64_tr_b16 v[202:203], v226 offset:4096
    ds_read_b128 a[12:15], v245 offset:1024
    ds_read_b128 a[16:19], v245 offset:3072
    ds_read_b128 a[20:23], v245 offset:5120
    ds_read_b64_tr_b16 v[204:205], v227 offset:0
    ds_read_b64_tr_b16 v[206:207], v227 offset:4096
    ds_read_b64_tr_b16 v[208:209], v224 offset:8192
    ds_read_b64_tr_b16 v[210:211], v224 offset:12288
    s_waitcnt lgkmcnt(11)
    v_mfma_f32_16x16x32_bf16 a[192:195], v[192:195], a[0:3], 0
    s_add_u32 s68, s68, 3072
    v_xor_b32 v244, 128, v243
    buffer_load_dwordx4 v244, s[24:27], s68 offen offset:1024  lds
    v_mfma_f32_16x16x32_bf16 a[196:199], v[192:195], a[4:7], 0
    ds_read_b64_tr_b16 v[212:213], v225 offset:8192
    ds_read_b64_tr_b16 v[214:215], v225 offset:12288
    v_mfma_f32_16x16x32_bf16 a[200:203], v[192:195], a[8:11], 0
    s_waitcnt lgkmcnt(11)
    v_mfma_f32_16x16x32_bf16 a[204:207], v[196:199], a[0:3], 0
    s_add_u32 s68, s68, 3072
    buffer_load_dwordx4 v243, s[24:27], s68 offen offset:2048  lds
    v_mfma_f32_16x16x32_bf16 a[208:211], v[196:199], a[4:7], 0
    ds_read_b64_tr_b16 v[216:217], v226 offset:8192
    ds_read_b64_tr_b16 v[218:219], v226 offset:12288
    v_mfma_f32_16x16x32_bf16 a[212:215], v[196:199], a[8:11], 0
    s_waitcnt lgkmcnt(11)
    v_mfma_f32_16x16x32_bf16 a[216:219], v[200:203], a[0:3], 0
    s_add_u32 s68, s68, 3072
    buffer_load_dwordx4 v244, s[24:27], s68 offen offset:3072  lds
    v_mfma_f32_16x16x32_bf16 a[220:223], v[200:203], a[4:7], 0
    ds_read_b64_tr_b16 v[220:221], v227 offset:8192
    ds_read_b64_tr_b16 v[222:223], v227 offset:12288
    v_mfma_f32_16x16x32_bf16 a[224:227], v[200:203], a[8:11], 0
    s_add_u32 s48, s60, 49152
    v_add_u32 v245, s48, v248
    s_waitcnt lgkmcnt(8)
    v_mfma_f32_16x16x32_bf16 a[228:231], v[204:207], a[0:3], 0
    v_add_u32 v224, 81920, v246
    s_add_u32 m0, s59, 131072
    s_add_u32 s68, s73, 0
    buffer_load_dwordx4 v243, s[24:27], s68 offen offset:0  lds
    v_xor_b32 v225, 32, v224
    v_mfma_f32_16x16x32_bf16 a[232:235], v[204:207], a[4:7], 0
    v_xor_b32 v226, 64, v224
    v_xor_b32 v227, 96, v224
    v_mfma_f32_16x16x32_bf16 a[236:239], v[204:207], a[8:11], 0
    s_waitcnt lgkmcnt(6)
    v_mfma_f32_16x16x32_bf16 a[192:195], v[208:211], a[12:15], a[192:195]
    s_add_u32 s68, s68, 3072
    v_xor_b32 v244, 128, v243
    buffer_load_dwordx4 v244, s[24:27], s68 offen offset:1024  lds
    v_mfma_f32_16x16x32_bf16 a[196:199], v[208:211], a[16:19], a[196:199]
    v_mfma_f32_16x16x32_bf16 a[200:203], v[208:211], a[20:23], a[200:203]
    s_waitcnt vmcnt(6) lgkmcnt(0)
    s_barrier
    s_lshl_b32 s48, s40, 28
    s_add_u32 s48, s48, s47
    v_lshlrev_b32 v238, 24, v248
    s_add_u32 s68, s68, 3072
    buffer_load_dwordx4 v243, s[24:27], s68 offen offset:2048  lds
    v_lshrrev_b32 v239, 8, v248
    v_lshl_or_b32 v238, v239, 28, v238
    v_or_b32 v238, s48, v238
    v_mov_b32 v239, s71
    buffer_store_dword v239, v238, s[32:35], 0 offen offset:2048 sc1
    v_mfma_f32_16x16x32_bf16 a[204:207], v[212:215], a[12:15], a[204:207]
    ds_read_b64_tr_b16 v[192:193], v224 offset:0
    ds_read_b64_tr_b16 v[194:195], v224 offset:4096
    v_mfma_f32_16x16x32_bf16 a[208:211], v[212:215], a[16:19], a[208:211]
    ds_read_b128 a[24:27], v245 offset:0
    ds_read_b128 a[28:31], v245 offset:2048
    s_add_u32 s68, s68, 3072
    buffer_load_dwordx4 v244, s[24:27], s68 offen offset:3072  lds
    v_mfma_f32_16x16x32_bf16 a[212:215], v[212:215], a[20:23], a[212:215]
    ds_read_b128 a[32:35], v245 offset:4096
    ds_read_b64_tr_b16 v[196:197], v225 offset:0
    v_mfma_f32_16x16x32_bf16 a[216:219], v[216:219], a[12:15], a[216:219]
    ds_read_b64_tr_b16 v[198:199], v225 offset:4096
    ds_read_b64_tr_b16 v[200:201], v226 offset:0
    v_mfma_f32_16x16x32_bf16 a[220:223], v[216:219], a[16:19], a[220:223]
    ds_read_b64_tr_b16 v[202:203], v226 offset:4096
    ds_read_b128 a[36:39], v245 offset:1024
    s_add_u32 m0, s61, 147456
    s_add_u32 s68, s81, 0
    buffer_load_dwordx4 v248, s[32:35], s68 offen offset:0 sc1 lds
    v_mfma_f32_16x16x32_bf16 a[224:227], v[216:219], a[20:23], a[224:227]
    ds_read_b128 a[40:43], v245 offset:3072
    ds_read_b128 a[44:47], v245 offset:5120
    v_mfma_f32_16x16x32_bf16 a[228:231], v[220:223], a[12:15], a[228:231]
    ds_read_b64_tr_b16 v[204:205], v227 offset:0
    ds_read_b64_tr_b16 v[206:207], v227 offset:4096
    v_mfma_f32_16x16x32_bf16 a[232:235], v[220:223], a[16:19], a[232:235]
    ds_read_b64_tr_b16 v[208:209], v224 offset:8192
    ds_read_b64_tr_b16 v[210:211], v224 offset:12288
    buffer_load_dwordx4 v248, s[32:35], s68 offen offset:1024 sc1 lds
    v_mfma_f32_16x16x32_bf16 a[236:239], v[220:223], a[20:23], a[236:239]
    s_waitcnt lgkmcnt(11)
    v_mfma_f32_16x16x32_bf16 a[192:195], v[192:195], a[24:27], a[192:195]
    v_mfma_f32_16x16x32_bf16 a[196:199], v[192:195], a[28:31], a[196:199]
    ds_read_b64_tr_b16 v[212:213], v225 offset:8192
    ds_read_b64_tr_b16 v[214:215], v225 offset:12288
    buffer_load_dwordx4 v248, s[32:35], s68 offen offset:2048 sc1 lds
    v_mfma_f32_16x16x32_bf16 a[200:203], v[192:195], a[32:35], a[200:203]
    s_waitcnt lgkmcnt(11)
    v_mfma_f32_16x16x32_bf16 a[204:207], v[196:199], a[24:27], a[204:207]
    v_mfma_f32_16x16x32_bf16 a[208:211], v[196:199], a[28:31], a[208:211]
    ds_read_b64_tr_b16 v[216:217], v226 offset:8192
    ds_read_b64_tr_b16 v[218:219], v226 offset:12288
    s_add_u32 m0, s59, 16384
    s_add_u32 s68, s73, 65536
    buffer_load_dwordx4 v243, s[24:27], s68 offen offset:0  lds
    v_mfma_f32_16x16x32_bf16 a[212:215], v[196:199], a[32:35], a[212:215]
    s_waitcnt lgkmcnt(11)
    v_mfma_f32_16x16x32_bf16 a[216:219], v[200:203], a[24:27], a[216:219]
    v_mfma_f32_16x16x32_bf16 a[220:223], v[200:203], a[28:31], a[220:223]
    ds_read_b64_tr_b16 v[220:221], v227 offset:8192
    ds_read_b64_tr_b16 v[222:223], v227 offset:12288
    s_add_u32 s68, s68, 3072
    v_xor_b32 v244, 128, v243
    buffer_load_dwordx4 v244, s[24:27], s68 offen offset:1024  lds
    v_mfma_f32_16x16x32_bf16 a[224:227], v[200:203], a[32:35], a[224:227]
    s_add_u32 s48, s60, 98304
    v_add_u32 v245, s48, v248
    s_waitcnt lgkmcnt(8)
    v_mfma_f32_16x16x32_bf16 a[228:231], v[204:207], a[24:27], a[228:231]
    v_add_u32 v224, 32768, v246
    v_xor_b32 v225, 32, v224
    v_mfma_f32_16x16x32_bf16 a[232:235], v[204:207], a[28:31], a[232:235]
    v_xor_b32 v226, 64, v224
    s_add_u32 s68, s68, 3072
    buffer_load_dwordx4 v243, s[24:27], s68 offen offset:2048  lds
    v_xor_b32 v227, 96, v224
    v_mfma_f32_16x16x32_bf16 a[236:239], v[204:207], a[32:35], a[236:239]
    s_waitcnt lgkmcnt(6)
    v_mfma_f32_16x16x32_bf16 a[192:195], v[208:211], a[36:39], a[192:195]
    v_mfma_f32_16x16x32_bf16 a[196:199], v[208:211], a[40:43], a[196:199]
    s_add_u32 s68, s68, 3072
    buffer_load_dwordx4 v244, s[24:27], s68 offen offset:3072  lds
    v_mfma_f32_16x16x32_bf16 a[200:203], v[208:211], a[44:47], a[200:203]
    s_waitcnt lgkmcnt(0)
    s_barrier
    v_mfma_f32_16x16x32_bf16 a[204:207], v[212:215], a[36:39], a[204:207]
    ds_read_b64_tr_b16 v[192:193], v224 offset:0
    ds_read_b64_tr_b16 v[194:195], v224 offset:4096
    s_add_u32 m0, s61, 0
    s_add_u32 s68, s81, 12288
    buffer_load_dwordx4 v248, s[32:35], s68 offen offset:0 sc1 lds
    v_mfma_f32_16x16x32_bf16 a[208:211], v[212:215], a[40:43], a[208:211]
    ds_read_b128 a[0:3], v245 offset:0
    ds_read_b128 a[4:7], v245 offset:2048
    v_mfma_f32_16x16x32_bf16 a[212:215], v[212:215], a[44:47], a[212:215]
    ds_read_b128 a[8:11], v245 offset:4096
    ds_read_b64_tr_b16 v[196:197], v225 offset:0
    v_mfma_f32_16x16x32_bf16 a[216:219], v[216:219], a[36:39], a[216:219]
    ds_read_b64_tr_b16 v[198:199], v225 offset:4096
    ds_read_b64_tr_b16 v[200:201], v226 offset:0
    buffer_load_dwordx4 v248, s[32:35], s68 offen offset:1024 sc1 lds
    v_mfma_f32_16x16x32_bf16 a[220:223], v[216:219], a[40:43], a[220:223]
    ds_read_b64_tr_b16 v[202:203], v226 offset:4096
    ds_read_b128 a[12:15], v245 offset:1024
    v_mfma_f32_16x16x32_bf16 a[224:227], v[216:219], a[44:47], a[224:227]
    ds_read_b128 a[16:19], v245 offset:3072
    ds_read_b128 a[20:23], v245 offset:5120
    v_mfma_f32_16x16x32_bf16 a[228:231], v[220:223], a[36:39], a[228:231]
    ds_read_b64_tr_b16 v[204:205], v227 offset:0
    ds_read_b64_tr_b16 v[206:207], v227 offset:4096
    buffer_load_dwordx4 v248, s[32:35], s68 offen offset:2048 sc1 lds
    v_mfma_f32_16x16x32_bf16 a[232:235], v[220:223], a[40:43], a[232:235]
    ds_read_b64_tr_b16 v[208:209], v224 offset:8192
    ds_read_b64_tr_b16 v[210:211], v224 offset:12288
    v_mfma_f32_16x16x32_bf16 a[236:239], v[220:223], a[44:47], a[236:239]
    s_waitcnt lgkmcnt(11)
    v_mfma_f32_16x16x32_bf16 a[192:195], v[192:195], a[0:3], a[192:195]
    s_add_u32 m0, s59, 81920
    s_add_u32 s68, s74, 0
    buffer_load_dwordx4 v243, s[24:27], s68 offen offset:0  lds
    v_mfma_f32_16x16x32_bf16 a[196:199], v[192:195], a[4:7], a[196:199]
    ds_read_b64_tr_b16 v[212:213], v225 offset:8192
    ds_read_b64_tr_b16 v[214:215], v225 offset:12288
    v_mfma_f32_16x16x32_bf16 a[200:203], v[192:195], a[8:11], a[200:203]
    s_waitcnt lgkmcnt(11)
    v_mfma_f32_16x16x32_bf16 a[204:207], v[196:199], a[0:3], a[204:207]
    s_add_u32 s68, s68, 3072
    v_xor_b32 v244, 128, v243
    buffer_load_dwordx4 v244, s[24:27], s68 offen offset:1024  lds
    v_mfma_f32_16x16x32_bf16 a[208:211], v[196:199], a[4:7], a[208:211]
    ds_read_b64_tr_b16 v[216:217], v226 offset:8192
    ds_read_b64_tr_b16 v[218:219], v226 offset:12288
    v_mfma_f32_16x16x32_bf16 a[212:215], v[196:199], a[8:11], a[212:215]
    s_waitcnt lgkmcnt(11)
    v_mfma_f32_16x16x32_bf16 a[216:219], v[200:203], a[0:3], a[216:219]
    s_add_u32 s68, s68, 3072
    buffer_load_dwordx4 v243, s[24:27], s68 offen offset:2048  lds
    v_mfma_f32_16x16x32_bf16 a[220:223], v[200:203], a[4:7], a[220:223]
    ds_read_b64_tr_b16 v[220:221], v227 offset:8192
    ds_read_b64_tr_b16 v[222:223], v227 offset:12288
    v_mfma_f32_16x16x32_bf16 a[224:227], v[200:203], a[8:11], a[224:227]
    s_add_u32 s48, s60, 65536
    v_add_u32 v245, s48, v248
    s_waitcnt lgkmcnt(8)
    v_mfma_f32_16x16x32_bf16 a[228:231], v[204:207], a[0:3], a[228:231]
    v_add_u32 v224, 114688, v246
    s_add_u32 s68, s68, 3072
    buffer_load_dwordx4 v244, s[24:27], s68 offen offset:3072  lds
    v_xor_b32 v225, 32, v224
    v_mfma_f32_16x16x32_bf16 a[232:235], v[204:207], a[4:7], a[232:235]
    v_xor_b32 v226, 64, v224
    v_xor_b32 v227, 96, v224
    v_mfma_f32_16x16x32_bf16 a[236:239], v[204:207], a[8:11], a[236:239]
    s_waitcnt lgkmcnt(6)
    v_mfma_f32_16x16x32_bf16 a[192:195], v[208:211], a[12:15], a[192:195]
    s_add_u32 m0, s61, 49152
    s_add_u32 s68, s82, 0
    buffer_load_dwordx4 v248, s[32:35], s68 offen offset:0 sc1 lds
    v_mfma_f32_16x16x32_bf16 a[196:199], v[208:211], a[16:19], a[196:199]
    v_mfma_f32_16x16x32_bf16 a[200:203], v[208:211], a[20:23], a[200:203]
    s_waitcnt vmcnt(20) lgkmcnt(0)
    s_barrier
    v_mfma_f32_16x16x32_bf16 a[204:207], v[212:215], a[12:15], a[204:207]
    ds_read_b64_tr_b16 v[192:193], v224 offset:0
    ds_read_b64_tr_b16 v[194:195], v224 offset:4096
    buffer_load_dwordx4 v248, s[32:35], s68 offen offset:1024 sc1 lds
    v_mfma_f32_16x16x32_bf16 a[208:211], v[212:215], a[16:19], a[208:211]
    ds_read_b128 a[24:27], v245 offset:0
    ds_read_b128 a[28:31], v245 offset:2048
    v_mfma_f32_16x16x32_bf16 a[212:215], v[212:215], a[20:23], a[212:215]
    ds_read_b128 a[32:35], v245 offset:4096
    ds_read_b64_tr_b16 v[196:197], v225 offset:0
    v_mfma_f32_16x16x32_bf16 a[216:219], v[216:219], a[12:15], a[216:219]
    ds_read_b64_tr_b16 v[198:199], v225 offset:4096
    ds_read_b64_tr_b16 v[200:201], v226 offset:0
    buffer_load_dwordx4 v248, s[32:35], s68 offen offset:2048 sc1 lds
    v_mfma_f32_16x16x32_bf16 a[220:223], v[216:219], a[16:19], a[220:223]
    ds_read_b64_tr_b16 v[202:203], v226 offset:4096
    ds_read_b128 a[36:39], v245 offset:1024
    v_mfma_f32_16x16x32_bf16 a[224:227], v[216:219], a[20:23], a[224:227]
    ds_read_b128 a[40:43], v245 offset:3072
    ds_read_b128 a[44:47], v245 offset:5120
    v_mfma_f32_16x16x32_bf16 a[228:231], v[220:223], a[12:15], a[228:231]
    ds_read_b64_tr_b16 v[204:205], v227 offset:0
    ds_read_b64_tr_b16 v[206:207], v227 offset:4096
    s_add_u32 m0, s59, 32768
    s_add_u32 s68, s74, 65536
    buffer_load_dwordx4 v243, s[24:27], s68 offen offset:0  lds
    v_mfma_f32_16x16x32_bf16 a[232:235], v[220:223], a[16:19], a[232:235]
    ds_read_b64_tr_b16 v[208:209], v224 offset:8192
    ds_read_b64_tr_b16 v[210:211], v224 offset:12288
    v_mfma_f32_16x16x32_bf16 a[236:239], v[220:223], a[20:23], a[236:239]
    s_waitcnt lgkmcnt(11)
    v_mfma_f32_16x16x32_bf16 a[192:195], v[192:195], a[24:27], a[192:195]
    s_add_u32 s68, s68, 3072
    v_xor_b32 v244, 128, v243
    buffer_load_dwordx4 v244, s[24:27], s68 offen offset:1024  lds
    v_mfma_f32_16x16x32_bf16 a[196:199], v[192:195], a[28:31], a[196:199]
    ds_read_b64_tr_b16 v[212:213], v225 offset:8192
    ds_read_b64_tr_b16 v[214:215], v225 offset:12288
    v_mfma_f32_16x16x32_bf16 a[200:203], v[192:195], a[32:35], a[200:203]
    s_waitcnt lgkmcnt(11)
    v_mfma_f32_16x16x32_bf16 a[204:207], v[196:199], a[24:27], a[204:207]
    s_add_u32 s68, s68, 3072
    buffer_load_dwordx4 v243, s[24:27], s68 offen offset:2048  lds
    v_mfma_f32_16x16x32_bf16 a[208:211], v[196:199], a[28:31], a[208:211]
    ds_read_b64_tr_b16 v[216:217], v226 offset:8192
    ds_read_b64_tr_b16 v[218:219], v226 offset:12288
    v_mfma_f32_16x16x32_bf16 a[212:215], v[196:199], a[32:35], a[212:215]
    s_waitcnt lgkmcnt(11)
    v_mfma_f32_16x16x32_bf16 a[216:219], v[200:203], a[24:27], a[216:219]
    s_add_u32 s68, s68, 3072
    buffer_load_dwordx4 v244, s[24:27], s68 offen offset:3072  lds
    v_mfma_f32_16x16x32_bf16 a[220:223], v[200:203], a[28:31], a[220:223]
    ds_read_b64_tr_b16 v[220:221], v227 offset:8192
    ds_read_b64_tr_b16 v[222:223], v227 offset:12288
    v_mfma_f32_16x16x32_bf16 a[224:227], v[200:203], a[32:35], a[224:227]
    s_add_u32 s48, s60, 147456
    v_add_u32 v245, s48, v248
    s_waitcnt lgkmcnt(8)
    v_mfma_f32_16x16x32_bf16 a[228:231], v[204:207], a[24:27], a[228:231]
    v_add_u32 v224, 131072, v246
    v_xor_b32 v225, 32, v224
    v_mfma_f32_16x16x32_bf16 a[232:235], v[204:207], a[28:31], a[232:235]
    v_xor_b32 v226, 64, v224
    v_xor_b32 v227, 96, v224
    v_mfma_f32_16x16x32_bf16 a[236:239], v[204:207], a[32:35], a[236:239]
    s_waitcnt lgkmcnt(6)
    v_mfma_f32_16x16x32_bf16 a[192:195], v[208:211], a[36:39], a[192:195]
    v_mfma_f32_16x16x32_bf16 a[196:199], v[208:211], a[40:43], a[196:199]
    v_mfma_f32_16x16x32_bf16 a[200:203], v[208:211], a[44:47], a[200:203]
    s_waitcnt vmcnt(18) lgkmcnt(0)
    s_barrier
    v_mfma_f32_16x16x32_bf16 a[204:207], v[212:215], a[36:39], a[204:207]
    ds_read_b64_tr_b16 v[192:193], v224 offset:0
    ds_read_b64_tr_b16 v[194:195], v224 offset:4096
    s_add_u32 m0, s61, 114688
    s_add_u32 s68, s82, 12288
    buffer_load_dwordx4 v248, s[32:35], s68 offen offset:0 sc1 lds
    v_mfma_f32_16x16x32_bf16 a[208:211], v[212:215], a[40:43], a[208:211]
    ds_read_b128 a[0:3], v245 offset:0
    ds_read_b128 a[4:7], v245 offset:2048
    v_mfma_f32_16x16x32_bf16 a[212:215], v[212:215], a[44:47], a[212:215]
    ds_read_b128 a[8:11], v245 offset:4096
    ds_read_b64_tr_b16 v[196:197], v225 offset:0
    v_mfma_f32_16x16x32_bf16 a[216:219], v[216:219], a[36:39], a[216:219]
    ds_read_b64_tr_b16 v[198:199], v225 offset:4096
    ds_read_b64_tr_b16 v[200:201], v226 offset:0
    buffer_load_dwordx4 v248, s[32:35], s68 offen offset:1024 sc1 lds
    v_mfma_f32_16x16x32_bf16 a[220:223], v[216:219], a[40:43], a[220:223]
    ds_read_b64_tr_b16 v[202:203], v226 offset:4096
    ds_read_b128 a[12:15], v245 offset:1024
    v_mfma_f32_16x16x32_bf16 a[224:227], v[216:219], a[44:47], a[224:227]
    ds_read_b128 a[16:19], v245 offset:3072
    ds_read_b128 a[20:23], v245 offset:5120
    v_mfma_f32_16x16x32_bf16 a[228:231], v[220:223], a[36:39], a[228:231]
    ds_read_b64_tr_b16 v[204:205], v227 offset:0
    ds_read_b64_tr_b16 v[206:207], v227 offset:4096
    buffer_load_dwordx4 v248, s[32:35], s68 offen offset:2048 sc1 lds
    v_mfma_f32_16x16x32_bf16 a[232:235], v[220:223], a[40:43], a[232:235]
    ds_read_b64_tr_b16 v[208:209], v224 offset:8192
    ds_read_b64_tr_b16 v[210:211], v224 offset:12288
    v_mfma_f32_16x16x32_bf16 a[236:239], v[220:223], a[44:47], a[236:239]
    s_waitcnt lgkmcnt(11)
    v_mfma_f32_16x16x32_bf16 a[192:195], v[192:195], a[0:3], a[192:195]
    s_add_u32 m0, s59, 98304
    s_add_u32 s68, s75, 0
    buffer_load_dwordx4 v243, s[24:27], s68 offen offset:0  lds
    v_mfma_f32_16x16x32_bf16 a[196:199], v[192:195], a[4:7], a[196:199]
    ds_read_b64_tr_b16 v[212:213], v225 offset:8192
    ds_read_b64_tr_b16 v[214:215], v225 offset:12288
    v_mfma_f32_16x16x32_bf16 a[200:203], v[192:195], a[8:11], a[200:203]
    s_waitcnt lgkmcnt(11)
    v_mfma_f32_16x16x32_bf16 a[204:207], v[196:199], a[0:3], a[204:207]
    s_add_u32 s68, s68, 3072
    v_xor_b32 v244, 128, v243
    buffer_load_dwordx4 v244, s[24:27], s68 offen offset:1024  lds
    v_mfma_f32_16x16x32_bf16 a[208:211], v[196:199], a[4:7], a[208:211]
    ds_read_b64_tr_b16 v[216:217], v226 offset:8192
    ds_read_b64_tr_b16 v[218:219], v226 offset:12288
    v_mfma_f32_16x16x32_bf16 a[212:215], v[196:199], a[8:11], a[212:215]
    s_waitcnt lgkmcnt(11)
    v_mfma_f32_16x16x32_bf16 a[216:219], v[200:203], a[0:3], a[216:219]
    s_add_u32 s68, s68, 3072
    buffer_load_dwordx4 v243, s[24:27], s68 offen offset:2048  lds
    v_mfma_f32_16x16x32_bf16 a[220:223], v[200:203], a[4:7], a[220:223]
    ds_read_b64_tr_b16 v[220:221], v227 offset:8192
    ds_read_b64_tr_b16 v[222:223], v227 offset:12288
    v_mfma_f32_16x16x32_bf16 a[224:227], v[200:203], a[8:11], a[224:227]
    s_add_u32 s48, s60, 0
    v_add_u32 v245, s48, v248
    s_waitcnt lgkmcnt(8)
    v_mfma_f32_16x16x32_bf16 a[228:231], v[204:207], a[0:3], a[228:231]
    v_add_u32 v224, 16384, v246
    s_add_u32 s68, s68, 3072
    buffer_load_dwordx4 v244, s[24:27], s68 offen offset:3072  lds
    v_xor_b32 v225, 32, v224
    v_mfma_f32_16x16x32_bf16 a[232:235], v[204:207], a[4:7], a[232:235]
    v_xor_b32 v226, 64, v224
    v_xor_b32 v227, 96, v224
    v_mfma_f32_16x16x32_bf16 a[236:239], v[204:207], a[8:11], a[236:239]
    s_waitcnt lgkmcnt(6)
    v_mfma_f32_16x16x32_bf16 a[192:195], v[208:211], a[12:15], a[192:195]
    v_mfma_f32_16x16x32_bf16 a[196:199], v[208:211], a[16:19], a[196:199]
    v_mfma_f32_16x16x32_bf16 a[200:203], v[208:211], a[20:23], a[200:203]
    s_waitcnt vmcnt(18) lgkmcnt(0)
    s_barrier
    v_mfma_f32_16x16x32_bf16 a[204:207], v[212:215], a[12:15], a[204:207]
    ds_read_b64_tr_b16 v[192:193], v224 offset:0
    ds_read_b64_tr_b16 v[194:195], v224 offset:4096
    s_add_u32 m0, s61, 131072
    s_add_u32 s68, s83, 0
    buffer_load_dwordx4 v248, s[32:35], s68 offen offset:0 sc1 lds
    v_mfma_f32_16x16x32_bf16 a[208:211], v[212:215], a[16:19], a[208:211]
    ds_read_b128 a[24:27], v245 offset:0
    ds_read_b128 a[28:31], v245 offset:2048
    v_mfma_f32_16x16x32_bf16 a[212:215], v[212:215], a[20:23], a[212:215]
    ds_read_b128 a[32:35], v245 offset:4096
    ds_read_b64_tr_b16 v[196:197], v225 offset:0
    v_mfma_f32_16x16x32_bf16 a[216:219], v[216:219], a[12:15], a[216:219]
    ds_read_b64_tr_b16 v[198:199], v225 offset:4096
    ds_read_b64_tr_b16 v[200:201], v226 offset:0
    buffer_load_dwordx4 v248, s[32:35], s68 offen offset:1024 sc1 lds
    v_mfma_f32_16x16x32_bf16 a[220:223], v[216:219], a[16:19], a[220:223]
    ds_read_b64_tr_b16 v[202:203], v226 offset:4096
    ds_read_b128 a[36:39], v245 offset:1024
    v_mfma_f32_16x16x32_bf16 a[224:227], v[216:219], a[20:23], a[224:227]
    ds_read_b128 a[40:43], v245 offset:3072
    ds_read_b128 a[44:47], v245 offset:5120
    v_mfma_f32_16x16x32_bf16 a[228:231], v[220:223], a[12:15], a[228:231]
    ds_read_b64_tr_b16 v[204:205], v227 offset:0
    ds_read_b64_tr_b16 v[206:207], v227 offset:4096
    buffer_load_dwordx4 v248, s[32:35], s68 offen offset:2048 sc1 lds
    v_mfma_f32_16x16x32_bf16 a[232:235], v[220:223], a[16:19], a[232:235]
    ds_read_b64_tr_b16 v[208:209], v224 offset:8192
    ds_read_b64_tr_b16 v[210:211], v224 offset:12288
    v_mfma_f32_16x16x32_bf16 a[236:239], v[220:223], a[20:23], a[236:239]
    s_waitcnt lgkmcnt(11)
    v_mfma_f32_16x16x32_bf16 a[192:195], v[192:195], a[24:27], a[192:195]
    s_add_u32 m0, s59, 147456
    s_add_u32 s68, s75, 65536
    buffer_load_dwordx4 v243, s[24:27], s68 offen offset:0  lds
    v_mfma_f32_16x16x32_bf16 a[196:199], v[192:195], a[28:31], a[196:199]
    ds_read_b64_tr_b16 v[212:213], v225 offset:8192
    ds_read_b64_tr_b16 v[214:215], v225 offset:12288
    v_mfma_f32_16x16x32_bf16 a[200:203], v[192:195], a[32:35], a[200:203]
    s_waitcnt lgkmcnt(11)
    v_mfma_f32_16x16x32_bf16 a[204:207], v[196:199], a[24:27], a[204:207]
    s_add_u32 s68, s68, 3072
    v_xor_b32 v244, 128, v243
    buffer_load_dwordx4 v244, s[24:27], s68 offen offset:1024  lds
    v_mfma_f32_16x16x32_bf16 a[208:211], v[196:199], a[28:31], a[208:211]
    ds_read_b64_tr_b16 v[216:217], v226 offset:8192
    ds_read_b64_tr_b16 v[218:219], v226 offset:12288
    v_mfma_f32_16x16x32_bf16 a[212:215], v[196:199], a[32:35], a[212:215]
    s_waitcnt lgkmcnt(11)
    v_mfma_f32_16x16x32_bf16 a[216:219], v[200:203], a[24:27], a[216:219]
    s_add_u32 s68, s68, 3072
    buffer_load_dwordx4 v243, s[24:27], s68 offen offset:2048  lds
    v_mfma_f32_16x16x32_bf16 a[220:223], v[200:203], a[28:31], a[220:223]
    ds_read_b64_tr_b16 v[220:221], v227 offset:8192
    ds_read_b64_tr_b16 v[222:223], v227 offset:12288
    v_mfma_f32_16x16x32_bf16 a[224:227], v[200:203], a[32:35], a[224:227]
    s_add_u32 s48, s60, 49152
    v_add_u32 v245, s48, v248
    s_waitcnt lgkmcnt(8)
    v_mfma_f32_16x16x32_bf16 a[228:231], v[204:207], a[24:27], a[228:231]
    v_add_u32 v224, 81920, v246
    s_add_u32 s68, s68, 3072
    buffer_load_dwordx4 v244, s[24:27], s68 offen offset:3072  lds
    v_xor_b32 v225, 32, v224
    v_mfma_f32_16x16x32_bf16 a[232:235], v[204:207], a[28:31], a[232:235]
    v_xor_b32 v226, 64, v224
    v_xor_b32 v227, 96, v224
    v_mfma_f32_16x16x32_bf16 a[236:239], v[204:207], a[32:35], a[236:239]
    s_waitcnt lgkmcnt(6)
    v_mfma_f32_16x16x32_bf16 a[192:195], v[208:211], a[36:39], a[192:195]
    v_mfma_f32_16x16x32_bf16 a[196:199], v[208:211], a[40:43], a[196:199]
    v_mfma_f32_16x16x32_bf16 a[200:203], v[208:211], a[44:47], a[200:203]
    s_waitcnt vmcnt(18) lgkmcnt(0)
    s_barrier
    v_bfe_u32 v238, v248, 4, 2
    v_lshl_add_u32 v238, v238, 2, s63
    buffer_load_dword v232, v238, s[32:35], 0 offen offset:2048 sc1
    v_mfma_f32_16x16x32_bf16 a[204:207], v[212:215], a[36:39], a[204:207]
    ds_read_b64_tr_b16 v[192:193], v224 offset:0
    ds_read_b64_tr_b16 v[194:195], v224 offset:4096
    s_add_u32 m0, s61, 65536
    s_add_u32 s68, s83, 12288
    buffer_load_dwordx4 v248, s[32:35], s68 offen offset:0 sc1 lds
    v_mfma_f32_16x16x32_bf16 a[208:211], v[212:215], a[40:43], a[208:211]
    ds_read_b128 a[0:3], v245 offset:0
    ds_read_b128 a[4:7], v245 offset:2048
    v_mfma_f32_16x16x32_bf16 a[212:215], v[212:215], a[44:47], a[212:215]
    ds_read_b128 a[8:11], v245 offset:4096
    ds_read_b64_tr_b16 v[196:197], v225 offset:0
    v_mfma_f32_16x16x32_bf16 a[216:219], v[216:219], a[36:39], a[216:219]
    ds_read_b64_tr_b16 v[198:199], v225 offset:4096
    ds_read_b64_tr_b16 v[200:201], v226 offset:0
    buffer_load_dwordx4 v248, s[32:35], s68 offen offset:1024 sc1 lds
    v_mfma_f32_16x16x32_bf16 a[220:223], v[216:219], a[40:43], a[220:223]
    ds_read_b64_tr_b16 v[202:203], v226 offset:4096
    ds_read_b128 a[12:15], v245 offset:1024
    v_mfma_f32_16x16x32_bf16 a[224:227], v[216:219], a[44:47], a[224:227]
    ds_read_b128 a[16:19], v245 offset:3072
    ds_read_b128 a[20:23], v245 offset:5120
    v_mfma_f32_16x16x32_bf16 a[228:231], v[220:223], a[36:39], a[228:231]
    ds_read_b64_tr_b16 v[204:205], v227 offset:0
    ds_read_b64_tr_b16 v[206:207], v227 offset:4096
    buffer_load_dwordx4 v248, s[32:35], s68 offen offset:2048 sc1 lds
    v_mfma_f32_16x16x32_bf16 a[232:235], v[220:223], a[40:43], a[232:235]
    ds_read_b64_tr_b16 v[208:209], v224 offset:8192
    ds_read_b64_tr_b16 v[210:211], v224 offset:12288
    v_mfma_f32_16x16x32_bf16 a[236:239], v[220:223], a[44:47], a[236:239]
    s_waitcnt lgkmcnt(11)
    v_mfma_f32_16x16x32_bf16 a[192:195], v[192:195], a[0:3], a[192:195]
    s_add_u32 m0, s59, 16384
    s_add_u32 s68, s73, 131072
    buffer_load_dwordx4 v243, s[24:27], s68 offen offset:0  lds
    v_mfma_f32_16x16x32_bf16 a[196:199], v[192:195], a[4:7], a[196:199]
    ds_read_b64_tr_b16 v[212:213], v225 offset:8192
    ds_read_b64_tr_b16 v[214:215], v225 offset:12288
    v_mfma_f32_16x16x32_bf16 a[200:203], v[192:195], a[8:11], a[200:203]
    s_waitcnt lgkmcnt(11)
    v_mfma_f32_16x16x32_bf16 a[204:207], v[196:199], a[0:3], a[204:207]
    s_add_u32 s68, s68, 3072
    v_xor_b32 v244, 128, v243
    buffer_load_dwordx4 v244, s[24:27], s68 offen offset:1024  lds
    v_mfma_f32_16x16x32_bf16 a[208:211], v[196:199], a[4:7], a[208:211]
    ds_read_b64_tr_b16 v[216:217], v226 offset:8192
    ds_read_b64_tr_b16 v[218:219], v226 offset:12288
    v_mfma_f32_16x16x32_bf16 a[212:215], v[196:199], a[8:11], a[212:215]
    s_waitcnt lgkmcnt(11)
    v_mfma_f32_16x16x32_bf16 a[216:219], v[200:203], a[0:3], a[216:219]
    s_add_u32 s68, s68, 3072
    buffer_load_dwordx4 v243, s[24:27], s68 offen offset:2048  lds
    v_mfma_f32_16x16x32_bf16 a[220:223], v[200:203], a[4:7], a[220:223]
    ds_read_b64_tr_b16 v[220:221], v227 offset:8192
    ds_read_b64_tr_b16 v[222:223], v227 offset:12288
    v_mfma_f32_16x16x32_bf16 a[224:227], v[200:203], a[8:11], a[224:227]
    s_add_u32 s48, s60, 114688
    v_add_u32 v245, s48, v248
    s_waitcnt lgkmcnt(8)
    v_mfma_f32_16x16x32_bf16 a[228:231], v[204:207], a[0:3], a[228:231]
    v_add_u32 v224, 32768, v246
    s_add_u32 s68, s68, 3072
    buffer_load_dwordx4 v244, s[24:27], s68 offen offset:3072  lds
    v_xor_b32 v225, 32, v224
    v_mfma_f32_16x16x32_bf16 a[232:235], v[204:207], a[4:7], a[232:235]
    v_xor_b32 v226, 64, v224
    v_xor_b32 v227, 96, v224
    v_mfma_f32_16x16x32_bf16 a[236:239], v[204:207], a[8:11], a[236:239]
    s_waitcnt lgkmcnt(6)
    v_mfma_f32_16x16x32_bf16 a[192:195], v[208:211], a[12:15], a[192:195]
    v_mfma_f32_16x16x32_bf16 a[196:199], v[208:211], a[16:19], a[196:199]
    v_mfma_f32_16x16x32_bf16 a[200:203], v[208:211], a[20:23], a[200:203]
    s_waitcnt vmcnt(19) lgkmcnt(0)
    s_barrier
    v_mfma_f32_16x16x32_bf16 a[204:207], v[212:215], a[12:15], a[204:207]
    ds_read_b64_tr_b16 v[192:193], v224 offset:0
    ds_read_b64_tr_b16 v[194:195], v224 offset:4096
    s_add_u32 m0, s59, 0
    s_add_u32 s68, s73, 196608
    buffer_load_dwordx4 v243, s[24:27], s68 offen offset:0  lds
    v_mfma_f32_16x16x32_bf16 a[208:211], v[212:215], a[16:19], a[208:211]
    ds_read_b128 a[24:27], v245 offset:0
    ds_read_b128 a[28:31], v245 offset:2048
    v_mfma_f32_16x16x32_bf16 a[212:215], v[212:215], a[20:23], a[212:215]
    ds_read_b128 a[32:35], v245 offset:4096
    ds_read_b64_tr_b16 v[196:197], v225 offset:0
    v_mfma_f32_16x16x32_bf16 a[216:219], v[216:219], a[12:15], a[216:219]
    ds_read_b64_tr_b16 v[198:199], v225 offset:4096
    ds_read_b64_tr_b16 v[200:201], v226 offset:0
    s_add_u32 s68, s68, 3072
    v_xor_b32 v244, 128, v243
    buffer_load_dwordx4 v244, s[24:27], s68 offen offset:1024  lds
    v_mfma_f32_16x16x32_bf16 a[220:223], v[216:219], a[16:19], a[220:223]
    ds_read_b64_tr_b16 v[202:203], v226 offset:4096
    ds_read_b128 a[36:39], v245 offset:1024
    v_mfma_f32_16x16x32_bf16 a[224:227], v[216:219], a[20:23], a[224:227]
    ds_read_b128 a[40:43], v245 offset:3072
    ds_read_b128 a[44:47], v245 offset:5120
    v_mfma_f32_16x16x32_bf16 a[228:231], v[220:223], a[12:15], a[228:231]
    ds_read_b64_tr_b16 v[204:205], v227 offset:0
    ds_read_b64_tr_b16 v[206:207], v227 offset:4096
    s_add_u32 s68, s68, 3072
    buffer_load_dwordx4 v243, s[24:27], s68 offen offset:2048  lds
    v_mfma_f32_16x16x32_bf16 a[232:235], v[220:223], a[16:19], a[232:235]
    ds_read_b64_tr_b16 v[208:209], v224 offset:8192
    ds_read_b64_tr_b16 v[210:211], v224 offset:12288
    v_mfma_f32_16x16x32_bf16 a[236:239], v[220:223], a[20:23], a[236:239]
    s_waitcnt lgkmcnt(11)
    v_mfma_f32_16x16x32_bf16 a[192:195], v[192:195], a[24:27], a[192:195]
    s_add_u32 s68, s68, 3072
    buffer_load_dwordx4 v244, s[24:27], s68 offen offset:3072  lds
    v_mfma_f32_16x16x32_bf16 a[196:199], v[192:195], a[28:31], a[196:199]
    ds_read_b64_tr_b16 v[212:213], v225 offset:8192
    ds_read_b64_tr_b16 v[214:215], v225 offset:12288
    v_mfma_f32_16x16x32_bf16 a[200:203], v[192:195], a[32:35], a[200:203]
    s_waitcnt lgkmcnt(11)
    v_mfma_f32_16x16x32_bf16 a[204:207], v[196:199], a[24:27], a[204:207]
    v_mfma_f32_16x16x32_bf16 a[208:211], v[196:199], a[28:31], a[208:211]
    ds_read_b64_tr_b16 v[216:217], v226 offset:8192
    ds_read_b64_tr_b16 v[218:219], v226 offset:12288
    v_mfma_f32_16x16x32_bf16 a[212:215], v[196:199], a[32:35], a[212:215]
    s_waitcnt lgkmcnt(11)
    v_mfma_f32_16x16x32_bf16 a[216:219], v[200:203], a[24:27], a[216:219]
    v_mfma_f32_16x16x32_bf16 a[220:223], v[200:203], a[28:31], a[220:223]
    ds_read_b64_tr_b16 v[220:221], v227 offset:8192
    ds_read_b64_tr_b16 v[222:223], v227 offset:12288
    v_mfma_f32_16x16x32_bf16 a[224:227], v[200:203], a[32:35], a[224:227]
    s_add_u32 s48, s60, 131072
    v_add_u32 v245, s48, v248
    s_waitcnt lgkmcnt(8)
    v_mfma_f32_16x16x32_bf16 a[228:231], v[204:207], a[24:27], a[228:231]
    v_add_u32 v224, 98304, v246
    v_xor_b32 v225, 32, v224
    v_mfma_f32_16x16x32_bf16 a[232:235], v[204:207], a[28:31], a[232:235]
    v_xor_b32 v226, 64, v224
    v_xor_b32 v227, 96, v224
    v_mfma_f32_16x16x32_bf16 a[236:239], v[204:207], a[32:35], a[236:239]
    s_waitcnt lgkmcnt(6)
    v_mfma_f32_16x16x32_bf16 a[192:195], v[208:211], a[36:39], a[192:195]
    v_mfma_f32_16x16x32_bf16 a[196:199], v[208:211], a[40:43], a[196:199]
    v_mfma_f32_16x16x32_bf16 a[200:203], v[208:211], a[44:47], a[200:203]
    s_waitcnt vmcnt(16) lgkmcnt(0)
    s_barrier
    v_bfe_u32 v238, v248, 4, 2
    v_lshl_add_u32 v238, v238, 2, s63
    buffer_load_dword v233, v238, s[32:35], 0 offen offset:2048 sc1
    v_bfe_u32 v238, v248, 4, 2
    v_lshl_add_u32 v238, v238, 2, s63
    s_add_u32 s49, s56, 1
    s_and_b32 s49, s49, 3
    s_waitcnt vmcnt(12)
    s_mov_b32 s70, 0
L_p110_X:
    v_cmp_eq_u32 vcc, s71, v232
    s_nop 0
    s_bitcmp1_b32 vcc_lo, s49
    s_cbranch_scc1 L_p110ok_X
    s_add_u32 s70, s70, 1
    s_cmp_gt_u32 s70, 20000
    s_cbranch_scc1 L_p110ok_X
    s_sleep 1
    buffer_load_dword v232, v238, s[32:35], 0 offen offset:2048 sc1
    s_waitcnt vmcnt(0)
    s_branch L_p110_X
L_p110ok_X:
    v_mfma_f32_16x16x32_bf16 a[204:207], v[212:215], a[36:39], a[204:207]
    ds_read_b64_tr_b16 v[192:193], v224 offset:0
    ds_read_b64_tr_b16 v[194:195], v224 offset:4096
    s_add_u32 m0, s61, 114688
    s_add_u32 s68, s81, 24576
    buffer_load_dwordx4 v248, s[32:35], s68 offen offset:0 sc1 lds
    v_mfma_f32_16x16x32_bf16 a[208:211], v[212:215], a[40:43], a[208:211]
    ds_read_b128 a[0:3], v245 offset:0
    ds_read_b128 a[4:7], v245 offset:2048
    v_mfma_f32_16x16x32_bf16 a[212:215], v[212:215], a[44:47], a[212:215]
    ds_read_b128 a[8:11], v245 offset:4096
    ds_read_b64_tr_b16 v[196:197], v225 offset:0
    v_mfma_f32_16x16x32_bf16 a[216:219], v[216:219], a[36:39], a[216:219]
    ds_read_b64_tr_b16 v[198:199], v225 offset:4096
    ds_read_b64_tr_b16 v[200:201], v226 offset:0
    buffer_load_dwordx4 v248, s[32:35], s68 offen offset:1024 sc1 lds
    v_mfma_f32_16x16x32_bf16 a[220:223], v[216:219], a[40:43], a[220:223]
    ds_read_b64_tr_b16 v[202:203], v226 offset:4096
    ds_read_b128 a[12:15], v245 offset:1024
    v_mfma_f32_16x16x32_bf16 a[224:227], v[216:219], a[44:47], a[224:227]
    ds_read_b128 a[16:19], v245 offset:3072
    ds_read_b128 a[20:23], v245 offset:5120
    v_mfma_f32_16x16x32_bf16 a[228:231], v[220:223], a[36:39], a[228:231]
    ds_read_b64_tr_b16 v[204:205], v227 offset:0
    ds_read_b64_tr_b16 v[206:207], v227 offset:4096
    buffer_load_dwordx4 v248, s[32:35], s68 offen offset:2048 sc1 lds
    v_mfma_f32_16x16x32_bf16 a[232:235], v[220:223], a[40:43], a[232:235]
    ds_read_b64_tr_b16 v[208:209], v224 offset:8192
    ds_read_b64_tr_b16 v[210:211], v224 offset:12288
    v_mfma_f32_16x16x32_bf16 a[236:239], v[220:223], a[44:47], a[236:239]
    s_waitcnt lgkmcnt(11)
    v_mfma_f32_16x16x32_bf16 a[192:195], v[192:195], a[0:3], a[192:195]
    s_add_u32 m0, s61, 81920
    s_add_u32 s68, s81, 36864
    buffer_load_dwordx4 v248, s[32:35], s68 offen offset:0 sc1 lds
    v_mfma_f32_16x16x32_bf16 a[196:199], v[192:195], a[4:7], a[196:199]
    ds_read_b64_tr_b16 v[212:213], v225 offset:8192
    ds_read_b64_tr_b16 v[214:215], v225 offset:12288
    v_mfma_f32_16x16x32_bf16 a[200:203], v[192:195], a[8:11], a[200:203]
    s_waitcnt lgkmcnt(11)
    v_mfma_f32_16x16x32_bf16 a[204:207], v[196:199], a[0:3], a[204:207]
    buffer_load_dwordx4 v248, s[32:35], s68 offen offset:1024 sc1 lds
    v_mfma_f32_16x16x32_bf16 a[208:211], v[196:199], a[4:7], a[208:211]
    ds_read_b64_tr_b16 v[216:217], v226 offset:8192
    ds_read_b64_tr_b16 v[218:219], v226 offset:12288
    v_mfma_f32_16x16x32_bf16 a[212:215], v[196:199], a[8:11], a[212:215]
    s_waitcnt lgkmcnt(11)
    v_mfma_f32_16x16x32_bf16 a[216:219], v[200:203], a[0:3], a[216:219]
    buffer_load_dwordx4 v248, s[32:35], s68 offen offset:2048 sc1 lds
    v_mfma_f32_16x16x32_bf16 a[220:223], v[200:203], a[4:7], a[220:223]
    ds_read_b64_tr_b16 v[220:221], v227 offset:8192
    ds_read_b64_tr_b16 v[222:223], v227 offset:12288
    v_mfma_f32_16x16x32_bf16 a[224:227], v[200:203], a[8:11], a[224:227]
    s_add_u32 s48, s60, 65536
    v_add_u32 v245, s48, v248
    s_waitcnt lgkmcnt(8)
    v_mfma_f32_16x16x32_bf16 a[228:231], v[204:207], a[0:3], a[228:231]
    v_add_u32 v224, 147456, v246
    s_add_u32 m0, s59, 49152
    s_add_u32 s68, s74, 131072
    buffer_load_dwordx4 v243, s[24:27], s68 offen offset:0  lds
    v_xor_b32 v225, 32, v224
    v_mfma_f32_16x16x32_bf16 a[232:235], v[204:207], a[4:7], a[232:235]
    v_xor_b32 v226, 64, v224
    v_xor_b32 v227, 96, v224
    v_mfma_f32_16x16x32_bf16 a[236:239], v[204:207], a[8:11], a[236:239]
    s_waitcnt lgkmcnt(6)
    v_mfma_f32_16x16x32_bf16 a[192:195], v[208:211], a[12:15], a[192:195]
    s_add_u32 s68, s68, 3072
    v_xor_b32 v244, 128, v243
    buffer_load_dwordx4 v244, s[24:27], s68 offen offset:1024  lds
    v_mfma_f32_16x16x32_bf16 a[196:199], v[208:211], a[16:19], a[196:199]
    v_mfma_f32_16x16x32_bf16 a[200:203], v[208:211], a[20:23], a[200:203]
    s_waitcnt vmcnt(17) lgkmcnt(0)
    s_barrier
    v_mfma_f32_16x16x32_bf16 a[204:207], v[212:215], a[12:15], a[204:207]
    ds_read_b64_tr_b16 v[192:193], v224 offset:0
    ds_read_b64_tr_b16 v[194:195], v224 offset:4096
    s_add_u32 s68, s68, 3072
    buffer_load_dwordx4 v243, s[24:27], s68 offen offset:2048  lds
    v_mfma_f32_16x16x32_bf16 a[208:211], v[212:215], a[16:19], a[208:211]
    ds_read_b128 a[24:27], v245 offset:0
    ds_read_b128 a[28:31], v245 offset:2048
    v_mfma_f32_16x16x32_bf16 a[212:215], v[212:215], a[20:23], a[212:215]
    ds_read_b128 a[32:35], v245 offset:4096
    ds_read_b64_tr_b16 v[196:197], v225 offset:0
    v_mfma_f32_16x16x32_bf16 a[216:219], v[216:219], a[12:15], a[216:219]
    ds_read_b64_tr_b16 v[198:199], v225 offset:4096
    ds_read_b64_tr_b16 v[200:201], v226 offset:0
    s_add_u32 s68, s68, 3072
    buffer_load_dwordx4 v244, s[24:27], s68 offen offset:3072  lds
    v_mfma_f32_16x16x32_bf16 a[220:223], v[216:219], a[16:19], a[220:223]
    ds_read_b64_tr_b16 v[202:203], v226 offset:4096
    ds_read_b128 a[36:39], v245 offset:1024
    v_mfma_f32_16x16x32_bf16 a[224:227], v[216:219], a[20:23], a[224:227]
    ds_read_b128 a[40:43], v245 offset:3072
    ds_read_b128 a[44:47], v245 offset:5120
    v_mfma_f32_16x16x32_bf16 a[228:231], v[220:223], a[12:15], a[228:231]
    ds_read_b64_tr_b16 v[204:205], v227 offset:0
    ds_read_b64_tr_b16 v[206:207], v227 offset:4096
    s_add_u32 m0, s59, 131072
    s_add_u32 s68, s74, 196608
    buffer_load_dwordx4 v243, s[24:27], s68 offen offset:0  lds
    v_mfma_f32_16x16x32_bf16 a[232:235], v[220:223], a[16:19], a[232:235]
    ds_read_b64_tr_b16 v[208:209], v224 offset:8192
    ds_read_b64_tr_b16 v[210:211], v224 offset:12288
    v_mfma_f32_16x16x32_bf16 a[236:239], v[220:223], a[20:23], a[236:239]
    s_waitcnt lgkmcnt(11)
    v_mfma_f32_16x16x32_bf16 a[192:195], v[192:195], a[24:27], a[192:195]
    s_add_u32 s68, s68, 3072
    v_xor_b32 v244, 128, v243
    buffer_load_dwordx4 v244, s[24:27], s68 offen offset:1024  lds
    v_mfma_f32_16x16x32_bf16 a[196:199], v[192:195], a[28:31], a[196:199]
    ds_read_b64_tr_b16 v[212:213], v225 offset:8192
    ds_read_b64_tr_b16 v[214:215], v225 offset:12288
    v_mfma_f32_16x16x32_bf16 a[200:203], v[192:195], a[32:35], a[200:203]
    s_waitcnt lgkmcnt(11)
    v_mfma_f32_16x16x32_bf16 a[204:207], v[196:199], a[24:27], a[204:207]
    s_add_u32 s68, s68, 3072
    buffer_load_dwordx4 v243, s[24:27], s68 offen offset:2048  lds
    v_mfma_f32_16x16x32_bf16 a[208:211], v[196:199], a[28:31], a[208:211]
    ds_read_b64_tr_b16 v[216:217], v226 offset:8192
    ds_read_b64_tr_b16 v[218:219], v226 offset:12288
    v_mfma_f32_16x16x32_bf16 a[212:215], v[196:199], a[32:35], a[212:215]
    s_waitcnt lgkmcnt(11)
    v_mfma_f32_16x16x32_bf16 a[216:219], v[200:203], a[24:27], a[216:219]
    s_add_u32 s68, s68, 3072
    buffer_load_dwordx4 v244, s[24:27], s68 offen offset:3072  lds
    v_mfma_f32_16x16x32_bf16 a[220:223], v[200:203], a[28:31], a[220:223]
    ds_read_b64_tr_b16 v[220:221], v227 offset:8192
    ds_read_b64_tr_b16 v[222:223], v227 offset:12288
    v_mfma_f32_16x16x32_bf16 a[224:227], v[200:203], a[32:35], a[224:227]
    s_add_u32 s48, s60, 114688
    v_add_u32 v245, s48, v248
    s_waitcnt lgkmcnt(8)
    v_mfma_f32_16x16x32_bf16 a[228:231], v[204:207], a[24:27], a[228:231]
    v_add_u32 v224, 16384, v246
    v_xor_b32 v225, 32, v224
    v_mfma_f32_16x16x32_bf16 a[232:235], v[204:207], a[28:31], a[232:235]
    v_xor_b32 v226, 64, v224
    v_xor_b32 v227, 96, v224
    v_mfma_f32_16x16x32_bf16 a[236:239], v[204:207], a[32:35], a[236:239]
    s_waitcnt lgkmcnt(6)
    v_mfma_f32_16x16x32_bf16 a[192:195], v[208:211], a[36:39], a[192:195]
    v_mfma_f32_16x16x32_bf16 a[196:199], v[208:211], a[40:43], a[196:199]
    v_mfma_f32_16x16x32_bf16 a[200:203], v[208:211], a[44:47], a[200:203]
    s_waitcnt vmcnt(11) lgkmcnt(0)
    s_barrier
    v_bfe_u32 v238, v248, 4, 2
    v_lshl_add_u32 v238, v238, 2, s63
    buffer_load_dword v234, v238, s[32:35], 0 offen offset:2048 sc1
    v_bfe_u32 v238, v248, 4, 2
    v_lshl_add_u32 v238, v238, 2, s63
    s_add_u32 s49, s56, 2
    s_and_b32 s49, s49, 3
    s_mov_b32 s70, 0
L_p112_X:
    v_cmp_eq_u32 vcc, s71, v233
    s_nop 0
    s_bitcmp1_b32 vcc_lo, s49
    s_cbranch_scc1 L_p112ok_X
    s_add_u32 s70, s70, 1
    s_cmp_gt_u32 s70, 20000
    s_cbranch_scc1 L_p112ok_X
    s_sleep 1
    buffer_load_dword v233, v238, s[32:35], 0 offen offset:2048 sc1
    s_waitcnt vmcnt(0)
    s_branch L_p112_X
L_p112ok_X:
    v_mfma_f32_16x16x32_bf16 a[204:207], v[212:215], a[36:39], a[204:207]
    ds_read_b64_tr_b16 v[192:193], v224 offset:0
    ds_read_b64_tr_b16 v[194:195], v224 offset:4096
    s_add_u32 m0, s61, 147456
    s_add_u32 s68, s82, 24576
    buffer_load_dwordx4 v248, s[32:35], s68 offen offset:0 sc1 lds
    v_mfma_f32_16x16x32_bf16 a[208:211], v[212:215], a[40:43], a[208:211]
    ds_read_b128 a[0:3], v245 offset:0
    ds_read_b128 a[4:7], v245 offset:2048
    v_mfma_f32_16x16x32_bf16 a[212:215], v[212:215], a[44:47], a[212:215]
    ds_read_b128 a[8:11], v245 offset:4096
    ds_read_b64_tr_b16 v[196:197], v225 offset:0
    v_mfma_f32_16x16x32_bf16 a[216:219], v[216:219], a[36:39], a[216:219]
    ds_read_b64_tr_b16 v[198:199], v225 offset:4096
    ds_read_b64_tr_b16 v[200:201], v226 offset:0
    buffer_load_dwordx4 v248, s[32:35], s68 offen offset:1024 sc1 lds
    v_mfma_f32_16x16x32_bf16 a[220:223], v[216:219], a[40:43], a[220:223]
    ds_read_b64_tr_b16 v[202:203], v226 offset:4096
    ds_read_b128 a[12:15], v245 offset:1024
    v_mfma_f32_16x16x32_bf16 a[224:227], v[216:219], a[44:47], a[224:227]
    ds_read_b128 a[16:19], v245 offset:3072
    ds_read_b128 a[20:23], v245 offset:5120
    v_mfma_f32_16x16x32_bf16 a[228:231], v[220:223], a[36:39], a[228:231]
    ds_read_b64_tr_b16 v[204:205], v227 offset:0
    ds_read_b64_tr_b16 v[206:207], v227 offset:4096
    buffer_load_dwordx4 v248, s[32:35], s68 offen offset:2048 sc1 lds
    v_mfma_f32_16x16x32_bf16 a[232:235], v[220:223], a[40:43], a[232:235]
    ds_read_b64_tr_b16 v[208:209], v224 offset:8192
    ds_read_b64_tr_b16 v[210:211], v224 offset:12288
    v_mfma_f32_16x16x32_bf16 a[236:239], v[220:223], a[44:47], a[236:239]
    s_waitcnt lgkmcnt(11)
    v_mfma_f32_16x16x32_bf16 a[192:195], v[192:195], a[0:3], a[192:195]
    s_add_u32 m0, s61, 32768
    s_add_u32 s68, s82, 36864
    buffer_load_dwordx4 v248, s[32:35], s68 offen offset:0 sc1 lds
    v_mfma_f32_16x16x32_bf16 a[196:199], v[192:195], a[4:7], a[196:199]
    ds_read_b64_tr_b16 v[212:213], v225 offset:8192
    ds_read_b64_tr_b16 v[214:215], v225 offset:12288
    v_mfma_f32_16x16x32_bf16 a[200:203], v[192:195], a[8:11], a[200:203]
    s_waitcnt lgkmcnt(11)
    v_mfma_f32_16x16x32_bf16 a[204:207], v[196:199], a[0:3], a[204:207]
    buffer_load_dwordx4 v248, s[32:35], s68 offen offset:1024 sc1 lds
    v_mfma_f32_16x16x32_bf16 a[208:211], v[196:199], a[4:7], a[208:211]
    ds_read_b64_tr_b16 v[216:217], v226 offset:8192
    ds_read_b64_tr_b16 v[218:219], v226 offset:12288
    v_mfma_f32_16x16x32_bf16 a[212:215], v[196:199], a[8:11], a[212:215]
    s_waitcnt lgkmcnt(11)
    v_mfma_f32_16x16x32_bf16 a[216:219], v[200:203], a[0:3], a[216:219]
    buffer_load_dwordx4 v248, s[32:35], s68 offen offset:2048 sc1 lds
    v_mfma_f32_16x16x32_bf16 a[220:223], v[200:203], a[4:7], a[220:223]
    ds_read_b64_tr_b16 v[220:221], v227 offset:8192
    ds_read_b64_tr_b16 v[222:223], v227 offset:12288
    v_mfma_f32_16x16x32_bf16 a[224:227], v[200:203], a[8:11], a[224:227]
    s_add_u32 s48, s60, 81920
    v_add_u32 v245, s48, v248
    s_waitcnt lgkmcnt(8)
    v_mfma_f32_16x16x32_bf16 a[228:231], v[204:207], a[0:3], a[228:231]
    v_add_u32 v224, 0, v246
    s_add_u32 m0, s59, 98304
    s_add_u32 s68, s75, 131072
    buffer_load_dwordx4 v243, s[24:27], s68 offen offset:0  lds
    v_xor_b32 v225, 32, v224
    v_mfma_f32_16x16x32_bf16 a[232:235], v[204:207], a[4:7], a[232:235]
    v_xor_b32 v226, 64, v224
    v_xor_b32 v227, 96, v224
    v_mfma_f32_16x16x32_bf16 a[236:239], v[204:207], a[8:11], a[236:239]
    s_waitcnt lgkmcnt(6)
    v_mfma_f32_16x16x32_bf16 a[192:195], v[208:211], a[12:15], a[192:195]
    s_add_u32 s68, s68, 3072
    v_xor_b32 v244, 128, v243
    buffer_load_dwordx4 v244, s[24:27], s68 offen offset:1024  lds
    v_mfma_f32_16x16x32_bf16 a[196:199], v[208:211], a[16:19], a[196:199]
    v_mfma_f32_16x16x32_bf16 a[200:203], v[208:211], a[20:23], a[200:203]
    s_waitcnt vmcnt(17) lgkmcnt(0)
    s_barrier
    v_mfma_f32_16x16x32_bf16 a[204:207], v[212:215], a[12:15], a[204:207]
    ds_read_b64_tr_b16 v[192:193], v224 offset:0
    ds_read_b64_tr_b16 v[194:195], v224 offset:4096
    s_add_u32 s68, s68, 3072
    buffer_load_dwordx4 v243, s[24:27], s68 offen offset:2048  lds
    v_mfma_f32_16x16x32_bf16 a[208:211], v[212:215], a[16:19], a[208:211]
    ds_read_b128 a[24:27], v245 offset:0
    ds_read_b128 a[28:31], v245 offset:2048
    v_mfma_f32_16x16x32_bf16 a[212:215], v[212:215], a[20:23], a[212:215]
    ds_read_b128 a[32:35], v245 offset:4096
    ds_read_b64_tr_b16 v[196:197], v225 offset:0
    v_mfma_f32_16x16x32_bf16 a[216:219], v[216:219], a[12:15], a[216:219]
    ds_read_b64_tr_b16 v[198:199], v225 offset:4096
    ds_read_b64_tr_b16 v[200:201], v226 offset:0
    s_add_u32 s68, s68, 3072
    buffer_load_dwordx4 v244, s[24:27], s68 offen offset:3072  lds
    v_mfma_f32_16x16x32_bf16 a[220:223], v[216:219], a[16:19], a[220:223]
    ds_read_b64_tr_b16 v[202:203], v226 offset:4096
    ds_read_b128 a[36:39], v245 offset:1024
    v_mfma_f32_16x16x32_bf16 a[224:227], v[216:219], a[20:23], a[224:227]
    ds_read_b128 a[40:43], v245 offset:3072
    ds_read_b128 a[44:47], v245 offset:5120
    v_mfma_f32_16x16x32_bf16 a[228:231], v[220:223], a[12:15], a[228:231]
    ds_read_b64_tr_b16 v[204:205], v227 offset:0
    ds_read_b64_tr_b16 v[206:207], v227 offset:4096
    s_add_u32 m0, s59, 114688
    s_add_u32 s68, s75, 196608
    buffer_load_dwordx4 v243, s[24:27], s68 offen offset:0  lds
    v_mfma_f32_16x16x32_bf16 a[232:235], v[220:223], a[16:19], a[232:235]
    ds_read_b64_tr_b16 v[208:209], v224 offset:8192
    ds_read_b64_tr_b16 v[210:211], v224 offset:12288
    v_mfma_f32_16x16x32_bf16 a[236:239], v[220:223], a[20:23], a[236:239]
    s_waitcnt lgkmcnt(11)
    v_mfma_f32_16x16x32_bf16 a[192:195], v[192:195], a[24:27], a[192:195]
    s_add_u32 s68, s68, 3072
    v_xor_b32 v244, 128, v243
    buffer_load_dwordx4 v244, s[24:27], s68 offen offset:1024  lds
    v_mfma_f32_16x16x32_bf16 a[196:199], v[192:195], a[28:31], a[196:199]
    ds_read_b64_tr_b16 v[212:213], v225 offset:8192
    ds_read_b64_tr_b16 v[214:215], v225 offset:12288
    v_mfma_f32_16x16x32_bf16 a[200:203], v[192:195], a[32:35], a[200:203]
    s_waitcnt lgkmcnt(11)
    v_mfma_f32_16x16x32_bf16 a[204:207], v[196:199], a[24:27], a[204:207]
    s_add_u32 s68, s68, 3072
    buffer_load_dwordx4 v243, s[24:27], s68 offen offset:2048  lds
    v_mfma_f32_16x16x32_bf16 a[208:211], v[196:199], a[28:31], a[208:211]
    ds_read_b64_tr_b16 v[216:217], v226 offset:8192
    ds_read_b64_tr_b16 v[218:219], v226 offset:12288
    v_mfma_f32_16x16x32_bf16 a[212:215], v[196:199], a[32:35], a[212:215]
    s_waitcnt lgkmcnt(11)
    v_mfma_f32_16x16x32_bf16 a[216:219], v[200:203], a[24:27], a[216:219]
    s_add_u32 s68, s68, 3072
    buffer_load_dwordx4 v244, s[24:27], s68 offen offset:3072  lds
    v_mfma_f32_16x16x32_bf16 a[220:223], v[200:203], a[28:31], a[220:223]
    ds_read_b64_tr_b16 v[220:221], v227 offset:8192
    ds_read_b64_tr_b16 v[222:223], v227 offset:12288
    v_mfma_f32_16x16x32_bf16 a[224:227], v[200:203], a[32:35], a[224:227]
    s_add_u32 s48, s60, 147456
    v_add_u32 v245, s48, v248
    s_waitcnt lgkmcnt(8)
    v_mfma_f32_16x16x32_bf16 a[228:231], v[204:207], a[24:27], a[228:231]
    v_add_u32 v224, 49152, v246
    v_xor_b32 v225, 32, v224
    v_mfma_f32_16x16x32_bf16 a[232:235], v[204:207], a[28:31], a[232:235]
    v_xor_b32 v226, 64, v224
    v_xor_b32 v227, 96, v224
    v_mfma_f32_16x16x32_bf16 a[236:239], v[204:207], a[32:35], a[236:239]
    s_waitcnt lgkmcnt(6)
    v_mfma_f32_16x16x32_bf16 a[192:195], v[208:211], a[36:39], a[192:195]
    v_mfma_f32_16x16x32_bf16 a[196:199], v[208:211], a[40:43], a[196:199]
    v_mfma_f32_16x16x32_bf16 a[200:203], v[208:211], a[44:47], a[200:203]
    s_waitcnt vmcnt(11) lgkmcnt(0)
    s_barrier
    v_bfe_u32 v238, v248, 4, 2
    v_lshl_add_u32 v238, v238, 2, s63
    s_add_u32 s49, s56, 3
    s_and_b32 s49, s49, 3
    s_mov_b32 s70, 0
L_p114_X:
    v_cmp_eq_u32 vcc, s71, v234
    s_nop 0
    s_bitcmp1_b32 vcc_lo, s49
    s_cbranch_scc1 L_p114ok_X
    s_add_u32 s70, s70, 1
    s_cmp_gt_u32 s70, 20000
    s_cbranch_scc1 L_p114ok_X
    s_sleep 1
    buffer_load_dword v234, v238, s[32:35], 0 offen offset:2048 sc1
    s_waitcnt vmcnt(0)
    s_branch L_p114_X
L_p114ok_X:
    v_mfma_f32_16x16x32_bf16 a[204:207], v[212:215], a[36:39], a[204:207]
    ds_read_b64_tr_b16 v[192:193], v224 offset:0
    ds_read_b64_tr_b16 v[194:195], v224 offset:4096
    s_add_u32 m0, s61, 65536
    s_add_u32 s68, s83, 24576
    buffer_load_dwordx4 v248, s[32:35], s68 offen offset:0 sc1 lds
    v_mfma_f32_16x16x32_bf16 a[208:211], v[212:215], a[40:43], a[208:211]
    ds_read_b128 a[0:3], v245 offset:0
    ds_read_b128 a[4:7], v245 offset:2048
    v_mfma_f32_16x16x32_bf16 a[212:215], v[212:215], a[44:47], a[212:215]
    ds_read_b128 a[8:11], v245 offset:4096
    ds_read_b64_tr_b16 v[196:197], v225 offset:0
    v_mfma_f32_16x16x32_bf16 a[216:219], v[216:219], a[36:39], a[216:219]
    ds_read_b64_tr_b16 v[198:199], v225 offset:4096
    ds_read_b64_tr_b16 v[200:201], v226 offset:0
    buffer_load_dwordx4 v248, s[32:35], s68 offen offset:1024 sc1 lds
    v_mfma_f32_16x16x32_bf16 a[220:223], v[216:219], a[40:43], a[220:223]
    ds_read_b64_tr_b16 v[202:203], v226 offset:4096
    ds_read_b128 a[12:15], v245 offset:1024
    v_mfma_f32_16x16x32_bf16 a[224:227], v[216:219], a[44:47], a[224:227]
    ds_read_b128 a[16:19], v245 offset:3072
    ds_read_b128 a[20:23], v245 offset:5120
    v_mfma_f32_16x16x32_bf16 a[228:231], v[220:223], a[36:39], a[228:231]
    ds_read_b64_tr_b16 v[204:205], v227 offset:0
    ds_read_b64_tr_b16 v[206:207], v227 offset:4096
    buffer_load_dwordx4 v248, s[32:35], s68 offen offset:2048 sc1 lds
    v_mfma_f32_16x16x32_bf16 a[232:235], v[220:223], a[40:43], a[232:235]
    ds_read_b64_tr_b16 v[208:209], v224 offset:8192
    ds_read_b64_tr_b16 v[210:211], v224 offset:12288
    v_mfma_f32_16x16x32_bf16 a[236:239], v[220:223], a[44:47], a[236:239]
    s_waitcnt lgkmcnt(11)
    v_mfma_f32_16x16x32_bf16 a[192:195], v[192:195], a[0:3], a[192:195]
    s_add_u32 m0, s61, 16384
    s_add_u32 s68, s83, 36864
    buffer_load_dwordx4 v248, s[32:35], s68 offen offset:0 sc1 lds
    v_mfma_f32_16x16x32_bf16 a[196:199], v[192:195], a[4:7], a[196:199]
    ds_read_b64_tr_b16 v[212:213], v225 offset:8192
    ds_read_b64_tr_b16 v[214:215], v225 offset:12288
    v_mfma_f32_16x16x32_bf16 a[200:203], v[192:195], a[8:11], a[200:203]
    s_waitcnt lgkmcnt(11)
    v_mfma_f32_16x16x32_bf16 a[204:207], v[196:199], a[0:3], a[204:207]
    buffer_load_dwordx4 v248, s[32:35], s68 offen offset:1024 sc1 lds
    v_mfma_f32_16x16x32_bf16 a[208:211], v[196:199], a[4:7], a[208:211]
    ds_read_b64_tr_b16 v[216:217], v226 offset:8192
    ds_read_b64_tr_b16 v[218:219], v226 offset:12288
    v_mfma_f32_16x16x32_bf16 a[212:215], v[196:199], a[8:11], a[212:215]
    s_waitcnt lgkmcnt(11)
    v_mfma_f32_16x16x32_bf16 a[216:219], v[200:203], a[0:3], a[216:219]
    buffer_load_dwordx4 v248, s[32:35], s68 offen offset:2048 sc1 lds
    v_mfma_f32_16x16x32_bf16 a[220:223], v[200:203], a[4:7], a[220:223]
    ds_read_b64_tr_b16 v[220:221], v227 offset:8192
    ds_read_b64_tr_b16 v[222:223], v227 offset:12288
    v_mfma_f32_16x16x32_bf16 a[224:227], v[200:203], a[8:11], a[224:227]
    s_add_u32 s48, s60, 32768
    v_add_u32 v245, s48, v248
    s_waitcnt lgkmcnt(8)
    v_mfma_f32_16x16x32_bf16 a[228:231], v[204:207], a[0:3], a[228:231]
    v_add_u32 v224, 131072, v246
    v_xor_b32 v225, 32, v224
    v_mfma_f32_16x16x32_bf16 a[232:235], v[204:207], a[4:7], a[232:235]
    v_xor_b32 v226, 64, v224
    v_xor_b32 v227, 96, v224
    v_mfma_f32_16x16x32_bf16 a[236:239], v[204:207], a[8:11], a[236:239]
    s_waitcnt lgkmcnt(6)
    v_mfma_f32_16x16x32_bf16 a[192:195], v[208:211], a[12:15], a[192:195]
    v_mfma_f32_16x16x32_bf16 a[196:199], v[208:211], a[16:19], a[196:199]
    v_mfma_f32_16x16x32_bf16 a[200:203], v[208:211], a[20:23], a[200:203]
    s_waitcnt vmcnt(14) lgkmcnt(0)
    s_barrier
    s_mul_i32 s76, s58, 147456
    s_mul_i32 s48, s40, 3072
    s_add_u32 s76, s76, s48
    s_add_u32 s76, s76, 20971520
    s_xor_b32 s48, s57, 1
    s_mul_i32 s48, s48, 36864
    s_add_u32 s48, s48, s76
    s_add_u32 s84, s48, 0
    s_xor_b32 s48, s57, 2
    s_mul_i32 s48, s48, 36864
    s_add_u32 s48, s48, s76
    s_add_u32 s85, s48, 12288
    s_xor_b32 s48, s57, 3
    s_mul_i32 s48, s48, 36864
    s_add_u32 s48, s48, s76
    s_add_u32 s86, s48, 24576
    s_mul_i32 s50, s57, 36864
    s_add_u32 s76, s76, s50
    v_bfe_u32 v50, v248, 4, 4
    v_lshrrev_b32 v51, 8, v248
    v_lshlrev_b32 v50, 11, v50
    v_lshl_add_u32 v50, v51, 3, v50
    s_mul_i32 s77, s44, 196608
    s_mul_i32 s49, s41, 98304
    s_add_u32 s77, s77, s49
    s_lshl_b32 s49, s43, 10
    s_add_u32 s77, s77, s49
    s_lshl_b32 s49, s90, 8
    s_add_u32 s77, s77, s49
    s_lshl_b32 s49, s42, 7
    s_add_u32 s77, s77, s49
    s_lshl_b32 s49, s57, 5
    s_add_u32 s77, s77, s49
    v_mfma_f32_16x16x32_bf16 a[204:207], v[212:215], a[12:15], a[204:207]
    ds_read_b64_tr_b16 v[192:193], v224 offset:0
    ds_read_b64_tr_b16 v[194:195], v224 offset:4096
    v_mfma_f32_16x16x32_bf16 a[208:211], v[212:215], a[16:19], a[208:211]
    ds_read_b128 a[24:27], v245 offset:0
    ds_read_b128 a[28:31], v245 offset:2048
    v_mfma_f32_16x16x32_bf16 a[212:215], v[212:215], a[20:23], a[212:215]
    ds_read_b128 a[32:35], v245 offset:4096
    ds_read_b64_tr_b16 v[196:197], v225 offset:0
    v_mfma_f32_16x16x32_bf16 a[216:219], v[216:219], a[12:15], a[216:219]
    ds_read_b64_tr_b16 v[198:199], v225 offset:4096
    ds_read_b64_tr_b16 v[200:201], v226 offset:0
    v_mfma_f32_16x16x32_bf16 a[220:223], v[216:219], a[16:19], a[220:223]
    ds_read_b64_tr_b16 v[202:203], v226 offset:4096
    ds_read_b128 a[36:39], v245 offset:1024
    v_mfma_f32_16x16x32_bf16 a[224:227], v[216:219], a[20:23], a[224:227]
    ds_read_b128 a[40:43], v245 offset:3072
    ds_read_b128 a[44:47], v245 offset:5120
    v_mfma_f32_16x16x32_bf16 a[228:231], v[220:223], a[12:15], a[228:231]
    ds_read_b64_tr_b16 v[204:205], v227 offset:0
    ds_read_b64_tr_b16 v[206:207], v227 offset:4096
    v_mfma_f32_16x16x32_bf16 a[232:235], v[220:223], a[16:19], a[232:235]
    ds_read_b64_tr_b16 v[208:209], v224 offset:8192
    ds_read_b64_tr_b16 v[210:211], v224 offset:12288
    v_mfma_f32_16x16x32_bf16 a[236:239], v[220:223], a[20:23], a[236:239]
    s_waitcnt lgkmcnt(11)
    v_mfma_f32_16x16x32_bf16 a[192:195], v[192:195], a[24:27], a[192:195]
    v_mfma_f32_16x16x32_bf16 a[196:199], v[192:195], a[28:31], a[196:199]
    ds_read_b64_tr_b16 v[212:213], v225 offset:8192
    ds_read_b64_tr_b16 v[214:215], v225 offset:12288
    v_mfma_f32_16x16x32_bf16 a[200:203], v[192:195], a[32:35], a[200:203]
    s_waitcnt lgkmcnt(11)
    v_mfma_f32_16x16x32_bf16 a[204:207], v[196:199], a[24:27], a[204:207]
    v_mfma_f32_16x16x32_bf16 a[208:211], v[196:199], a[28:31], a[208:211]
    ds_read_b64_tr_b16 v[216:217], v226 offset:8192
    ds_read_b64_tr_b16 v[218:219], v226 offset:12288
    v_mfma_f32_16x16x32_bf16 a[212:215], v[196:199], a[32:35], a[212:215]
    s_waitcnt lgkmcnt(11)
    v_mfma_f32_16x16x32_bf16 a[216:219], v[200:203], a[24:27], a[216:219]
    v_mfma_f32_16x16x32_bf16 a[220:223], v[200:203], a[28:31], a[220:223]
    ds_read_b64_tr_b16 v[220:221], v227 offset:8192
    ds_read_b64_tr_b16 v[222:223], v227 offset:12288
    v_mfma_f32_16x16x32_bf16 a[224:227], v[200:203], a[32:35], a[224:227]
    s_add_u32 s48, s60, 65536
    v_add_u32 v245, s48, v248
    s_waitcnt lgkmcnt(8)
    v_mfma_f32_16x16x32_bf16 a[228:231], v[204:207], a[24:27], a[228:231]
    v_add_u32 v224, 98304, v246
    v_xor_b32 v225, 32, v224
    v_mfma_f32_16x16x32_bf16 a[232:235], v[204:207], a[28:31], a[232:235]
    v_xor_b32 v226, 64, v224
    v_xor_b32 v227, 96, v224
    v_mfma_f32_16x16x32_bf16 a[236:239], v[204:207], a[32:35], a[236:239]
    s_waitcnt lgkmcnt(6)
    v_mfma_f32_16x16x32_bf16 a[192:195], v[208:211], a[36:39], a[192:195]
    v_mfma_f32_16x16x32_bf16 a[196:199], v[208:211], a[40:43], a[196:199]
    v_mfma_f32_16x16x32_bf16 a[200:203], v[208:211], a[44:47], a[200:203]
    s_waitcnt vmcnt(3) lgkmcnt(0)
    s_barrier
    v_mfma_f32_16x16x32_bf16 a[204:207], v[212:215], a[36:39], a[204:207]
    ds_read_b64_tr_b16 v[192:193], v224 offset:0
    ds_read_b64_tr_b16 v[194:195], v224 offset:4096
    v_mfma_f32_16x16x32_bf16 a[208:211], v[212:215], a[40:43], a[208:211]
    ds_read_b128 a[0:3], v245 offset:0
    ds_read_b128 a[4:7], v245 offset:2048
    v_mfma_f32_16x16x32_bf16 a[212:215], v[212:215], a[44:47], a[212:215]
    ds_read_b128 a[8:11], v245 offset:4096
    ds_read_b64_tr_b16 v[196:197], v225 offset:0
    v_mfma_f32_16x16x32_bf16 a[216:219], v[216:219], a[36:39], a[216:219]
    ds_read_b64_tr_b16 v[198:199], v225 offset:4096
    ds_read_b64_tr_b16 v[200:201], v226 offset:0
    v_mfma_f32_16x16x32_bf16 a[220:223], v[216:219], a[40:43], a[220:223]
    ds_read_b64_tr_b16 v[202:203], v226 offset:4096
    ds_read_b128 a[12:15], v245 offset:1024
    v_mfma_f32_16x16x32_bf16 a[224:227], v[216:219], a[44:47], a[224:227]
    ds_read_b128 a[16:19], v245 offset:3072
    ds_read_b128 a[20:23], v245 offset:5120
    v_mfma_f32_16x16x32_bf16 a[228:231], v[220:223], a[36:39], a[228:231]
    ds_read_b64_tr_b16 v[204:205], v227 offset:0
    ds_read_b64_tr_b16 v[206:207], v227 offset:4096
    v_mfma_f32_16x16x32_bf16 a[232:235], v[220:223], a[40:43], a[232:235]
    ds_read_b64_tr_b16 v[208:209], v224 offset:8192
    ds_read_b64_tr_b16 v[210:211], v224 offset:12288
    v_mfma_f32_16x16x32_bf16 a[236:239], v[220:223], a[44:47], a[236:239]
    s_waitcnt lgkmcnt(11)
    v_mfma_f32_16x16x32_bf16 a[192:195], v[192:195], a[0:3], a[192:195]
    v_mfma_f32_16x16x32_bf16 a[196:199], v[192:195], a[4:7], a[196:199]
    ds_read_b64_tr_b16 v[212:213], v225 offset:8192
    ds_read_b64_tr_b16 v[214:215], v225 offset:12288
    v_mfma_f32_16x16x32_bf16 a[200:203], v[192:195], a[8:11], a[200:203]
    s_waitcnt lgkmcnt(11)
    v_mfma_f32_16x16x32_bf16 a[204:207], v[196:199], a[0:3], a[204:207]
    v_mfma_f32_16x16x32_bf16 a[208:211], v[196:199], a[4:7], a[208:211]
    ds_read_b64_tr_b16 v[216:217], v226 offset:8192
    ds_read_b64_tr_b16 v[218:219], v226 offset:12288
    v_mfma_f32_16x16x32_bf16 a[212:215], v[196:199], a[8:11], a[212:215]
    s_waitcnt lgkmcnt(11)
    v_mfma_f32_16x16x32_bf16 a[216:219], v[200:203], a[0:3], a[216:219]
    v_mfma_f32_16x16x32_bf16 a[220:223], v[200:203], a[4:7], a[220:223]
    ds_read_b64_tr_b16 v[220:221], v227 offset:8192
    ds_read_b64_tr_b16 v[222:223], v227 offset:12288
    v_mfma_f32_16x16x32_bf16 a[224:227], v[200:203], a[8:11], a[224:227]
    s_add_u32 s48, s60, 16384
    v_add_u32 v245, s48, v248
    s_waitcnt lgkmcnt(8)
    v_mfma_f32_16x16x32_bf16 a[228:231], v[204:207], a[0:3], a[228:231]
    v_add_u32 v224, 114688, v246
    v_xor_b32 v225, 32, v224
    v_mfma_f32_16x16x32_bf16 a[232:235], v[204:207], a[4:7], a[232:235]
    v_xor_b32 v226, 64, v224
    v_xor_b32 v227, 96, v224
    v_mfma_f32_16x16x32_bf16 a[236:239], v[204:207], a[8:11], a[236:239]
    s_waitcnt lgkmcnt(6)
    v_mfma_f32_16x16x32_bf16 a[192:195], v[208:211], a[12:15], a[192:195]
    v_mfma_f32_16x16x32_bf16 a[196:199], v[208:211], a[16:19], a[196:199]
    v_mfma_f32_16x16x32_bf16 a[200:203], v[208:211], a[20:23], a[200:203]
    s_waitcnt vmcnt(0) lgkmcnt(0)
    s_barrier
    v_mfma_f32_16x16x32_bf16 a[204:207], v[212:215], a[12:15], a[204:207]
    ds_read_b64_tr_b16 v[192:193], v224 offset:0
    ds_read_b64_tr_b16 v[194:195], v224 offset:4096
    v_mfma_f32_16x16x32_bf16 a[208:211], v[212:215], a[16:19], a[208:211]
    ds_read_b128 a[24:27], v245 offset:0
    ds_read_b128 a[28:31], v245 offset:2048
    v_mfma_f32_16x16x32_bf16 a[212:215], v[212:215], a[20:23], a[212:215]
    ds_read_b128 a[32:35], v245 offset:4096
    ds_read_b64_tr_b16 v[196:197], v225 offset:0
    v_mfma_f32_16x16x32_bf16 a[216:219], v[216:219], a[12:15], a[216:219]
    ds_read_b64_tr_b16 v[198:199], v225 offset:4096
    ds_read_b64_tr_b16 v[200:201], v226 offset:0
    v_mfma_f32_16x16x32_bf16 a[220:223], v[216:219], a[16:19], a[220:223]
    ds_read_b64_tr_b16 v[202:203], v226 offset:4096
    ds_read_b128 a[36:39], v245 offset:1024
    v_mfma_f32_16x16x32_bf16 a[224:227], v[216:219], a[20:23], a[224:227]
    ds_read_b128 a[40:43], v245 offset:3072
    ds_read_b128 a[44:47], v245 offset:5120
    v_mfma_f32_16x16x32_bf16 a[228:231], v[220:223], a[12:15], a[228:231]
    ds_read_b64_tr_b16 v[204:205], v227 offset:0
    ds_read_b64_tr_b16 v[206:207], v227 offset:4096
    v_mfma_f32_16x16x32_bf16 a[232:235], v[220:223], a[16:19], a[232:235]
    ds_read_b64_tr_b16 v[208:209], v224 offset:8192
    ds_read_b64_tr_b16 v[210:211], v224 offset:12288
    v_mfma_f32_16x16x32_bf16 a[236:239], v[220:223], a[20:23], a[236:239]
    s_waitcnt lgkmcnt(11)
    v_mfma_f32_16x16x32_bf16 a[192:195], v[192:195], a[24:27], a[192:195]
    v_mfma_f32_16x16x32_bf16 a[196:199], v[192:195], a[28:31], a[196:199]
    ds_read_b64_tr_b16 v[212:213], v225 offset:8192
    ds_read_b64_tr_b16 v[214:215], v225 offset:12288
    v_mfma_f32_16x16x32_bf16 a[200:203], v[192:195], a[32:35], a[200:203]
    s_waitcnt lgkmcnt(11)
    v_mfma_f32_16x16x32_bf16 a[204:207], v[196:199], a[24:27], a[204:207]
    v_mfma_f32_16x16x32_bf16 a[208:211], v[196:199], a[28:31], a[208:211]
    ds_read_b64_tr_b16 v[216:217], v226 offset:8192
    ds_read_b64_tr_b16 v[218:219], v226 offset:12288
    v_mfma_f32_16x16x32_bf16 a[212:215], v[196:199], a[32:35], a[212:215]
    s_waitcnt lgkmcnt(11)
    v_mfma_f32_16x16x32_bf16 a[216:219], v[200:203], a[24:27], a[216:219]
    v_mfma_f32_16x16x32_bf16 a[220:223], v[200:203], a[28:31], a[220:223]
    ds_read_b64_tr_b16 v[220:221], v227 offset:8192
    ds_read_b64_tr_b16 v[222:223], v227 offset:12288
    v_mfma_f32_16x16x32_bf16 a[224:227], v[200:203], a[32:35], a[224:227]
    s_waitcnt lgkmcnt(8)
    v_mfma_f32_16x16x32_bf16 a[228:231], v[204:207], a[24:27], a[228:231]
    v_mfma_f32_16x16x32_bf16 a[232:235], v[204:207], a[28:31], a[232:235]
    v_mfma_f32_16x16x32_bf16 a[236:239], v[204:207], a[32:35], a[236:239]
    s_waitcnt lgkmcnt(6)
    v_mfma_f32_16x16x32_bf16 a[192:195], v[208:211], a[36:39], a[192:195]
    v_mfma_f32_16x16x32_bf16 a[196:199], v[208:211], a[40:43], a[196:199]
    v_mfma_f32_16x16x32_bf16 a[200:203], v[208:211], a[44:47], a[200:203]
    s_waitcnt lgkmcnt(4)
    v_mfma_f32_16x16x32_bf16 a[204:207], v[212:215], a[36:39], a[204:207]
    v_mfma_f32_16x16x32_bf16 a[208:211], v[212:215], a[40:43], a[208:211]
    v_mfma_f32_16x16x32_bf16 a[212:215], v[212:215], a[44:47], a[212:215]
    s_waitcnt lgkmcnt(2)
    v_mfma_f32_16x16x32_bf16 a[216:219], v[216:219], a[36:39], a[216:219]
    v_mfma_f32_16x16x32_bf16 a[220:223], v[216:219], a[40:43], a[220:223]
    v_mfma_f32_16x16x32_bf16 a[224:227], v[216:219], a[44:47], a[224:227]
    s_waitcnt lgkmcnt(0)
    v_mfma_f32_16x16x32_bf16 a[228:231], v[220:223], a[36:39], a[228:231]
    v_mfma_f32_16x16x32_bf16 a[232:235], v[220:223], a[40:43], a[232:235]
    v_mfma_f32_16x16x32_bf16 a[236:239], v[220:223], a[44:47], a[236:239]
    buffer_store_dwordx4 a[204:207], v248, s[32:35], s84 offen offset:0 sc1
    buffer_store_dwordx4 a[208:211], v248, s[32:35], s84 offen offset:1024 sc1
    buffer_store_dwordx4 a[212:215], v248, s[32:35], s84 offen offset:2048 sc1
    buffer_store_dwordx4 a[216:219], v248, s[32:35], s85 offen offset:0 sc1
    buffer_store_dwordx4 a[220:223], v248, s[32:35], s85 offen offset:1024 sc1
    buffer_store_dwordx4 a[224:227], v248, s[32:35], s85 offen offset:2048 sc1
    buffer_store_dwordx4 a[228:231], v248, s[32:35], s86 offen offset:0 sc1
    buffer_store_dwordx4 a[232:235], v248, s[32:35], s86 offen offset:1024 sc1
    buffer_store_dwordx4 a[236:239], v248, s[32:35], s86 offen offset:2048 sc1
    s_lshl_b32 s63, s58, 6
    s_add_u32 s63, s63, 16785408
    s_lshl_b32 s49, s57, 2
    s_add_u32 s47, s63, s49
    v_accvgpr_read_b32 v96, a192
    v_accvgpr_read_b32 v97, a193
    v_accvgpr_read_b32 v98, a194
    v_accvgpr_read_b32 v99, a195
    v_accvgpr_read_b32 v100, a196
    v_accvgpr_read_b32 v101, a197
    v_accvgpr_read_b32 v102, a198
    v_accvgpr_read_b32 v103, a199
    v_accvgpr_read_b32 v104, a200
    v_accvgpr_read_b32 v105, a201
    v_accvgpr_read_b32 v106, a202
    v_accvgpr_read_b32 v107, a203
    s_waitcnt vmcnt(0)
    s_barrier
    s_lshl_b32 s48, s40, 28
    s_add_u32 s48, s48, s47
    v_lshlrev_b32 v52, 24, v248
    v_lshrrev_b32 v53, 8, v248
    v_lshl_or_b32 v52, v53, 28, v52
    v_or_b32 v52, s48, v52
    v_mov_b32 v53, s71
    buffer_store_dword v53, v52, s[32:35], 0 offen offset:0 sc1
    v_bfe_u32 v54, v248, 4, 2
    v_lshl_add_u32 v54, v54, 2, s63
    buffer_load_dword v55, v54, s[32:35], 0 offen offset:0 sc1
    v_bfe_u32 v54, v248, 4, 2
    v_lshl_add_u32 v54, v54, 2, s63
    s_waitcnt vmcnt(0)
    s_mov_b32 s70, 0
L_p2_X:
    v_cmp_eq_u32 vcc, s71, v55
    s_nop 0
    s_cmp_eq_u64 vcc, -1
    s_cbranch_scc1 L_p2ok_X
    s_add_u32 s70, s70, 1
    s_cmp_gt_u32 s70, 20000
    s_cbranch_scc1 L_p2ok_X
    s_sleep 1
    buffer_load_dword v55, v54, s[32:35], 0 offen offset:0 sc1
    s_waitcnt vmcnt(0)
    s_branch L_p2_X
L_p2ok_X:
    buffer_load_dwordx4 v[0:3], v248, s[32:35], s76 offen offset:0 sc1
    buffer_load_dwordx4 v[4:7], v248, s[32:35], s76 offen offset:1024 sc1
    buffer_load_dwordx4 v[8:11], v248, s[32:35], s76 offen offset:2048 sc1
    s_add_u32 s76, s76, 12288
    buffer_load_dwordx4 v[12:15], v248, s[32:35], s76 offen offset:0 sc1
    buffer_load_dwordx4 v[16:19], v248, s[32:35], s76 offen offset:1024 sc1
    buffer_load_dwordx4 v[20:23], v248, s[32:35], s76 offen offset:2048 sc1
    s_add_u32 s76, s76, 12288
    buffer_load_dwordx4 v[24:27], v248, s[32:35], s76 offen offset:0 sc1
    buffer_load_dwordx4 v[28:31], v248, s[32:35], s76 offen offset:1024 sc1
    buffer_load_dwordx4 v[32:35], v248, s[32:35], s76 offen offset:2048 sc1
    s_waitcnt vmcnt(0)
    v_add_f32 v96, v96, v0
    v_add_f32 v12, v12, v24
    v_add_f32 v96, v96, v12
    v_add_f32 v97, v97, v1
    v_add_f32 v13, v13, v25
    v_add_f32 v97, v97, v13
    v_add_f32 v98, v98, v2
    v_add_f32 v14, v14, v26
    v_add_f32 v98, v98, v14
    v_add_f32 v99, v99, v3
    v_add_f32 v15, v15, v27
    v_add_f32 v99, v99, v15
    v_cvt_pk_bf16_f32 v56, v96, v97
    v_cvt_pk_bf16_f32 v57, v98, v99
    buffer_store_dwordx2 v[56:57], v50, s[28:31], s77 offen
    v_add_f32 v100, v100, v4
    v_add_f32 v16, v16, v28
    v_add_f32 v100, v100, v16
    v_add_f32 v101, v101, v5
    v_add_f32 v17, v17, v29
    v_add_f32 v101, v101, v17
    v_add_f32 v102, v102, v6
    v_add_f32 v18, v18, v30
    v_add_f32 v102, v102, v18
    v_add_f32 v103, v103, v7
    v_add_f32 v19, v19, v31
    v_add_f32 v103, v103, v19
    v_cvt_pk_bf16_f32 v58, v100, v101
    v_cvt_pk_bf16_f32 v59, v102, v103
    s_add_u32 s77, s77, 32768
    buffer_store_dwordx2 v[58:59], v50, s[28:31], s77 offen
    v_add_f32 v104, v104, v8
    v_add_f32 v20, v20, v32
    v_add_f32 v104, v104, v20
    v_add_f32 v105, v105, v9
    v_add_f32 v21, v21, v33
    v_add_f32 v105, v105, v21
    v_add_f32 v106, v106, v10
    v_add_f32 v22, v22, v34
    v_add_f32 v106, v106, v22
    v_add_f32 v107, v107, v11
    v_add_f32 v23, v23, v35
    v_add_f32 v107, v107, v23
    v_cvt_pk_bf16_f32 v60, v104, v105
    v_cvt_pk_bf16_f32 v61, v106, v107
    s_add_u32 s77, s77, 32768
    buffer_store_dwordx2 v[60:61], v50, s[28:31], s77 offen
    s_waitcnt vmcnt(0)
    s_endpgm
L_end:
    s_endpgm
.p2align 6
L_cls_Y:
    s_nop 4
    s_add_u32 s69, s53, 0
    s_and_b32 s69, s69, 7
    s_add_u32 m0, s61, 65536
    s_lshl_b32 s68, s69, 7
    s_add_u32 s68, s68, s55
    buffer_load_dwordx4 v96, s[8:11], s68 offen offset:0 lds
    buffer_load_dwordx4 v97, s[8:11], s68 offen offset:1024 lds
    buffer_load_dwordx4 v98, s[8:11], s68 offen offset:2048 lds
    s_add_u32 m0, s59, 114688
    s_add_u32 s69, s53, 0
    s_and_b32 s69, s69, 7
    s_lshl_b32 s68, s69, 19
    s_add_u32 s68, s68, s54
    buffer_load_dwordx4 v242, s[20:23], s68 offen offset:0  lds
    s_add_u32 s68, s68, 31744
    buffer_load_dwordx4 v242, s[20:23], s68 offen offset:1024  lds
    s_add_u32 s68, s68, 31744
    v_xor_b32 v244, 128, v242
    buffer_load_dwordx4 v244, s[20:23], s68 offen offset:2048  lds
    s_add_u32 s68, s68, 31744
    buffer_load_dwordx4 v244, s[20:23], s68 offen offset:3072  lds
    s_add_u32 s69, s53, 1
    s_and_b32 s69, s69, 7
    s_add_u32 m0, s61, 77824
    s_lshl_b32 s68, s69, 7
    s_add_u32 s68, s68, s55
    buffer_load_dwordx4 v96, s[8:11], s68 offen offset:0 lds
    buffer_load_dwordx4 v97, s[8:11], s68 offen offset:1024 lds
    buffer_load_dwordx4 v98, s[8:11], s68 offen offset:2048 lds
    v_lshl_add_u32 v241, v2, 8, v4
    v_lshl_add_u32 v243, v2, 10, v4
    v_lshlrev_b32 v4, 4, v2
    v_xor_b32 v4, v4, v3
    v_lshl_add_u32 v240, v2, 8, v4
    v_bfe_u32 v5, v0, 2, 2
    v_and_b32 v6, 3, v0
    v_and_b32 v7, 15, v0
    s_lshl_b32 s48, s42, 7
    s_lshl_b32 s49, s42, 13
    s_mul_i32 s60, s41, 6144
    v_lshl_add_u32 v8, v2, 3, v5
    v_lshlrev_b32 v8, 8, v8
    v_and_b32 v9, 1, v2
    v_lshl_add_u32 v9, v9, 2, v5
    v_lshl_add_u32 v8, v9, 5, v8
    v_lshl_add_u32 v8, v6, 3, v8
    v_xor_b32 v245, s48, v8
    v_lshrrev_b32 v8, 2, v0
    v_and_b32 v9, 7, v8
    v_lshlrev_b32 v9, 5, v9
    v_lshl_add_u32 v9, v8, 8, v9
    v_lshl_add_u32 v9, v6, 3, v9
    v_add_u32 v9, s49, v9
    v_xor_b32 v247, s48, v9
    v_xor_b32 v8, v2, v7
    v_lshlrev_b32 v8, 4, v8
    v_lshl_add_u32 v8, v7, 8, v8
    v_add_u32 v246, s49, v8
    v_lshrrev_b32 v8, 1, v7
    v_xor_b32 v8, v8, v2
    v_lshlrev_b32 v8, 4, v8
    v_lshl_add_u32 v8, v7, 7, v8
    s_add_u32 s48, s60, 65536
    v_add_u32 v100, s48, v8
    v_xor_b32 v101, 64, v100
    s_add_u32 m0, s59, 131072
    s_add_u32 s69, s53, 1
    s_and_b32 s69, s69, 7
    s_lshl_b32 s68, s69, 19
    s_add_u32 s68, s68, s54
    buffer_load_dwordx4 v242, s[20:23], s68 offen offset:0  lds
    s_add_u32 s68, s68, 31744
    buffer_load_dwordx4 v242, s[20:23], s68 offen offset:1024  lds
    s_add_u32 s68, s68, 31744
    v_xor_b32 v244, 128, v242
    buffer_load_dwordx4 v244, s[20:23], s68 offen offset:2048  lds
    s_add_u32 s68, s68, 31744
    buffer_load_dwordx4 v244, s[20:23], s68 offen offset:3072  lds
    s_add_u32 s69, s53, 2
    s_and_b32 s69, s69, 7
    s_add_u32 m0, s61, 90112
    s_lshl_b32 s68, s69, 7
    s_add_u32 s68, s68, s55
    buffer_load_dwordx4 v96, s[8:11], s68 offen offset:0 lds
    buffer_load_dwordx4 v97, s[8:11], s68 offen offset:1024 lds
    buffer_load_dwordx4 v98, s[8:11], s68 offen offset:2048 lds
    s_add_u32 m0, s59, 147456
    s_add_u32 s69, s53, 2
    s_and_b32 s69, s69, 7
    s_lshl_b32 s68, s69, 19
    s_add_u32 s68, s68, s54
    buffer_load_dwordx4 v242, s[20:23], s68 offen offset:0  lds
    s_add_u32 s68, s68, 31744
    buffer_load_dwordx4 v242, s[20:23], s68 offen offset:1024  lds
    s_add_u32 s68, s68, 31744
    v_xor_b32 v244, 128, v242
    buffer_load_dwordx4 v244, s[20:23], s68 offen offset:2048  lds
    s_add_u32 s68, s68, 31744
    buffer_load_dwordx4 v244, s[20:23], s68 offen offset:3072  lds
    s_mov_b32 s12, s74
    s_mov_b32 s13, s75
    s_mov_b32 s14, 33554432
    s_mov_b32 s15, 0x20000
    s_mov_b32 s16, s76
    s_mov_b32 s17, s77
    s_mov_b32 s18, 33554432
    s_mov_b32 s19, 0x20000
    s_mov_b32 s24, s80
    s_mov_b32 s25, s81
    s_mov_b32 s26, 4194304
    s_mov_b32 s27, 0x20000
    s_mov_b32 s28, s84
    s_mov_b32 s29, s85
    s_mov_b32 s30, 1572864
    s_mov_b32 s31, 0x20000
    s_mov_b32 s32, s88
    s_mov_b32 s33, s89
    s_mov_b32 s34, 268435456
    s_mov_b32 s35, 0x20000
    s_lshl_b32 s46, s44, 5
    s_add_u32 s46, s46, s45
    s_lshl_b32 s46, s46, 17
    s_lshl_b32 s49, s40, 10
    s_add_u32 s46, s46, s49
    s_lshl_b32 s51, s43, 3
    s_add_u32 s51, s51, s44
    s_lshl_b32 s63, s51, 7
    s_lshl_b32 s49, s7, 4
    s_add_u32 s63, s63, s49
    s_add_u32 s63, s63, 16777216
    s_lshl_b32 s49, s56, 2
    s_add_u32 s47, s63, s49
    s_add_u32 s90, s56, s44
    s_and_b32 s90, s90, 3
    s_lshl_b32 s62, s51, 5
    s_add_u32 s62, s62, s45
    s_mul_i32 s62, s62, 24576
    s_mul_i32 s49, s42, 12288
    s_add_u32 s62, s62, s49
    s_add_u32 s62, s62, s60
    s_mov_b32 s52, 0x3e0293ee
    s_lshl_b32 s48, s7, 20
    s_lshl_b32 s49, s40, 14
    s_add_u32 s48, s48, s49
    s_lshl_b32 s49, s90, 8
    s_add_u32 s48, s48, s49
    s_lshl_b32 s50, s51, 2
    s_add_u32 s50, s50, s7
    s_mul_i32 s50, s50, 196608
    s_add_u32 s50, s50, s61
    s_add_u32 s49, s56, 0
    s_and_b32 s49, s49, 3
    s_lshl_b32 s72, s49, 18
    s_add_u32 s72, s72, s48
    s_mul_i32 s80, s49, 49152
    s_add_u32 s80, s80, s50
    s_add_u32 s49, s56, 1
    s_and_b32 s49, s49, 3
    s_lshl_b32 s73, s49, 18
    s_add_u32 s73, s73, s48
    s_mul_i32 s81, s49, 49152
    s_add_u32 s81, s81, s50
    s_add_u32 s49, s56, 2
    s_and_b32 s49, s49, 3
    s_lshl_b32 s74, s49, 18
    s_add_u32 s74, s74, s48
    s_mul_i32 s82, s49, 49152
    s_add_u32 s82, s82, s50
    s_add_u32 s49, s56, 3
    s_and_b32 s49, s49, 3
    s_lshl_b32 s75, s49, 18
    s_add_u32 s75, s75, s48
    s_mul_i32 s83, s49, 49152
    s_add_u32 s83, s83, s50
    s_lshl_b32 s58, s51, 2
    s_add_u32 s58, s58, s56
    s_mov_b32 s57, s7
    s_add_u32 m0, s59, 0
    s_add_u32 s68, s46, 0
    buffer_load_dwordx4 v240, s[12:15], s68 offen offset:0 nt lds
    s_add_u32 s68, s68, 3072
    v_xor_b32 v244, 64, v240
    buffer_load_dwordx4 v244, s[12:15], s68 offen offset:1024 nt lds
    s_add_u32 s68, s68, 3072
    v_xor_b32 v244, 128, v240
    buffer_load_dwordx4 v244, s[12:15], s68 offen offset:2048 nt lds
    s_add_u32 s68, s68, 3072
    v_xor_b32 v244, 192, v240
    buffer_load_dwordx4 v244, s[12:15], s68 offen offset:3072 nt lds
    s_add_u32 m0, s59, 16384
    s_add_u32 s68, s46, 16384
    buffer_load_dwordx4 v240, s[12:15], s68 offen offset:0 nt lds
    s_add_u32 s68, s68, 3072
    v_xor_b32 v244, 64, v240
    buffer_load_dwordx4 v244, s[12:15], s68 offen offset:1024 nt lds
    s_add_u32 s68, s68, 3072
    v_xor_b32 v244, 128, v240
    buffer_load_dwordx4 v244, s[12:15], s68 offen offset:2048 nt lds
    s_add_u32 s68, s68, 3072
    v_xor_b32 v244, 192, v240
    buffer_load_dwordx4 v244, s[12:15], s68 offen offset:3072 nt lds
    s_add_u32 m0, s59, 32768
    s_add_u32 s68, s46, 32768
    buffer_load_dwordx4 v240, s[12:15], s68 offen offset:0 nt lds
    s_add_u32 s68, s68, 3072
    v_xor_b32 v244, 64, v240
    buffer_load_dwordx4 v244, s[12:15], s68 offen offset:1024 nt lds
    s_add_u32 s68, s68, 3072
    v_xor_b32 v244, 128, v240
    buffer_load_dwordx4 v244, s[12:15], s68 offen offset:2048 nt lds
    s_add_u32 s68, s68, 3072
    v_xor_b32 v244, 192, v240
    buffer_load_dwordx4 v244, s[12:15], s68 offen offset:3072 nt lds
    v_add_u32 v224, 114688, v245
    v_xor_b32 v225, 32, v224
    v_xor_b32 v226, 64, v224
    v_xor_b32 v227, 96, v224
    s_waitcnt vmcnt(26)
    s_barrier
    ds_read_b64_tr_b16 v[192:193], v224 offset:0
    ds_read_b64_tr_b16 v[194:195], v224 offset:1024
    ds_read_b128 a[0:3], v100 offset:0
    ds_read_b128 a[4:7], v100 offset:2048
    ds_read_b128 a[8:11], v100 offset:4096
    ds_read_b64_tr_b16 v[196:197], v225 offset:0
    ds_read_b64_tr_b16 v[198:199], v225 offset:1024
    ds_read_b64_tr_b16 v[200:201], v226 offset:0
    ds_read_b64_tr_b16 v[202:203], v226 offset:1024
    ds_read_b128 a[12:15], v101 offset:0
    ds_read_b128 a[16:19], v101 offset:2048
    ds_read_b128 a[20:23], v101 offset:4096
    ds_read_b64_tr_b16 v[204:205], v227 offset:0
    ds_read_b64_tr_b16 v[206:207], v227 offset:1024
    ds_read_b64_tr_b16 v[208:209], v224 offset:8192
    ds_read_b64_tr_b16 v[210:211], v224 offset:9216
    s_waitcnt lgkmcnt(11)
    v_mfma_f32_16x16x32_bf16 v[0:3], v[192:195], a[0:3], 0
    v_mfma_f32_16x16x32_bf16 v[4:7], v[192:195], a[4:7], 0
    ds_read_b64_tr_b16 v[212:213], v225 offset:8192
    ds_read_b64_tr_b16 v[214:215], v225 offset:9216
    v_mfma_f32_16x16x32_bf16 v[8:11], v[192:195], a[8:11], 0
    s_waitcnt lgkmcnt(11)
    v_mfma_f32_16x16x32_bf16 v[12:15], v[196:199], a[0:3], 0
    v_mfma_f32_16x16x32_bf16 v[16:19], v[196:199], a[4:7], 0
    ds_read_b64_tr_b16 v[216:217], v226 offset:8192
    ds_read_b64_tr_b16 v[218:219], v226 offset:9216
    v_mfma_f32_16x16x32_bf16 v[20:23], v[196:199], a[8:11], 0
    s_waitcnt lgkmcnt(11)
    v_mfma_f32_16x16x32_bf16 v[24:27], v[200:203], a[0:3], 0
    v_mfma_f32_16x16x32_bf16 v[28:31], v[200:203], a[4:7], 0
    ds_read_b64_tr_b16 v[220:221], v227 offset:8192
    ds_read_b64_tr_b16 v[222:223], v227 offset:9216
    v_mfma_f32_16x16x32_bf16 v[32:35], v[200:203], a[8:11], 0
    s_waitcnt lgkmcnt(8)
    v_mfma_f32_16x16x32_bf16 v[36:39], v[204:207], a[0:3], 0
    v_add_u32 v224, 131072, v245
    v_xor_b32 v225, 32, v224
    v_mfma_f32_16x16x32_bf16 v[40:43], v[204:207], a[4:7], 0
    v_xor_b32 v226, 64, v224
    v_xor_b32 v227, 96, v224
    v_mfma_f32_16x16x32_bf16 v[44:47], v[204:207], a[8:11], 0
    s_waitcnt lgkmcnt(6)
    v_mfma_f32_16x16x32_bf16 v[0:3], v[208:211], a[12:15], v[0:3]
    v_mfma_f32_16x16x32_bf16 v[4:7], v[208:211], a[16:19], v[4:7]
    v_mfma_f32_16x16x32_bf16 v[8:11], v[208:211], a[20:23], v[8:11]
    s_waitcnt vmcnt(19) lgkmcnt(0)
    s_barrier
    v_mfma_f32_16x16x32_bf16 v[12:15], v[212:215], a[12:15], v[12:15]
    ds_read_b64_tr_b16 v[192:193], v224 offset:0
    ds_read_b64_tr_b16 v[194:195], v224 offset:1024
    s_add_u32 s69, s53, 3
    s_and_b32 s69, s69, 7
    s_add_u32 m0, s61, 102400
    s_lshl_b32 s68, s69, 7
    s_add_u32 s68, s68, s55
    buffer_load_dwordx4 v96, s[8:11], s68 offen offset:0 lds
    v_mfma_f32_16x16x32_bf16 v[16:19], v[212:215], a[16:19], v[16:19]
    ds_read_b128 a[24:27], v100 offset:12288
    ds_read_b128 a[28:31], v100 offset:14336
    v_mfma_f32_16x16x32_bf16 v[20:23], v[212:215], a[20:23], v[20:23]
    ds_read_b128 a[32:35], v100 offset:16384
    ds_read_b64_tr_b16 v[196:197], v225 offset:0
    v_mfma_f32_16x16x32_bf16 v[24:27], v[216:219], a[12:15], v[24:27]
    ds_read_b64_tr_b16 v[198:199], v225 offset:1024
    ds_read_b64_tr_b16 v[200:201], v226 offset:0
    buffer_load_dwordx4 v97, s[8:11], s68 offen offset:1024 lds
    v_mfma_f32_16x16x32_bf16 v[28:31], v[216:219], a[16:19], v[28:31]
    ds_read_b64_tr_b16 v[202:203], v226 offset:1024
    ds_read_b128 a[36:39], v101 offset:12288
    v_mfma_f32_16x16x32_bf16 v[32:35], v[216:219], a[20:23], v[32:35]
    ds_read_b128 a[40:43], v101 offset:14336
    ds_read_b128 a[44:47], v101 offset:16384
    v_mfma_f32_16x16x32_bf16 v[36:39], v[220:223], a[12:15], v[36:39]
    ds_read_b64_tr_b16 v[204:205], v227 offset:0
    ds_read_b64_tr_b16 v[206:207], v227 offset:1024
    buffer_load_dwordx4 v98, s[8:11], s68 offen offset:2048 lds
    v_mfma_f32_16x16x32_bf16 v[40:43], v[220:223], a[16:19], v[40:43]
    ds_read_b64_tr_b16 v[208:209], v224 offset:8192
    ds_read_b64_tr_b16 v[210:211], v224 offset:9216
    v_mfma_f32_16x16x32_bf16 v[44:47], v[220:223], a[20:23], v[44:47]
    s_waitcnt lgkmcnt(11)
    v_mfma_f32_16x16x32_bf16 v[0:3], v[192:195], a[24:27], v[0:3]
    s_add_u32 m0, s59, 114688
    s_add_u32 s69, s53, 3
    s_and_b32 s69, s69, 7
    s_lshl_b32 s68, s69, 19
    s_add_u32 s68, s68, s54
    buffer_load_dwordx4 v242, s[20:23], s68 offen offset:0  lds
    v_mfma_f32_16x16x32_bf16 v[4:7], v[192:195], a[28:31], v[4:7]
    ds_read_b64_tr_b16 v[212:213], v225 offset:8192
    ds_read_b64_tr_b16 v[214:215], v225 offset:9216
    v_mfma_f32_16x16x32_bf16 v[8:11], v[192:195], a[32:35], v[8:11]
    s_waitcnt lgkmcnt(11)
    v_mfma_f32_16x16x32_bf16 v[12:15], v[196:199], a[24:27], v[12:15]
    s_add_u32 s68, s68, 31744
    buffer_load_dwordx4 v242, s[20:23], s68 offen offset:1024  lds
    v_mfma_f32_16x16x32_bf16 v[16:19], v[196:199], a[28:31], v[16:19]
    ds_read_b64_tr_b16 v[216:217], v226 offset:8192
    ds_read_b64_tr_b16 v[218:219], v226 offset:9216
    v_mfma_f32_16x16x32_bf16 v[20:23], v[196:199], a[32:35], v[20:23]
    s_waitcnt lgkmcnt(11)
    v_mfma_f32_16x16x32_bf16 v[24:27], v[200:203], a[24:27], v[24:27]
    s_add_u32 s68, s68, 31744
    v_xor_b32 v244, 128, v242
    buffer_load_dwordx4 v244, s[20:23], s68 offen offset:2048  lds
    v_mfma_f32_16x16x32_bf16 v[28:31], v[200:203], a[28:31], v[28:31]
    ds_read_b64_tr_b16 v[220:221], v227 offset:8192
    ds_read_b64_tr_b16 v[222:223], v227 offset:9216
    v_mfma_f32_16x16x32_bf16 v[32:35], v[200:203], a[32:35], v[32:35]
    s_waitcnt lgkmcnt(8)
    v_mfma_f32_16x16x32_bf16 v[36:39], v[204:207], a[24:27], v[36:39]
    v_add_u32 v224, 147456, v245
    s_add_u32 s68, s68, 31744
    buffer_load_dwordx4 v244, s[20:23], s68 offen offset:3072  lds
    v_xor_b32 v225, 32, v224
    v_mfma_f32_16x16x32_bf16 v[40:43], v[204:207], a[28:31], v[40:43]
    v_xor_b32 v226, 64, v224
    v_xor_b32 v227, 96, v224
    v_mfma_f32_16x16x32_bf16 v[44:47], v[204:207], a[32:35], v[44:47]
    s_waitcnt lgkmcnt(6)
    v_mfma_f32_16x16x32_bf16 v[0:3], v[208:211], a[36:39], v[0:3]
    v_mfma_f32_16x16x32_bf16 v[4:7], v[208:211], a[40:43], v[4:7]
    v_mfma_f32_16x16x32_bf16 v[8:11], v[208:211], a[44:47], v[8:11]
    s_waitcnt vmcnt(19) lgkmcnt(0)
    s_barrier
    v_mfma_f32_16x16x32_bf16 v[12:15], v[212:215], a[36:39], v[12:15]
    ds_read_b64_tr_b16 v[192:193], v224 offset:0
    ds_read_b64_tr_b16 v[194:195], v224 offset:1024
    s_add_u32 s69, s53, 4
    s_and_b32 s69, s69, 7
    s_add_u32 m0, s61, 65536
    s_lshl_b32 s68, s69, 7
    s_add_u32 s68, s68, s55
    buffer_load_dwordx4 v96, s[8:11], s68 offen offset:0 lds
    v_mfma_f32_16x16x32_bf16 v[16:19], v[212:215], a[40:43], v[16:19]
    ds_read_b128 a[48:51], v100 offset:24576
    ds_read_b128 a[52:55], v100 offset:26624
    v_mfma_f32_16x16x32_bf16 v[20:23], v[212:215], a[44:47], v[20:23]
    ds_read_b128 a[56:59], v100 offset:28672
    ds_read_b64_tr_b16 v[196:197], v225 offset:0
    v_mfma_f32_16x16x32_bf16 v[24:27], v[216:219], a[36:39], v[24:27]
    ds_read_b64_tr_b16 v[198:199], v225 offset:1024
    ds_read_b64_tr_b16 v[200:201], v226 offset:0
    buffer_load_dwordx4 v97, s[8:11], s68 offen offset:1024 lds
    v_mfma_f32_16x16x32_bf16 v[28:31], v[216:219], a[40:43], v[28:31]
    ds_read_b64_tr_b16 v[202:203], v226 offset:1024
    ds_read_b128 a[60:63], v101 offset:24576
    v_mfma_f32_16x16x32_bf16 v[32:35], v[216:219], a[44:47], v[32:35]
    ds_read_b128 a[64:67], v101 offset:26624
    ds_read_b128 a[68:71], v101 offset:28672
    v_mfma_f32_16x16x32_bf16 v[36:39], v[220:223], a[36:39], v[36:39]
    ds_read_b64_tr_b16 v[204:205], v227 offset:0
    ds_read_b64_tr_b16 v[206:207], v227 offset:1024
    buffer_load_dwordx4 v98, s[8:11], s68 offen offset:2048 lds
    v_mfma_f32_16x16x32_bf16 v[40:43], v[220:223], a[40:43], v[40:43]
    ds_read_b64_tr_b16 v[208:209], v224 offset:8192
    ds_read_b64_tr_b16 v[210:211], v224 offset:9216
    v_mfma_f32_16x16x32_bf16 v[44:47], v[220:223], a[44:47], v[44:47]
    s_waitcnt lgkmcnt(11)
    v_mfma_f32_16x16x32_bf16 v[0:3], v[192:195], a[48:51], v[0:3]
    s_add_u32 m0, s59, 131072
    s_add_u32 s69, s53, 4
    s_and_b32 s69, s69, 7
    s_lshl_b32 s68, s69, 19
    s_add_u32 s68, s68, s54
    buffer_load_dwordx4 v242, s[20:23], s68 offen offset:0  lds
    v_mfma_f32_16x16x32_bf16 v[4:7], v[192:195], a[52:55], v[4:7]
    ds_read_b64_tr_b16 v[212:213], v225 offset:8192
    ds_read_b64_tr_b16 v[214:215], v225 offset:9216
    v_mfma_f32_16x16x32_bf16 v[8:11], v[192:195], a[56:59], v[8:11]
    s_waitcnt lgkmcnt(11)
    v_mfma_f32_16x16x32_bf16 v[12:15], v[196:199], a[48:51], v[12:15]
    s_add_u32 s68, s68, 31744
    buffer_load_dwordx4 v242, s[20:23], s68 offen offset:1024  lds
    v_mfma_f32_16x16x32_bf16 v[16:19], v[196:199], a[52:55], v[16:19]
    ds_read_b64_tr_b16 v[216:217], v226 offset:8192
    ds_read_b64_tr_b16 v[218:219], v226 offset:9216
    v_mfma_f32_16x16x32_bf16 v[20:23], v[196:199], a[56:59], v[20:23]
    s_waitcnt lgkmcnt(11)
    v_mfma_f32_16x16x32_bf16 v[24:27], v[200:203], a[48:51], v[24:27]
    s_add_u32 s68, s68, 31744
    v_xor_b32 v244, 128, v242
    buffer_load_dwordx4 v244, s[20:23], s68 offen offset:2048  lds
    v_mfma_f32_16x16x32_bf16 v[28:31], v[200:203], a[52:55], v[28:31]
    ds_read_b64_tr_b16 v[220:221], v227 offset:8192
    ds_read_b64_tr_b16 v[222:223], v227 offset:9216
    v_mfma_f32_16x16x32_bf16 v[32:35], v[200:203], a[56:59], v[32:35]
    s_waitcnt lgkmcnt(8)
    v_mfma_f32_16x16x32_bf16 v[36:39], v[204:207], a[48:51], v[36:39]
    v_add_u32 v224, 114688, v245
    s_add_u32 s68, s68, 31744
    buffer_load_dwordx4 v244, s[20:23], s68 offen offset:3072  lds
    v_xor_b32 v225, 32, v224
    v_mfma_f32_16x16x32_bf16 v[40:43], v[204:207], a[52:55], v[40:43]
    v_xor_b32 v226, 64, v224
    v_xor_b32 v227, 96, v224
    v_mfma_f32_16x16x32_bf16 v[44:47], v[204:207], a[56:59], v[44:47]
    s_waitcnt lgkmcnt(6)
    v_mfma_f32_16x16x32_bf16 v[0:3], v[208:211], a[60:63], v[0:3]
    v_mfma_f32_16x16x32_bf16 v[4:7], v[208:211], a[64:67], v[4:7]
    v_mfma_f32_16x16x32_bf16 v[8:11], v[208:211], a[68:71], v[8:11]
    s_waitcnt vmcnt(7) lgkmcnt(0)
    s_barrier
    v_mfma_f32_16x16x32_bf16 v[12:15], v[212:215], a[60:63], v[12:15]
    ds_read_b64_tr_b16 v[192:193], v224 offset:0
    ds_read_b64_tr_b16 v[194:195], v224 offset:1024
    s_add_u32 s69, s53, 5
    s_and_b32 s69, s69, 7
    s_add_u32 m0, s61, 77824
    s_lshl_b32 s68, s69, 7
    s_add_u32 s68, s68, s55
    buffer_load_dwordx4 v96, s[8:11], s68 offen offset:0 lds
    v_mfma_f32_16x16x32_bf16 v[16:19], v[212:215], a[64:67], v[16:19]
    ds_read_b128 a[72:75], v100 offset:36864
    ds_read_b128 a[76:79], v100 offset:38912
    v_mfma_f32_16x16x32_bf16 v[20:23], v[212:215], a[68:71], v[20:23]
    ds_read_b128 a[80:83], v100 offset:40960
    ds_read_b64_tr_b16 v[196:197], v225 offset:0
    v_mfma_f32_16x16x32_bf16 v[24:27], v[216:219], a[60:63], v[24:27]
    ds_read_b64_tr_b16 v[198:199], v225 offset:1024
    ds_read_b64_tr_b16 v[200:201], v226 offset:0
    buffer_load_dwordx4 v97, s[8:11], s68 offen offset:1024 lds
    v_mfma_f32_16x16x32_bf16 v[28:31], v[216:219], a[64:67], v[28:31]
    ds_read_b64_tr_b16 v[202:203], v226 offset:1024
    ds_read_b128 a[84:87], v101 offset:36864
    v_mfma_f32_16x16x32_bf16 v[32:35], v[216:219], a[68:71], v[32:35]
    ds_read_b128 a[88:91], v101 offset:38912
    ds_read_b128 a[92:95], v101 offset:40960
    v_mfma_f32_16x16x32_bf16 v[36:39], v[220:223], a[60:63], v[36:39]
    ds_read_b64_tr_b16 v[204:205], v227 offset:0
    ds_read_b64_tr_b16 v[206:207], v227 offset:1024
    buffer_load_dwordx4 v98, s[8:11], s68 offen offset:2048 lds
    v_mfma_f32_16x16x32_bf16 v[40:43], v[220:223], a[64:67], v[40:43]
    ds_read_b64_tr_b16 v[208:209], v224 offset:8192
    ds_read_b64_tr_b16 v[210:211], v224 offset:9216
    v_mfma_f32_16x16x32_bf16 v[44:47], v[220:223], a[68:71], v[44:47]
    s_waitcnt lgkmcnt(11)
    v_mfma_f32_16x16x32_bf16 v[0:3], v[192:195], a[72:75], v[0:3]
    s_add_u32 m0, s59, 147456
    s_add_u32 s69, s53, 5
    s_and_b32 s69, s69, 7
    s_lshl_b32 s68, s69, 19
    s_add_u32 s68, s68, s54
    buffer_load_dwordx4 v242, s[20:23], s68 offen offset:0  lds
    v_mfma_f32_16x16x32_bf16 v[4:7], v[192:195], a[76:79], v[4:7]
    ds_read_b64_tr_b16 v[212:213], v225 offset:8192
    ds_read_b64_tr_b16 v[214:215], v225 offset:9216
    v_mfma_f32_16x16x32_bf16 v[8:11], v[192:195], a[80:83], v[8:11]
    s_waitcnt lgkmcnt(11)
    v_mfma_f32_16x16x32_bf16 v[12:15], v[196:199], a[72:75], v[12:15]
    s_add_u32 s68, s68, 31744
    buffer_load_dwordx4 v242, s[20:23], s68 offen offset:1024  lds
    v_mfma_f32_16x16x32_bf16 v[16:19], v[196:199], a[76:79], v[16:19]
    ds_read_b64_tr_b16 v[216:217], v226 offset:8192
    ds_read_b64_tr_b16 v[218:219], v226 offset:9216
    v_mfma_f32_16x16x32_bf16 v[20:23], v[196:199], a[80:83], v[20:23]
    s_waitcnt lgkmcnt(11)
    v_mfma_f32_16x16x32_bf16 v[24:27], v[200:203], a[72:75], v[24:27]
    s_add_u32 s68, s68, 31744
    v_xor_b32 v244, 128, v242
    buffer_load_dwordx4 v244, s[20:23], s68 offen offset:2048  lds
    v_mfma_f32_16x16x32_bf16 v[28:31], v[200:203], a[76:79], v[28:31]
    ds_read_b64_tr_b16 v[220:221], v227 offset:8192
    ds_read_b64_tr_b16 v[222:223], v227 offset:9216
    v_mfma_f32_16x16x32_bf16 v[32:35], v[200:203], a[80:83], v[32:35]
    s_waitcnt lgkmcnt(8)
    v_mfma_f32_16x16x32_bf16 v[36:39], v[204:207], a[72:75], v[36:39]
    v_add_u32 v224, 131072, v245
    s_add_u32 s68, s68, 31744
    buffer_load_dwordx4 v244, s[20:23], s68 offen offset:3072  lds
    v_xor_b32 v225, 32, v224
    v_mfma_f32_16x16x32_bf16 v[40:43], v[204:207], a[76:79], v[40:43]
    v_xor_b32 v226, 64, v224
    v_xor_b32 v227, 96, v224
    v_mfma_f32_16x16x32_bf16 v[44:47], v[204:207], a[80:83], v[44:47]
    s_waitcnt lgkmcnt(6)
    v_mfma_f32_16x16x32_bf16 v[0:3], v[208:211], a[84:87], v[0:3]
    v_mfma_f32_16x16x32_bf16 v[4:7], v[208:211], a[88:91], v[4:7]
    v_mfma_f32_16x16x32_bf16 v[8:11], v[208:211], a[92:95], v[8:11]
    s_waitcnt vmcnt(7) lgkmcnt(0)
    s_barrier
    v_mfma_f32_16x16x32_bf16 v[12:15], v[212:215], a[84:87], v[12:15]
    ds_read_b64_tr_b16 v[192:193], v224 offset:0
    ds_read_b64_tr_b16 v[194:195], v224 offset:1024
    s_add_u32 s69, s53, 6
    s_and_b32 s69, s69, 7
    s_add_u32 m0, s61, 90112
    s_lshl_b32 s68, s69, 7
    s_add_u32 s68, s68, s55
    buffer_load_dwordx4 v96, s[8:11], s68 offen offset:0 lds
    v_mfma_f32_16x16x32_bf16 v[16:19], v[212:215], a[88:91], v[16:19]
    ds_read_b128 a[144:147], v100 offset:0
    ds_read_b128 a[148:151], v100 offset:2048
    v_mfma_f32_16x16x32_bf16 v[20:23], v[212:215], a[92:95], v[20:23]
    ds_read_b128 a[152:155], v100 offset:4096
    ds_read_b64_tr_b16 v[196:197], v225 offset:0
    v_mfma_f32_16x16x32_bf16 v[24:27], v[216:219], a[84:87], v[24:27]
    ds_read_b64_tr_b16 v[198:199], v225 offset:1024
    ds_read_b64_tr_b16 v[200:201], v226 offset:0
    buffer_load_dwordx4 v97, s[8:11], s68 offen offset:1024 lds
    v_mfma_f32_16x16x32_bf16 v[28:31], v[216:219], a[88:91], v[28:31]
    ds_read_b64_tr_b16 v[202:203], v226 offset:1024
    ds_read_b128 a[156:159], v101 offset:0
    v_mfma_f32_16x16x32_bf16 v[32:35], v[216:219], a[92:95], v[32:35]
    ds_read_b128 a[160:163], v101 offset:2048
    ds_read_b128 a[164:167], v101 offset:4096
    v_mfma_f32_16x16x32_bf16 v[36:39], v[220:223], a[84:87], v[36:39]
    ds_read_b64_tr_b16 v[204:205], v227 offset:0
    ds_read_b64_tr_b16 v[206:207], v227 offset:1024
    buffer_load_dwordx4 v98, s[8:11], s68 offen offset:2048 lds
    v_mfma_f32_16x16x32_bf16 v[40:43], v[220:223], a[88:91], v[40:43]
    ds_read_b64_tr_b16 v[208:209], v224 offset:8192
    ds_read_b64_tr_b16 v[210:211], v224 offset:9216
    v_mfma_f32_16x16x32_bf16 v[44:47], v[220:223], a[92:95], v[44:47]
    s_waitcnt lgkmcnt(11)
    v_mfma_f32_16x16x32_bf16 v[0:3], v[192:195], a[144:147], v[0:3]
    s_add_u32 m0, s59, 114688
    s_add_u32 s69, s53, 6
    s_and_b32 s69, s69, 7
    s_lshl_b32 s68, s69, 19
    s_add_u32 s68, s68, s54
    buffer_load_dwordx4 v242, s[20:23], s68 offen offset:0  lds
    v_mfma_f32_16x16x32_bf16 v[4:7], v[192:195], a[148:151], v[4:7]
    ds_read_b64_tr_b16 v[212:213], v225 offset:8192
    ds_read_b64_tr_b16 v[214:215], v225 offset:9216
    v_mfma_f32_16x16x32_bf16 v[8:11], v[192:195], a[152:155], v[8:11]
    s_waitcnt lgkmcnt(11)
    v_mfma_f32_16x16x32_bf16 v[12:15], v[196:199], a[144:147], v[12:15]
    s_add_u32 s68, s68, 31744
    buffer_load_dwordx4 v242, s[20:23], s68 offen offset:1024  lds
    v_mfma_f32_16x16x32_bf16 v[16:19], v[196:199], a[148:151], v[16:19]
    ds_read_b64_tr_b16 v[216:217], v226 offset:8192
    ds_read_b64_tr_b16 v[218:219], v226 offset:9216
    v_mfma_f32_16x16x32_bf16 v[20:23], v[196:199], a[152:155], v[20:23]
    s_waitcnt lgkmcnt(11)
    v_mfma_f32_16x16x32_bf16 v[24:27], v[200:203], a[144:147], v[24:27]
    s_add_u32 s68, s68, 31744
    v_xor_b32 v244, 128, v242
    buffer_load_dwordx4 v244, s[20:23], s68 offen offset:2048  lds
    v_mfma_f32_16x16x32_bf16 v[28:31], v[200:203], a[148:151], v[28:31]
    ds_read_b64_tr_b16 v[220:221], v227 offset:8192
    ds_read_b64_tr_b16 v[222:223], v227 offset:9216
    v_mfma_f32_16x16x32_bf16 v[32:35], v[200:203], a[152:155], v[32:35]
    s_waitcnt lgkmcnt(8)
    v_mfma_f32_16x16x32_bf16 v[36:39], v[204:207], a[144:147], v[36:39]
    v_add_u32 v224, 147456, v245
    s_add_u32 s68, s68, 31744
    buffer_load_dwordx4 v244, s[20:23], s68 offen offset:3072  lds
    v_xor_b32 v225, 32, v224
    v_mfma_f32_16x16x32_bf16 v[40:43], v[204:207], a[148:151], v[40:43]
    v_xor_b32 v226, 64, v224
    v_xor_b32 v227, 96, v224
    v_mfma_f32_16x16x32_bf16 v[44:47], v[204:207], a[152:155], v[44:47]
    s_waitcnt lgkmcnt(6)
    v_mfma_f32_16x16x32_bf16 v[0:3], v[208:211], a[156:159], v[0:3]
    v_mfma_f32_16x16x32_bf16 v[4:7], v[208:211], a[160:163], v[4:7]
    v_mfma_f32_16x16x32_bf16 v[8:11], v[208:211], a[164:167], v[8:11]
    s_waitcnt vmcnt(7) lgkmcnt(0)
    s_barrier
    v_mfma_f32_16x16x32_bf16 v[12:15], v[212:215], a[156:159], v[12:15]
    ds_read_b64_tr_b16 v[192:193], v224 offset:0
    ds_read_b64_tr_b16 v[194:195], v224 offset:1024
    s_add_u32 s69, s53, 7
    s_and_b32 s69, s69, 7
    s_add_u32 m0, s61, 102400
    s_lshl_b32 s68, s69, 7
    s_add_u32 s68, s68, s55
    buffer_load_dwordx4 v96, s[8:11], s68 offen offset:0 lds
    v_mfma_f32_16x16x32_bf16 v[16:19], v[212:215], a[160:163], v[16:19]
    ds_read_b128 a[168:171], v100 offset:12288
    ds_read_b128 a[172:175], v100 offset:14336
    v_mfma_f32_16x16x32_bf16 v[20:23], v[212:215], a[164:167], v[20:23]
    ds_read_b128 a[176:179], v100 offset:16384
    ds_read_b64_tr_b16 v[196:197], v225 offset:0
    v_mfma_f32_16x16x32_bf16 v[24:27], v[216:219], a[156:159], v[24:27]
    ds_read_b64_tr_b16 v[198:199], v225 offset:1024
    ds_read_b64_tr_b16 v[200:201], v226 offset:0
    buffer_load_dwordx4 v97, s[8:11], s68 offen offset:1024 lds
    v_mfma_f32_16x16x32_bf16 v[28:31], v[216:219], a[160:163], v[28:31]
    ds_read_b64_tr_b16 v[202:203], v226 offset:1024
    ds_read_b128 a[180:183], v101 offset:12288
    v_mfma_f32_16x16x32_bf16 v[32:35], v[216:219], a[164:167], v[32:35]
    ds_read_b128 a[184:187], v101 offset:14336
    ds_read_b128 a[188:191], v101 offset:16384
    v_mfma_f32_16x16x32_bf16 v[36:39], v[220:223], a[156:159], v[36:39]
    ds_read_b64_tr_b16 v[204:205], v227 offset:0
    ds_read_b64_tr_b16 v[206:207], v227 offset:1024
    buffer_load_dwordx4 v98, s[8:11], s68 offen offset:2048 lds
    v_mfma_f32_16x16x32_bf16 v[40:43], v[220:223], a[160:163], v[40:43]
    ds_read_b64_tr_b16 v[208:209], v224 offset:8192
    ds_read_b64_tr_b16 v[210:211], v224 offset:9216
    v_mfma_f32_16x16x32_bf16 v[44:47], v[220:223], a[164:167], v[44:47]
    s_waitcnt lgkmcnt(11)
    v_mfma_f32_16x16x32_bf16 v[0:3], v[192:195], a[168:171], v[0:3]
    s_add_u32 m0, s59, 131072
    s_add_u32 s69, s53, 7
    s_and_b32 s69, s69, 7
    s_lshl_b32 s68, s69, 19
    s_add_u32 s68, s68, s54
    buffer_load_dwordx4 v242, s[20:23], s68 offen offset:0  lds
    v_mfma_f32_16x16x32_bf16 v[4:7], v[192:195], a[172:175], v[4:7]
    ds_read_b64_tr_b16 v[212:213], v225 offset:8192
    ds_read_b64_tr_b16 v[214:215], v225 offset:9216
    v_mfma_f32_16x16x32_bf16 v[8:11], v[192:195], a[176:179], v[8:11]
    s_waitcnt lgkmcnt(11)
    v_mfma_f32_16x16x32_bf16 v[12:15], v[196:199], a[168:171], v[12:15]
    s_add_u32 s68, s68, 31744
    buffer_load_dwordx4 v242, s[20:23], s68 offen offset:1024  lds
    v_mfma_f32_16x16x32_bf16 v[16:19], v[196:199], a[172:175], v[16:19]
    ds_read_b64_tr_b16 v[216:217], v226 offset:8192
    ds_read_b64_tr_b16 v[218:219], v226 offset:9216
    v_mfma_f32_16x16x32_bf16 v[20:23], v[196:199], a[176:179], v[20:23]
    s_waitcnt lgkmcnt(11)
    v_mfma_f32_16x16x32_bf16 v[24:27], v[200:203], a[168:171], v[24:27]
    s_add_u32 s68, s68, 31744
    v_xor_b32 v244, 128, v242
    buffer_load_dwordx4 v244, s[20:23], s68 offen offset:2048  lds
    v_mfma_f32_16x16x32_bf16 v[28:31], v[200:203], a[172:175], v[28:31]
    ds_read_b64_tr_b16 v[220:221], v227 offset:8192
    ds_read_b64_tr_b16 v[222:223], v227 offset:9216
    v_mfma_f32_16x16x32_bf16 v[32:35], v[200:203], a[176:179], v[32:35]
    s_waitcnt lgkmcnt(8)
    v_mfma_f32_16x16x32_bf16 v[36:39], v[204:207], a[168:171], v[36:39]
    v_add_u32 v224, 114688, v245
    s_add_u32 s68, s68, 31744
    buffer_load_dwordx4 v244, s[20:23], s68 offen offset:3072  lds
    v_xor_b32 v225, 32, v224
    v_mfma_f32_16x16x32_bf16 v[40:43], v[204:207], a[172:175], v[40:43]
    v_xor_b32 v226, 64, v224
    v_xor_b32 v227, 96, v224
    v_mfma_f32_16x16x32_bf16 v[44:47], v[204:207], a[176:179], v[44:47]
    s_waitcnt lgkmcnt(6)
    v_mfma_f32_16x16x32_bf16 v[0:3], v[208:211], a[180:183], v[0:3]
    v_mfma_f32_16x16x32_bf16 v[4:7], v[208:211], a[184:187], v[4:7]
    v_mfma_f32_16x16x32_bf16 v[8:11], v[208:211], a[188:191], v[8:11]
    s_waitcnt vmcnt(7) lgkmcnt(0)
    s_barrier
    v_mfma_f32_16x16x32_bf16 v[12:15], v[212:215], a[180:183], v[12:15]
    ds_read_b64_tr_b16 v[192:193], v224 offset:0
    ds_read_b64_tr_b16 v[194:195], v224 offset:1024
    s_add_u32 m0, s59, 49152
    s_add_u32 s68, s46, 49152
    buffer_load_dwordx4 v240, s[12:15], s68 offen offset:0 nt lds
    v_mfma_f32_16x16x32_bf16 v[16:19], v[212:215], a[184:187], v[16:19]
    ds_read_b128 a[192:195], v100 offset:24576
    ds_read_b128 a[196:199], v100 offset:26624
    v_mfma_f32_16x16x32_bf16 v[20:23], v[212:215], a[188:191], v[20:23]
    ds_read_b128 a[200:203], v100 offset:28672
    ds_read_b64_tr_b16 v[196:197], v225 offset:0
    v_mfma_f32_16x16x32_bf16 v[24:27], v[216:219], a[180:183], v[24:27]
    ds_read_b64_tr_b16 v[198:199], v225 offset:1024
    ds_read_b64_tr_b16 v[200:201], v226 offset:0
    v_mfma_f32_16x16x32_bf16 v[28:31], v[216:219], a[184:187], v[28:31]
    ds_read_b64_tr_b16 v[202:203], v226 offset:1024
    ds_read_b128 a[204:207], v101 offset:24576
    s_add_u32 s68, s68, 3072
    v_xor_b32 v244, 64, v240
    buffer_load_dwordx4 v244, s[12:15], s68 offen offset:1024 nt lds
    v_mfma_f32_16x16x32_bf16 v[32:35], v[216:219], a[188:191], v[32:35]
    ds_read_b128 a[208:211], v101 offset:26624
    ds_read_b128 a[212:215], v101 offset:28672
    v_mfma_f32_16x16x32_bf16 v[36:39], v[220:223], a[180:183], v[36:39]
    ds_read_b64_tr_b16 v[204:205], v227 offset:0
    ds_read_b64_tr_b16 v[206:207], v227 offset:1024
    v_mfma_f32_16x16x32_bf16 v[40:43], v[220:223], a[184:187], v[40:43]
    ds_read_b64_tr_b16 v[208:209], v224 offset:8192
    ds_read_b64_tr_b16 v[210:211], v224 offset:9216
    v_mfma_f32_16x16x32_bf16 v[44:47], v[220:223], a[188:191], v[44:47]
    s_add_u32 s68, s68, 3072
    v_xor_b32 v244, 128, v240
    buffer_load_dwordx4 v244, s[12:15], s68 offen offset:2048 nt lds
    s_waitcnt lgkmcnt(11)
    v_mfma_f32_16x16x32_bf16 v[0:3], v[192:195], a[192:195], v[0:3]
    v_mfma_f32_16x16x32_bf16 v[4:7], v[192:195], a[196:199], v[4:7]
    ds_read_b64_tr_b16 v[212:213], v225 offset:8192
    ds_read_b64_tr_b16 v[214:215], v225 offset:9216
    v_mfma_f32_16x16x32_bf16 v[8:11], v[192:195], a[200:203], v[8:11]
    s_waitcnt lgkmcnt(11)
    v_mfma_f32_16x16x32_bf16 v[12:15], v[196:199], a[192:195], v[12:15]
    s_add_u32 s68, s68, 3072
    v_xor_b32 v244, 192, v240
    buffer_load_dwordx4 v244, s[12:15], s68 offen offset:3072 nt lds
    v_mfma_f32_16x16x32_bf16 v[16:19], v[196:199], a[196:199], v[16:19]
    ds_read_b64_tr_b16 v[216:217], v226 offset:8192
    ds_read_b64_tr_b16 v[218:219], v226 offset:9216
    v_mfma_f32_16x16x32_bf16 v[20:23], v[196:199], a[200:203], v[20:23]
    s_waitcnt lgkmcnt(11)
    v_mfma_f32_16x16x32_bf16 v[24:27], v[200:203], a[192:195], v[24:27]
    v_mfma_f32_16x16x32_bf16 v[28:31], v[200:203], a[196:199], v[28:31]
    ds_read_b64_tr_b16 v[220:221], v227 offset:8192
    ds_read_b64_tr_b16 v[222:223], v227 offset:9216
    v_mfma_f32_16x16x32_bf16 v[32:35], v[200:203], a[200:203], v[32:35]
    s_waitcnt lgkmcnt(8)
    v_mfma_f32_16x16x32_bf16 v[36:39], v[204:207], a[192:195], v[36:39]
    v_add_u32 v224, 131072, v245
    v_xor_b32 v225, 32, v224
    v_mfma_f32_16x16x32_bf16 v[40:43], v[204:207], a[196:199], v[40:43]
    v_xor_b32 v226, 64, v224
    v_xor_b32 v227, 96, v224
    v_mfma_f32_16x16x32_bf16 v[44:47], v[204:207], a[200:203], v[44:47]
    s_waitcnt lgkmcnt(6)
    v_mfma_f32_16x16x32_bf16 v[0:3], v[208:211], a[204:207], v[0:3]
    v_mfma_f32_16x16x32_bf16 v[4:7], v[208:211], a[208:211], v[4:7]
    v_mfma_f32_16x16x32_bf16 v[8:11], v[208:211], a[212:215], v[8:11]
    s_waitcnt vmcnt(4) lgkmcnt(0)
    s_barrier
    v_mfma_f32_16x16x32_bf16 v[12:15], v[212:215], a[204:207], v[12:15]
    ds_read_b64_tr_b16 v[192:193], v224 offset:0
    ds_read_b64_tr_b16 v[194:195], v224 offset:1024
    v_mfma_f32_16x16x32_bf16 v[16:19], v[212:215], a[208:211], v[16:19]
    ds_read_b128 a[216:219], v100 offset:36864
    ds_read_b128 a[220:223], v100 offset:38912
    v_mfma_f32_16x16x32_bf16 v[20:23], v[212:215], a[212:215], v[20:23]
    ds_read_b128 a[224:227], v100 offset:40960
    ds_read_b64_tr_b16 v[196:197], v225 offset:0
    v_mfma_f32_16x16x32_bf16 v[24:27], v[216:219], a[204:207], v[24:27]
    ds_read_b64_tr_b16 v[198:199], v225 offset:1024
    ds_read_b64_tr_b16 v[200:201], v226 offset:0
    v_mfma_f32_16x16x32_bf16 v[28:31], v[216:219], a[208:211], v[28:31]
    ds_read_b64_tr_b16 v[202:203], v226 offset:1024
    ds_read_b128 a[228:231], v101 offset:36864
    v_mfma_f32_16x16x32_bf16 v[32:35], v[216:219], a[212:215], v[32:35]
    ds_read_b128 a[232:235], v101 offset:38912
    ds_read_b128 a[236:239], v101 offset:40960
    v_mfma_f32_16x16x32_bf16 v[36:39], v[220:223], a[204:207], v[36:39]
    ds_read_b64_tr_b16 v[204:205], v227 offset:0
    ds_read_b64_tr_b16 v[206:207], v227 offset:1024
    v_mfma_f32_16x16x32_bf16 v[40:43], v[220:223], a[208:211], v[40:43]
    ds_read_b64_tr_b16 v[208:209], v224 offset:8192
    ds_read_b64_tr_b16 v[210:211], v224 offset:9216
    v_mfma_f32_16x16x32_bf16 v[44:47], v[220:223], a[212:215], v[44:47]
    s_waitcnt lgkmcnt(11)
    v_mfma_f32_16x16x32_bf16 v[0:3], v[192:195], a[216:219], v[0:3]
    v_mfma_f32_16x16x32_bf16 v[4:7], v[192:195], a[220:223], v[4:7]
    ds_read_b64_tr_b16 v[212:213], v225 offset:8192
    ds_read_b64_tr_b16 v[214:215], v225 offset:9216
    v_mfma_f32_16x16x32_bf16 v[8:11], v[192:195], a[224:227], v[8:11]
    s_waitcnt lgkmcnt(11)
    v_mfma_f32_16x16x32_bf16 v[12:15], v[196:199], a[216:219], v[12:15]
    v_mfma_f32_16x16x32_bf16 v[16:19], v[196:199], a[220:223], v[16:19]
    ds_read_b64_tr_b16 v[216:217], v226 offset:8192
    ds_read_b64_tr_b16 v[218:219], v226 offset:9216
    v_mfma_f32_16x16x32_bf16 v[20:23], v[196:199], a[224:227], v[20:23]
    s_waitcnt lgkmcnt(11)
    v_mfma_f32_16x16x32_bf16 v[24:27], v[200:203], a[216:219], v[24:27]
    v_mfma_f32_16x16x32_bf16 v[28:31], v[200:203], a[220:223], v[28:31]
    ds_read_b64_tr_b16 v[220:221], v227 offset:8192
    ds_read_b64_tr_b16 v[222:223], v227 offset:9216
    v_mfma_f32_16x16x32_bf16 v[32:35], v[200:203], a[224:227], v[32:35]
    s_waitcnt lgkmcnt(8)
    v_mfma_f32_16x16x32_bf16 v[36:39], v[204:207], a[216:219], v[36:39]
    v_mfma_f32_16x16x32_bf16 v[40:43], v[204:207], a[220:223], v[40:43]
    v_mfma_f32_16x16x32_bf16 v[44:47], v[204:207], a[224:227], v[44:47]
    s_waitcnt lgkmcnt(6)
    v_mfma_f32_16x16x32_bf16 v[0:3], v[208:211], a[228:231], v[0:3]
    v_mfma_f32_16x16x32_bf16 v[4:7], v[208:211], a[232:235], v[4:7]
    v_mfma_f32_16x16x32_bf16 v[8:11], v[208:211], a[236:239], v[8:11]
    s_waitcnt lgkmcnt(4)
    v_mfma_f32_16x16x32_bf16 v[12:15], v[212:215], a[228:231], v[12:15]
    v_mfma_f32_16x16x32_bf16 v[16:19], v[212:215], a[232:235], v[16:19]
    v_mfma_f32_16x16x32_bf16 v[20:23], v[212:215], a[236:239], v[20:23]
    s_waitcnt lgkmcnt(2)
    v_mfma_f32_16x16x32_bf16 v[24:27], v[216:219], a[228:231], v[24:27]
    v_mfma_f32_16x16x32_bf16 v[28:31], v[216:219], a[232:235], v[28:31]
    v_mfma_f32_16x16x32_bf16 v[32:35], v[216:219], a[236:239], v[32:35]
    s_waitcnt lgkmcnt(0)
    v_mfma_f32_16x16x32_bf16 v[36:39], v[220:223], a[228:231], v[36:39]
    v_mfma_f32_16x16x32_bf16 v[40:43], v[220:223], a[232:235], v[40:43]
    v_mfma_f32_16x16x32_bf16 v[44:47], v[220:223], a[236:239], v[44:47]
    v_lshrrev_b32 v228, 8, v248
    v_bfe_u32 v229, v248, 4, 4
    v_lshrrev_b32 v230, 1, v228
    v_xor_b32 v230, v230, v229
    v_lshlrev_b32 v230, 4, v230
    v_lshl_add_u32 v230, v229, 8, v230
    v_and_b32 v231, 1, v228
    v_lshl_add_u32 v230, v231, 3, v230
    s_mul_i32 s48, s41, 12288
    s_add_u32 s48, s48, 114688
    s_lshl_b32 s49, s42, 7
    v_xor_b32 v192, s49, v230
    v_add_u32 v192, s48, v192
    v_xor_b32 v193, 32, v192
    v_xor_b32 v194, 64, v192
    v_xor_b32 v195, 96, v192
    v_xor_b32 v230, v228, v229
    v_lshlrev_b32 v230, 4, v230
    v_lshl_add_u32 v230, v229, 8, v230
    v_add_u32 v196, s48, v230
    v_xor_b32 v197, 64, v196
    v_xor_b32 v198, 128, v196
    v_xor_b32 v199, 192, v196
    v_cvt_pk_bf16_f32 v200, v0, v1
    v_cvt_pk_bf16_f32 v201, v2, v3
    v_cvt_pk_bf16_f32 v202, v4, v5
    v_cvt_pk_bf16_f32 v203, v6, v7
    v_cvt_pk_bf16_f32 v204, v8, v9
    v_cvt_pk_bf16_f32 v205, v10, v11
    v_cvt_pk_bf16_f32 v206, v12, v13
    v_cvt_pk_bf16_f32 v207, v14, v15
    v_cvt_pk_bf16_f32 v208, v16, v17
    v_cvt_pk_bf16_f32 v209, v18, v19
    v_cvt_pk_bf16_f32 v210, v20, v21
    v_cvt_pk_bf16_f32 v211, v22, v23
    v_cvt_pk_bf16_f32 v212, v24, v25
    v_cvt_pk_bf16_f32 v213, v26, v27
    v_cvt_pk_bf16_f32 v214, v28, v29
    v_cvt_pk_bf16_f32 v215, v30, v31
    v_cvt_pk_bf16_f32 v216, v32, v33
    v_cvt_pk_bf16_f32 v217, v34, v35
    v_cvt_pk_bf16_f32 v218, v36, v37
    v_cvt_pk_bf16_f32 v219, v38, v39
    v_cvt_pk_bf16_f32 v220, v40, v41
    v_cvt_pk_bf16_f32 v221, v42, v43
    v_cvt_pk_bf16_f32 v222, v44, v45
    v_cvt_pk_bf16_f32 v223, v46, v47
    s_barrier
    ds_write_b64 v192, v[200:201] offset:0
    ds_write_b64 v192, v[202:203] offset:4096
    ds_write_b64 v192, v[204:205] offset:8192
    ds_write_b64 v193, v[206:207] offset:0
    ds_write_b64 v193, v[208:209] offset:4096
    ds_write_b64 v193, v[210:211] offset:8192
    ds_write_b64 v194, v[212:213] offset:0
    ds_write_b64 v194, v[214:215] offset:4096
    ds_write_b64 v194, v[216:217] offset:8192
    ds_write_b64 v195, v[218:219] offset:0
    ds_write_b64 v195, v[220:221] offset:4096
    ds_write_b64 v195, v[222:223] offset:8192
    s_waitcnt lgkmcnt(0)
    s_barrier
    ds_read_b128 a[96:99], v196 offset:0
    ds_read_b128 a[100:103], v197 offset:0
    ds_read_b128 a[104:107], v198 offset:0
    ds_read_b128 a[108:111], v199 offset:0
    ds_read_b128 a[112:115], v196 offset:4096
    ds_read_b128 a[116:119], v197 offset:4096
    ds_read_b128 a[120:123], v198 offset:4096
    ds_read_b128 a[124:127], v199 offset:4096
    ds_read_b128 a[128:131], v196 offset:8192
    ds_read_b128 a[132:135], v197 offset:8192
    ds_read_b128 a[136:139], v198 offset:8192
    ds_read_b128 a[140:143], v199 offset:8192
    v_add_u32 v224, 0, v246
    s_add_u32 m0, s59, 65536
    s_add_u32 s68, s46, 65536
    buffer_load_dwordx4 v240, s[12:15], s68 offen offset:0 nt lds
    v_xor_b32 v225, 64, v224
    v_xor_b32 v226, 128, v224
    v_xor_b32 v227, 192, v224
    s_waitcnt lgkmcnt(0)
    s_barrier
    ds_read_b128 v[192:195], v224 offset:0
    ds_read_b128 v[196:199], v225 offset:0
    ds_read_b128 v[200:203], v226 offset:0
    ds_read_b128 v[204:207], v227 offset:0
    ds_read_b128 v[208:211], v224 offset:4096
    s_waitcnt lgkmcnt(4)
    v_mfma_f32_16x16x32_bf16 v[0:3], v[192:195], a[96:99], 0
    s_add_u32 s68, s68, 3072
    v_xor_b32 v244, 64, v240
    buffer_load_dwordx4 v244, s[12:15], s68 offen offset:1024 nt lds
    v_mfma_f32_16x16x32_bf16 v[8:11], v[192:195], a[112:115], 0
    ds_read_b128 v[212:215], v225 offset:4096
    v_mfma_f32_16x16x32_bf16 v[16:19], v[192:195], a[128:131], 0
    s_waitcnt lgkmcnt(4)
    v_mfma_f32_16x16x32_bf16 v[0:3], v[196:199], a[100:103], v[0:3]
    v_mfma_f32_16x16x32_bf16 v[8:11], v[196:199], a[116:119], v[8:11]
    ds_read_b128 v[216:219], v226 offset:4096
    s_add_u32 s68, s68, 3072
    v_xor_b32 v244, 128, v240
    buffer_load_dwordx4 v244, s[12:15], s68 offen offset:2048 nt lds
    v_mfma_f32_16x16x32_bf16 v[16:19], v[196:199], a[132:135], v[16:19]
    s_waitcnt lgkmcnt(4)
    v_mfma_f32_16x16x32_bf16 v[0:3], v[200:203], a[104:107], v[0:3]
    v_mfma_f32_16x16x32_bf16 v[8:11], v[200:203], a[120:123], v[8:11]
    ds_read_b128 v[220:223], v227 offset:4096
    v_mfma_f32_16x16x32_bf16 v[16:19], v[200:203], a[136:139], v[16:19]
    s_add_u32 s68, s68, 3072
    v_xor_b32 v244, 192, v240
    buffer_load_dwordx4 v244, s[12:15], s68 offen offset:3072 nt lds
    s_waitcnt lgkmcnt(4)
    v_mfma_f32_16x16x32_bf16 v[0:3], v[204:207], a[108:111], v[0:3]
    v_add_u32 v224, 16384, v246
    v_xor_b32 v225, 64, v224
    v_mfma_f32_16x16x32_bf16 v[8:11], v[204:207], a[124:127], v[8:11]
    v_xor_b32 v226, 128, v224
    v_xor_b32 v227, 192, v224
    v_mfma_f32_16x16x32_bf16 v[16:19], v[204:207], a[140:143], v[16:19]
    s_add_u32 m0, s59, 81920
    s_add_u32 s68, s46, 81920
    buffer_load_dwordx4 v240, s[12:15], s68 offen offset:0 nt lds
    s_waitcnt lgkmcnt(3)
    v_mfma_f32_16x16x32_bf16 v[4:7], v[208:211], a[96:99], 0
    v_mfma_f32_16x16x32_bf16 v[12:15], v[208:211], a[112:115], 0
    v_mfma_f32_16x16x32_bf16 v[20:23], v[208:211], a[128:131], 0
    s_waitcnt lgkmcnt(0)
    s_barrier
    v_mfma_f32_16x16x32_bf16 v[4:7], v[212:215], a[100:103], v[4:7]
    ds_read_b128 v[192:195], v224 offset:0
    ds_read_b128 v[196:199], v225 offset:0
    s_add_u32 s68, s68, 3072
    v_xor_b32 v244, 64, v240
    buffer_load_dwordx4 v244, s[12:15], s68 offen offset:1024 nt lds
    v_mfma_f32_16x16x32_bf16 v[12:15], v[212:215], a[116:119], v[12:15]
    ds_read_b128 v[200:203], v226 offset:0
    ds_read_b128 v[204:207], v227 offset:0
    v_mfma_f32_16x16x32_bf16 v[20:23], v[212:215], a[132:135], v[20:23]
    ds_read_b128 v[208:211], v224 offset:4096
    v_mfma_f32_16x16x32_bf16 v[4:7], v[216:219], a[104:107], v[4:7]
    v_mfma_f32_16x16x32_bf16 v[12:15], v[216:219], a[120:123], v[12:15]
    s_add_u32 s68, s68, 3072
    v_xor_b32 v244, 128, v240
    buffer_load_dwordx4 v244, s[12:15], s68 offen offset:2048 nt lds
    v_mfma_f32_16x16x32_bf16 v[20:23], v[216:219], a[136:139], v[20:23]
    v_mfma_f32_16x16x32_bf16 v[4:7], v[220:223], a[108:111], v[4:7]
    v_mfma_f32_16x16x32_bf16 v[12:15], v[220:223], a[124:127], v[12:15]
    v_mfma_f32_16x16x32_bf16 v[20:23], v[220:223], a[140:143], v[20:23]
    s_add_u32 s68, s68, 3072
    v_xor_b32 v244, 192, v240
    buffer_load_dwordx4 v244, s[12:15], s68 offen offset:3072 nt lds
    s_waitcnt lgkmcnt(4)
    v_mfma_f32_16x16x32_bf16 v[24:27], v[192:195], a[96:99], 0
    v_max_f32 v232, v0, v1
    v_max_f32 v233, v8, v9
    v_mfma_f32_16x16x32_bf16 v[32:35], v[192:195], a[112:115], 0
    ds_read_b128 v[212:215], v225 offset:4096
    v_max_f32 v234, v16, v17
    v_mfma_f32_16x16x32_bf16 v[40:43], v[192:195], a[128:131], 0
    v_max3_f32 v232, v232, v2, v3
    v_max3_f32 v233, v233, v10, v11
    s_waitcnt lgkmcnt(4)
    v_mfma_f32_16x16x32_bf16 v[24:27], v[196:199], a[100:103], v[24:27]
    v_max3_f32 v234, v234, v18, v19
    v_max3_f32 v232, v232, v4, v5
    v_mfma_f32_16x16x32_bf16 v[32:35], v[196:199], a[116:119], v[32:35]
    ds_read_b128 v[216:219], v226 offset:4096
    v_max3_f32 v233, v233, v12, v13
    v_mfma_f32_16x16x32_bf16 v[40:43], v[196:199], a[132:135], v[40:43]
    v_max3_f32 v234, v234, v20, v21
    v_max3_f32 v232, v232, v6, v7
    s_waitcnt lgkmcnt(4)
    v_mfma_f32_16x16x32_bf16 v[24:27], v[200:203], a[104:107], v[24:27]
    v_max3_f32 v233, v233, v14, v15
    v_max3_f32 v234, v234, v22, v23
    v_mfma_f32_16x16x32_bf16 v[32:35], v[200:203], a[120:123], v[32:35]
    ds_read_b128 v[220:223], v227 offset:4096
    v_mfma_f32_16x16x32_bf16 v[40:43], v[200:203], a[136:139], v[40:43]
    s_waitcnt lgkmcnt(4)
    v_mfma_f32_16x16x32_bf16 v[24:27], v[204:207], a[108:111], v[24:27]
    v_add_u32 v224, 32768, v246
    v_xor_b32 v225, 64, v224
    v_mfma_f32_16x16x32_bf16 v[32:35], v[204:207], a[124:127], v[32:35]
    v_xor_b32 v226, 128, v224
    v_xor_b32 v227, 192, v224
    v_mfma_f32_16x16x32_bf16 v[40:43], v[204:207], a[140:143], v[40:43]
    s_waitcnt lgkmcnt(3)
    v_mfma_f32_16x16x32_bf16 v[28:31], v[208:211], a[96:99], 0
    v_mfma_f32_16x16x32_bf16 v[36:39], v[208:211], a[112:115], 0
    v_mfma_f32_16x16x32_bf16 v[44:47], v[208:211], a[128:131], 0
    s_waitcnt lgkmcnt(0)
    s_barrier
    v_mfma_f32_16x16x32_bf16 v[28:31], v[212:215], a[100:103], v[28:31]
    ds_read_b128 v[192:195], v224 offset:0
    ds_read_b128 v[196:199], v225 offset:0
    v_mfma_f32_16x16x32_bf16 v[36:39], v[212:215], a[116:119], v[36:39]
    ds_read_b128 v[200:203], v226 offset:0
    ds_read_b128 v[204:207], v227 offset:0
    v_mfma_f32_16x16x32_bf16 v[44:47], v[212:215], a[132:135], v[44:47]
    ds_read_b128 v[208:211], v224 offset:4096
    v_mfma_f32_16x16x32_bf16 v[28:31], v[216:219], a[104:107], v[28:31]
    v_mfma_f32_16x16x32_bf16 v[36:39], v[216:219], a[120:123], v[36:39]
    v_mfma_f32_16x16x32_bf16 v[44:47], v[216:219], a[136:139], v[44:47]
    v_mfma_f32_16x16x32_bf16 v[28:31], v[220:223], a[108:111], v[28:31]
    v_mfma_f32_16x16x32_bf16 v[36:39], v[220:223], a[124:127], v[36:39]
    v_mfma_f32_16x16x32_bf16 v[44:47], v[220:223], a[140:143], v[44:47]
    s_waitcnt lgkmcnt(4)
    v_mfma_f32_16x16x32_bf16 v[48:51], v[192:195], a[96:99], 0
    v_max3_f32 v232, v232, v24, v25
    v_max3_f32 v233, v233, v32, v33
    v_mfma_f32_16x16x32_bf16 v[56:59], v[192:195], a[112:115], 0
    ds_read_b128 v[212:215], v225 offset:4096
    v_max3_f32 v234, v234, v40, v41
    v_mfma_f32_16x16x32_bf16 v[64:67], v[192:195], a[128:131], 0
    v_max3_f32 v232, v232, v26, v27
    v_max3_f32 v233, v233, v34, v35
    s_waitcnt lgkmcnt(4)
    v_mfma_f32_16x16x32_bf16 v[48:51], v[196:199], a[100:103], v[48:51]
    v_max3_f32 v234, v234, v42, v43
    v_max3_f32 v232, v232, v28, v29
    v_mfma_f32_16x16x32_bf16 v[56:59], v[196:199], a[116:119], v[56:59]
    ds_read_b128 v[216:219], v226 offset:4096
    v_max3_f32 v233, v233, v36, v37
    v_mfma_f32_16x16x32_bf16 v[64:67], v[196:199], a[132:135], v[64:67]
    v_max3_f32 v234, v234, v44, v45
    v_max3_f32 v232, v232, v30, v31
    s_waitcnt lgkmcnt(4)
    v_mfma_f32_16x16x32_bf16 v[48:51], v[200:203], a[104:107], v[48:51]
    v_max3_f32 v233, v233, v38, v39
    v_max3_f32 v234, v234, v46, v47
    v_mfma_f32_16x16x32_bf16 v[56:59], v[200:203], a[120:123], v[56:59]
    ds_read_b128 v[220:223], v227 offset:4096
    v_mfma_f32_16x16x32_bf16 v[64:67], v[200:203], a[136:139], v[64:67]
    s_waitcnt lgkmcnt(4)
    v_mfma_f32_16x16x32_bf16 v[48:51], v[204:207], a[108:111], v[48:51]
    v_add_u32 v224, 49152, v246
    v_xor_b32 v225, 64, v224
    v_mfma_f32_16x16x32_bf16 v[56:59], v[204:207], a[124:127], v[56:59]
    v_xor_b32 v226, 128, v224
    v_xor_b32 v227, 192, v224
    v_mfma_f32_16x16x32_bf16 v[64:67], v[204:207], a[140:143], v[64:67]
    s_waitcnt lgkmcnt(3)
    v_mfma_f32_16x16x32_bf16 v[52:55], v[208:211], a[96:99], 0
    v_mfma_f32_16x16x32_bf16 v[60:63], v[208:211], a[112:115], 0
    v_mfma_f32_16x16x32_bf16 v[68:71], v[208:211], a[128:131], 0
    s_waitcnt vmcnt(8) lgkmcnt(0)
    s_barrier
    v_mfma_f32_16x16x32_bf16 v[52:55], v[212:215], a[100:103], v[52:55]
    ds_read_b128 v[192:195], v224 offset:0
    ds_read_b128 v[196:199], v225 offset:0
    s_add_u32 m0, s59, 98304
    s_add_u32 s68, s46, 98304
    buffer_load_dwordx4 v240, s[12:15], s68 offen offset:0 nt lds
    v_mfma_f32_16x16x32_bf16 v[60:63], v[212:215], a[116:119], v[60:63]
    ds_read_b128 v[200:203], v226 offset:0
    ds_read_b128 v[204:207], v227 offset:0
    v_mfma_f32_16x16x32_bf16 v[68:71], v[212:215], a[132:135], v[68:71]
    ds_read_b128 v[208:211], v224 offset:4096
    v_mfma_f32_16x16x32_bf16 v[52:55], v[216:219], a[104:107], v[52:55]
    v_mfma_f32_16x16x32_bf16 v[60:63], v[216:219], a[120:123], v[60:63]
    s_add_u32 s68, s68, 3072
    v_xor_b32 v244, 64, v240
    buffer_load_dwordx4 v244, s[12:15], s68 offen offset:1024 nt lds
    v_mfma_f32_16x16x32_bf16 v[68:71], v[216:219], a[136:139], v[68:71]
    v_mfma_f32_16x16x32_bf16 v[52:55], v[220:223], a[108:111], v[52:55]
    v_mfma_f32_16x16x32_bf16 v[60:63], v[220:223], a[124:127], v[60:63]
    v_mfma_f32_16x16x32_bf16 v[68:71], v[220:223], a[140:143], v[68:71]
    s_add_u32 s68, s68, 3072
    v_xor_b32 v244, 128, v240
    buffer_load_dwordx4 v244, s[12:15], s68 offen offset:2048 nt lds
    s_waitcnt lgkmcnt(4)
    v_mfma_f32_16x16x32_bf16 v[72:75], v[192:195], a[96:99], 0
    v_max3_f32 v232, v232, v48, v49
    v_max3_f32 v233, v233, v56, v57
    v_mfma_f32_16x16x32_bf16 v[80:83], v[192:195], a[112:115], 0
    ds_read_b128 v[212:215], v225 offset:4096
    v_max3_f32 v234, v234, v64, v65
    v_mfma_f32_16x16x32_bf16 v[88:91], v[192:195], a[128:131], 0
    v_max3_f32 v232, v232, v50, v51
    s_add_u32 s68, s68, 3072
    v_xor_b32 v244, 192, v240
    buffer_load_dwordx4 v244, s[12:15], s68 offen offset:3072 nt lds
    v_max3_f32 v233, v233, v58, v59
    s_waitcnt lgkmcnt(4)
    v_mfma_f32_16x16x32_bf16 v[72:75], v[196:199], a[100:103], v[72:75]
    v_max3_f32 v234, v234, v66, v67
    v_max3_f32 v232, v232, v52, v53
    v_mfma_f32_16x16x32_bf16 v[80:83], v[196:199], a[116:119], v[80:83]
    ds_read_b128 v[216:219], v226 offset:4096
    v_max3_f32 v233, v233, v60, v61
    v_mfma_f32_16x16x32_bf16 v[88:91], v[196:199], a[132:135], v[88:91]
    v_max3_f32 v234, v234, v68, v69
    v_max3_f32 v232, v232, v54, v55
    s_waitcnt lgkmcnt(4)
    v_mfma_f32_16x16x32_bf16 v[72:75], v[200:203], a[104:107], v[72:75]
    v_max3_f32 v233, v233, v62, v63
    v_max3_f32 v234, v234, v70, v71
    v_mfma_f32_16x16x32_bf16 v[80:83], v[200:203], a[120:123], v[80:83]
    ds_read_b128 v[220:223], v227 offset:4096
    v_mfma_f32_16x16x32_bf16 v[88:91], v[200:203], a[136:139], v[88:91]
    s_waitcnt lgkmcnt(4)
    v_mfma_f32_16x16x32_bf16 v[72:75], v[204:207], a[108:111], v[72:75]
    v_add_u32 v224, 65536, v246
    v_xor_b32 v225, 64, v224
    v_mfma_f32_16x16x32_bf16 v[80:83], v[204:207], a[124:127], v[80:83]
    v_xor_b32 v226, 128, v224
    v_xor_b32 v227, 192, v224
    v_mfma_f32_16x16x32_bf16 v[88:91], v[204:207], a[140:143], v[88:91]
    s_waitcnt lgkmcnt(3)
    v_mfma_f32_16x16x32_bf16 v[76:79], v[208:211], a[96:99], 0
    v_mfma_f32_16x16x32_bf16 v[84:87], v[208:211], a[112:115], 0
    v_mfma_f32_16x16x32_bf16 v[92:95], v[208:211], a[128:131], 0
    s_waitcnt vmcnt(8) lgkmcnt(0)
    s_barrier
    v_mfma_f32_16x16x32_bf16 v[76:79], v[212:215], a[100:103], v[76:79]
    ds_read_b128 v[192:195], v224 offset:0
    ds_read_b128 v[196:199], v225 offset:0
    s_add_u32 m0, s59, 0
    s_add_u32 s68, s46, 114688
    buffer_load_dwordx4 v240, s[12:15], s68 offen offset:0 nt lds
    v_mfma_f32_16x16x32_bf16 v[84:87], v[212:215], a[116:119], v[84:87]
    ds_read_b128 v[200:203], v226 offset:0
    ds_read_b128 v[204:207], v227 offset:0
    v_mfma_f32_16x16x32_bf16 v[92:95], v[212:215], a[132:135], v[92:95]
    ds_read_b128 v[208:211], v224 offset:4096
    v_mfma_f32_16x16x32_bf16 v[76:79], v[216:219], a[104:107], v[76:79]
    v_mfma_f32_16x16x32_bf16 v[84:87], v[216:219], a[120:123], v[84:87]
    s_add_u32 s68, s68, 3072
    v_xor_b32 v244, 64, v240
    buffer_load_dwordx4 v244, s[12:15], s68 offen offset:1024 nt lds
    v_mfma_f32_16x16x32_bf16 v[92:95], v[216:219], a[136:139], v[92:95]
    v_mfma_f32_16x16x32_bf16 v[76:79], v[220:223], a[108:111], v[76:79]
    v_mfma_f32_16x16x32_bf16 v[84:87], v[220:223], a[124:127], v[84:87]
    v_mfma_f32_16x16x32_bf16 v[92:95], v[220:223], a[140:143], v[92:95]
    s_add_u32 s68, s68, 3072
    v_xor_b32 v244, 128, v240
    buffer_load_dwordx4 v244, s[12:15], s68 offen offset:2048 nt lds
    s_waitcnt lgkmcnt(4)
    v_mfma_f32_16x16x32_bf16 v[96:99], v[192:195], a[96:99], 0
    v_max3_f32 v232, v232, v72, v73
    v_max3_f32 v233, v233, v80, v81
    v_mfma_f32_16x16x32_bf16 v[104:107], v[192:195], a[112:115], 0
    ds_read_b128 v[212:215], v225 offset:4096
    v_max3_f32 v234, v234, v88, v89
    v_mfma_f32_16x16x32_bf16 v[112:115], v[192:195], a[128:131], 0
    v_max3_f32 v232, v232, v74, v75
    s_add_u32 s68, s68, 3072
    v_xor_b32 v244, 192, v240
    buffer_load_dwordx4 v244, s[12:15], s68 offen offset:3072 nt lds
    v_max3_f32 v233, v233, v82, v83
    s_waitcnt lgkmcnt(4)
    v_mfma_f32_16x16x32_bf16 v[96:99], v[196:199], a[100:103], v[96:99]
    v_max3_f32 v234, v234, v90, v91
    v_max3_f32 v232, v232, v76, v77
    v_mfma_f32_16x16x32_bf16 v[104:107], v[196:199], a[116:119], v[104:107]
    ds_read_b128 v[216:219], v226 offset:4096
    v_max3_f32 v233, v233, v84, v85
    v_mfma_f32_16x16x32_bf16 v[112:115], v[196:199], a[132:135], v[112:115]
    v_max3_f32 v234, v234, v92, v93
    v_max3_f32 v232, v232, v78, v79
    s_waitcnt lgkmcnt(4)
    v_mfma_f32_16x16x32_bf16 v[96:99], v[200:203], a[104:107], v[96:99]
    v_max3_f32 v233, v233, v86, v87
    v_max3_f32 v234, v234, v94, v95
    v_mfma_f32_16x16x32_bf16 v[104:107], v[200:203], a[120:123], v[104:107]
    ds_read_b128 v[220:223], v227 offset:4096
    v_mfma_f32_16x16x32_bf16 v[112:115], v[200:203], a[136:139], v[112:115]
    s_waitcnt lgkmcnt(4)
    v_mfma_f32_16x16x32_bf16 v[96:99], v[204:207], a[108:111], v[96:99]
    v_add_u32 v224, 81920, v246
    v_xor_b32 v225, 64, v224
    v_mfma_f32_16x16x32_bf16 v[104:107], v[204:207], a[124:127], v[104:107]
    v_xor_b32 v226, 128, v224
    v_xor_b32 v227, 192, v224
    v_mfma_f32_16x16x32_bf16 v[112:115], v[204:207], a[140:143], v[112:115]
    s_waitcnt lgkmcnt(3)
    v_mfma_f32_16x16x32_bf16 v[100:103], v[208:211], a[96:99], 0
    v_mfma_f32_16x16x32_bf16 v[108:111], v[208:211], a[112:115], 0
    v_mfma_f32_16x16x32_bf16 v[116:119], v[208:211], a[128:131], 0
    s_waitcnt vmcnt(8) lgkmcnt(0)
    s_barrier
    v_mfma_f32_16x16x32_bf16 v[100:103], v[212:215], a[100:103], v[100:103]
    ds_read_b128 v[192:195], v224 offset:0
    ds_read_b128 v[196:199], v225 offset:0
    s_add_u32 m0, s59, 16384
    s_add_u32 s68, s46, 0
    buffer_load_dwordx4 v241, s[16:19], s68 offen offset:0 nt lds
    v_mfma_f32_16x16x32_bf16 v[108:111], v[212:215], a[116:119], v[108:111]
    ds_read_b128 v[200:203], v226 offset:0
    ds_read_b128 v[204:207], v227 offset:0
    v_mfma_f32_16x16x32_bf16 v[116:119], v[212:215], a[132:135], v[116:119]
    ds_read_b128 v[208:211], v224 offset:4096
    v_mfma_f32_16x16x32_bf16 v[100:103], v[216:219], a[104:107], v[100:103]
    v_mfma_f32_16x16x32_bf16 v[108:111], v[216:219], a[120:123], v[108:111]
    s_add_u32 s68, s68, 3072
    v_xor_b32 v244, 128, v241
    buffer_load_dwordx4 v244, s[16:19], s68 offen offset:1024 nt lds
    v_mfma_f32_16x16x32_bf16 v[116:119], v[216:219], a[136:139], v[116:119]
    v_mfma_f32_16x16x32_bf16 v[100:103], v[220:223], a[108:111], v[100:103]
    v_mfma_f32_16x16x32_bf16 v[108:111], v[220:223], a[124:127], v[108:111]
    v_mfma_f32_16x16x32_bf16 v[116:119], v[220:223], a[140:143], v[116:119]
    s_add_u32 s68, s68, 3072
    buffer_load_dwordx4 v241, s[16:19], s68 offen offset:2048 nt lds
    s_waitcnt lgkmcnt(4)
    v_mfma_f32_16x16x32_bf16 v[120:123], v[192:195], a[96:99], 0
    v_max3_f32 v232, v232, v96, v97
    v_max3_f32 v233, v233, v104, v105
    v_mfma_f32_16x16x32_bf16 v[128:131], v[192:195], a[112:115], 0
    ds_read_b128 v[212:215], v225 offset:4096
    v_max3_f32 v234, v234, v112, v113
    v_mfma_f32_16x16x32_bf16 v[136:139], v[192:195], a[128:131], 0
    v_max3_f32 v232, v232, v98, v99
    s_add_u32 s68, s68, 3072
    buffer_load_dwordx4 v244, s[16:19], s68 offen offset:3072 nt lds
    v_max3_f32 v233, v233, v106, v107
    s_waitcnt lgkmcnt(4)
    v_mfma_f32_16x16x32_bf16 v[120:123], v[196:199], a[100:103], v[120:123]
    v_max3_f32 v234, v234, v114, v115
    v_max3_f32 v232, v232, v100, v101
    v_mfma_f32_16x16x32_bf16 v[128:131], v[196:199], a[116:119], v[128:131]
    ds_read_b128 v[216:219], v226 offset:4096
    v_max3_f32 v233, v233, v108, v109
    v_mfma_f32_16x16x32_bf16 v[136:139], v[196:199], a[132:135], v[136:139]
    v_max3_f32 v234, v234, v116, v117
    v_max3_f32 v232, v232, v102, v103
    s_waitcnt lgkmcnt(4)
    v_mfma_f32_16x16x32_bf16 v[120:123], v[200:203], a[104:107], v[120:123]
    v_max3_f32 v233, v233, v110, v111
    v_max3_f32 v234, v234, v118, v119
    v_mfma_f32_16x16x32_bf16 v[128:131], v[200:203], a[120:123], v[128:131]
    ds_read_b128 v[220:223], v227 offset:4096
    v_mfma_f32_16x16x32_bf16 v[136:139], v[200:203], a[136:139], v[136:139]
    s_waitcnt lgkmcnt(4)
    v_mfma_f32_16x16x32_bf16 v[120:123], v[204:207], a[108:111], v[120:123]
    v_add_u32 v224, 98304, v246
    v_xor_b32 v225, 64, v224
    v_mfma_f32_16x16x32_bf16 v[128:131], v[204:207], a[124:127], v[128:131]
    v_xor_b32 v226, 128, v224
    v_xor_b32 v227, 192, v224
    v_mfma_f32_16x16x32_bf16 v[136:139], v[204:207], a[140:143], v[136:139]
    s_waitcnt lgkmcnt(3)
    v_mfma_f32_16x16x32_bf16 v[124:127], v[208:211], a[96:99], 0
    v_mfma_f32_16x16x32_bf16 v[132:135], v[208:211], a[112:115], 0
    v_mfma_f32_16x16x32_bf16 v[140:143], v[208:211], a[128:131], 0
    s_waitcnt vmcnt(8) lgkmcnt(0)
    s_barrier
    v_mfma_f32_16x16x32_bf16 v[124:127], v[212:215], a[100:103], v[124:127]
    ds_read_b128 v[192:195], v224 offset:0
    ds_read_b128 v[196:199], v225 offset:0
    s_add_u32 m0, s59, 32768
    s_add_u32 s68, s46, 16384
    buffer_load_dwordx4 v241, s[16:19], s68 offen offset:0 nt lds
    v_mfma_f32_16x16x32_bf16 v[132:135], v[212:215], a[116:119], v[132:135]
    ds_read_b128 v[200:203], v226 offset:0
    ds_read_b128 v[204:207], v227 offset:0
    v_mfma_f32_16x16x32_bf16 v[140:143], v[212:215], a[132:135], v[140:143]
    ds_read_b128 v[208:211], v224 offset:4096
    v_mfma_f32_16x16x32_bf16 v[124:127], v[216:219], a[104:107], v[124:127]
    v_mfma_f32_16x16x32_bf16 v[132:135], v[216:219], a[120:123], v[132:135]
    s_add_u32 s68, s68, 3072
    v_xor_b32 v244, 128, v241
    buffer_load_dwordx4 v244, s[16:19], s68 offen offset:1024 nt lds
    v_mfma_f32_16x16x32_bf16 v[140:143], v[216:219], a[136:139], v[140:143]
    v_mfma_f32_16x16x32_bf16 v[124:127], v[220:223], a[108:111], v[124:127]
    v_mfma_f32_16x16x32_bf16 v[132:135], v[220:223], a[124:127], v[132:135]
    v_mfma_f32_16x16x32_bf16 v[140:143], v[220:223], a[140:143], v[140:143]
    s_add_u32 s68, s68, 3072
    buffer_load_dwordx4 v241, s[16:19], s68 offen offset:2048 nt lds
    s_waitcnt lgkmcnt(4)
    v_mfma_f32_16x16x32_bf16 v[144:147], v[192:195], a[96:99], 0
    v_max3_f32 v232, v232, v120, v121
    v_max3_f32 v233, v233, v128, v129
    v_mfma_f32_16x16x32_bf16 v[152:155], v[192:195], a[112:115], 0
    ds_read_b128 v[212:215], v225 offset:4096
    v_max3_f32 v234, v234, v136, v137
    v_mfma_f32_16x16x32_bf16 v[160:163], v[192:195], a[128:131], 0
    v_max3_f32 v232, v232, v122, v123
    s_add_u32 s68, s68, 3072
    buffer_load_dwordx4 v244, s[16:19], s68 offen offset:3072 nt lds
    v_max3_f32 v233, v233, v130, v131
    s_waitcnt lgkmcnt(4)
    v_mfma_f32_16x16x32_bf16 v[144:147], v[196:199], a[100:103], v[144:147]
    v_max3_f32 v234, v234, v138, v139
    v_max3_f32 v232, v232, v124, v125
    v_mfma_f32_16x16x32_bf16 v[152:155], v[196:199], a[116:119], v[152:155]
    ds_read_b128 v[216:219], v226 offset:4096
    v_max3_f32 v233, v233, v132, v133
    v_mfma_f32_16x16x32_bf16 v[160:163], v[196:199], a[132:135], v[160:163]
    v_max3_f32 v234, v234, v140, v141
    v_max3_f32 v232, v232, v126, v127
    s_waitcnt lgkmcnt(4)
    v_mfma_f32_16x16x32_bf16 v[144:147], v[200:203], a[104:107], v[144:147]
    v_max3_f32 v233, v233, v134, v135
    v_max3_f32 v234, v234, v142, v143
    v_mfma_f32_16x16x32_bf16 v[152:155], v[200:203], a[120:123], v[152:155]
    ds_read_b128 v[220:223], v227 offset:4096
    v_mfma_f32_16x16x32_bf16 v[160:163], v[200:203], a[136:139], v[160:163]
    s_waitcnt lgkmcnt(4)
    v_mfma_f32_16x16x32_bf16 v[144:147], v[204:207], a[108:111], v[144:147]
    v_add_u32 v224, 0, v246
    v_xor_b32 v225, 64, v224
    v_mfma_f32_16x16x32_bf16 v[152:155], v[204:207], a[124:127], v[152:155]
    v_xor_b32 v226, 128, v224
    v_xor_b32 v227, 192, v224
    v_mfma_f32_16x16x32_bf16 v[160:163], v[204:207], a[140:143], v[160:163]
    s_waitcnt lgkmcnt(3)
    v_mfma_f32_16x16x32_bf16 v[148:151], v[208:211], a[96:99], 0
    v_mfma_f32_16x16x32_bf16 v[156:159], v[208:211], a[112:115], 0
    v_mfma_f32_16x16x32_bf16 v[164:167], v[208:211], a[128:131], 0
    s_waitcnt vmcnt(8) lgkmcnt(0)
    s_barrier
    v_mfma_f32_16x16x32_bf16 v[148:151], v[212:215], a[100:103], v[148:151]
    ds_read_b128 v[192:195], v224 offset:0
    ds_read_b128 v[196:199], v225 offset:0
    s_add_u32 m0, s59, 49152
    s_add_u32 s68, s46, 32768
    buffer_load_dwordx4 v241, s[16:19], s68 offen offset:0 nt lds
    v_mfma_f32_16x16x32_bf16 v[156:159], v[212:215], a[116:119], v[156:159]
    ds_read_b128 v[200:203], v226 offset:0
    ds_read_b128 v[204:207], v227 offset:0
    v_mfma_f32_16x16x32_bf16 v[164:167], v[212:215], a[132:135], v[164:167]
    ds_read_b128 v[208:211], v224 offset:4096
    v_mfma_f32_16x16x32_bf16 v[148:151], v[216:219], a[104:107], v[148:151]
    v_mfma_f32_16x16x32_bf16 v[156:159], v[216:219], a[120:123], v[156:159]
    s_add_u32 s68, s68, 3072
    v_xor_b32 v244, 128, v241
    buffer_load_dwordx4 v244, s[16:19], s68 offen offset:1024 nt lds
    v_mfma_f32_16x16x32_bf16 v[164:167], v[216:219], a[136:139], v[164:167]
    v_mfma_f32_16x16x32_bf16 v[148:151], v[220:223], a[108:111], v[148:151]
    v_mfma_f32_16x16x32_bf16 v[156:159], v[220:223], a[124:127], v[156:159]
    v_mfma_f32_16x16x32_bf16 v[164:167], v[220:223], a[140:143], v[164:167]
    s_add_u32 s68, s68, 3072
    buffer_load_dwordx4 v241, s[16:19], s68 offen offset:2048 nt lds
    s_waitcnt lgkmcnt(4)
    v_mfma_f32_16x16x32_bf16 v[168:171], v[192:195], a[96:99], 0
    v_max3_f32 v232, v232, v144, v145
    v_max3_f32 v233, v233, v152, v153
    v_mfma_f32_16x16x32_bf16 v[176:179], v[192:195], a[112:115], 0
    ds_read_b128 v[212:215], v225 offset:4096
    v_max3_f32 v234, v234, v160, v161
    v_mfma_f32_16x16x32_bf16 v[184:187], v[192:195], a[128:131], 0
    v_max3_f32 v232, v232, v146, v147
    s_add_u32 s68, s68, 3072
    buffer_load_dwordx4 v244, s[16:19], s68 offen offset:3072 nt lds
    v_max3_f32 v233, v233, v154, v155
    s_waitcnt lgkmcnt(4)
    v_mfma_f32_16x16x32_bf16 v[168:171], v[196:199], a[100:103], v[168:171]
    v_max3_f32 v234, v234, v162, v163
    v_max3_f32 v232, v232, v148, v149
    v_mfma_f32_16x16x32_bf16 v[176:179], v[196:199], a[116:119], v[176:179]
    ds_read_b128 v[216:219], v226 offset:4096
    v_max3_f32 v233, v233, v156, v157
    v_mfma_f32_16x16x32_bf16 v[184:187], v[196:199], a[132:135], v[184:187]
    v_max3_f32 v234, v234, v164, v165
    v_max3_f32 v232, v232, v150, v151
    s_waitcnt lgkmcnt(4)
    v_mfma_f32_16x16x32_bf16 v[168:171], v[200:203], a[104:107], v[168:171]
    v_max3_f32 v233, v233, v158, v159
    v_max3_f32 v234, v234, v166, v167
    v_mfma_f32_16x16x32_bf16 v[176:179], v[200:203], a[120:123], v[176:179]
    ds_read_b128 v[220:223], v227 offset:4096
    v_mfma_f32_16x16x32_bf16 v[184:187], v[200:203], a[136:139], v[184:187]
    s_waitcnt lgkmcnt(4)
    v_mfma_f32_16x16x32_bf16 v[168:171], v[204:207], a[108:111], v[168:171]
    v_mfma_f32_16x16x32_bf16 v[176:179], v[204:207], a[124:127], v[176:179]
    v_mfma_f32_16x16x32_bf16 v[184:187], v[204:207], a[140:143], v[184:187]
    s_waitcnt lgkmcnt(3)
    v_mfma_f32_16x16x32_bf16 v[172:175], v[208:211], a[96:99], 0
    v_mfma_f32_16x16x32_bf16 v[180:183], v[208:211], a[112:115], 0
    v_mfma_f32_16x16x32_bf16 v[188:191], v[208:211], a[128:131], 0
    s_waitcnt lgkmcnt(2)
    v_mfma_f32_16x16x32_bf16 v[172:175], v[212:215], a[100:103], v[172:175]
    v_mfma_f32_16x16x32_bf16 v[180:183], v[212:215], a[116:119], v[180:183]
    v_mfma_f32_16x16x32_bf16 v[188:191], v[212:215], a[132:135], v[188:191]
    s_waitcnt lgkmcnt(1)
    v_mfma_f32_16x16x32_bf16 v[172:175], v[216:219], a[104:107], v[172:175]
    v_mfma_f32_16x16x32_bf16 v[180:183], v[216:219], a[120:123], v[180:183]
    v_mfma_f32_16x16x32_bf16 v[188:191], v[216:219], a[136:139], v[188:191]
    s_waitcnt lgkmcnt(0)
    v_mfma_f32_16x16x32_bf16 v[172:175], v[220:223], a[108:111], v[172:175]
    v_mfma_f32_16x16x32_bf16 v[180:183], v[220:223], a[124:127], v[180:183]
    v_mfma_f32_16x16x32_bf16 v[188:191], v[220:223], a[140:143], v[188:191]
    buffer_load_dword a247, off, s[36:39], 0 offset:4 sc1
    v_max3_f32 v232, v232, v168, v169
    s_add_u32 m0, s59, 147456
    s_add_u32 s69, s53, 0
    s_and_b32 s69, s69, 7
    s_lshl_b32 s68, s69, 19
    s_add_u32 s68, s68, s54
    s_add_u32 s68, s68, 256
    buffer_load_dwordx4 v242, s[20:23], s68 offen offset:0  lds
    v_max3_f32 v233, v233, v176, v177
    v_max3_f32 v234, v234, v184, v185
    v_max3_f32 v232, v232, v170, v171
    v_max3_f32 v233, v233, v178, v179
    v_max3_f32 v234, v234, v186, v187
    v_max3_f32 v232, v232, v172, v173
    v_max3_f32 v233, v233, v180, v181
    v_max3_f32 v234, v234, v188, v189
    v_max3_f32 v232, v232, v174, v175
    v_max3_f32 v233, v233, v182, v183
    v_max3_f32 v234, v234, v190, v191
    v_mov_b32 v228, v232
    v_mov_b32 v229, v233
    v_mov_b32 v230, v234
    v_permlane32_swap_b32 v228, v232
    v_permlane32_swap_b32 v229, v233
    v_permlane32_swap_b32 v230, v234
    v_max_f32 v232, v228, v232
    v_max_f32 v233, v229, v233
    v_max_f32 v234, v230, v234
    v_mov_b32 v228, v232
    v_mov_b32 v229, v233
    v_mov_b32 v230, v234
    v_permlane16_swap_b32 v228, v232
    v_permlane16_swap_b32 v229, v233
    v_permlane16_swap_b32 v230, v234
    v_max_f32 v232, v228, v232
    v_max_f32 v233, v229, v233
    v_max_f32 v234, v230, v234
    v_mul_f32 v232, s52, v232
    v_mul_f32 v233, s52, v233
    v_mul_f32 v234, s52, v234
    v_mov_b32 v230, v233
    v_pk_fma_f32 v[0:1], v[0:1], s[52:53], v[232:233] op_sel_hi:[1,0,0] neg_lo:[0,0,1] neg_hi:[0,0,1]
    v_pk_fma_f32 v[2:3], v[2:3], s[52:53], v[232:233] op_sel_hi:[1,0,0] neg_lo:[0,0,1] neg_hi:[0,0,1]
    v_pk_fma_f32 v[4:5], v[4:5], s[52:53], v[232:233] op_sel_hi:[1,0,0] neg_lo:[0,0,1] neg_hi:[0,0,1]
    v_pk_fma_f32 v[6:7], v[6:7], s[52:53], v[232:233] op_sel_hi:[1,0,0] neg_lo:[0,0,1] neg_hi:[0,0,1]
    v_exp_f32 v0, v0
    v_exp_f32 v1, v1
    v_exp_f32 v2, v2
    v_exp_f32 v3, v3
    v_exp_f32 v4, v4
    v_exp_f32 v5, v5
    v_exp_f32 v6, v6
    s_add_u32 s68, s68, 31744
    buffer_load_dwordx4 v242, s[20:23], s68 offen offset:1024  lds
    v_exp_f32 v7, v7
    v_pk_add_f32 v[250:251], v[0:1], v[2:3]
    v_pk_add_f32 v[250:251], v[250:251], v[4:5]
    v_pk_add_f32 v[250:251], v[250:251], v[6:7]
    v_cvt_pk_bf16_f32 v0, v0, v1
    v_cvt_pk_bf16_f32 v1, v2, v3
    v_cvt_pk_bf16_f32 v2, v4, v5
    v_cvt_pk_bf16_f32 v3, v6, v7
    v_pk_fma_f32 v[8:9], v[8:9], s[52:53], v[230:231] op_sel_hi:[1,0,0] neg_lo:[0,0,1] neg_hi:[0,0,1]
    v_pk_fma_f32 v[10:11], v[10:11], s[52:53], v[230:231] op_sel_hi:[1,0,0] neg_lo:[0,0,1] neg_hi:[0,0,1]
    v_pk_fma_f32 v[12:13], v[12:13], s[52:53], v[230:231] op_sel_hi:[1,0,0] neg_lo:[0,0,1] neg_hi:[0,0,1]
    v_pk_fma_f32 v[14:15], v[14:15], s[52:53], v[230:231] op_sel_hi:[1,0,0] neg_lo:[0,0,1] neg_hi:[0,0,1]
    v_exp_f32 v8, v8
    v_exp_f32 v9, v9
    v_exp_f32 v10, v10
    v_exp_f32 v11, v11
    v_exp_f32 v12, v12
    v_exp_f32 v13, v13
    v_exp_f32 v14, v14
    v_exp_f32 v15, v15
    v_pk_add_f32 v[252:253], v[8:9], v[10:11]
    v_pk_add_f32 v[252:253], v[252:253], v[12:13]
    v_pk_add_f32 v[252:253], v[252:253], v[14:15]
    v_cvt_pk_bf16_f32 v4, v8, v9
    v_cvt_pk_bf16_f32 v5, v10, v11
    v_cvt_pk_bf16_f32 v6, v12, v13
    v_cvt_pk_bf16_f32 v7, v14, v15
    v_pk_fma_f32 v[16:17], v[16:17], s[52:53], v[234:235] op_sel_hi:[1,0,0] neg_lo:[0,0,1] neg_hi:[0,0,1]
    v_pk_fma_f32 v[18:19], v[18:19], s[52:53], v[234:235] op_sel_hi:[1,0,0] neg_lo:[0,0,1] neg_hi:[0,0,1]
    v_pk_fma_f32 v[20:21], v[20:21], s[52:53], v[234:235] op_sel_hi:[1,0,0] neg_lo:[0,0,1] neg_hi:[0,0,1]
    v_pk_fma_f32 v[22:23], v[22:23], s[52:53], v[234:235] op_sel_hi:[1,0,0] neg_lo:[0,0,1] neg_hi:[0,0,1]
    v_exp_f32 v16, v16
    v_exp_f32 v17, v17
    v_exp_f32 v18, v18
    v_exp_f32 v19, v19
    v_exp_f32 v20, v20
    s_add_u32 s68, s68, 31744
    v_xor_b32 v244, 128, v242
    buffer_load_dwordx4 v244, s[20:23], s68 offen offset:2048  lds
    v_exp_f32 v21, v21
    v_exp_f32 v22, v22
    v_exp_f32 v23, v23
    v_pk_add_f32 v[238:239], v[16:17], v[18:19]
    v_pk_add_f32 v[238:239], v[238:239], v[20:21]
    v_pk_add_f32 v[238:239], v[238:239], v[22:23]
    v_cvt_pk_bf16_f32 v8, v16, v17
    v_cvt_pk_bf16_f32 v9, v18, v19
    v_cvt_pk_bf16_f32 v10, v20, v21
    v_cvt_pk_bf16_f32 v11, v22, v23
    v_pk_fma_f32 v[24:25], v[24:25], s[52:53], v[232:233] op_sel_hi:[1,0,0] neg_lo:[0,0,1] neg_hi:[0,0,1]
    v_pk_fma_f32 v[26:27], v[26:27], s[52:53], v[232:233] op_sel_hi:[1,0,0] neg_lo:[0,0,1] neg_hi:[0,0,1]
    v_pk_fma_f32 v[28:29], v[28:29], s[52:53], v[232:233] op_sel_hi:[1,0,0] neg_lo:[0,0,1] neg_hi:[0,0,1]
    v_pk_fma_f32 v[30:31], v[30:31], s[52:53], v[232:233] op_sel_hi:[1,0,0] neg_lo:[0,0,1] neg_hi:[0,0,1]
    v_exp_f32 v24, v24
    v_exp_f32 v25, v25
    v_exp_f32 v26, v26
    v_exp_f32 v27, v27
    v_exp_f32 v28, v28
    v_exp_f32 v29, v29
    v_exp_f32 v30, v30
    v_exp_f32 v31, v31
    v_pk_add_f32 v[250:251], v[250:251], v[24:25]
    v_pk_add_f32 v[250:251], v[250:251], v[26:27]
    v_pk_add_f32 v[250:251], v[250:251], v[28:29]
    v_pk_add_f32 v[250:251], v[250:251], v[30:31]
    v_cvt_pk_bf16_f32 v12, v24, v25
    v_cvt_pk_bf16_f32 v13, v26, v27
    v_cvt_pk_bf16_f32 v14, v28, v29
    v_cvt_pk_bf16_f32 v15, v30, v31
    v_pk_fma_f32 v[32:33], v[32:33], s[52:53], v[230:231] op_sel_hi:[1,0,0] neg_lo:[0,0,1] neg_hi:[0,0,1]
    v_pk_fma_f32 v[34:35], v[34:35], s[52:53], v[230:231] op_sel_hi:[1,0,0] neg_lo:[0,0,1] neg_hi:[0,0,1]
    v_pk_fma_f32 v[36:37], v[36:37], s[52:53], v[230:231] op_sel_hi:[1,0,0] neg_lo:[0,0,1] neg_hi:[0,0,1]
    v_pk_fma_f32 v[38:39], v[38:39], s[52:53], v[230:231] op_sel_hi:[1,0,0] neg_lo:[0,0,1] neg_hi:[0,0,1]
    v_exp_f32 v32, v32
    v_exp_f32 v33, v33
    v_exp_f32 v34, v34
    s_add_u32 s68, s68, 31744
    buffer_load_dwordx4 v244, s[20:23], s68 offen offset:3072  lds
    v_exp_f32 v35, v35
    v_exp_f32 v36, v36
    v_exp_f32 v37, v37
    v_exp_f32 v38, v38
    v_exp_f32 v39, v39
    v_pk_add_f32 v[252:253], v[252:253], v[32:33]
    v_pk_add_f32 v[252:253], v[252:253], v[34:35]
    v_pk_add_f32 v[252:253], v[252:253], v[36:37]
    v_pk_add_f32 v[252:253], v[252:253], v[38:39]
    v_cvt_pk_bf16_f32 v16, v32, v33
    v_cvt_pk_bf16_f32 v17, v34, v35
    v_cvt_pk_bf16_f32 v18, v36, v37
    v_cvt_pk_bf16_f32 v19, v38, v39
    v_pk_fma_f32 v[40:41], v[40:41], s[52:53], v[234:235] op_sel_hi:[1,0,0] neg_lo:[0,0,1] neg_hi:[0,0,1]
    v_pk_fma_f32 v[42:43], v[42:43], s[52:53], v[234:235] op_sel_hi:[1,0,0] neg_lo:[0,0,1] neg_hi:[0,0,1]
    v_pk_fma_f32 v[44:45], v[44:45], s[52:53], v[234:235] op_sel_hi:[1,0,0] neg_lo:[0,0,1] neg_hi:[0,0,1]
    v_pk_fma_f32 v[46:47], v[46:47], s[52:53], v[234:235] op_sel_hi:[1,0,0] neg_lo:[0,0,1] neg_hi:[0,0,1]
    v_exp_f32 v40, v40
    v_exp_f32 v41, v41
    v_exp_f32 v42, v42
    v_exp_f32 v43, v43
    v_exp_f32 v44, v44
    v_exp_f32 v45, v45
    v_exp_f32 v46, v46
    v_exp_f32 v47, v47
    v_pk_add_f32 v[238:239], v[238:239], v[40:41]
    v_pk_add_f32 v[238:239], v[238:239], v[42:43]
    v_pk_add_f32 v[238:239], v[238:239], v[44:45]
    v_pk_add_f32 v[238:239], v[238:239], v[46:47]
    v_cvt_pk_bf16_f32 v20, v40, v41
    v_cvt_pk_bf16_f32 v21, v42, v43
    v_cvt_pk_bf16_f32 v22, v44, v45
    v_cvt_pk_bf16_f32 v23, v46, v47
    v_pk_fma_f32 v[48:49], v[48:49], s[52:53], v[232:233] op_sel_hi:[1,0,0] neg_lo:[0,0,1] neg_hi:[0,0,1]
    v_pk_fma_f32 v[50:51], v[50:51], s[52:53], v[232:233] op_sel_hi:[1,0,0] neg_lo:[0,0,1] neg_hi:[0,0,1]
    v_pk_fma_f32 v[52:53], v[52:53], s[52:53], v[232:233] op_sel_hi:[1,0,0] neg_lo:[0,0,1] neg_hi:[0,0,1]
    v_pk_fma_f32 v[54:55], v[54:55], s[52:53], v[232:233] op_sel_hi:[1,0,0] neg_lo:[0,0,1] neg_hi:[0,0,1]
    s_add_u32 m0, s59, 65536
    s_add_u32 s68, s46, 49152
    buffer_load_dwordx4 v241, s[16:19], s68 offen offset:0 nt lds
    v_exp_f32 v48, v48
    v_exp_f32 v49, v49
    v_exp_f32 v50, v50
    v_exp_f32 v51, v51
    v_exp_f32 v52, v52
    v_exp_f32 v53, v53
    v_exp_f32 v54, v54
    v_exp_f32 v55, v55
    v_pk_add_f32 v[250:251], v[250:251], v[48:49]
    v_pk_add_f32 v[250:251], v[250:251], v[50:51]
    v_pk_add_f32 v[250:251], v[250:251], v[52:53]
    v_pk_add_f32 v[250:251], v[250:251], v[54:55]
    v_cvt_pk_bf16_f32 v24, v48, v49
    v_cvt_pk_bf16_f32 v25, v50, v51
    v_cvt_pk_bf16_f32 v26, v52, v53
    v_cvt_pk_bf16_f32 v27, v54, v55
    v_pk_fma_f32 v[56:57], v[56:57], s[52:53], v[230:231] op_sel_hi:[1,0,0] neg_lo:[0,0,1] neg_hi:[0,0,1]
    v_pk_fma_f32 v[58:59], v[58:59], s[52:53], v[230:231] op_sel_hi:[1,0,0] neg_lo:[0,0,1] neg_hi:[0,0,1]
    v_pk_fma_f32 v[60:61], v[60:61], s[52:53], v[230:231] op_sel_hi:[1,0,0] neg_lo:[0,0,1] neg_hi:[0,0,1]
    v_pk_fma_f32 v[62:63], v[62:63], s[52:53], v[230:231] op_sel_hi:[1,0,0] neg_lo:[0,0,1] neg_hi:[0,0,1]
    v_exp_f32 v56, v56
    v_exp_f32 v57, v57
    v_exp_f32 v58, v58
    v_exp_f32 v59, v59
    v_exp_f32 v60, v60
    v_exp_f32 v61, v61
    v_exp_f32 v62, v62
    v_exp_f32 v63, v63
    v_pk_add_f32 v[252:253], v[252:253], v[56:57]
    v_pk_add_f32 v[252:253], v[252:253], v[58:59]
    v_pk_add_f32 v[252:253], v[252:253], v[60:61]
    v_pk_add_f32 v[252:253], v[252:253], v[62:63]
    v_cvt_pk_bf16_f32 v28, v56, v57
    v_cvt_pk_bf16_f32 v29, v58, v59
    s_add_u32 s68, s68, 3072
    v_xor_b32 v244, 128, v241
    buffer_load_dwordx4 v244, s[16:19], s68 offen offset:1024 nt lds
    v_cvt_pk_bf16_f32 v30, v60, v61
    v_cvt_pk_bf16_f32 v31, v62, v63
    v_pk_fma_f32 v[64:65], v[64:65], s[52:53], v[234:235] op_sel_hi:[1,0,0] neg_lo:[0,0,1] neg_hi:[0,0,1]
    v_pk_fma_f32 v[66:67], v[66:67], s[52:53], v[234:235] op_sel_hi:[1,0,0] neg_lo:[0,0,1] neg_hi:[0,0,1]
    v_pk_fma_f32 v[68:69], v[68:69], s[52:53], v[234:235] op_sel_hi:[1,0,0] neg_lo:[0,0,1] neg_hi:[0,0,1]
    v_pk_fma_f32 v[70:71], v[70:71], s[52:53], v[234:235] op_sel_hi:[1,0,0] neg_lo:[0,0,1] neg_hi:[0,0,1]
    v_exp_f32 v64, v64
    v_exp_f32 v65, v65
    v_exp_f32 v66, v66
    v_exp_f32 v67, v67
    v_exp_f32 v68, v68
    v_exp_f32 v69, v69
    v_exp_f32 v70, v70
    v_exp_f32 v71, v71
    v_pk_add_f32 v[238:239], v[238:239], v[64:65]
    v_pk_add_f32 v[238:239], v[238:239], v[66:67]
    v_pk_add_f32 v[238:239], v[238:239], v[68:69]
    v_pk_add_f32 v[238:239], v[238:239], v[70:71]
    v_cvt_pk_bf16_f32 v32, v64, v65
    v_cvt_pk_bf16_f32 v33, v66, v67
    v_cvt_pk_bf16_f32 v34, v68, v69
    v_cvt_pk_bf16_f32 v35, v70, v71
    v_pk_fma_f32 v[72:73], v[72:73], s[52:53], v[232:233] op_sel_hi:[1,0,0] neg_lo:[0,0,1] neg_hi:[0,0,1]
    v_pk_fma_f32 v[74:75], v[74:75], s[52:53], v[232:233] op_sel_hi:[1,0,0] neg_lo:[0,0,1] neg_hi:[0,0,1]
    v_pk_fma_f32 v[76:77], v[76:77], s[52:53], v[232:233] op_sel_hi:[1,0,0] neg_lo:[0,0,1] neg_hi:[0,0,1]
    v_pk_fma_f32 v[78:79], v[78:79], s[52:53], v[232:233] op_sel_hi:[1,0,0] neg_lo:[0,0,1] neg_hi:[0,0,1]
    v_exp_f32 v72, v72
    v_exp_f32 v73, v73
    v_exp_f32 v74, v74
    v_exp_f32 v75, v75
    v_exp_f32 v76, v76
    v_exp_f32 v77, v77
    v_exp_f32 v78, v78
    v_exp_f32 v79, v79
    s_add_u32 s68, s68, 3072
    buffer_load_dwordx4 v241, s[16:19], s68 offen offset:2048 nt lds
    v_pk_add_f32 v[250:251], v[250:251], v[72:73]
    v_pk_add_f32 v[250:251], v[250:251], v[74:75]
    v_pk_add_f32 v[250:251], v[250:251], v[76:77]
    v_pk_add_f32 v[250:251], v[250:251], v[78:79]
    v_cvt_pk_bf16_f32 v36, v72, v73
    v_cvt_pk_bf16_f32 v37, v74, v75
    v_cvt_pk_bf16_f32 v38, v76, v77
    v_cvt_pk_bf16_f32 v39, v78, v79
    v_pk_fma_f32 v[80:81], v[80:81], s[52:53], v[230:231] op_sel_hi:[1,0,0] neg_lo:[0,0,1] neg_hi:[0,0,1]
    v_pk_fma_f32 v[82:83], v[82:83], s[52:53], v[230:231] op_sel_hi:[1,0,0] neg_lo:[0,0,1] neg_hi:[0,0,1]
    v_pk_fma_f32 v[84:85], v[84:85], s[52:53], v[230:231] op_sel_hi:[1,0,0] neg_lo:[0,0,1] neg_hi:[0,0,1]
    v_pk_fma_f32 v[86:87], v[86:87], s[52:53], v[230:231] op_sel_hi:[1,0,0] neg_lo:[0,0,1] neg_hi:[0,0,1]
    v_exp_f32 v80, v80
    v_exp_f32 v81, v81
    v_exp_f32 v82, v82
    v_exp_f32 v83, v83
    v_exp_f32 v84, v84
    v_exp_f32 v85, v85
    v_exp_f32 v86, v86
    v_exp_f32 v87, v87
    v_pk_add_f32 v[252:253], v[252:253], v[80:81]
    v_pk_add_f32 v[252:253], v[252:253], v[82:83]
    v_pk_add_f32 v[252:253], v[252:253], v[84:85]
    v_pk_add_f32 v[252:253], v[252:253], v[86:87]
    v_cvt_pk_bf16_f32 v40, v80, v81
    v_cvt_pk_bf16_f32 v41, v82, v83
    v_cvt_pk_bf16_f32 v42, v84, v85
    v_cvt_pk_bf16_f32 v43, v86, v87
    v_pk_fma_f32 v[88:89], v[88:89], s[52:53], v[234:235] op_sel_hi:[1,0,0] neg_lo:[0,0,1] neg_hi:[0,0,1]
    v_pk_fma_f32 v[90:91], v[90:91], s[52:53], v[234:235] op_sel_hi:[1,0,0] neg_lo:[0,0,1] neg_hi:[0,0,1]
    v_pk_fma_f32 v[92:93], v[92:93], s[52:53], v[234:235] op_sel_hi:[1,0,0] neg_lo:[0,0,1] neg_hi:[0,0,1]
    v_pk_fma_f32 v[94:95], v[94:95], s[52:53], v[234:235] op_sel_hi:[1,0,0] neg_lo:[0,0,1] neg_hi:[0,0,1]
    v_exp_f32 v88, v88
    v_exp_f32 v89, v89
    v_exp_f32 v90, v90
    v_exp_f32 v91, v91
    v_exp_f32 v92, v92
    s_add_u32 s68, s68, 3072
    buffer_load_dwordx4 v244, s[16:19], s68 offen offset:3072 nt lds
    v_exp_f32 v93, v93
    v_exp_f32 v94, v94
    v_exp_f32 v95, v95
    v_pk_add_f32 v[238:239], v[238:239], v[88:89]
    v_pk_add_f32 v[238:239], v[238:239], v[90:91]
    v_pk_add_f32 v[238:239], v[238:239], v[92:93]
    v_pk_add_f32 v[238:239], v[238:239], v[94:95]
    v_cvt_pk_bf16_f32 v44, v88, v89
    v_cvt_pk_bf16_f32 v45, v90, v91
    v_cvt_pk_bf16_f32 v46, v92, v93
    v_cvt_pk_bf16_f32 v47, v94, v95
    v_pk_fma_f32 v[96:97], v[96:97], s[52:53], v[232:233] op_sel_hi:[1,0,0] neg_lo:[0,0,1] neg_hi:[0,0,1]
    v_pk_fma_f32 v[98:99], v[98:99], s[52:53], v[232:233] op_sel_hi:[1,0,0] neg_lo:[0,0,1] neg_hi:[0,0,1]
    v_pk_fma_f32 v[100:101], v[100:101], s[52:53], v[232:233] op_sel_hi:[1,0,0] neg_lo:[0,0,1] neg_hi:[0,0,1]
    v_pk_fma_f32 v[102:103], v[102:103], s[52:53], v[232:233] op_sel_hi:[1,0,0] neg_lo:[0,0,1] neg_hi:[0,0,1]
    v_exp_f32 v96, v96
    v_exp_f32 v97, v97
    v_exp_f32 v98, v98
    v_exp_f32 v99, v99
    v_exp_f32 v100, v100
    v_exp_f32 v101, v101
    v_exp_f32 v102, v102
    v_exp_f32 v103, v103
    v_pk_add_f32 v[250:251], v[250:251], v[96:97]
    v_pk_add_f32 v[250:251], v[250:251], v[98:99]
    v_pk_add_f32 v[250:251], v[250:251], v[100:101]
    v_pk_add_f32 v[250:251], v[250:251], v[102:103]
    v_cvt_pk_bf16_f32 v48, v96, v97
    v_cvt_pk_bf16_f32 v49, v98, v99
    v_cvt_pk_bf16_f32 v50, v100, v101
    v_cvt_pk_bf16_f32 v51, v102, v103
    v_pk_fma_f32 v[104:105], v[104:105], s[52:53], v[230:231] op_sel_hi:[1,0,0] neg_lo:[0,0,1] neg_hi:[0,0,1]
    v_pk_fma_f32 v[106:107], v[106:107], s[52:53], v[230:231] op_sel_hi:[1,0,0] neg_lo:[0,0,1] neg_hi:[0,0,1]
    v_pk_fma_f32 v[108:109], v[108:109], s[52:53], v[230:231] op_sel_hi:[1,0,0] neg_lo:[0,0,1] neg_hi:[0,0,1]
    v_pk_fma_f32 v[110:111], v[110:111], s[52:53], v[230:231] op_sel_hi:[1,0,0] neg_lo:[0,0,1] neg_hi:[0,0,1]
    v_exp_f32 v104, v104
    v_exp_f32 v105, v105
    s_add_u32 m0, s59, 131072
    s_add_u32 s69, s53, 1
    s_and_b32 s69, s69, 7
    s_lshl_b32 s68, s69, 19
    s_add_u32 s68, s68, s54
    s_add_u32 s68, s68, 256
    buffer_load_dwordx4 v242, s[20:23], s68 offen offset:0  lds
    v_exp_f32 v106, v106
    v_exp_f32 v107, v107
    v_exp_f32 v108, v108
    v_exp_f32 v109, v109
    v_exp_f32 v110, v110
    v_exp_f32 v111, v111
    v_pk_add_f32 v[252:253], v[252:253], v[104:105]
    v_pk_add_f32 v[252:253], v[252:253], v[106:107]
    v_pk_add_f32 v[252:253], v[252:253], v[108:109]
    v_pk_add_f32 v[252:253], v[252:253], v[110:111]
    v_cvt_pk_bf16_f32 v52, v104, v105
    v_cvt_pk_bf16_f32 v53, v106, v107
    v_cvt_pk_bf16_f32 v54, v108, v109
    v_cvt_pk_bf16_f32 v55, v110, v111
    v_pk_fma_f32 v[112:113], v[112:113], s[52:53], v[234:235] op_sel_hi:[1,0,0] neg_lo:[0,0,1] neg_hi:[0,0,1]
    v_pk_fma_f32 v[114:115], v[114:115], s[52:53], v[234:235] op_sel_hi:[1,0,0] neg_lo:[0,0,1] neg_hi:[0,0,1]
    v_pk_fma_f32 v[116:117], v[116:117], s[52:53], v[234:235] op_sel_hi:[1,0,0] neg_lo:[0,0,1] neg_hi:[0,0,1]
    v_pk_fma_f32 v[118:119], v[118:119], s[52:53], v[234:235] op_sel_hi:[1,0,0] neg_lo:[0,0,1] neg_hi:[0,0,1]
    v_exp_f32 v112, v112
    v_exp_f32 v113, v113
    v_exp_f32 v114, v114
    v_exp_f32 v115, v115
    v_exp_f32 v116, v116
    v_exp_f32 v117, v117
    v_exp_f32 v118, v118
    v_exp_f32 v119, v119
    v_pk_add_f32 v[238:239], v[238:239], v[112:113]
    v_pk_add_f32 v[238:239], v[238:239], v[114:115]
    v_pk_add_f32 v[238:239], v[238:239], v[116:117]
    v_pk_add_f32 v[238:239], v[238:239], v[118:119]
    v_cvt_pk_bf16_f32 v56, v112, v113
    v_cvt_pk_bf16_f32 v57, v114, v115
    v_cvt_pk_bf16_f32 v58, v116, v117
    v_cvt_pk_bf16_f32 v59, v118, v119
    v_pk_fma_f32 v[120:121], v[120:121], s[52:53], v[232:233] op_sel_hi:[1,0,0] neg_lo:[0,0,1] neg_hi:[0,0,1]
    v_pk_fma_f32 v[122:123], v[122:123], s[52:53], v[232:233] op_sel_hi:[1,0,0] neg_lo:[0,0,1] neg_hi:[0,0,1]
    s_add_u32 s68, s68, 31744
    buffer_load_dwordx4 v242, s[20:23], s68 offen offset:1024  lds
    v_pk_fma_f32 v[124:125], v[124:125], s[52:53], v[232:233] op_sel_hi:[1,0,0] neg_lo:[0,0,1] neg_hi:[0,0,1]
    v_pk_fma_f32 v[126:127], v[126:127], s[52:53], v[232:233] op_sel_hi:[1,0,0] neg_lo:[0,0,1] neg_hi:[0,0,1]
    v_exp_f32 v120, v120
    v_exp_f32 v121, v121
    v_exp_f32 v122, v122
    v_exp_f32 v123, v123
    v_exp_f32 v124, v124
    v_exp_f32 v125, v125
    v_exp_f32 v126, v126
    v_exp_f32 v127, v127
    v_pk_add_f32 v[250:251], v[250:251], v[120:121]
    v_pk_add_f32 v[250:251], v[250:251], v[122:123]
    v_pk_add_f32 v[250:251], v[250:251], v[124:125]
    v_pk_add_f32 v[250:251], v[250:251], v[126:127]
    v_cvt_pk_bf16_f32 v60, v120, v121
    v_cvt_pk_bf16_f32 v61, v122, v123
    v_cvt_pk_bf16_f32 v62, v124, v125
    v_cvt_pk_bf16_f32 v63, v126, v127
    v_pk_fma_f32 v[128:129], v[128:129], s[52:53], v[230:231] op_sel_hi:[1,0,0] neg_lo:[0,0,1] neg_hi:[0,0,1]
    v_pk_fma_f32 v[130:131], v[130:131], s[52:53], v[230:231] op_sel_hi:[1,0,0] neg_lo:[0,0,1] neg_hi:[0,0,1]
    v_pk_fma_f32 v[132:133], v[132:133], s[52:53], v[230:231] op_sel_hi:[1,0,0] neg_lo:[0,0,1] neg_hi:[0,0,1]
    v_pk_fma_f32 v[134:135], v[134:135], s[52:53], v[230:231] op_sel_hi:[1,0,0] neg_lo:[0,0,1] neg_hi:[0,0,1]
    v_exp_f32 v128, v128
    v_exp_f32 v129, v129
    v_exp_f32 v130, v130
    v_exp_f32 v131, v131
    v_exp_f32 v132, v132
    v_exp_f32 v133, v133
    v_exp_f32 v134, v134
    v_exp_f32 v135, v135
    v_pk_add_f32 v[252:253], v[252:253], v[128:129]
    v_pk_add_f32 v[252:253], v[252:253], v[130:131]
    v_pk_add_f32 v[252:253], v[252:253], v[132:133]
    v_pk_add_f32 v[252:253], v[252:253], v[134:135]
    s_add_u32 s68, s68, 31744
    v_xor_b32 v244, 128, v242
    buffer_load_dwordx4 v244, s[20:23], s68 offen offset:2048  lds
    v_cvt_pk_bf16_f32 v64, v128, v129
    v_cvt_pk_bf16_f32 v65, v130, v131
    v_cvt_pk_bf16_f32 v66, v132, v133
    v_cvt_pk_bf16_f32 v67, v134, v135
    v_pk_fma_f32 v[136:137], v[136:137], s[52:53], v[234:235] op_sel_hi:[1,0,0] neg_lo:[0,0,1] neg_hi:[0,0,1]
    v_pk_fma_f32 v[138:139], v[138:139], s[52:53], v[234:235] op_sel_hi:[1,0,0] neg_lo:[0,0,1] neg_hi:[0,0,1]
    v_pk_fma_f32 v[140:141], v[140:141], s[52:53], v[234:235] op_sel_hi:[1,0,0] neg_lo:[0,0,1] neg_hi:[0,0,1]
    v_pk_fma_f32 v[142:143], v[142:143], s[52:53], v[234:235] op_sel_hi:[1,0,0] neg_lo:[0,0,1] neg_hi:[0,0,1]
    v_exp_f32 v136, v136
    v_exp_f32 v137, v137
    v_exp_f32 v138, v138
    v_exp_f32 v139, v139
    v_exp_f32 v140, v140
    v_exp_f32 v141, v141
    v_exp_f32 v142, v142
    v_exp_f32 v143, v143
    v_pk_add_f32 v[238:239], v[238:239], v[136:137]
    v_pk_add_f32 v[238:239], v[238:239], v[138:139]
    v_pk_add_f32 v[238:239], v[238:239], v[140:141]
    v_pk_add_f32 v[238:239], v[238:239], v[142:143]
    v_cvt_pk_bf16_f32 v68, v136, v137
    v_cvt_pk_bf16_f32 v69, v138, v139
    v_cvt_pk_bf16_f32 v70, v140, v141
    v_cvt_pk_bf16_f32 v71, v142, v143
    v_pk_fma_f32 v[144:145], v[144:145], s[52:53], v[232:233] op_sel_hi:[1,0,0] neg_lo:[0,0,1] neg_hi:[0,0,1]
    v_pk_fma_f32 v[146:147], v[146:147], s[52:53], v[232:233] op_sel_hi:[1,0,0] neg_lo:[0,0,1] neg_hi:[0,0,1]
    v_pk_fma_f32 v[148:149], v[148:149], s[52:53], v[232:233] op_sel_hi:[1,0,0] neg_lo:[0,0,1] neg_hi:[0,0,1]
    v_pk_fma_f32 v[150:151], v[150:151], s[52:53], v[232:233] op_sel_hi:[1,0,0] neg_lo:[0,0,1] neg_hi:[0,0,1]
    v_exp_f32 v144, v144
    v_exp_f32 v145, v145
    v_exp_f32 v146, v146
    v_exp_f32 v147, v147
    v_exp_f32 v148, v148
    v_exp_f32 v149, v149
    v_exp_f32 v150, v150
    s_add_u32 s68, s68, 31744
    buffer_load_dwordx4 v244, s[20:23], s68 offen offset:3072  lds
    v_exp_f32 v151, v151
    v_pk_add_f32 v[250:251], v[250:251], v[144:145]
    v_pk_add_f32 v[250:251], v[250:251], v[146:147]
    v_pk_add_f32 v[250:251], v[250:251], v[148:149]
    v_pk_add_f32 v[250:251], v[250:251], v[150:151]
    v_cvt_pk_bf16_f32 v72, v144, v145
    v_cvt_pk_bf16_f32 v73, v146, v147
    v_cvt_pk_bf16_f32 v74, v148, v149
    v_cvt_pk_bf16_f32 v75, v150, v151
    v_pk_fma_f32 v[152:153], v[152:153], s[52:53], v[230:231] op_sel_hi:[1,0,0] neg_lo:[0,0,1] neg_hi:[0,0,1]
    v_pk_fma_f32 v[154:155], v[154:155], s[52:53], v[230:231] op_sel_hi:[1,0,0] neg_lo:[0,0,1] neg_hi:[0,0,1]
    v_pk_fma_f32 v[156:157], v[156:157], s[52:53], v[230:231] op_sel_hi:[1,0,0] neg_lo:[0,0,1] neg_hi:[0,0,1]
    v_pk_fma_f32 v[158:159], v[158:159], s[52:53], v[230:231] op_sel_hi:[1,0,0] neg_lo:[0,0,1] neg_hi:[0,0,1]
    v_exp_f32 v152, v152
    v_exp_f32 v153, v153
    v_exp_f32 v154, v154
    v_exp_f32 v155, v155
    v_exp_f32 v156, v156
    v_exp_f32 v157, v157
    v_exp_f32 v158, v158
    v_exp_f32 v159, v159
    v_pk_add_f32 v[252:253], v[252:253], v[152:153]
    v_pk_add_f32 v[252:253], v[252:253], v[154:155]
    v_pk_add_f32 v[252:253], v[252:253], v[156:157]
    v_pk_add_f32 v[252:253], v[252:253], v[158:159]
    v_cvt_pk_bf16_f32 v76, v152, v153
    v_cvt_pk_bf16_f32 v77, v154, v155
    v_cvt_pk_bf16_f32 v78, v156, v157
    v_cvt_pk_bf16_f32 v79, v158, v159
    v_pk_fma_f32 v[160:161], v[160:161], s[52:53], v[234:235] op_sel_hi:[1,0,0] neg_lo:[0,0,1] neg_hi:[0,0,1]
    v_pk_fma_f32 v[162:163], v[162:163], s[52:53], v[234:235] op_sel_hi:[1,0,0] neg_lo:[0,0,1] neg_hi:[0,0,1]
    v_pk_fma_f32 v[164:165], v[164:165], s[52:53], v[234:235] op_sel_hi:[1,0,0] neg_lo:[0,0,1] neg_hi:[0,0,1]
    v_pk_fma_f32 v[166:167], v[166:167], s[52:53], v[234:235] op_sel_hi:[1,0,0] neg_lo:[0,0,1] neg_hi:[0,0,1]
    v_exp_f32 v160, v160
    v_exp_f32 v161, v161
    v_exp_f32 v162, v162
    v_exp_f32 v163, v163
    s_add_u32 m0, s59, 81920
    s_add_u32 s68, s46, 65536
    buffer_load_dwordx4 v241, s[16:19], s68 offen offset:0 nt lds
    v_exp_f32 v164, v164
    v_exp_f32 v165, v165
    v_exp_f32 v166, v166
    v_exp_f32 v167, v167
    v_pk_add_f32 v[238:239], v[238:239], v[160:161]
    v_pk_add_f32 v[238:239], v[238:239], v[162:163]
    v_pk_add_f32 v[238:239], v[238:239], v[164:165]
    v_pk_add_f32 v[238:239], v[238:239], v[166:167]
    v_cvt_pk_bf16_f32 v80, v160, v161
    v_cvt_pk_bf16_f32 v81, v162, v163
    v_cvt_pk_bf16_f32 v82, v164, v165
    v_cvt_pk_bf16_f32 v83, v166, v167
    v_pk_fma_f32 v[168:169], v[168:169], s[52:53], v[232:233] op_sel_hi:[1,0,0] neg_lo:[0,0,1] neg_hi:[0,0,1]
    v_pk_fma_f32 v[170:171], v[170:171], s[52:53], v[232:233] op_sel_hi:[1,0,0] neg_lo:[0,0,1] neg_hi:[0,0,1]
    v_pk_fma_f32 v[172:173], v[172:173], s[52:53], v[232:233] op_sel_hi:[1,0,0] neg_lo:[0,0,1] neg_hi:[0,0,1]
    v_pk_fma_f32 v[174:175], v[174:175], s[52:53], v[232:233] op_sel_hi:[1,0,0] neg_lo:[0,0,1] neg_hi:[0,0,1]
    v_exp_f32 v168, v168
    v_exp_f32 v169, v169
    v_exp_f32 v170, v170
    v_exp_f32 v171, v171
    v_exp_f32 v172, v172
    v_exp_f32 v173, v173
    v_exp_f32 v174, v174
    v_exp_f32 v175, v175
    v_pk_add_f32 v[250:251], v[250:251], v[168:169]
    v_pk_add_f32 v[250:251], v[250:251], v[170:171]
    v_pk_add_f32 v[250:251], v[250:251], v[172:173]
    v_pk_add_f32 v[250:251], v[250:251], v[174:175]
    v_cvt_pk_bf16_f32 v84, v168, v169
    v_cvt_pk_bf16_f32 v85, v170, v171
    v_cvt_pk_bf16_f32 v86, v172, v173
    v_cvt_pk_bf16_f32 v87, v174, v175
    v_pk_fma_f32 v[176:177], v[176:177], s[52:53], v[230:231] op_sel_hi:[1,0,0] neg_lo:[0,0,1] neg_hi:[0,0,1]
    v_pk_fma_f32 v[178:179], v[178:179], s[52:53], v[230:231] op_sel_hi:[1,0,0] neg_lo:[0,0,1] neg_hi:[0,0,1]
    v_pk_fma_f32 v[180:181], v[180:181], s[52:53], v[230:231] op_sel_hi:[1,0,0] neg_lo:[0,0,1] neg_hi:[0,0,1]
    v_pk_fma_f32 v[182:183], v[182:183], s[52:53], v[230:231] op_sel_hi:[1,0,0] neg_lo:[0,0,1] neg_hi:[0,0,1]
    v_exp_f32 v176, v176
    s_add_u32 s68, s68, 3072
    v_xor_b32 v244, 128, v241
    buffer_load_dwordx4 v244, s[16:19], s68 offen offset:1024 nt lds
    v_exp_f32 v177, v177
    v_exp_f32 v178, v178
    v_exp_f32 v179, v179
    v_exp_f32 v180, v180
    v_exp_f32 v181, v181
    v_exp_f32 v182, v182
    v_exp_f32 v183, v183
    v_pk_add_f32 v[252:253], v[252:253], v[176:177]
    v_pk_add_f32 v[252:253], v[252:253], v[178:179]
    v_pk_add_f32 v[252:253], v[252:253], v[180:181]
    v_pk_add_f32 v[252:253], v[252:253], v[182:183]
    v_cvt_pk_bf16_f32 v88, v176, v177
    v_cvt_pk_bf16_f32 v89, v178, v179
    v_cvt_pk_bf16_f32 v90, v180, v181
    v_cvt_pk_bf16_f32 v91, v182, v183
    v_pk_fma_f32 v[184:185], v[184:185], s[52:53], v[234:235] op_sel_hi:[1,0,0] neg_lo:[0,0,1] neg_hi:[0,0,1]
    v_pk_fma_f32 v[186:187], v[186:187], s[52:53], v[234:235] op_sel_hi:[1,0,0] neg_lo:[0,0,1] neg_hi:[0,0,1]
    v_pk_fma_f32 v[188:189], v[188:189], s[52:53], v[234:235] op_sel_hi:[1,0,0] neg_lo:[0,0,1] neg_hi:[0,0,1]
    v_pk_fma_f32 v[190:191], v[190:191], s[52:53], v[234:235] op_sel_hi:[1,0,0] neg_lo:[0,0,1] neg_hi:[0,0,1]
    v_exp_f32 v184, v184
    v_exp_f32 v185, v185
    v_exp_f32 v186, v186
    v_exp_f32 v187, v187
    v_exp_f32 v188, v188
    v_exp_f32 v189, v189
    v_exp_f32 v190, v190
    v_exp_f32 v191, v191
    v_pk_add_f32 v[238:239], v[238:239], v[184:185]
    v_pk_add_f32 v[238:239], v[238:239], v[186:187]
    v_pk_add_f32 v[238:239], v[238:239], v[188:189]
    v_pk_add_f32 v[238:239], v[238:239], v[190:191]
    v_cvt_pk_bf16_f32 v92, v184, v185
    v_cvt_pk_bf16_f32 v93, v186, v187
    v_cvt_pk_bf16_f32 v94, v188, v189
    v_cvt_pk_bf16_f32 v95, v190, v191
    s_add_u32 s68, s68, 3072
    buffer_load_dwordx4 v241, s[16:19], s68 offen offset:2048 nt lds
    v_add_f32 v235, v250, v251
    v_add_f32 v236, v252, v253
    v_add_f32 v237, v238, v239
    v_mov_b32 v228, v235
    v_mov_b32 v229, v236
    v_mov_b32 v230, v237
    v_permlane32_swap_b32 v228, v235
    v_permlane32_swap_b32 v229, v236
    v_permlane32_swap_b32 v230, v237
    v_add_f32 v235, v228, v235
    v_add_f32 v236, v229, v236
    v_add_f32 v237, v230, v237
    v_mov_b32 v228, v235
    v_mov_b32 v229, v236
    v_mov_b32 v230, v237
    v_permlane16_swap_b32 v228, v235
    v_permlane16_swap_b32 v229, v236
    v_permlane16_swap_b32 v230, v237
    v_add_f32 v235, v228, v235
    v_add_f32 v236, v229, v236
    v_add_f32 v237, v230, v237
    s_lshl_b32 s48, s40, 11
    s_add_u32 s48, s48, 114688
    v_add_u32 v228, s48, v248
    v_xor_b32 v238, 4096, v228
    ds_write_b128 v228, v[232:235]
    ds_write_b64 v228, v[236:237] offset:1024
    v_add_u32 v224, 16384, v247
    v_xor_b32 v225, 32, v224
    v_xor_b32 v226, 64, v224
    v_xor_b32 v227, 96, v224
    v_xor_b32 v228, 128, v224
    v_xor_b32 v229, 160, v224
    v_xor_b32 v230, 192, v224
    v_xor_b32 v231, 224, v224
    s_waitcnt vmcnt(24) lgkmcnt(0)
    s_barrier
    ds_read_b64_tr_b16 v[192:193], v224 offset:0
    ds_read_b64_tr_b16 v[194:195], v224 offset:4096
    ds_read_b128 a[240:243], v238
    ds_read_b64 a[244:245], v238 offset:1024
    ds_read_b64_tr_b16 v[196:197], v225 offset:0
    ds_read_b64_tr_b16 v[198:199], v225 offset:4096
    ds_read_b64_tr_b16 v[200:201], v226 offset:0
    ds_read_b64_tr_b16 v[202:203], v226 offset:4096
    ds_read_b64_tr_b16 v[204:205], v227 offset:0
    ds_read_b64_tr_b16 v[206:207], v227 offset:4096
    ds_read_b64_tr_b16 v[208:209], v228 offset:0
    ds_read_b64_tr_b16 v[210:211], v228 offset:4096
    s_waitcnt lgkmcnt(8)
    v_mfma_f32_16x16x32_bf16 v[96:99], v[192:195], v[0:3], 0
    s_add_u32 s68, s68, 3072
    buffer_load_dwordx4 v244, s[16:19], s68 offen offset:3072 nt lds
    v_mfma_f32_16x16x32_bf16 v[100:103], v[192:195], v[4:7], 0
    ds_read_b64_tr_b16 v[212:213], v229 offset:0
    ds_read_b64_tr_b16 v[214:215], v229 offset:4096
    v_mfma_f32_16x16x32_bf16 v[104:107], v[192:195], v[8:11], 0
    s_waitcnt lgkmcnt(8)
    v_mfma_f32_16x16x32_bf16 v[108:111], v[196:199], v[0:3], 0
    v_mfma_f32_16x16x32_bf16 v[112:115], v[196:199], v[4:7], 0
    ds_read_b64_tr_b16 v[216:217], v230 offset:0
    ds_read_b64_tr_b16 v[218:219], v230 offset:4096
    v_mfma_f32_16x16x32_bf16 v[116:119], v[196:199], v[8:11], 0
    s_waitcnt lgkmcnt(8)
    v_mfma_f32_16x16x32_bf16 v[120:123], v[200:203], v[0:3], 0
    v_mfma_f32_16x16x32_bf16 v[124:127], v[200:203], v[4:7], 0
    ds_read_b64_tr_b16 v[220:221], v231 offset:0
    ds_read_b64_tr_b16 v[222:223], v231 offset:4096
    v_mfma_f32_16x16x32_bf16 v[128:131], v[200:203], v[8:11], 0
    s_waitcnt lgkmcnt(8)
    v_mfma_f32_16x16x32_bf16 v[132:135], v[204:207], v[0:3], 0
    v_add_u32 v224, 147456, v245
    v_xor_b32 v225, 32, v224
    v_mfma_f32_16x16x32_bf16 v[136:139], v[204:207], v[4:7], 0
    v_xor_b32 v226, 64, v224
    v_xor_b32 v227, 96, v224
    v_mfma_f32_16x16x32_bf16 v[140:143], v[204:207], v[8:11], 0
    s_add_u32 m0, s59, 98304
    s_add_u32 s69, s53, 2
    s_and_b32 s69, s69, 7
    s_lshl_b32 s68, s69, 19
    s_add_u32 s68, s68, s54
    s_add_u32 s68, s68, 256
    buffer_load_dwordx4 v242, s[20:23], s68 offen offset:0  lds
    s_waitcnt lgkmcnt(6)
    v_mfma_f32_16x16x32_bf16 v[144:147], v[208:211], v[0:3], 0
    v_mfma_f32_16x16x32_bf16 v[148:151], v[208:211], v[4:7], 0
    v_mfma_f32_16x16x32_bf16 v[152:155], v[208:211], v[8:11], 0
    s_waitcnt vmcnt(13) lgkmcnt(0)
    s_barrier
    v_mfma_f32_16x16x32_bf16 v[156:159], v[212:215], v[0:3], 0
    ds_read_b64_tr_b16 v[192:193], v224 offset:0
    ds_read_b64_tr_b16 v[194:195], v224 offset:1024
    v_mfma_f32_16x16x32_bf16 v[160:163], v[212:215], v[4:7], 0
    ds_read_b64_tr_b16 v[196:197], v225 offset:0
    ds_read_b64_tr_b16 v[198:199], v225 offset:1024
    v_mfma_f32_16x16x32_bf16 v[164:167], v[212:215], v[8:11], 0
    ds_read_b64_tr_b16 v[200:201], v226 offset:0
    ds_read_b64_tr_b16 v[202:203], v226 offset:1024
    v_mfma_f32_16x16x32_bf16 v[168:171], v[216:219], v[0:3], 0
    ds_read_b64_tr_b16 v[204:205], v227 offset:0
    ds_read_b64_tr_b16 v[206:207], v227 offset:1024
    v_mfma_f32_16x16x32_bf16 v[172:175], v[216:219], v[4:7], 0
    ds_read_b64_tr_b16 v[208:209], v224 offset:8192
    ds_read_b64_tr_b16 v[210:211], v224 offset:9216
    v_mfma_f32_16x16x32_bf16 v[176:179], v[216:219], v[8:11], 0
    s_add_u32 s68, s68, 31744
    buffer_load_dwordx4 v242, s[20:23], s68 offen offset:1024  lds
    v_mfma_f32_16x16x32_bf16 v[180:183], v[220:223], v[0:3], 0
    v_mfma_f32_16x16x32_bf16 v[184:187], v[220:223], v[4:7], 0
    v_mfma_f32_16x16x32_bf16 v[188:191], v[220:223], v[8:11], 0
    v_accvgpr_read_b32 v238, a240
    v_accvgpr_read_b32 v239, a243
    v_max_f32 v249, v238, v232
    v_sub_f32 v252, v238, v249
    v_sub_f32 v249, v232, v249
    v_exp_f32 v252, v252
    v_exp_f32 v249, v249
    v_mul_f32 v239, v239, v252
    v_fma_f32 v239, v235, v249, v239
    v_rcp_f32 v239, v239
    s_nop 0
    v_mul_f32 v249, v249, v239
    v_mul_f32 v252, v252, v239
    v_accvgpr_read_b32 v238, a241
    v_accvgpr_read_b32 v239, a244
    v_max_f32 v250, v238, v233
    v_sub_f32 v253, v238, v250
    v_sub_f32 v250, v233, v250
    v_exp_f32 v253, v253
    v_exp_f32 v250, v250
    v_mul_f32 v239, v239, v253
    v_fma_f32 v239, v236, v250, v239
    v_rcp_f32 v239, v239
    s_nop 0
    v_mul_f32 v250, v250, v239
    v_mul_f32 v253, v253, v239
    v_accvgpr_read_b32 v238, a242
    v_accvgpr_read_b32 v239, a245
    v_max_f32 v251, v238, v234
    v_sub_f32 v254, v238, v251
    v_sub_f32 v251, v234, v251
    v_exp_f32 v254, v254
    v_exp_f32 v251, v251
    s_add_u32 s68, s68, 31744
    v_xor_b32 v244, 128, v242
    buffer_load_dwordx4 v244, s[20:23], s68 offen offset:2048  lds
    v_mul_f32 v239, v239, v254
    v_fma_f32 v239, v237, v251, v239
    v_rcp_f32 v239, v239
    s_nop 0
    v_mul_f32 v251, v251, v239
    v_mul_f32 v254, v254, v239
    s_waitcnt lgkmcnt(8)
    v_mfma_f32_16x16x32_bf16 a[96:99], v[192:195], a[0:3], 0
    v_mfma_f32_16x16x32_bf16 a[100:103], v[192:195], a[4:7], 0
    ds_read_b64_tr_b16 v[212:213], v225 offset:8192
    ds_read_b64_tr_b16 v[214:215], v225 offset:9216
    v_mfma_f32_16x16x32_bf16 a[104:107], v[192:195], a[8:11], 0
    s_waitcnt lgkmcnt(8)
    v_mfma_f32_16x16x32_bf16 a[108:111], v[196:199], a[0:3], 0
    v_mfma_f32_16x16x32_bf16 a[112:115], v[196:199], a[4:7], 0
    ds_read_b64_tr_b16 v[216:217], v226 offset:8192
    ds_read_b64_tr_b16 v[218:219], v226 offset:9216
    v_mfma_f32_16x16x32_bf16 a[116:119], v[196:199], a[8:11], 0
    s_waitcnt lgkmcnt(8)
    v_mfma_f32_16x16x32_bf16 a[120:123], v[200:203], a[0:3], 0
    v_mfma_f32_16x16x32_bf16 a[124:127], v[200:203], a[4:7], 0
    ds_read_b64_tr_b16 v[220:221], v227 offset:8192
    ds_read_b64_tr_b16 v[222:223], v227 offset:9216
    v_mfma_f32_16x16x32_bf16 a[128:131], v[200:203], a[8:11], 0
    s_waitcnt lgkmcnt(8)
    v_mfma_f32_16x16x32_bf16 a[132:135], v[204:207], a[0:3], 0
    v_add_u32 v224, 32768, v247
    s_add_u32 s68, s68, 31744
    buffer_load_dwordx4 v244, s[20:23], s68 offen offset:3072  lds
    v_xor_b32 v225, 32, v224
    v_mfma_f32_16x16x32_bf16 a[136:139], v[204:207], a[4:7], 0
    v_xor_b32 v226, 64, v224
    v_xor_b32 v227, 96, v224
    v_mfma_f32_16x16x32_bf16 a[140:143], v[204:207], a[8:11], 0
    v_xor_b32 v228, 128, v224
    v_xor_b32 v229, 160, v224
    s_waitcnt lgkmcnt(6)
    v_mfma_f32_16x16x32_bf16 a[96:99], v[208:211], a[12:15], a[96:99]
    v_xor_b32 v230, 192, v224
    v_xor_b32 v231, 224, v224
    v_mfma_f32_16x16x32_bf16 a[100:103], v[208:211], a[16:19], a[100:103]
    v_mfma_f32_16x16x32_bf16 a[104:107], v[208:211], a[20:23], a[104:107]
    s_waitcnt lgkmcnt(0)
    s_barrier
    v_mfma_f32_16x16x32_bf16 a[108:111], v[212:215], a[12:15], a[108:111]
    ds_read_b64_tr_b16 v[192:193], v224 offset:0
    ds_read_b64_tr_b16 v[194:195], v224 offset:4096
    s_add_u32 m0, s59, 0
    s_add_u32 s68, s46, 81920
    buffer_load_dwordx4 v241, s[16:19], s68 offen offset:0 nt lds
    v_mfma_f32_16x16x32_bf16 a[112:115], v[212:215], a[16:19], a[112:115]
    ds_read_b64_tr_b16 v[196:197], v225 offset:0
    ds_read_b64_tr_b16 v[198:199], v225 offset:4096
    v_mfma_f32_16x16x32_bf16 a[116:119], v[212:215], a[20:23], a[116:119]
    ds_read_b64_tr_b16 v[200:201], v226 offset:0
    ds_read_b64_tr_b16 v[202:203], v226 offset:4096
    v_mfma_f32_16x16x32_bf16 a[120:123], v[216:219], a[12:15], a[120:123]
    ds_read_b64_tr_b16 v[204:205], v227 offset:0
    ds_read_b64_tr_b16 v[206:207], v227 offset:4096
    v_mfma_f32_16x16x32_bf16 a[124:127], v[216:219], a[16:19], a[124:127]
    ds_read_b64_tr_b16 v[208:209], v228 offset:0
    ds_read_b64_tr_b16 v[210:211], v228 offset:4096
    s_add_u32 s68, s68, 3072
    v_xor_b32 v244, 128, v241
    buffer_load_dwordx4 v244, s[16:19], s68 offen offset:1024 nt lds
    v_mfma_f32_16x16x32_bf16 a[128:131], v[216:219], a[20:23], a[128:131]
    v_mfma_f32_16x16x32_bf16 a[132:135], v[220:223], a[12:15], a[132:135]
    v_mfma_f32_16x16x32_bf16 a[136:139], v[220:223], a[16:19], a[136:139]
    v_mfma_f32_16x16x32_bf16 a[140:143], v[220:223], a[20:23], a[140:143]
    s_add_u32 s68, s68, 3072
    buffer_load_dwordx4 v241, s[16:19], s68 offen offset:2048 nt lds
    s_waitcnt lgkmcnt(8)
    v_mfma_f32_16x16x32_bf16 v[96:99], v[192:195], v[12:15], v[96:99]
    v_mfma_f32_16x16x32_bf16 v[100:103], v[192:195], v[16:19], v[100:103]
    ds_read_b64_tr_b16 v[212:213], v229 offset:0
    ds_read_b64_tr_b16 v[214:215], v229 offset:4096
    v_mfma_f32_16x16x32_bf16 v[104:107], v[192:195], v[20:23], v[104:107]
    s_waitcnt lgkmcnt(8)
    v_mfma_f32_16x16x32_bf16 v[108:111], v[196:199], v[12:15], v[108:111]
    s_add_u32 s68, s68, 3072
    buffer_load_dwordx4 v244, s[16:19], s68 offen offset:3072 nt lds
    v_mfma_f32_16x16x32_bf16 v[112:115], v[196:199], v[16:19], v[112:115]
    ds_read_b64_tr_b16 v[216:217], v230 offset:0
    ds_read_b64_tr_b16 v[218:219], v230 offset:4096
    v_mfma_f32_16x16x32_bf16 v[116:119], v[196:199], v[20:23], v[116:119]
    s_waitcnt lgkmcnt(8)
    v_mfma_f32_16x16x32_bf16 v[120:123], v[200:203], v[12:15], v[120:123]
    v_mfma_f32_16x16x32_bf16 v[124:127], v[200:203], v[16:19], v[124:127]
    ds_read_b64_tr_b16 v[220:221], v231 offset:0
    ds_read_b64_tr_b16 v[222:223], v231 offset:4096
    v_mfma_f32_16x16x32_bf16 v[128:131], v[200:203], v[20:23], v[128:131]
    s_waitcnt lgkmcnt(8)
    v_mfma_f32_16x16x32_bf16 v[132:135], v[204:207], v[12:15], v[132:135]
    v_add_u32 v224, 131072, v245
    v_xor_b32 v225, 32, v224
    v_mfma_f32_16x16x32_bf16 v[136:139], v[204:207], v[16:19], v[136:139]
    v_xor_b32 v226, 64, v224
    v_xor_b32 v227, 96, v224
    v_mfma_f32_16x16x32_bf16 v[140:143], v[204:207], v[20:23], v[140:143]
    s_waitcnt lgkmcnt(6)
    v_mfma_f32_16x16x32_bf16 v[144:147], v[208:211], v[12:15], v[144:147]
    v_mfma_f32_16x16x32_bf16 v[148:151], v[208:211], v[16:19], v[148:151]
    v_mfma_f32_16x16x32_bf16 v[152:155], v[208:211], v[20:23], v[152:155]
    s_waitcnt vmcnt(12) lgkmcnt(0)
    s_barrier
    v_mfma_f32_16x16x32_bf16 v[156:159], v[212:215], v[12:15], v[156:159]
    ds_read_b64_tr_b16 v[192:193], v224 offset:0
    ds_read_b64_tr_b16 v[194:195], v224 offset:1024
    s_add_u32 m0, s59, 147456
    s_add_u32 s69, s53, 3
    s_and_b32 s69, s69, 7
    s_lshl_b32 s68, s69, 19
    s_add_u32 s68, s68, s54
    s_add_u32 s68, s68, 256
    buffer_load_dwordx4 v242, s[20:23], s68 offen offset:0  lds
    v_mfma_f32_16x16x32_bf16 v[160:163], v[212:215], v[16:19], v[160:163]
    ds_read_b64_tr_b16 v[196:197], v225 offset:0
    ds_read_b64_tr_b16 v[198:199], v225 offset:1024
    v_mfma_f32_16x16x32_bf16 v[164:167], v[212:215], v[20:23], v[164:167]
    ds_read_b64_tr_b16 v[200:201], v226 offset:0
    ds_read_b64_tr_b16 v[202:203], v226 offset:1024
    v_mfma_f32_16x16x32_bf16 v[168:171], v[216:219], v[12:15], v[168:171]
    ds_read_b64_tr_b16 v[204:205], v227 offset:0
    ds_read_b64_tr_b16 v[206:207], v227 offset:1024
    s_add_u32 s68, s68, 31744
    buffer_load_dwordx4 v242, s[20:23], s68 offen offset:1024  lds
    v_mfma_f32_16x16x32_bf16 v[172:175], v[216:219], v[16:19], v[172:175]
    ds_read_b64_tr_b16 v[208:209], v224 offset:8192
    ds_read_b64_tr_b16 v[210:211], v224 offset:9216
    v_mfma_f32_16x16x32_bf16 v[176:179], v[216:219], v[20:23], v[176:179]
    v_mfma_f32_16x16x32_bf16 v[180:183], v[220:223], v[12:15], v[180:183]
    s_add_u32 s68, s68, 31744
    v_xor_b32 v244, 128, v242
    buffer_load_dwordx4 v244, s[20:23], s68 offen offset:2048  lds
    v_mfma_f32_16x16x32_bf16 v[184:187], v[220:223], v[16:19], v[184:187]
    v_mfma_f32_16x16x32_bf16 v[188:191], v[220:223], v[20:23], v[188:191]
    s_waitcnt lgkmcnt(8)
    v_mfma_f32_16x16x32_bf16 a[96:99], v[192:195], a[24:27], a[96:99]
    v_mfma_f32_16x16x32_bf16 a[100:103], v[192:195], a[28:31], a[100:103]
    ds_read_b64_tr_b16 v[212:213], v225 offset:8192
    ds_read_b64_tr_b16 v[214:215], v225 offset:9216
    s_add_u32 s68, s68, 31744
    buffer_load_dwordx4 v244, s[20:23], s68 offen offset:3072  lds
    v_mfma_f32_16x16x32_bf16 a[104:107], v[192:195], a[32:35], a[104:107]
    s_waitcnt lgkmcnt(8)
    v_mfma_f32_16x16x32_bf16 a[108:111], v[196:199], a[24:27], a[108:111]
    v_mfma_f32_16x16x32_bf16 a[112:115], v[196:199], a[28:31], a[112:115]
    ds_read_b64_tr_b16 v[216:217], v226 offset:8192
    ds_read_b64_tr_b16 v[218:219], v226 offset:9216
    v_mfma_f32_16x16x32_bf16 a[116:119], v[196:199], a[32:35], a[116:119]
    s_waitcnt lgkmcnt(8)
    v_mfma_f32_16x16x32_bf16 a[120:123], v[200:203], a[24:27], a[120:123]
    v_mfma_f32_16x16x32_bf16 a[124:127], v[200:203], a[28:31], a[124:127]
    ds_read_b64_tr_b16 v[220:221], v227 offset:8192
    ds_read_b64_tr_b16 v[222:223], v227 offset:9216
    v_mfma_f32_16x16x32_bf16 a[128:131], v[200:203], a[32:35], a[128:131]
    s_waitcnt lgkmcnt(8)
    v_mfma_f32_16x16x32_bf16 a[132:135], v[204:207], a[24:27], a[132:135]
    v_add_u32 v224, 49152, v247
    v_xor_b32 v225, 32, v224
    v_mfma_f32_16x16x32_bf16 a[136:139], v[204:207], a[28:31], a[136:139]
    v_xor_b32 v226, 64, v224
    v_xor_b32 v227, 96, v224
    v_mfma_f32_16x16x32_bf16 a[140:143], v[204:207], a[32:35], a[140:143]
    v_xor_b32 v228, 128, v224
    v_xor_b32 v229, 160, v224
    s_waitcnt lgkmcnt(6)
    v_mfma_f32_16x16x32_bf16 a[96:99], v[208:211], a[36:39], a[96:99]
    v_xor_b32 v230, 192, v224
    v_xor_b32 v231, 224, v224
    v_mfma_f32_16x16x32_bf16 a[100:103], v[208:211], a[40:43], a[100:103]
    v_mfma_f32_16x16x32_bf16 a[104:107], v[208:211], a[44:47], a[104:107]
    s_waitcnt lgkmcnt(0)
    s_barrier
    v_mfma_f32_16x16x32_bf16 a[108:111], v[212:215], a[36:39], a[108:111]
    ds_read_b64_tr_b16 v[192:193], v224 offset:0
    ds_read_b64_tr_b16 v[194:195], v224 offset:4096
    s_add_u32 m0, s59, 16384
    s_add_u32 s68, s46, 98304
    buffer_load_dwordx4 v241, s[16:19], s68 offen offset:0 nt lds
    v_mfma_f32_16x16x32_bf16 a[112:115], v[212:215], a[40:43], a[112:115]
    ds_read_b64_tr_b16 v[196:197], v225 offset:0
    ds_read_b64_tr_b16 v[198:199], v225 offset:4096
    v_mfma_f32_16x16x32_bf16 a[116:119], v[212:215], a[44:47], a[116:119]
    ds_read_b64_tr_b16 v[200:201], v226 offset:0
    ds_read_b64_tr_b16 v[202:203], v226 offset:4096
    v_mfma_f32_16x16x32_bf16 a[120:123], v[216:219], a[36:39], a[120:123]
    ds_read_b64_tr_b16 v[204:205], v227 offset:0
    ds_read_b64_tr_b16 v[206:207], v227 offset:4096
    v_mfma_f32_16x16x32_bf16 a[124:127], v[216:219], a[40:43], a[124:127]
    ds_read_b64_tr_b16 v[208:209], v228 offset:0
    ds_read_b64_tr_b16 v[210:211], v228 offset:4096
    s_add_u32 s68, s68, 3072
    v_xor_b32 v244, 128, v241
    buffer_load_dwordx4 v244, s[16:19], s68 offen offset:1024 nt lds
    v_mfma_f32_16x16x32_bf16 a[128:131], v[216:219], a[44:47], a[128:131]
    v_mfma_f32_16x16x32_bf16 a[132:135], v[220:223], a[36:39], a[132:135]
    v_mfma_f32_16x16x32_bf16 a[136:139], v[220:223], a[40:43], a[136:139]
    v_mfma_f32_16x16x32_bf16 a[140:143], v[220:223], a[44:47], a[140:143]
    s_add_u32 s68, s68, 3072
    buffer_load_dwordx4 v241, s[16:19], s68 offen offset:2048 nt lds
    s_waitcnt lgkmcnt(8)
    v_mfma_f32_16x16x32_bf16 v[96:99], v[192:195], v[24:27], v[96:99]
    v_mfma_f32_16x16x32_bf16 v[100:103], v[192:195], v[28:31], v[100:103]
    ds_read_b64_tr_b16 v[212:213], v229 offset:0
    ds_read_b64_tr_b16 v[214:215], v229 offset:4096
    v_mfma_f32_16x16x32_bf16 v[104:107], v[192:195], v[32:35], v[104:107]
    s_waitcnt lgkmcnt(8)
    v_mfma_f32_16x16x32_bf16 v[108:111], v[196:199], v[24:27], v[108:111]
    s_add_u32 s68, s68, 3072
    buffer_load_dwordx4 v244, s[16:19], s68 offen offset:3072 nt lds
    v_mfma_f32_16x16x32_bf16 v[112:115], v[196:199], v[28:31], v[112:115]
    ds_read_b64_tr_b16 v[216:217], v230 offset:0
    ds_read_b64_tr_b16 v[218:219], v230 offset:4096
    v_mfma_f32_16x16x32_bf16 v[116:119], v[196:199], v[32:35], v[116:119]
    s_waitcnt lgkmcnt(8)
    v_mfma_f32_16x16x32_bf16 v[120:123], v[200:203], v[24:27], v[120:123]
    v_mfma_f32_16x16x32_bf16 v[124:127], v[200:203], v[28:31], v[124:127]
    ds_read_b64_tr_b16 v[220:221], v231 offset:0
    ds_read_b64_tr_b16 v[222:223], v231 offset:4096
    v_mfma_f32_16x16x32_bf16 v[128:131], v[200:203], v[32:35], v[128:131]
    s_waitcnt lgkmcnt(8)
    v_mfma_f32_16x16x32_bf16 v[132:135], v[204:207], v[24:27], v[132:135]
    v_add_u32 v224, 98304, v245
    v_xor_b32 v225, 32, v224
    v_mfma_f32_16x16x32_bf16 v[136:139], v[204:207], v[28:31], v[136:139]
    v_xor_b32 v226, 64, v224
    v_xor_b32 v227, 96, v224
    v_mfma_f32_16x16x32_bf16 v[140:143], v[204:207], v[32:35], v[140:143]
    s_waitcnt lgkmcnt(6)
    v_mfma_f32_16x16x32_bf16 v[144:147], v[208:211], v[24:27], v[144:147]
    v_mfma_f32_16x16x32_bf16 v[148:151], v[208:211], v[28:31], v[148:151]
    v_mfma_f32_16x16x32_bf16 v[152:155], v[208:211], v[32:35], v[152:155]
    s_waitcnt vmcnt(12) lgkmcnt(0)
    s_barrier
    v_mfma_f32_16x16x32_bf16 v[156:159], v[212:215], v[24:27], v[156:159]
    ds_read_b64_tr_b16 v[192:193], v224 offset:0
    ds_read_b64_tr_b16 v[194:195], v224 offset:1024
    s_add_u32 m0, s59, 131072
    s_add_u32 s69, s53, 4
    s_and_b32 s69, s69, 7
    s_lshl_b32 s68, s69, 19
    s_add_u32 s68, s68, s54
    s_add_u32 s68, s68, 256
    buffer_load_dwordx4 v242, s[20:23], s68 offen offset:0  lds
    v_mfma_f32_16x16x32_bf16 v[160:163], v[212:215], v[28:31], v[160:163]
    ds_read_b64_tr_b16 v[196:197], v225 offset:0
    ds_read_b64_tr_b16 v[198:199], v225 offset:1024
    v_mfma_f32_16x16x32_bf16 v[164:167], v[212:215], v[32:35], v[164:167]
    ds_read_b64_tr_b16 v[200:201], v226 offset:0
    ds_read_b64_tr_b16 v[202:203], v226 offset:1024
    v_mfma_f32_16x16x32_bf16 v[168:171], v[216:219], v[24:27], v[168:171]
    ds_read_b64_tr_b16 v[204:205], v227 offset:0
    ds_read_b64_tr_b16 v[206:207], v227 offset:1024
    s_add_u32 s68, s68, 31744
    buffer_load_dwordx4 v242, s[20:23], s68 offen offset:1024  lds
    v_mfma_f32_16x16x32_bf16 v[172:175], v[216:219], v[28:31], v[172:175]
    ds_read_b64_tr_b16 v[208:209], v224 offset:8192
    ds_read_b64_tr_b16 v[210:211], v224 offset:9216
    v_mfma_f32_16x16x32_bf16 v[176:179], v[216:219], v[32:35], v[176:179]
    v_mfma_f32_16x16x32_bf16 v[180:183], v[220:223], v[24:27], v[180:183]
    s_add_u32 s68, s68, 31744
    v_xor_b32 v244, 128, v242
    buffer_load_dwordx4 v244, s[20:23], s68 offen offset:2048  lds
    v_mfma_f32_16x16x32_bf16 v[184:187], v[220:223], v[28:31], v[184:187]
    v_mfma_f32_16x16x32_bf16 v[188:191], v[220:223], v[32:35], v[188:191]
    s_waitcnt lgkmcnt(8)
    v_mfma_f32_16x16x32_bf16 a[96:99], v[192:195], a[48:51], a[96:99]
    v_mfma_f32_16x16x32_bf16 a[100:103], v[192:195], a[52:55], a[100:103]
    ds_read_b64_tr_b16 v[212:213], v225 offset:8192
    ds_read_b64_tr_b16 v[214:215], v225 offset:9216
    s_add_u32 s68, s68, 31744
    buffer_load_dwordx4 v244, s[20:23], s68 offen offset:3072  lds
    v_mfma_f32_16x16x32_bf16 a[104:107], v[192:195], a[56:59], a[104:107]
    s_waitcnt lgkmcnt(8)
    v_mfma_f32_16x16x32_bf16 a[108:111], v[196:199], a[48:51], a[108:111]
    v_mfma_f32_16x16x32_bf16 a[112:115], v[196:199], a[52:55], a[112:115]
    ds_read_b64_tr_b16 v[216:217], v226 offset:8192
    ds_read_b64_tr_b16 v[218:219], v226 offset:9216
    v_mfma_f32_16x16x32_bf16 a[116:119], v[196:199], a[56:59], a[116:119]
    s_waitcnt lgkmcnt(8)
    v_mfma_f32_16x16x32_bf16 a[120:123], v[200:203], a[48:51], a[120:123]
    v_mfma_f32_16x16x32_bf16 a[124:127], v[200:203], a[52:55], a[124:127]
    ds_read_b64_tr_b16 v[220:221], v227 offset:8192
    ds_read_b64_tr_b16 v[222:223], v227 offset:9216
    v_mfma_f32_16x16x32_bf16 a[128:131], v[200:203], a[56:59], a[128:131]
    s_waitcnt lgkmcnt(8)
    v_mfma_f32_16x16x32_bf16 a[132:135], v[204:207], a[48:51], a[132:135]
    v_add_u32 v224, 65536, v247
    v_xor_b32 v225, 32, v224
    v_mfma_f32_16x16x32_bf16 a[136:139], v[204:207], a[52:55], a[136:139]
    v_xor_b32 v226, 64, v224
    v_xor_b32 v227, 96, v224
    v_mfma_f32_16x16x32_bf16 a[140:143], v[204:207], a[56:59], a[140:143]
    v_xor_b32 v228, 128, v224
    v_xor_b32 v229, 160, v224
    s_waitcnt lgkmcnt(6)
    v_mfma_f32_16x16x32_bf16 a[96:99], v[208:211], a[60:63], a[96:99]
    v_xor_b32 v230, 192, v224
    v_xor_b32 v231, 224, v224
    v_mfma_f32_16x16x32_bf16 a[100:103], v[208:211], a[64:67], a[100:103]
    v_mfma_f32_16x16x32_bf16 a[104:107], v[208:211], a[68:71], a[104:107]
    s_waitcnt lgkmcnt(0)
    s_barrier
    v_mfma_f32_16x16x32_bf16 a[108:111], v[212:215], a[60:63], a[108:111]
    ds_read_b64_tr_b16 v[192:193], v224 offset:0
    ds_read_b64_tr_b16 v[194:195], v224 offset:4096
    s_add_u32 m0, s59, 32768
    s_add_u32 s68, s46, 114688
    buffer_load_dwordx4 v241, s[16:19], s68 offen offset:0 nt lds
    v_mfma_f32_16x16x32_bf16 a[112:115], v[212:215], a[64:67], a[112:115]
    ds_read_b64_tr_b16 v[196:197], v225 offset:0
    ds_read_b64_tr_b16 v[198:199], v225 offset:4096
    v_mfma_f32_16x16x32_bf16 a[116:119], v[212:215], a[68:71], a[116:119]
    ds_read_b64_tr_b16 v[200:201], v226 offset:0
    ds_read_b64_tr_b16 v[202:203], v226 offset:4096
    v_mfma_f32_16x16x32_bf16 a[120:123], v[216:219], a[60:63], a[120:123]
    ds_read_b64_tr_b16 v[204:205], v227 offset:0
    ds_read_b64_tr_b16 v[206:207], v227 offset:4096
    v_mfma_f32_16x16x32_bf16 a[124:127], v[216:219], a[64:67], a[124:127]
    ds_read_b64_tr_b16 v[208:209], v228 offset:0
    ds_read_b64_tr_b16 v[210:211], v228 offset:4096
    s_add_u32 s68, s68, 3072
    v_xor_b32 v244, 128, v241
    buffer_load_dwordx4 v244, s[16:19], s68 offen offset:1024 nt lds
    v_mfma_f32_16x16x32_bf16 a[128:131], v[216:219], a[68:71], a[128:131]
    v_mfma_f32_16x16x32_bf16 a[132:135], v[220:223], a[60:63], a[132:135]
    v_mfma_f32_16x16x32_bf16 a[136:139], v[220:223], a[64:67], a[136:139]
    v_mfma_f32_16x16x32_bf16 a[140:143], v[220:223], a[68:71], a[140:143]
    s_add_u32 s68, s68, 3072
    buffer_load_dwordx4 v241, s[16:19], s68 offen offset:2048 nt lds
    s_waitcnt lgkmcnt(8)
    v_mfma_f32_16x16x32_bf16 v[96:99], v[192:195], v[36:39], v[96:99]
    v_mfma_f32_16x16x32_bf16 v[100:103], v[192:195], v[40:43], v[100:103]
    ds_read_b64_tr_b16 v[212:213], v229 offset:0
    ds_read_b64_tr_b16 v[214:215], v229 offset:4096
    v_mfma_f32_16x16x32_bf16 v[104:107], v[192:195], v[44:47], v[104:107]
    s_waitcnt lgkmcnt(8)
    v_mfma_f32_16x16x32_bf16 v[108:111], v[196:199], v[36:39], v[108:111]
    s_add_u32 s68, s68, 3072
    buffer_load_dwordx4 v244, s[16:19], s68 offen offset:3072 nt lds
    v_mfma_f32_16x16x32_bf16 v[112:115], v[196:199], v[40:43], v[112:115]
    ds_read_b64_tr_b16 v[216:217], v230 offset:0
    ds_read_b64_tr_b16 v[218:219], v230 offset:4096
    v_mfma_f32_16x16x32_bf16 v[116:119], v[196:199], v[44:47], v[116:119]
    s_waitcnt lgkmcnt(8)
    v_mfma_f32_16x16x32_bf16 v[120:123], v[200:203], v[36:39], v[120:123]
    v_mfma_f32_16x16x32_bf16 v[124:127], v[200:203], v[40:43], v[124:127]
    ds_read_b64_tr_b16 v[220:221], v231 offset:0
    ds_read_b64_tr_b16 v[222:223], v231 offset:4096
    v_mfma_f32_16x16x32_bf16 v[128:131], v[200:203], v[44:47], v[128:131]
    s_waitcnt lgkmcnt(8)
    v_mfma_f32_16x16x32_bf16 v[132:135], v[204:207], v[36:39], v[132:135]
    v_add_u32 v224, 147456, v245
    v_xor_b32 v225, 32, v224
    v_mfma_f32_16x16x32_bf16 v[136:139], v[204:207], v[40:43], v[136:139]
    v_xor_b32 v226, 64, v224
    v_xor_b32 v227, 96, v224
    v_mfma_f32_16x16x32_bf16 v[140:143], v[204:207], v[44:47], v[140:143]
    s_waitcnt lgkmcnt(6)
    v_mfma_f32_16x16x32_bf16 v[144:147], v[208:211], v[36:39], v[144:147]
    v_mfma_f32_16x16x32_bf16 v[148:151], v[208:211], v[40:43], v[148:151]
    v_mfma_f32_16x16x32_bf16 v[152:155], v[208:211], v[44:47], v[152:155]
    s_waitcnt vmcnt(12) lgkmcnt(0)
    s_barrier
    v_mfma_f32_16x16x32_bf16 v[156:159], v[212:215], v[36:39], v[156:159]
    ds_read_b64_tr_b16 v[192:193], v224 offset:0
    ds_read_b64_tr_b16 v[194:195], v224 offset:1024
    s_add_u32 m0, s59, 49152
    s_add_u32 s69, s53, 5
    s_and_b32 s69, s69, 7
    s_lshl_b32 s68, s69, 19
    s_add_u32 s68, s68, s54
    s_add_u32 s68, s68, 256
    buffer_load_dwordx4 v242, s[20:23], s68 offen offset:0  lds
    v_mfma_f32_16x16x32_bf16 v[160:163], v[212:215], v[40:43], v[160:163]
    ds_read_b64_tr_b16 v[196:197], v225 offset:0
    ds_read_b64_tr_b16 v[198:199], v225 offset:1024
    v_mfma_f32_16x16x32_bf16 v[164:167], v[212:215], v[44:47], v[164:167]
    ds_read_b64_tr_b16 v[200:201], v226 offset:0
    ds_read_b64_tr_b16 v[202:203], v226 offset:1024
    v_mfma_f32_16x16x32_bf16 v[168:171], v[216:219], v[36:39], v[168:171]
    ds_read_b64_tr_b16 v[204:205], v227 offset:0
    ds_read_b64_tr_b16 v[206:207], v227 offset:1024
    s_add_u32 s68, s68, 31744
    buffer_load_dwordx4 v242, s[20:23], s68 offen offset:1024  lds
    v_mfma_f32_16x16x32_bf16 v[172:175], v[216:219], v[40:43], v[172:175]
    ds_read_b64_tr_b16 v[208:209], v224 offset:8192
    ds_read_b64_tr_b16 v[210:211], v224 offset:9216
    v_mfma_f32_16x16x32_bf16 v[176:179], v[216:219], v[44:47], v[176:179]
    v_mfma_f32_16x16x32_bf16 v[180:183], v[220:223], v[36:39], v[180:183]
    s_add_u32 s68, s68, 31744
    v_xor_b32 v244, 128, v242
    buffer_load_dwordx4 v244, s[20:23], s68 offen offset:2048  lds
    v_mfma_f32_16x16x32_bf16 v[184:187], v[220:223], v[40:43], v[184:187]
    v_mfma_f32_16x16x32_bf16 v[188:191], v[220:223], v[44:47], v[188:191]
    s_waitcnt lgkmcnt(8)
    v_mfma_f32_16x16x32_bf16 a[96:99], v[192:195], a[72:75], a[96:99]
    v_mfma_f32_16x16x32_bf16 a[100:103], v[192:195], a[76:79], a[100:103]
    ds_read_b64_tr_b16 v[212:213], v225 offset:8192
    ds_read_b64_tr_b16 v[214:215], v225 offset:9216
    s_add_u32 s68, s68, 31744
    buffer_load_dwordx4 v244, s[20:23], s68 offen offset:3072  lds
    v_mfma_f32_16x16x32_bf16 a[104:107], v[192:195], a[80:83], a[104:107]
    s_waitcnt lgkmcnt(8)
    v_mfma_f32_16x16x32_bf16 a[108:111], v[196:199], a[72:75], a[108:111]
    v_mfma_f32_16x16x32_bf16 a[112:115], v[196:199], a[76:79], a[112:115]
    ds_read_b64_tr_b16 v[216:217], v226 offset:8192
    ds_read_b64_tr_b16 v[218:219], v226 offset:9216
    v_mfma_f32_16x16x32_bf16 a[116:119], v[196:199], a[80:83], a[116:119]
    s_waitcnt lgkmcnt(8)
    v_mfma_f32_16x16x32_bf16 a[120:123], v[200:203], a[72:75], a[120:123]
    v_mfma_f32_16x16x32_bf16 a[124:127], v[200:203], a[76:79], a[124:127]
    ds_read_b64_tr_b16 v[220:221], v227 offset:8192
    ds_read_b64_tr_b16 v[222:223], v227 offset:9216
    v_mfma_f32_16x16x32_bf16 a[128:131], v[200:203], a[80:83], a[128:131]
    s_waitcnt lgkmcnt(8)
    v_mfma_f32_16x16x32_bf16 a[132:135], v[204:207], a[72:75], a[132:135]
    v_add_u32 v224, 81920, v247
    v_xor_b32 v225, 32, v224
    v_mfma_f32_16x16x32_bf16 a[136:139], v[204:207], a[76:79], a[136:139]
    v_xor_b32 v226, 64, v224
    v_xor_b32 v227, 96, v224
    v_mfma_f32_16x16x32_bf16 a[140:143], v[204:207], a[80:83], a[140:143]
    v_xor_b32 v228, 128, v224
    v_xor_b32 v229, 160, v224
    s_waitcnt lgkmcnt(6)
    v_mfma_f32_16x16x32_bf16 a[96:99], v[208:211], a[84:87], a[96:99]
    v_xor_b32 v230, 192, v224
    v_xor_b32 v231, 224, v224
    v_mfma_f32_16x16x32_bf16 a[100:103], v[208:211], a[88:91], a[100:103]
    v_mfma_f32_16x16x32_bf16 a[104:107], v[208:211], a[92:95], a[104:107]
    s_waitcnt lgkmcnt(0)
    s_barrier
    v_mfma_f32_16x16x32_bf16 a[108:111], v[212:215], a[84:87], a[108:111]
    ds_read_b64_tr_b16 v[192:193], v224 offset:0
    ds_read_b64_tr_b16 v[194:195], v224 offset:4096
    s_add_u32 m0, s59, 98304
    s_add_u32 s68, s46, 131072
    buffer_load_dwordx4 v240, s[12:15], s68 offen offset:0 nt lds
    v_mfma_f32_16x16x32_bf16 a[112:115], v[212:215], a[88:91], a[112:115]
    ds_read_b64_tr_b16 v[196:197], v225 offset:0
    ds_read_b64_tr_b16 v[198:199], v225 offset:4096
    v_mfma_f32_16x16x32_bf16 a[116:119], v[212:215], a[92:95], a[116:119]
    ds_read_b64_tr_b16 v[200:201], v226 offset:0
    ds_read_b64_tr_b16 v[202:203], v226 offset:4096
    v_mfma_f32_16x16x32_bf16 a[120:123], v[216:219], a[84:87], a[120:123]
    ds_read_b64_tr_b16 v[204:205], v227 offset:0
    ds_read_b64_tr_b16 v[206:207], v227 offset:4096
    v_mfma_f32_16x16x32_bf16 a[124:127], v[216:219], a[88:91], a[124:127]
    ds_read_b64_tr_b16 v[208:209], v228 offset:0
    ds_read_b64_tr_b16 v[210:211], v228 offset:4096
    s_add_u32 s68, s68, 3072
    v_xor_b32 v244, 64, v240
    buffer_load_dwordx4 v244, s[12:15], s68 offen offset:1024 nt lds
    v_mfma_f32_16x16x32_bf16 a[128:131], v[216:219], a[92:95], a[128:131]
    v_mfma_f32_16x16x32_bf16 a[132:135], v[220:223], a[84:87], a[132:135]
    v_mfma_f32_16x16x32_bf16 a[136:139], v[220:223], a[88:91], a[136:139]
    v_mfma_f32_16x16x32_bf16 a[140:143], v[220:223], a[92:95], a[140:143]
    s_add_u32 s68, s68, 3072
    v_xor_b32 v244, 128, v240
    buffer_load_dwordx4 v244, s[12:15], s68 offen offset:2048 nt lds
    s_waitcnt lgkmcnt(8)
    v_mfma_f32_16x16x32_bf16 v[96:99], v[192:195], v[48:51], v[96:99]
    v_mfma_f32_16x16x32_bf16 v[100:103], v[192:195], v[52:55], v[100:103]
    ds_read_b64_tr_b16 v[212:213], v229 offset:0
    ds_read_b64_tr_b16 v[214:215], v229 offset:4096
    v_mfma_f32_16x16x32_bf16 v[104:107], v[192:195], v[56:59], v[104:107]
    s_waitcnt lgkmcnt(8)
    v_mfma_f32_16x16x32_bf16 v[108:111], v[196:199], v[48:51], v[108:111]
    s_add_u32 s68, s68, 3072
    v_xor_b32 v244, 192, v240
    buffer_load_dwordx4 v244, s[12:15], s68 offen offset:3072 nt lds
    v_mfma_f32_16x16x32_bf16 v[112:115], v[196:199], v[52:55], v[112:115]
    ds_read_b64_tr_b16 v[216:217], v230 offset:0
    ds_read_b64_tr_b16 v[218:219], v230 offset:4096
    v_mfma_f32_16x16x32_bf16 v[116:119], v[196:199], v[56:59], v[116:119]
    s_waitcnt lgkmcnt(8)
    v_mfma_f32_16x16x32_bf16 v[120:123], v[200:203], v[48:51], v[120:123]
    v_mfma_f32_16x16x32_bf16 v[124:127], v[200:203], v[52:55], v[124:127]
    ds_read_b64_tr_b16 v[220:221], v231 offset:0
    ds_read_b64_tr_b16 v[222:223], v231 offset:4096
    v_mfma_f32_16x16x32_bf16 v[128:131], v[200:203], v[56:59], v[128:131]
    s_waitcnt lgkmcnt(8)
    v_mfma_f32_16x16x32_bf16 v[132:135], v[204:207], v[48:51], v[132:135]
    v_add_u32 v224, 131072, v245
    v_xor_b32 v225, 32, v224
    v_mfma_f32_16x16x32_bf16 v[136:139], v[204:207], v[52:55], v[136:139]
    v_xor_b32 v226, 64, v224
    v_xor_b32 v227, 96, v224
    v_mfma_f32_16x16x32_bf16 v[140:143], v[204:207], v[56:59], v[140:143]
    s_waitcnt lgkmcnt(6)
    v_mfma_f32_16x16x32_bf16 v[144:147], v[208:211], v[48:51], v[144:147]
    v_mfma_f32_16x16x32_bf16 v[148:151], v[208:211], v[52:55], v[148:151]
    v_mfma_f32_16x16x32_bf16 v[152:155], v[208:211], v[56:59], v[152:155]
    s_waitcnt vmcnt(12) lgkmcnt(0)
    s_barrier
    v_mfma_f32_16x16x32_bf16 v[156:159], v[212:215], v[48:51], v[156:159]
    ds_read_b64_tr_b16 v[192:193], v224 offset:0
    ds_read_b64_tr_b16 v[194:195], v224 offset:1024
    s_add_u32 m0, s59, 147456
    s_add_u32 s69, s53, 6
    s_and_b32 s69, s69, 7
    s_lshl_b32 s68, s69, 19
    s_add_u32 s68, s68, s54
    s_add_u32 s68, s68, 256
    buffer_load_dwordx4 v242, s[20:23], s68 offen offset:0  lds
    v_mfma_f32_16x16x32_bf16 v[160:163], v[212:215], v[52:55], v[160:163]
    ds_read_b64_tr_b16 v[196:197], v225 offset:0
    ds_read_b64_tr_b16 v[198:199], v225 offset:1024
    v_mfma_f32_16x16x32_bf16 v[164:167], v[212:215], v[56:59], v[164:167]
    ds_read_b64_tr_b16 v[200:201], v226 offset:0
    ds_read_b64_tr_b16 v[202:203], v226 offset:1024
    v_mfma_f32_16x16x32_bf16 v[168:171], v[216:219], v[48:51], v[168:171]
    ds_read_b64_tr_b16 v[204:205], v227 offset:0
    ds_read_b64_tr_b16 v[206:207], v227 offset:1024
    s_add_u32 s68, s68, 31744
    buffer_load_dwordx4 v242, s[20:23], s68 offen offset:1024  lds
    v_mfma_f32_16x16x32_bf16 v[172:175], v[216:219], v[52:55], v[172:175]
    ds_read_b64_tr_b16 v[208:209], v224 offset:8192
    ds_read_b64_tr_b16 v[210:211], v224 offset:9216
    v_mfma_f32_16x16x32_bf16 v[176:179], v[216:219], v[56:59], v[176:179]
    v_mfma_f32_16x16x32_bf16 v[180:183], v[220:223], v[48:51], v[180:183]
    s_add_u32 s68, s68, 31744
    v_xor_b32 v244, 128, v242
    buffer_load_dwordx4 v244, s[20:23], s68 offen offset:2048  lds
    v_mfma_f32_16x16x32_bf16 v[184:187], v[220:223], v[52:55], v[184:187]
    v_mfma_f32_16x16x32_bf16 v[188:191], v[220:223], v[56:59], v[188:191]
    s_waitcnt lgkmcnt(8)
    v_mfma_f32_16x16x32_bf16 a[96:99], v[192:195], a[144:147], a[96:99]
    v_mfma_f32_16x16x32_bf16 a[100:103], v[192:195], a[148:151], a[100:103]
    ds_read_b64_tr_b16 v[212:213], v225 offset:8192
    ds_read_b64_tr_b16 v[214:215], v225 offset:9216
    s_add_u32 s68, s68, 31744
    buffer_load_dwordx4 v244, s[20:23], s68 offen offset:3072  lds
    v_mfma_f32_16x16x32_bf16 a[104:107], v[192:195], a[152:155], a[104:107]
    s_waitcnt lgkmcnt(8)
    v_mfma_f32_16x16x32_bf16 a[108:111], v[196:199], a[144:147], a[108:111]
    v_mfma_f32_16x16x32_bf16 a[112:115], v[196:199], a[148:151], a[112:115]
    ds_read_b64_tr_b16 v[216:217], v226 offset:8192
    ds_read_b64_tr_b16 v[218:219], v226 offset:9216
    v_mfma_f32_16x16x32_bf16 a[116:119], v[196:199], a[152:155], a[116:119]
    s_waitcnt lgkmcnt(8)
    v_mfma_f32_16x16x32_bf16 a[120:123], v[200:203], a[144:147], a[120:123]
    v_mfma_f32_16x16x32_bf16 a[124:127], v[200:203], a[148:151], a[124:127]
    ds_read_b64_tr_b16 v[220:221], v227 offset:8192
    ds_read_b64_tr_b16 v[222:223], v227 offset:9216
    v_mfma_f32_16x16x32_bf16 a[128:131], v[200:203], a[152:155], a[128:131]
    s_waitcnt lgkmcnt(8)
    v_mfma_f32_16x16x32_bf16 a[132:135], v[204:207], a[144:147], a[132:135]
    v_add_u32 v224, 0, v247
    v_xor_b32 v225, 32, v224
    v_mfma_f32_16x16x32_bf16 a[136:139], v[204:207], a[148:151], a[136:139]
    v_xor_b32 v226, 64, v224
    v_xor_b32 v227, 96, v224
    v_mfma_f32_16x16x32_bf16 a[140:143], v[204:207], a[152:155], a[140:143]
    v_xor_b32 v228, 128, v224
    v_xor_b32 v229, 160, v224
    s_waitcnt lgkmcnt(6)
    v_mfma_f32_16x16x32_bf16 a[96:99], v[208:211], a[156:159], a[96:99]
    v_xor_b32 v230, 192, v224
    v_xor_b32 v231, 224, v224
    v_mfma_f32_16x16x32_bf16 a[100:103], v[208:211], a[160:163], a[100:103]
    v_mfma_f32_16x16x32_bf16 a[104:107], v[208:211], a[164:167], a[104:107]
    s_waitcnt lgkmcnt(0)
    s_barrier
    v_mfma_f32_16x16x32_bf16 a[108:111], v[212:215], a[156:159], a[108:111]
    ds_read_b64_tr_b16 v[192:193], v224 offset:0
    ds_read_b64_tr_b16 v[194:195], v224 offset:4096
    s_add_u32 m0, s59, 65536
    s_add_u32 s68, s46, 147456
    buffer_load_dwordx4 v240, s[12:15], s68 offen offset:0 nt lds
    v_mfma_f32_16x16x32_bf16 a[112:115], v[212:215], a[160:163], a[112:115]
    ds_read_b64_tr_b16 v[196:197], v225 offset:0
    ds_read_b64_tr_b16 v[198:199], v225 offset:4096
    v_mfma_f32_16x16x32_bf16 a[116:119], v[212:215], a[164:167], a[116:119]
    ds_read_b64_tr_b16 v[200:201], v226 offset:0
    ds_read_b64_tr_b16 v[202:203], v226 offset:4096
    v_mfma_f32_16x16x32_bf16 a[120:123], v[216:219], a[156:159], a[120:123]
    ds_read_b64_tr_b16 v[204:205], v227 offset:0
    ds_read_b64_tr_b16 v[206:207], v227 offset:4096
    v_mfma_f32_16x16x32_bf16 a[124:127], v[216:219], a[160:163], a[124:127]
    ds_read_b64_tr_b16 v[208:209], v228 offset:0
    ds_read_b64_tr_b16 v[210:211], v228 offset:4096
    s_add_u32 s68, s68, 3072
    v_xor_b32 v244, 64, v240
    buffer_load_dwordx4 v244, s[12:15], s68 offen offset:1024 nt lds
    v_mfma_f32_16x16x32_bf16 a[128:131], v[216:219], a[164:167], a[128:131]
    v_mfma_f32_16x16x32_bf16 a[132:135], v[220:223], a[156:159], a[132:135]
    v_mfma_f32_16x16x32_bf16 a[136:139], v[220:223], a[160:163], a[136:139]
    v_mfma_f32_16x16x32_bf16 a[140:143], v[220:223], a[164:167], a[140:143]
    s_add_u32 s68, s68, 3072
    v_xor_b32 v244, 128, v240
    buffer_load_dwordx4 v244, s[12:15], s68 offen offset:2048 nt lds
    s_waitcnt lgkmcnt(8)
    v_mfma_f32_16x16x32_bf16 v[96:99], v[192:195], v[60:63], v[96:99]
    v_mfma_f32_16x16x32_bf16 v[100:103], v[192:195], v[64:67], v[100:103]
    ds_read_b64_tr_b16 v[212:213], v229 offset:0
    ds_read_b64_tr_b16 v[214:215], v229 offset:4096
    v_mfma_f32_16x16x32_bf16 v[104:107], v[192:195], v[68:71], v[104:107]
    s_waitcnt lgkmcnt(8)
    v_mfma_f32_16x16x32_bf16 v[108:111], v[196:199], v[60:63], v[108:111]
    s_add_u32 s68, s68, 3072
    v_xor_b32 v244, 192, v240
    buffer_load_dwordx4 v244, s[12:15], s68 offen offset:3072 nt lds
    v_mfma_f32_16x16x32_bf16 v[112:115], v[196:199], v[64:67], v[112:115]
    ds_read_b64_tr_b16 v[216:217], v230 offset:0
    ds_read_b64_tr_b16 v[218:219], v230 offset:4096
    v_mfma_f32_16x16x32_bf16 v[116:119], v[196:199], v[68:71], v[116:119]
    s_waitcnt lgkmcnt(8)
    v_mfma_f32_16x16x32_bf16 v[120:123], v[200:203], v[60:63], v[120:123]
    v_mfma_f32_16x16x32_bf16 v[124:127], v[200:203], v[64:67], v[124:127]
    ds_read_b64_tr_b16 v[220:221], v231 offset:0
    ds_read_b64_tr_b16 v[222:223], v231 offset:4096
    v_mfma_f32_16x16x32_bf16 v[128:131], v[200:203], v[68:71], v[128:131]
    s_waitcnt lgkmcnt(8)
    v_mfma_f32_16x16x32_bf16 v[132:135], v[204:207], v[60:63], v[132:135]
    v_add_u32 v224, 49152, v245
    v_xor_b32 v225, 32, v224
    v_mfma_f32_16x16x32_bf16 v[136:139], v[204:207], v[64:67], v[136:139]
    v_xor_b32 v226, 64, v224
    v_xor_b32 v227, 96, v224
    v_mfma_f32_16x16x32_bf16 v[140:143], v[204:207], v[68:71], v[140:143]
    s_waitcnt lgkmcnt(6)
    v_mfma_f32_16x16x32_bf16 v[144:147], v[208:211], v[60:63], v[144:147]
    v_mfma_f32_16x16x32_bf16 v[148:151], v[208:211], v[64:67], v[148:151]
    v_mfma_f32_16x16x32_bf16 v[152:155], v[208:211], v[68:71], v[152:155]
    s_waitcnt vmcnt(12) lgkmcnt(0)
    s_barrier
    v_mfma_f32_16x16x32_bf16 v[156:159], v[212:215], v[60:63], v[156:159]
    ds_read_b64_tr_b16 v[192:193], v224 offset:0
    ds_read_b64_tr_b16 v[194:195], v224 offset:1024
    s_add_u32 m0, s59, 81920
    s_add_u32 s69, s53, 7
    s_and_b32 s69, s69, 7
    s_lshl_b32 s68, s69, 19
    s_add_u32 s68, s68, s54
    s_add_u32 s68, s68, 256
    buffer_load_dwordx4 v242, s[20:23], s68 offen offset:0  lds
    v_mfma_f32_16x16x32_bf16 v[160:163], v[212:215], v[64:67], v[160:163]
    ds_read_b64_tr_b16 v[196:197], v225 offset:0
    ds_read_b64_tr_b16 v[198:199], v225 offset:1024
    v_mfma_f32_16x16x32_bf16 v[164:167], v[212:215], v[68:71], v[164:167]
    ds_read_b64_tr_b16 v[200:201], v226 offset:0
    ds_read_b64_tr_b16 v[202:203], v226 offset:1024
    v_mfma_f32_16x16x32_bf16 v[168:171], v[216:219], v[60:63], v[168:171]
    ds_read_b64_tr_b16 v[204:205], v227 offset:0
    ds_read_b64_tr_b16 v[206:207], v227 offset:1024
    s_add_u32 s68, s68, 31744
    buffer_load_dwordx4 v242, s[20:23], s68 offen offset:1024  lds
    v_mfma_f32_16x16x32_bf16 v[172:175], v[216:219], v[64:67], v[172:175]
    ds_read_b64_tr_b16 v[208:209], v224 offset:8192
    ds_read_b64_tr_b16 v[210:211], v224 offset:9216
    v_mfma_f32_16x16x32_bf16 v[176:179], v[216:219], v[68:71], v[176:179]
    v_mfma_f32_16x16x32_bf16 v[180:183], v[220:223], v[60:63], v[180:183]
    s_add_u32 s68, s68, 31744
    v_xor_b32 v244, 128, v242
    buffer_load_dwordx4 v244, s[20:23], s68 offen offset:2048  lds
    v_mfma_f32_16x16x32_bf16 v[184:187], v[220:223], v[64:67], v[184:187]
    v_mfma_f32_16x16x32_bf16 v[188:191], v[220:223], v[68:71], v[188:191]
    s_waitcnt lgkmcnt(8)
    v_mfma_f32_16x16x32_bf16 a[96:99], v[192:195], a[168:171], a[96:99]
    v_mfma_f32_16x16x32_bf16 a[100:103], v[192:195], a[172:175], a[100:103]
    ds_read_b64_tr_b16 v[212:213], v225 offset:8192
    ds_read_b64_tr_b16 v[214:215], v225 offset:9216
    s_add_u32 s68, s68, 31744
    buffer_load_dwordx4 v244, s[20:23], s68 offen offset:3072  lds
    v_mfma_f32_16x16x32_bf16 a[104:107], v[192:195], a[176:179], a[104:107]
    s_waitcnt lgkmcnt(8)
    v_mfma_f32_16x16x32_bf16 a[108:111], v[196:199], a[168:171], a[108:111]
    v_mfma_f32_16x16x32_bf16 a[112:115], v[196:199], a[172:175], a[112:115]
    ds_read_b64_tr_b16 v[216:217], v226 offset:8192
    ds_read_b64_tr_b16 v[218:219], v226 offset:9216
    v_mfma_f32_16x16x32_bf16 a[116:119], v[196:199], a[176:179], a[116:119]
    s_waitcnt lgkmcnt(8)
    v_mfma_f32_16x16x32_bf16 a[120:123], v[200:203], a[168:171], a[120:123]
    v_mfma_f32_16x16x32_bf16 a[124:127], v[200:203], a[172:175], a[124:127]
    ds_read_b64_tr_b16 v[220:221], v227 offset:8192
    ds_read_b64_tr_b16 v[222:223], v227 offset:9216
    v_mfma_f32_16x16x32_bf16 a[128:131], v[200:203], a[176:179], a[128:131]
    s_waitcnt lgkmcnt(8)
    v_mfma_f32_16x16x32_bf16 a[132:135], v[204:207], a[168:171], a[132:135]
    v_add_u32 v224, 16384, v247
    v_xor_b32 v225, 32, v224
    v_mfma_f32_16x16x32_bf16 a[136:139], v[204:207], a[172:175], a[136:139]
    v_xor_b32 v226, 64, v224
    v_xor_b32 v227, 96, v224
    v_mfma_f32_16x16x32_bf16 a[140:143], v[204:207], a[176:179], a[140:143]
    v_xor_b32 v228, 128, v224
    v_xor_b32 v229, 160, v224
    s_waitcnt lgkmcnt(6)
    v_mfma_f32_16x16x32_bf16 a[96:99], v[208:211], a[180:183], a[96:99]
    v_xor_b32 v230, 192, v224
    v_xor_b32 v231, 224, v224
    v_mfma_f32_16x16x32_bf16 a[100:103], v[208:211], a[184:187], a[100:103]
    v_mfma_f32_16x16x32_bf16 a[104:107], v[208:211], a[188:191], a[104:107]
    s_waitcnt lgkmcnt(0)
    s_barrier
    v_mfma_f32_16x16x32_bf16 a[108:111], v[212:215], a[180:183], a[108:111]
    ds_read_b64_tr_b16 v[192:193], v224 offset:0
    ds_read_b64_tr_b16 v[194:195], v224 offset:4096
    s_add_u32 m0, s59, 0
    s_add_u32 s68, s46, 163840
    buffer_load_dwordx4 v240, s[12:15], s68 offen offset:0 nt lds
    v_mfma_f32_16x16x32_bf16 a[112:115], v[212:215], a[184:187], a[112:115]
    ds_read_b64_tr_b16 v[196:197], v225 offset:0
    ds_read_b64_tr_b16 v[198:199], v225 offset:4096
    v_mfma_f32_16x16x32_bf16 a[116:119], v[212:215], a[188:191], a[116:119]
    ds_read_b64_tr_b16 v[200:201], v226 offset:0
    ds_read_b64_tr_b16 v[202:203], v226 offset:4096
    v_mfma_f32_16x16x32_bf16 a[120:123], v[216:219], a[180:183], a[120:123]
    ds_read_b64_tr_b16 v[204:205], v227 offset:0
    ds_read_b64_tr_b16 v[206:207], v227 offset:4096
    v_mfma_f32_16x16x32_bf16 a[124:127], v[216:219], a[184:187], a[124:127]
    ds_read_b64_tr_b16 v[208:209], v228 offset:0
    ds_read_b64_tr_b16 v[210:211], v228 offset:4096
    s_add_u32 s68, s68, 3072
    v_xor_b32 v244, 64, v240
    buffer_load_dwordx4 v244, s[12:15], s68 offen offset:1024 nt lds
    v_mfma_f32_16x16x32_bf16 a[128:131], v[216:219], a[188:191], a[128:131]
    v_mfma_f32_16x16x32_bf16 a[132:135], v[220:223], a[180:183], a[132:135]
    v_mfma_f32_16x16x32_bf16 a[136:139], v[220:223], a[184:187], a[136:139]
    v_mfma_f32_16x16x32_bf16 a[140:143], v[220:223], a[188:191], a[140:143]
    s_add_u32 s68, s68, 3072
    v_xor_b32 v244, 128, v240
    buffer_load_dwordx4 v244, s[12:15], s68 offen offset:2048 nt lds
    s_waitcnt lgkmcnt(8)
    v_mfma_f32_16x16x32_bf16 v[96:99], v[192:195], v[72:75], v[96:99]
    v_mfma_f32_16x16x32_bf16 v[100:103], v[192:195], v[76:79], v[100:103]
    ds_read_b64_tr_b16 v[212:213], v229 offset:0
    ds_read_b64_tr_b16 v[214:215], v229 offset:4096
    v_mfma_f32_16x16x32_bf16 v[104:107], v[192:195], v[80:83], v[104:107]
    s_waitcnt lgkmcnt(8)
    v_mfma_f32_16x16x32_bf16 v[108:111], v[196:199], v[72:75], v[108:111]
    s_add_u32 s68, s68, 3072
    v_xor_b32 v244, 192, v240
    buffer_load_dwordx4 v244, s[12:15], s68 offen offset:3072 nt lds
    v_mfma_f32_16x16x32_bf16 v[112:115], v[196:199], v[76:79], v[112:115]
    ds_read_b64_tr_b16 v[216:217], v230 offset:0
    ds_read_b64_tr_b16 v[218:219], v230 offset:4096
    v_mfma_f32_16x16x32_bf16 v[116:119], v[196:199], v[80:83], v[116:119]
    s_waitcnt lgkmcnt(8)
    v_mfma_f32_16x16x32_bf16 v[120:123], v[200:203], v[72:75], v[120:123]
    v_mfma_f32_16x16x32_bf16 v[124:127], v[200:203], v[76:79], v[124:127]
    ds_read_b64_tr_b16 v[220:221], v231 offset:0
    ds_read_b64_tr_b16 v[222:223], v231 offset:4096
    v_mfma_f32_16x16x32_bf16 v[128:131], v[200:203], v[80:83], v[128:131]
    s_waitcnt lgkmcnt(8)
    v_mfma_f32_16x16x32_bf16 v[132:135], v[204:207], v[72:75], v[132:135]
    v_add_u32 v224, 147456, v245
    v_xor_b32 v225, 32, v224
    v_mfma_f32_16x16x32_bf16 v[136:139], v[204:207], v[76:79], v[136:139]
    v_xor_b32 v226, 64, v224
    v_xor_b32 v227, 96, v224
    v_mfma_f32_16x16x32_bf16 v[140:143], v[204:207], v[80:83], v[140:143]
    s_waitcnt lgkmcnt(6)
    v_mfma_f32_16x16x32_bf16 v[144:147], v[208:211], v[72:75], v[144:147]
    v_mfma_f32_16x16x32_bf16 v[148:151], v[208:211], v[76:79], v[148:151]
    v_mfma_f32_16x16x32_bf16 v[152:155], v[208:211], v[80:83], v[152:155]
    s_waitcnt vmcnt(12) lgkmcnt(0)
    s_barrier
    v_mfma_f32_16x16x32_bf16 v[156:159], v[212:215], v[72:75], v[156:159]
    ds_read_b64_tr_b16 v[192:193], v224 offset:0
    ds_read_b64_tr_b16 v[194:195], v224 offset:1024
    s_add_u32 m0, s59, 49152
    s_add_u32 s68, s46, 180224
    buffer_load_dwordx4 v240, s[12:15], s68 offen offset:0 nt lds
    v_mfma_f32_16x16x32_bf16 v[160:163], v[212:215], v[76:79], v[160:163]
    ds_read_b64_tr_b16 v[196:197], v225 offset:0
    ds_read_b64_tr_b16 v[198:199], v225 offset:1024
    v_mfma_f32_16x16x32_bf16 v[164:167], v[212:215], v[80:83], v[164:167]
    ds_read_b64_tr_b16 v[200:201], v226 offset:0
    ds_read_b64_tr_b16 v[202:203], v226 offset:1024
    v_mfma_f32_16x16x32_bf16 v[168:171], v[216:219], v[72:75], v[168:171]
    ds_read_b64_tr_b16 v[204:205], v227 offset:0
    ds_read_b64_tr_b16 v[206:207], v227 offset:1024
    v_mfma_f32_16x16x32_bf16 v[172:175], v[216:219], v[76:79], v[172:175]
    ds_read_b64_tr_b16 v[208:209], v224 offset:8192
    ds_read_b64_tr_b16 v[210:211], v224 offset:9216
    s_add_u32 s68, s68, 3072
    v_xor_b32 v244, 64, v240
    buffer_load_dwordx4 v244, s[12:15], s68 offen offset:1024 nt lds
    v_mfma_f32_16x16x32_bf16 v[176:179], v[216:219], v[80:83], v[176:179]
    v_mfma_f32_16x16x32_bf16 v[180:183], v[220:223], v[72:75], v[180:183]
    v_mfma_f32_16x16x32_bf16 v[184:187], v[220:223], v[76:79], v[184:187]
    v_mfma_f32_16x16x32_bf16 v[188:191], v[220:223], v[80:83], v[188:191]
    s_add_u32 s68, s68, 3072
    v_xor_b32 v244, 128, v240
    buffer_load_dwordx4 v244, s[12:15], s68 offen offset:2048 nt lds
    s_waitcnt lgkmcnt(8)
    v_mfma_f32_16x16x32_bf16 a[96:99], v[192:195], a[192:195], a[96:99]
    v_mfma_f32_16x16x32_bf16 a[100:103], v[192:195], a[196:199], a[100:103]
    ds_read_b64_tr_b16 v[212:213], v225 offset:8192
    ds_read_b64_tr_b16 v[214:215], v225 offset:9216
    v_mfma_f32_16x16x32_bf16 a[104:107], v[192:195], a[200:203], a[104:107]
    s_waitcnt lgkmcnt(8)
    v_mfma_f32_16x16x32_bf16 a[108:111], v[196:199], a[192:195], a[108:111]
    s_add_u32 s68, s68, 3072
    v_xor_b32 v244, 192, v240
    buffer_load_dwordx4 v244, s[12:15], s68 offen offset:3072 nt lds
    v_mfma_f32_16x16x32_bf16 a[112:115], v[196:199], a[196:199], a[112:115]
    ds_read_b64_tr_b16 v[216:217], v226 offset:8192
    ds_read_b64_tr_b16 v[218:219], v226 offset:9216
    v_mfma_f32_16x16x32_bf16 a[116:119], v[196:199], a[200:203], a[116:119]
    s_waitcnt lgkmcnt(8)
    v_mfma_f32_16x16x32_bf16 a[120:123], v[200:203], a[192:195], a[120:123]
    v_mfma_f32_16x16x32_bf16 a[124:127], v[200:203], a[196:199], a[124:127]
    ds_read_b64_tr_b16 v[220:221], v227 offset:8192
    ds_read_b64_tr_b16 v[222:223], v227 offset:9216
    v_mfma_f32_16x16x32_bf16 a[128:131], v[200:203], a[200:203], a[128:131]
    s_waitcnt lgkmcnt(8)
    v_mfma_f32_16x16x32_bf16 a[132:135], v[204:207], a[192:195], a[132:135]
    v_add_u32 v224, 81920, v245
    v_xor_b32 v225, 32, v224
    v_mfma_f32_16x16x32_bf16 a[136:139], v[204:207], a[196:199], a[136:139]
    v_xor_b32 v226, 64, v224
    v_xor_b32 v227, 96, v224
    v_mfma_f32_16x16x32_bf16 a[140:143], v[204:207], a[200:203], a[140:143]
    s_waitcnt lgkmcnt(6)
    v_mfma_f32_16x16x32_bf16 a[96:99], v[208:211], a[204:207], a[96:99]
    v_mfma_f32_16x16x32_bf16 a[100:103], v[208:211], a[208:211], a[100:103]
    v_mfma_f32_16x16x32_bf16 a[104:107], v[208:211], a[212:215], a[104:107]
    s_waitcnt vmcnt(8) lgkmcnt(0)
    s_barrier
    v_mfma_f32_16x16x32_bf16 a[108:111], v[212:215], a[204:207], a[108:111]
    ds_read_b64_tr_b16 v[192:193], v224 offset:0
    ds_read_b64_tr_b16 v[194:195], v224 offset:1024
    s_add_u32 m0, s59, 16384
    s_add_u32 s68, s46, 196608
    buffer_load_dwordx4 v240, s[12:15], s68 offen offset:0 nt lds
    v_mfma_f32_16x16x32_bf16 a[112:115], v[212:215], a[208:211], a[112:115]
    ds_read_b64_tr_b16 v[196:197], v225 offset:0
    ds_read_b64_tr_b16 v[198:199], v225 offset:1024
    v_mfma_f32_16x16x32_bf16 a[116:119], v[212:215], a[212:215], a[116:119]
    ds_read_b64_tr_b16 v[200:201], v226 offset:0
    ds_read_b64_tr_b16 v[202:203], v226 offset:1024
    v_mfma_f32_16x16x32_bf16 a[120:123], v[216:219], a[204:207], a[120:123]
    ds_read_b64_tr_b16 v[204:205], v227 offset:0
    ds_read_b64_tr_b16 v[206:207], v227 offset:1024
    v_mfma_f32_16x16x32_bf16 a[124:127], v[216:219], a[208:211], a[124:127]
    ds_read_b64_tr_b16 v[208:209], v224 offset:8192
    ds_read_b64_tr_b16 v[210:211], v224 offset:9216
    s_add_u32 s68, s68, 3072
    v_xor_b32 v244, 64, v240
    buffer_load_dwordx4 v244, s[12:15], s68 offen offset:1024 nt lds
    v_mfma_f32_16x16x32_bf16 a[128:131], v[216:219], a[212:215], a[128:131]
    v_mfma_f32_16x16x32_bf16 a[132:135], v[220:223], a[204:207], a[132:135]
    v_mfma_f32_16x16x32_bf16 a[136:139], v[220:223], a[208:211], a[136:139]
    v_mfma_f32_16x16x32_bf16 a[140:143], v[220:223], a[212:215], a[140:143]
    s_add_u32 s68, s68, 3072
    v_xor_b32 v244, 128, v240
    buffer_load_dwordx4 v244, s[12:15], s68 offen offset:2048 nt lds
    s_waitcnt lgkmcnt(8)
    v_mfma_f32_16x16x32_bf16 a[96:99], v[192:195], a[216:219], a[96:99]
    v_mfma_f32_16x16x32_bf16 a[100:103], v[192:195], a[220:223], a[100:103]
    ds_read_b64_tr_b16 v[212:213], v225 offset:8192
    ds_read_b64_tr_b16 v[214:215], v225 offset:9216
    v_mfma_f32_16x16x32_bf16 a[104:107], v[192:195], a[224:227], a[104:107]
    s_waitcnt lgkmcnt(8)
    v_mfma_f32_16x16x32_bf16 a[108:111], v[196:199], a[216:219], a[108:111]
    s_add_u32 s68, s68, 3072
    v_xor_b32 v244, 192, v240
    buffer_load_dwordx4 v244, s[12:15], s68 offen offset:3072 nt lds
    v_mfma_f32_16x16x32_bf16 a[112:115], v[196:199], a[220:223], a[112:115]
    ds_read_b64_tr_b16 v[216:217], v226 offset:8192
    ds_read_b64_tr_b16 v[218:219], v226 offset:9216
    v_mfma_f32_16x16x32_bf16 a[116:119], v[196:199], a[224:227], a[116:119]
    s_waitcnt lgkmcnt(8)
    v_mfma_f32_16x16x32_bf16 a[120:123], v[200:203], a[216:219], a[120:123]
    v_mfma_f32_16x16x32_bf16 a[124:127], v[200:203], a[220:223], a[124:127]
    ds_read_b64_tr_b16 v[220:221], v227 offset:8192
    ds_read_b64_tr_b16 v[222:223], v227 offset:9216
    v_mfma_f32_16x16x32_bf16 a[128:131], v[200:203], a[224:227], a[128:131]
    s_waitcnt lgkmcnt(8)
    v_mfma_f32_16x16x32_bf16 a[132:135], v[204:207], a[216:219], a[132:135]
    v_add_u32 v224, 32768, v247
    v_xor_b32 v225, 32, v224
    v_mfma_f32_16x16x32_bf16 a[136:139], v[204:207], a[220:223], a[136:139]
    v_xor_b32 v226, 64, v224
    v_xor_b32 v227, 96, v224
    v_mfma_f32_16x16x32_bf16 a[140:143], v[204:207], a[224:227], a[140:143]
    v_xor_b32 v228, 128, v224
    v_xor_b32 v229, 160, v224
    s_waitcnt lgkmcnt(6)
    v_mfma_f32_16x16x32_bf16 a[96:99], v[208:211], a[228:231], a[96:99]
    v_xor_b32 v230, 192, v224
    v_xor_b32 v231, 224, v224
    v_mfma_f32_16x16x32_bf16 a[100:103], v[208:211], a[232:235], a[100:103]
    v_mfma_f32_16x16x32_bf16 a[104:107], v[208:211], a[236:239], a[104:107]
    s_waitcnt lgkmcnt(0)
    s_barrier
    v_mfma_f32_16x16x32_bf16 a[108:111], v[212:215], a[228:231], a[108:111]
    ds_read_b64_tr_b16 v[192:193], v224 offset:0
    ds_read_b64_tr_b16 v[194:195], v224 offset:4096
    s_add_u32 m0, s59, 81920
    s_add_u32 s68, s46, 212992
    buffer_load_dwordx4 v240, s[12:15], s68 offen offset:0 nt lds
    v_mfma_f32_16x16x32_bf16 a[112:115], v[212:215], a[232:235], a[112:115]
    ds_read_b64_tr_b16 v[196:197], v225 offset:0
    ds_read_b64_tr_b16 v[198:199], v225 offset:4096
    v_mfma_f32_16x16x32_bf16 a[116:119], v[212:215], a[236:239], a[116:119]
    ds_read_b64_tr_b16 v[200:201], v226 offset:0
    ds_read_b64_tr_b16 v[202:203], v226 offset:4096
    v_mfma_f32_16x16x32_bf16 a[120:123], v[216:219], a[228:231], a[120:123]
    ds_read_b64_tr_b16 v[204:205], v227 offset:0
    ds_read_b64_tr_b16 v[206:207], v227 offset:4096
    v_mfma_f32_16x16x32_bf16 a[124:127], v[216:219], a[232:235], a[124:127]
    ds_read_b64_tr_b16 v[208:209], v228 offset:0
    ds_read_b64_tr_b16 v[210:211], v228 offset:4096
    s_add_u32 s68, s68, 3072
    v_xor_b32 v244, 64, v240
    buffer_load_dwordx4 v244, s[12:15], s68 offen offset:1024 nt lds
    v_mfma_f32_16x16x32_bf16 a[128:131], v[216:219], a[236:239], a[128:131]
    v_mfma_f32_16x16x32_bf16 a[132:135], v[220:223], a[228:231], a[132:135]
    v_mfma_f32_16x16x32_bf16 a[136:139], v[220:223], a[232:235], a[136:139]
    v_mfma_f32_16x16x32_bf16 a[140:143], v[220:223], a[236:239], a[140:143]
    s_add_u32 s68, s68, 3072
    v_xor_b32 v244, 128, v240
    buffer_load_dwordx4 v244, s[12:15], s68 offen offset:2048 nt lds
    s_waitcnt lgkmcnt(8)
    v_mfma_f32_16x16x32_bf16 v[96:99], v[192:195], v[84:87], v[96:99]
    v_mfma_f32_16x16x32_bf16 v[100:103], v[192:195], v[88:91], v[100:103]
    ds_read_b64_tr_b16 v[212:213], v229 offset:0
    ds_read_b64_tr_b16 v[214:215], v229 offset:4096
    v_mfma_f32_16x16x32_bf16 v[104:107], v[192:195], v[92:95], v[104:107]
    s_waitcnt lgkmcnt(8)
    v_mfma_f32_16x16x32_bf16 v[108:111], v[196:199], v[84:87], v[108:111]
    s_add_u32 s68, s68, 3072
    v_xor_b32 v244, 192, v240
    buffer_load_dwordx4 v244, s[12:15], s68 offen offset:3072 nt lds
    v_mfma_f32_16x16x32_bf16 v[112:115], v[196:199], v[88:91], v[112:115]
    ds_read_b64_tr_b16 v[216:217], v230 offset:0
    ds_read_b64_tr_b16 v[218:219], v230 offset:4096
    v_mfma_f32_16x16x32_bf16 v[116:119], v[196:199], v[92:95], v[116:119]
    s_waitcnt lgkmcnt(8)
    v_mfma_f32_16x16x32_bf16 v[120:123], v[200:203], v[84:87], v[120:123]
    v_mfma_f32_16x16x32_bf16 v[124:127], v[200:203], v[88:91], v[124:127]
    ds_read_b64_tr_b16 v[220:221], v231 offset:0
    ds_read_b64_tr_b16 v[222:223], v231 offset:4096
    v_mfma_f32_16x16x32_bf16 v[128:131], v[200:203], v[92:95], v[128:131]
    s_waitcnt lgkmcnt(8)
    v_mfma_f32_16x16x32_bf16 v[132:135], v[204:207], v[84:87], v[132:135]
    v_mfma_f32_16x16x32_bf16 v[136:139], v[204:207], v[88:91], v[136:139]
    v_mfma_f32_16x16x32_bf16 v[140:143], v[204:207], v[92:95], v[140:143]
    s_waitcnt lgkmcnt(6)
    v_mfma_f32_16x16x32_bf16 v[144:147], v[208:211], v[84:87], v[144:147]
    v_mfma_f32_16x16x32_bf16 v[148:151], v[208:211], v[88:91], v[148:151]
    v_mfma_f32_16x16x32_bf16 v[152:155], v[208:211], v[92:95], v[152:155]
    s_waitcnt lgkmcnt(4)
    v_mfma_f32_16x16x32_bf16 v[156:159], v[212:215], v[84:87], v[156:159]
    v_mfma_f32_16x16x32_bf16 v[160:163], v[212:215], v[88:91], v[160:163]
    v_mfma_f32_16x16x32_bf16 v[164:167], v[212:215], v[92:95], v[164:167]
    s_waitcnt lgkmcnt(2)
    v_mfma_f32_16x16x32_bf16 v[168:171], v[216:219], v[84:87], v[168:171]
    v_mfma_f32_16x16x32_bf16 v[172:175], v[216:219], v[88:91], v[172:175]
    v_mfma_f32_16x16x32_bf16 v[176:179], v[216:219], v[92:95], v[176:179]
    s_waitcnt lgkmcnt(0)
    v_mfma_f32_16x16x32_bf16 v[180:183], v[220:223], v[84:87], v[180:183]
    v_mfma_f32_16x16x32_bf16 v[184:187], v[220:223], v[88:91], v[184:187]
    v_mfma_f32_16x16x32_bf16 v[188:191], v[220:223], v[92:95], v[188:191]
    s_mul_i32 s48, s40, 12288
    s_add_u32 s48, s48, 114688
    v_add_u32 v192, s48, v248
    s_xor_b32 s49, s40, 2
    s_mul_i32 s49, s49, 12288
    s_add_u32 s49, s49, 114688
    v_add_u32 v193, s49, v248
    ds_write_b128 v192, v[144:147] offset:0
    v_mul_f32 v96, v96, v249
    v_mul_f32 v97, v97, v249
    v_mul_f32 v98, v98, v249
    v_mul_f32 v99, v99, v249
    ds_write_b128 v192, v[148:151] offset:1024
    v_mul_f32 v100, v100, v250
    v_mul_f32 v101, v101, v250
    v_mul_f32 v102, v102, v250
    v_mul_f32 v103, v103, v250
    ds_write_b128 v192, v[152:155] offset:2048
    v_mul_f32 v104, v104, v251
    v_mul_f32 v105, v105, v251
    v_mul_f32 v106, v106, v251
    v_mul_f32 v107, v107, v251
    ds_write_b128 v192, v[156:159] offset:3072
    v_mul_f32 v108, v108, v249
    v_mul_f32 v109, v109, v249
    v_mul_f32 v110, v110, v249
    v_mul_f32 v111, v111, v249
    ds_write_b128 v192, v[160:163] offset:4096
    v_mul_f32 v112, v112, v250
    v_mul_f32 v113, v113, v250
    v_mul_f32 v114, v114, v250
    v_mul_f32 v115, v115, v250
    ds_write_b128 v192, v[164:167] offset:5120
    v_mul_f32 v116, v116, v251
    v_mul_f32 v117, v117, v251
    v_mul_f32 v118, v118, v251
    v_mul_f32 v119, v119, v251
    ds_write_b128 v192, v[168:171] offset:6144
    v_mul_f32 v120, v120, v249
    v_mul_f32 v121, v121, v249
    v_mul_f32 v122, v122, v249
    v_mul_f32 v123, v123, v249
    ds_write_b128 v192, v[172:175] offset:7168
    v_mul_f32 v124, v124, v250
    v_mul_f32 v125, v125, v250
    v_mul_f32 v126, v126, v250
    v_mul_f32 v127, v127, v250
    ds_write_b128 v192, v[176:179] offset:8192
    v_mul_f32 v128, v128, v251
    v_mul_f32 v129, v129, v251
    v_mul_f32 v130, v130, v251
    v_mul_f32 v131, v131, v251
    ds_write_b128 v192, v[180:183] offset:9216
    v_mul_f32 v132, v132, v249
    v_mul_f32 v133, v133, v249
    v_mul_f32 v134, v134, v249
    v_mul_f32 v135, v135, v249
    ds_write_b128 v192, v[184:187] offset:10240
    v_mul_f32 v136, v136, v250
    v_mul_f32 v137, v137, v250
    v_mul_f32 v138, v138, v250
    v_mul_f32 v139, v139, v250
    ds_write_b128 v192, v[188:191] offset:11264
    v_mul_f32 v140, v140, v251
    v_mul_f32 v141, v141, v251
    v_mul_f32 v142, v142, v251
    v_mul_f32 v143, v143, v251
    s_waitcnt lgkmcnt(0)
    s_barrier
    ds_read_b128 v[0:3], v193 offset:0
    ds_read_b128 v[12:15], v193 offset:3072
    ds_read_b128 v[4:7], v193 offset:1024
    ds_read_b128 v[16:19], v193 offset:4096
    ds_read_b128 v[8:11], v193 offset:2048
    ds_read_b128 v[20:23], v193 offset:5120
    ds_read_b128 v[24:27], v193 offset:6144
    ds_read_b128 v[36:39], v193 offset:9216
    ds_read_b128 v[28:31], v193 offset:7168
    ds_read_b128 v[40:43], v193 offset:10240
    ds_read_b128 v[32:35], v193 offset:8192
    ds_read_b128 v[44:47], v193 offset:11264
    s_add_u32 s48, s62, 0
    s_add_u32 s49, s48, 2048
    s_add_u32 s50, s48, 4096
    s_waitcnt lgkmcnt(11)
    v_fma_f32 v96, v0, v252, v96
    v_fma_f32 v97, v1, v252, v97
    v_fma_f32 v98, v2, v252, v98
    v_fma_f32 v99, v3, v252, v99
    v_cvt_pk_bf16_f32 v48, v96, v97
    v_cvt_pk_bf16_f32 v49, v98, v99
    s_waitcnt lgkmcnt(10)
    v_fma_f32 v108, v12, v252, v108
    v_fma_f32 v109, v13, v252, v109
    v_fma_f32 v110, v14, v252, v110
    v_fma_f32 v111, v15, v252, v111
    v_cvt_pk_bf16_f32 v50, v108, v109
    v_cvt_pk_bf16_f32 v51, v110, v111
    buffer_store_dwordx4 v[48:51], v248, s[32:35], s48 offen offset:0 sc1
    v_accvgpr_write_b32 a48, v48
    v_accvgpr_write_b32 a49, v49
    v_accvgpr_write_b32 a50, v50
    v_accvgpr_write_b32 a51, v51
    s_waitcnt lgkmcnt(9)
    v_fma_f32 v100, v4, v253, v100
    v_fma_f32 v101, v5, v253, v101
    v_fma_f32 v102, v6, v253, v102
    v_fma_f32 v103, v7, v253, v103
    v_cvt_pk_bf16_f32 v52, v100, v101
    v_cvt_pk_bf16_f32 v53, v102, v103
    s_waitcnt lgkmcnt(8)
    v_fma_f32 v112, v16, v253, v112
    v_fma_f32 v113, v17, v253, v113
    v_fma_f32 v114, v18, v253, v114
    v_fma_f32 v115, v19, v253, v115
    v_cvt_pk_bf16_f32 v54, v112, v113
    v_cvt_pk_bf16_f32 v55, v114, v115
    buffer_store_dwordx4 v[52:55], v248, s[32:35], s49 offen offset:0 sc1
    v_accvgpr_write_b32 a52, v52
    v_accvgpr_write_b32 a53, v53
    v_accvgpr_write_b32 a54, v54
    v_accvgpr_write_b32 a55, v55
    s_waitcnt lgkmcnt(7)
    v_fma_f32 v104, v8, v254, v104
    v_fma_f32 v105, v9, v254, v105
    v_fma_f32 v106, v10, v254, v106
    v_fma_f32 v107, v11, v254, v107
    v_cvt_pk_bf16_f32 v56, v104, v105
    v_cvt_pk_bf16_f32 v57, v106, v107
    s_waitcnt lgkmcnt(6)
    v_fma_f32 v116, v20, v254, v116
    v_fma_f32 v117, v21, v254, v117
    v_fma_f32 v118, v22, v254, v118
    v_fma_f32 v119, v23, v254, v119
    v_cvt_pk_bf16_f32 v58, v116, v117
    v_cvt_pk_bf16_f32 v59, v118, v119
    buffer_store_dwordx4 v[56:59], v248, s[32:35], s50 offen offset:0 sc1
    v_accvgpr_write_b32 a56, v56
    v_accvgpr_write_b32 a57, v57
    v_accvgpr_write_b32 a58, v58
    v_accvgpr_write_b32 a59, v59
    s_waitcnt lgkmcnt(5)
    v_fma_f32 v120, v24, v252, v120
    v_fma_f32 v121, v25, v252, v121
    v_fma_f32 v122, v26, v252, v122
    v_fma_f32 v123, v27, v252, v123
    v_cvt_pk_bf16_f32 v60, v120, v121
    v_cvt_pk_bf16_f32 v61, v122, v123
    s_waitcnt lgkmcnt(4)
    v_fma_f32 v132, v36, v252, v132
    v_fma_f32 v133, v37, v252, v133
    v_fma_f32 v134, v38, v252, v134
    v_fma_f32 v135, v39, v252, v135
    v_cvt_pk_bf16_f32 v62, v132, v133
    v_cvt_pk_bf16_f32 v63, v134, v135
    buffer_store_dwordx4 v[60:63], v248, s[32:35], s48 offen offset:1024 sc1
    v_accvgpr_write_b32 a60, v60
    v_accvgpr_write_b32 a61, v61
    v_accvgpr_write_b32 a62, v62
    v_accvgpr_write_b32 a63, v63
    s_waitcnt lgkmcnt(3)
    v_fma_f32 v124, v28, v253, v124
    v_fma_f32 v125, v29, v253, v125
    v_fma_f32 v126, v30, v253, v126
    v_fma_f32 v127, v31, v253, v127
    v_cvt_pk_bf16_f32 v64, v124, v125
    v_cvt_pk_bf16_f32 v65, v126, v127
    s_waitcnt lgkmcnt(2)
    v_fma_f32 v136, v40, v253, v136
    v_fma_f32 v137, v41, v253, v137
    v_fma_f32 v138, v42, v253, v138
    v_fma_f32 v139, v43, v253, v139
    v_cvt_pk_bf16_f32 v66, v136, v137
    v_cvt_pk_bf16_f32 v67, v138, v139
    buffer_store_dwordx4 v[64:67], v248, s[32:35], s49 offen offset:1024 sc1
    v_accvgpr_write_b32 a64, v64
    v_accvgpr_write_b32 a65, v65
    v_accvgpr_write_b32 a66, v66
    v_accvgpr_write_b32 a67, v67
    s_waitcnt lgkmcnt(1)
    v_fma_f32 v128, v32, v254, v128
    v_fma_f32 v129, v33, v254, v129
    v_fma_f32 v130, v34, v254, v130
    v_fma_f32 v131, v35, v254, v131
    v_cvt_pk_bf16_f32 v68, v128, v129
    v_cvt_pk_bf16_f32 v69, v130, v131
    s_waitcnt lgkmcnt(0)
    v_fma_f32 v140, v44, v254, v140
    v_fma_f32 v141, v45, v254, v141
    v_fma_f32 v142, v46, v254, v142
    v_fma_f32 v143, v47, v254, v143
    v_cvt_pk_bf16_f32 v70, v140, v141
    v_cvt_pk_bf16_f32 v71, v142, v143
    buffer_store_dwordx4 v[68:71], v248, s[32:35], s50 offen offset:1024 sc1
    v_accvgpr_write_b32 a68, v68
    v_accvgpr_write_b32 a69, v69
    v_accvgpr_write_b32 a70, v70
    v_accvgpr_write_b32 a71, v71
    v_accvgpr_read_b32 v239, a247
    s_mov_b32 s70, 0
L_nonce_Y:
    v_readfirstlane_b32 s71, v239
    s_nop 0
    s_cmp_lg_u32 s71, 0
    s_cbranch_scc1 L_nonce_ok_Y
    s_add_u32 s70, s70, 1
    s_cmp_gt_u32 s70, 20000
    s_cbranch_scc1 L_nonce_ok_Y
    s_sleep 2
    buffer_load_dword v239, off, s[36:39], 0 offset:4 sc1
    s_waitcnt vmcnt(0)
    s_branch L_nonce_Y
L_nonce_ok_Y:
    v_lshrrev_b32 v228, 8, v248
    v_bfe_u32 v229, v248, 4, 4
    v_lshrrev_b32 v230, 1, v228
    v_xor_b32 v230, v230, v229
    v_lshlrev_b32 v230, 4, v230
    v_lshl_add_u32 v230, v229, 8, v230
    v_and_b32 v231, 1, v228
    v_lshl_add_u32 v230, v231, 3, v230
    s_mul_i32 s48, s41, 12288
    s_add_u32 s48, s48, 114688
    s_lshl_b32 s49, s42, 7
    v_xor_b32 v192, s49, v230
    v_add_u32 v192, s48, v192
    v_xor_b32 v193, 32, v192
    v_xor_b32 v194, 64, v192
    v_xor_b32 v195, 96, v192
    v_xor_b32 v230, v228, v229
    v_lshlrev_b32 v230, 4, v230
    v_lshl_add_u32 v230, v229, 8, v230
    v_add_u32 v196, s48, v230
    v_xor_b32 v197, 64, v196
    v_xor_b32 v198, 128, v196
    v_xor_b32 v199, 192, v196
    v_accvgpr_read_b32 v224, a96
    v_accvgpr_read_b32 v225, a97
    v_accvgpr_read_b32 v226, a98
    v_accvgpr_read_b32 v227, a99
    v_cvt_pk_bf16_f32 v200, v224, v225
    v_cvt_pk_bf16_f32 v201, v226, v227
    v_accvgpr_read_b32 v224, a100
    v_accvgpr_read_b32 v225, a101
    v_accvgpr_read_b32 v226, a102
    v_accvgpr_read_b32 v227, a103
    v_cvt_pk_bf16_f32 v202, v224, v225
    v_cvt_pk_bf16_f32 v203, v226, v227
    v_accvgpr_read_b32 v224, a104
    v_accvgpr_read_b32 v225, a105
    v_accvgpr_read_b32 v226, a106
    v_accvgpr_read_b32 v227, a107
    v_cvt_pk_bf16_f32 v204, v224, v225
    v_cvt_pk_bf16_f32 v205, v226, v227
    v_accvgpr_read_b32 v224, a108
    v_accvgpr_read_b32 v225, a109
    v_accvgpr_read_b32 v226, a110
    v_accvgpr_read_b32 v227, a111
    v_cvt_pk_bf16_f32 v206, v224, v225
    v_cvt_pk_bf16_f32 v207, v226, v227
    v_accvgpr_read_b32 v224, a112
    v_accvgpr_read_b32 v225, a113
    v_accvgpr_read_b32 v226, a114
    v_accvgpr_read_b32 v227, a115
    v_cvt_pk_bf16_f32 v208, v224, v225
    v_cvt_pk_bf16_f32 v209, v226, v227
    v_accvgpr_read_b32 v224, a116
    v_accvgpr_read_b32 v225, a117
    v_accvgpr_read_b32 v226, a118
    v_accvgpr_read_b32 v227, a119
    v_cvt_pk_bf16_f32 v210, v224, v225
    v_cvt_pk_bf16_f32 v211, v226, v227
    v_accvgpr_read_b32 v224, a120
    v_accvgpr_read_b32 v225, a121
    v_accvgpr_read_b32 v226, a122
    v_accvgpr_read_b32 v227, a123
    v_cvt_pk_bf16_f32 v212, v224, v225
    v_cvt_pk_bf16_f32 v213, v226, v227
    v_accvgpr_read_b32 v224, a124
    v_accvgpr_read_b32 v225, a125
    v_accvgpr_read_b32 v226, a126
    v_accvgpr_read_b32 v227, a127
    v_cvt_pk_bf16_f32 v214, v224, v225
    v_cvt_pk_bf16_f32 v215, v226, v227
    v_accvgpr_read_b32 v224, a128
    v_accvgpr_read_b32 v225, a129
    v_accvgpr_read_b32 v226, a130
    v_accvgpr_read_b32 v227, a131
    v_cvt_pk_bf16_f32 v216, v224, v225
    v_cvt_pk_bf16_f32 v217, v226, v227
    v_accvgpr_read_b32 v224, a132
    v_accvgpr_read_b32 v225, a133
    v_accvgpr_read_b32 v226, a134
    v_accvgpr_read_b32 v227, a135
    v_cvt_pk_bf16_f32 v218, v224, v225
    v_cvt_pk_bf16_f32 v219, v226, v227
    v_accvgpr_read_b32 v224, a136
    v_accvgpr_read_b32 v225, a137
    v_accvgpr_read_b32 v226, a138
    v_accvgpr_read_b32 v227, a139
    v_cvt_pk_bf16_f32 v220, v224, v225
    v_cvt_pk_bf16_f32 v221, v226, v227
    v_accvgpr_read_b32 v224, a140
    v_accvgpr_read_b32 v225, a141
    v_accvgpr_read_b32 v226, a142
    v_accvgpr_read_b32 v227, a143
    v_cvt_pk_bf16_f32 v222, v224, v225
    v_cvt_pk_bf16_f32 v223, v226, v227
    s_barrier
    ds_write_b64 v192, v[200:201] offset:0
    ds_write_b64 v192, v[202:203] offset:4096
    ds_write_b64 v192, v[204:205] offset:8192
    ds_write_b64 v193, v[206:207] offset:0
    ds_write_b64 v193, v[208:209] offset:4096
    ds_write_b64 v193, v[210:211] offset:8192
    ds_write_b64 v194, v[212:213] offset:0
    ds_write_b64 v194, v[214:215] offset:4096
    ds_write_b64 v194, v[216:217] offset:8192
    ds_write_b64 v195, v[218:219] offset:0
    ds_write_b64 v195, v[220:221] offset:4096
    ds_write_b64 v195, v[222:223] offset:8192
    s_waitcnt lgkmcnt(0)
    s_barrier
    ds_read_b128 a[144:147], v196 offset:0
    ds_read_b128 a[148:151], v197 offset:0
    ds_read_b128 a[152:155], v198 offset:0
    ds_read_b128 a[156:159], v199 offset:0
    ds_read_b128 a[160:163], v196 offset:4096
    ds_read_b128 a[164:167], v197 offset:4096
    ds_read_b128 a[168:171], v198 offset:4096
    ds_read_b128 a[172:175], v199 offset:4096
    ds_read_b128 a[176:179], v196 offset:8192
    ds_read_b128 a[180:183], v197 offset:8192
    ds_read_b128 a[184:187], v198 offset:8192
    ds_read_b128 a[188:191], v199 offset:8192
    v_add_u32 v224, 98304, v246
    s_add_u32 m0, s59, 32768
    s_add_u32 s68, s46, 229376
    buffer_load_dwordx4 v240, s[12:15], s68 offen offset:0 nt lds
    v_xor_b32 v225, 64, v224
    v_xor_b32 v226, 128, v224
    v_xor_b32 v227, 192, v224
    s_waitcnt lgkmcnt(0)
    s_barrier
    ds_read_b128 v[192:195], v224 offset:0
    ds_read_b128 v[196:199], v225 offset:0
    ds_read_b128 v[200:203], v226 offset:0
    ds_read_b128 v[204:207], v227 offset:0
    ds_read_b128 v[208:211], v224 offset:4096
    s_waitcnt lgkmcnt(4)
    v_mfma_f32_16x16x32_bf16 v[0:3], v[192:195], a[144:147], 0
    s_add_u32 s68, s68, 3072
    v_xor_b32 v244, 64, v240
    buffer_load_dwordx4 v244, s[12:15], s68 offen offset:1024 nt lds
    v_mfma_f32_16x16x32_bf16 v[8:11], v[192:195], a[160:163], 0
    ds_read_b128 v[212:215], v225 offset:4096
    v_mfma_f32_16x16x32_bf16 v[16:19], v[192:195], a[176:179], 0
    s_waitcnt lgkmcnt(4)
    v_mfma_f32_16x16x32_bf16 v[0:3], v[196:199], a[148:151], v[0:3]
    v_mfma_f32_16x16x32_bf16 v[8:11], v[196:199], a[164:167], v[8:11]
    ds_read_b128 v[216:219], v226 offset:4096
    s_add_u32 s68, s68, 3072
    v_xor_b32 v244, 128, v240
    buffer_load_dwordx4 v244, s[12:15], s68 offen offset:2048 nt lds
    v_mfma_f32_16x16x32_bf16 v[16:19], v[196:199], a[180:183], v[16:19]
    s_waitcnt lgkmcnt(4)
    v_mfma_f32_16x16x32_bf16 v[0:3], v[200:203], a[152:155], v[0:3]
    v_mfma_f32_16x16x32_bf16 v[8:11], v[200:203], a[168:171], v[8:11]
    ds_read_b128 v[220:223], v227 offset:4096
    v_mfma_f32_16x16x32_bf16 v[16:19], v[200:203], a[184:187], v[16:19]
    s_add_u32 s68, s68, 3072
    v_xor_b32 v244, 192, v240
    buffer_load_dwordx4 v244, s[12:15], s68 offen offset:3072 nt lds
    s_waitcnt lgkmcnt(4)
    v_mfma_f32_16x16x32_bf16 v[0:3], v[204:207], a[156:159], v[0:3]
    v_add_u32 v224, 65536, v246
    v_xor_b32 v225, 64, v224
    v_mfma_f32_16x16x32_bf16 v[8:11], v[204:207], a[172:175], v[8:11]
    v_xor_b32 v226, 128, v224
    v_xor_b32 v227, 192, v224
    v_mfma_f32_16x16x32_bf16 v[16:19], v[204:207], a[188:191], v[16:19]
    s_waitcnt lgkmcnt(3)
    v_mfma_f32_16x16x32_bf16 v[4:7], v[208:211], a[144:147], 0
    v_mfma_f32_16x16x32_bf16 v[12:15], v[208:211], a[160:163], 0
    v_mfma_f32_16x16x32_bf16 v[20:23], v[208:211], a[176:179], 0
    s_waitcnt lgkmcnt(0)
    s_barrier
    v_mfma_f32_16x16x32_bf16 v[4:7], v[212:215], a[148:151], v[4:7]
    ds_read_b128 v[192:195], v224 offset:0
    ds_read_b128 v[196:199], v225 offset:0
    v_mfma_f32_16x16x32_bf16 v[12:15], v[212:215], a[164:167], v[12:15]
    ds_read_b128 v[200:203], v226 offset:0
    ds_read_b128 v[204:207], v227 offset:0
    v_mfma_f32_16x16x32_bf16 v[20:23], v[212:215], a[180:183], v[20:23]
    ds_read_b128 v[208:211], v224 offset:4096
    v_mfma_f32_16x16x32_bf16 v[4:7], v[216:219], a[152:155], v[4:7]
    v_mfma_f32_16x16x32_bf16 v[12:15], v[216:219], a[168:171], v[12:15]
    v_mfma_f32_16x16x32_bf16 v[20:23], v[216:219], a[184:187], v[20:23]
    v_mfma_f32_16x16x32_bf16 v[4:7], v[220:223], a[156:159], v[4:7]
    v_mfma_f32_16x16x32_bf16 v[12:15], v[220:223], a[172:175], v[12:15]
    v_mfma_f32_16x16x32_bf16 v[20:23], v[220:223], a[188:191], v[20:23]
    s_waitcnt lgkmcnt(4)
    v_mfma_f32_16x16x32_bf16 v[24:27], v[192:195], a[144:147], 0
    v_max_f32 v232, v0, v1
    v_max_f32 v233, v8, v9
    v_mfma_f32_16x16x32_bf16 v[32:35], v[192:195], a[160:163], 0
    ds_read_b128 v[212:215], v225 offset:4096
    v_max_f32 v234, v16, v17
    v_mfma_f32_16x16x32_bf16 v[40:43], v[192:195], a[176:179], 0
    v_max3_f32 v232, v232, v2, v3
    v_max3_f32 v233, v233, v10, v11
    s_waitcnt lgkmcnt(4)
    v_mfma_f32_16x16x32_bf16 v[24:27], v[196:199], a[148:151], v[24:27]
    v_max3_f32 v234, v234, v18, v19
    v_max3_f32 v232, v232, v4, v5
    v_mfma_f32_16x16x32_bf16 v[32:35], v[196:199], a[164:167], v[32:35]
    ds_read_b128 v[216:219], v226 offset:4096
    v_max3_f32 v233, v233, v12, v13
    v_mfma_f32_16x16x32_bf16 v[40:43], v[196:199], a[180:183], v[40:43]
    v_max3_f32 v234, v234, v20, v21
    v_max3_f32 v232, v232, v6, v7
    s_waitcnt lgkmcnt(4)
    v_mfma_f32_16x16x32_bf16 v[24:27], v[200:203], a[152:155], v[24:27]
    v_max3_f32 v233, v233, v14, v15
    v_max3_f32 v234, v234, v22, v23
    v_mfma_f32_16x16x32_bf16 v[32:35], v[200:203], a[168:171], v[32:35]
    ds_read_b128 v[220:223], v227 offset:4096
    v_mfma_f32_16x16x32_bf16 v[40:43], v[200:203], a[184:187], v[40:43]
    s_waitcnt lgkmcnt(4)
    v_mfma_f32_16x16x32_bf16 v[24:27], v[204:207], a[156:159], v[24:27]
    v_add_u32 v224, 0, v246
    v_xor_b32 v225, 64, v224
    v_mfma_f32_16x16x32_bf16 v[32:35], v[204:207], a[172:175], v[32:35]
    v_xor_b32 v226, 128, v224
    v_xor_b32 v227, 192, v224
    v_mfma_f32_16x16x32_bf16 v[40:43], v[204:207], a[188:191], v[40:43]
    s_waitcnt lgkmcnt(3)
    v_mfma_f32_16x16x32_bf16 v[28:31], v[208:211], a[144:147], 0
    v_mfma_f32_16x16x32_bf16 v[36:39], v[208:211], a[160:163], 0
    v_mfma_f32_16x16x32_bf16 v[44:47], v[208:211], a[176:179], 0
    s_waitcnt vmcnt(22) lgkmcnt(0)
    s_barrier
    v_mfma_f32_16x16x32_bf16 v[28:31], v[212:215], a[148:151], v[28:31]
    ds_read_b128 v[192:195], v224 offset:0
    ds_read_b128 v[196:199], v225 offset:0
    v_mfma_f32_16x16x32_bf16 v[36:39], v[212:215], a[164:167], v[36:39]
    ds_read_b128 v[200:203], v226 offset:0
    ds_read_b128 v[204:207], v227 offset:0
    v_mfma_f32_16x16x32_bf16 v[44:47], v[212:215], a[180:183], v[44:47]
    ds_read_b128 v[208:211], v224 offset:4096
    v_mfma_f32_16x16x32_bf16 v[28:31], v[216:219], a[152:155], v[28:31]
    v_mfma_f32_16x16x32_bf16 v[36:39], v[216:219], a[168:171], v[36:39]
    v_mfma_f32_16x16x32_bf16 v[44:47], v[216:219], a[184:187], v[44:47]
    v_mfma_f32_16x16x32_bf16 v[28:31], v[220:223], a[156:159], v[28:31]
    v_mfma_f32_16x16x32_bf16 v[36:39], v[220:223], a[172:175], v[36:39]
    v_mfma_f32_16x16x32_bf16 v[44:47], v[220:223], a[188:191], v[44:47]
    s_waitcnt lgkmcnt(4)
    v_mfma_f32_16x16x32_bf16 v[48:51], v[192:195], a[144:147], 0
    v_max3_f32 v232, v232, v24, v25
    v_max3_f32 v233, v233, v32, v33
    v_mfma_f32_16x16x32_bf16 v[56:59], v[192:195], a[160:163], 0
    ds_read_b128 v[212:215], v225 offset:4096
    v_max3_f32 v234, v234, v40, v41
    v_mfma_f32_16x16x32_bf16 v[64:67], v[192:195], a[176:179], 0
    v_max3_f32 v232, v232, v26, v27
    v_max3_f32 v233, v233, v34, v35
    s_waitcnt lgkmcnt(4)
    v_mfma_f32_16x16x32_bf16 v[48:51], v[196:199], a[148:151], v[48:51]
    v_max3_f32 v234, v234, v42, v43
    v_max3_f32 v232, v232, v28, v29
    v_mfma_f32_16x16x32_bf16 v[56:59], v[196:199], a[164:167], v[56:59]
    ds_read_b128 v[216:219], v226 offset:4096
    v_max3_f32 v233, v233, v36, v37
    v_mfma_f32_16x16x32_bf16 v[64:67], v[196:199], a[180:183], v[64:67]
    v_max3_f32 v234, v234, v44, v45
    v_max3_f32 v232, v232, v30, v31
    s_waitcnt lgkmcnt(4)
    v_mfma_f32_16x16x32_bf16 v[48:51], v[200:203], a[152:155], v[48:51]
    v_max3_f32 v233, v233, v38, v39
    v_max3_f32 v234, v234, v46, v47
    v_mfma_f32_16x16x32_bf16 v[56:59], v[200:203], a[168:171], v[56:59]
    ds_read_b128 v[220:223], v227 offset:4096
    v_mfma_f32_16x16x32_bf16 v[64:67], v[200:203], a[184:187], v[64:67]
    s_waitcnt lgkmcnt(4)
    v_mfma_f32_16x16x32_bf16 v[48:51], v[204:207], a[156:159], v[48:51]
    v_add_u32 v224, 49152, v246
    v_xor_b32 v225, 64, v224
    v_mfma_f32_16x16x32_bf16 v[56:59], v[204:207], a[172:175], v[56:59]
    v_xor_b32 v226, 128, v224
    v_xor_b32 v227, 192, v224
    v_mfma_f32_16x16x32_bf16 v[64:67], v[204:207], a[188:191], v[64:67]
    s_waitcnt lgkmcnt(3)
    v_mfma_f32_16x16x32_bf16 v[52:55], v[208:211], a[144:147], 0
    v_mfma_f32_16x16x32_bf16 v[60:63], v[208:211], a[160:163], 0
    v_mfma_f32_16x16x32_bf16 v[68:71], v[208:211], a[176:179], 0
    s_waitcnt vmcnt(18) lgkmcnt(0)
    s_barrier
    v_mfma_f32_16x16x32_bf16 v[52:55], v[212:215], a[148:151], v[52:55]
    ds_read_b128 v[192:195], v224 offset:0
    ds_read_b128 v[196:199], v225 offset:0
    v_mfma_f32_16x16x32_bf16 v[60:63], v[212:215], a[164:167], v[60:63]
    ds_read_b128 v[200:203], v226 offset:0
    ds_read_b128 v[204:207], v227 offset:0
    v_mfma_f32_16x16x32_bf16 v[68:71], v[212:215], a[180:183], v[68:71]
    ds_read_b128 v[208:211], v224 offset:4096
    v_mfma_f32_16x16x32_bf16 v[52:55], v[216:219], a[152:155], v[52:55]
    v_mfma_f32_16x16x32_bf16 v[60:63], v[216:219], a[168:171], v[60:63]
    v_mfma_f32_16x16x32_bf16 v[68:71], v[216:219], a[184:187], v[68:71]
    v_mfma_f32_16x16x32_bf16 v[52:55], v[220:223], a[156:159], v[52:55]
    v_mfma_f32_16x16x32_bf16 v[60:63], v[220:223], a[172:175], v[60:63]
    v_mfma_f32_16x16x32_bf16 v[68:71], v[220:223], a[188:191], v[68:71]
    s_waitcnt lgkmcnt(4)
    v_mfma_f32_16x16x32_bf16 v[72:75], v[192:195], a[144:147], 0
    v_max3_f32 v232, v232, v48, v49
    v_max3_f32 v233, v233, v56, v57
    v_mfma_f32_16x16x32_bf16 v[80:83], v[192:195], a[160:163], 0
    ds_read_b128 v[212:215], v225 offset:4096
    v_max3_f32 v234, v234, v64, v65
    v_mfma_f32_16x16x32_bf16 v[88:91], v[192:195], a[176:179], 0
    v_max3_f32 v232, v232, v50, v51
    v_max3_f32 v233, v233, v58, v59
    s_waitcnt lgkmcnt(4)
    v_mfma_f32_16x16x32_bf16 v[72:75], v[196:199], a[148:151], v[72:75]
    v_max3_f32 v234, v234, v66, v67
    v_max3_f32 v232, v232, v52, v53
    v_mfma_f32_16x16x32_bf16 v[80:83], v[196:199], a[164:167], v[80:83]
    ds_read_b128 v[216:219], v226 offset:4096
    v_max3_f32 v233, v233, v60, v61
    v_mfma_f32_16x16x32_bf16 v[88:91], v[196:199], a[180:183], v[88:91]
    v_max3_f32 v234, v234, v68, v69
    v_max3_f32 v232, v232, v54, v55
    s_waitcnt lgkmcnt(4)
    v_mfma_f32_16x16x32_bf16 v[72:75], v[200:203], a[152:155], v[72:75]
    v_max3_f32 v233, v233, v62, v63
    v_max3_f32 v234, v234, v70, v71
    v_mfma_f32_16x16x32_bf16 v[80:83], v[200:203], a[168:171], v[80:83]
    ds_read_b128 v[220:223], v227 offset:4096
    v_mfma_f32_16x16x32_bf16 v[88:91], v[200:203], a[184:187], v[88:91]
    s_waitcnt lgkmcnt(4)
    v_mfma_f32_16x16x32_bf16 v[72:75], v[204:207], a[156:159], v[72:75]
    v_add_u32 v224, 16384, v246
    v_xor_b32 v225, 64, v224
    v_mfma_f32_16x16x32_bf16 v[80:83], v[204:207], a[172:175], v[80:83]
    v_xor_b32 v226, 128, v224
    v_xor_b32 v227, 192, v224
    v_mfma_f32_16x16x32_bf16 v[88:91], v[204:207], a[188:191], v[88:91]
    s_waitcnt lgkmcnt(3)
    v_mfma_f32_16x16x32_bf16 v[76:79], v[208:211], a[144:147], 0
    v_mfma_f32_16x16x32_bf16 v[84:87], v[208:211], a[160:163], 0
    v_mfma_f32_16x16x32_bf16 v[92:95], v[208:211], a[176:179], 0
    s_waitcnt vmcnt(14) lgkmcnt(0)
    s_barrier
    v_mfma_f32_16x16x32_bf16 v[76:79], v[212:215], a[148:151], v[76:79]
    ds_read_b128 v[192:195], v224 offset:0
    ds_read_b128 v[196:199], v225 offset:0
    s_add_u32 m0, s59, 98304
    s_add_u32 s68, s46, 245760
    buffer_load_dwordx4 v240, s[12:15], s68 offen offset:0 nt lds
    v_mfma_f32_16x16x32_bf16 v[84:87], v[212:215], a[164:167], v[84:87]
    ds_read_b128 v[200:203], v226 offset:0
    ds_read_b128 v[204:207], v227 offset:0
    v_mfma_f32_16x16x32_bf16 v[92:95], v[212:215], a[180:183], v[92:95]
    ds_read_b128 v[208:211], v224 offset:4096
    v_mfma_f32_16x16x32_bf16 v[76:79], v[216:219], a[152:155], v[76:79]
    v_mfma_f32_16x16x32_bf16 v[84:87], v[216:219], a[168:171], v[84:87]
    s_add_u32 s68, s68, 3072
    v_xor_b32 v244, 64, v240
    buffer_load_dwordx4 v244, s[12:15], s68 offen offset:1024 nt lds
    v_mfma_f32_16x16x32_bf16 v[92:95], v[216:219], a[184:187], v[92:95]
    v_mfma_f32_16x16x32_bf16 v[76:79], v[220:223], a[156:159], v[76:79]
    v_mfma_f32_16x16x32_bf16 v[84:87], v[220:223], a[172:175], v[84:87]
    v_mfma_f32_16x16x32_bf16 v[92:95], v[220:223], a[188:191], v[92:95]
    s_add_u32 s68, s68, 3072
    v_xor_b32 v244, 128, v240
    buffer_load_dwordx4 v244, s[12:15], s68 offen offset:2048 nt lds
    s_waitcnt lgkmcnt(4)
    v_mfma_f32_16x16x32_bf16 v[96:99], v[192:195], a[144:147], 0
    v_max3_f32 v232, v232, v72, v73
    v_max3_f32 v233, v233, v80, v81
    v_mfma_f32_16x16x32_bf16 v[104:107], v[192:195], a[160:163], 0
    ds_read_b128 v[212:215], v225 offset:4096
    v_max3_f32 v234, v234, v88, v89
    v_mfma_f32_16x16x32_bf16 v[112:115], v[192:195], a[176:179], 0
    v_max3_f32 v232, v232, v74, v75
    s_add_u32 s68, s68, 3072
    v_xor_b32 v244, 192, v240
    buffer_load_dwordx4 v244, s[12:15], s68 offen offset:3072 nt lds
    v_max3_f32 v233, v233, v82, v83
    s_waitcnt lgkmcnt(4)
    v_mfma_f32_16x16x32_bf16 v[96:99], v[196:199], a[148:151], v[96:99]
    v_max3_f32 v234, v234, v90, v91
    v_max3_f32 v232, v232, v76, v77
    v_mfma_f32_16x16x32_bf16 v[104:107], v[196:199], a[164:167], v[104:107]
    ds_read_b128 v[216:219], v226 offset:4096
    v_max3_f32 v233, v233, v84, v85
    v_mfma_f32_16x16x32_bf16 v[112:115], v[196:199], a[180:183], v[112:115]
    v_max3_f32 v234, v234, v92, v93
    v_max3_f32 v232, v232, v78, v79
    s_waitcnt lgkmcnt(4)
    v_mfma_f32_16x16x32_bf16 v[96:99], v[200:203], a[152:155], v[96:99]
    v_max3_f32 v233, v233, v86, v87
    v_max3_f32 v234, v234, v94, v95
    v_mfma_f32_16x16x32_bf16 v[104:107], v[200:203], a[168:171], v[104:107]
    ds_read_b128 v[220:223], v227 offset:4096
    v_mfma_f32_16x16x32_bf16 v[112:115], v[200:203], a[184:187], v[112:115]
    s_waitcnt lgkmcnt(4)
    v_mfma_f32_16x16x32_bf16 v[96:99], v[204:207], a[156:159], v[96:99]
    v_add_u32 v224, 81920, v246
    v_xor_b32 v225, 64, v224
    v_mfma_f32_16x16x32_bf16 v[104:107], v[204:207], a[172:175], v[104:107]
    v_xor_b32 v226, 128, v224
    v_xor_b32 v227, 192, v224
    v_mfma_f32_16x16x32_bf16 v[112:115], v[204:207], a[188:191], v[112:115]
    s_waitcnt lgkmcnt(3)
    v_mfma_f32_16x16x32_bf16 v[100:103], v[208:211], a[144:147], 0
    v_mfma_f32_16x16x32_bf16 v[108:111], v[208:211], a[160:163], 0
    v_mfma_f32_16x16x32_bf16 v[116:119], v[208:211], a[176:179], 0
    s_waitcnt vmcnt(14) lgkmcnt(0)
    s_barrier
    v_mfma_f32_16x16x32_bf16 v[100:103], v[212:215], a[148:151], v[100:103]
    ds_read_b128 v[192:195], v224 offset:0
    ds_read_b128 v[196:199], v225 offset:0
    s_add_u32 m0, s59, 65536
    s_add_u32 s68, s46, 131072
    buffer_load_dwordx4 v241, s[16:19], s68 offen offset:0 nt lds
    v_mfma_f32_16x16x32_bf16 v[108:111], v[212:215], a[164:167], v[108:111]
    ds_read_b128 v[200:203], v226 offset:0
    ds_read_b128 v[204:207], v227 offset:0
    v_mfma_f32_16x16x32_bf16 v[116:119], v[212:215], a[180:183], v[116:119]
    ds_read_b128 v[208:211], v224 offset:4096
    v_mfma_f32_16x16x32_bf16 v[100:103], v[216:219], a[152:155], v[100:103]
    v_mfma_f32_16x16x32_bf16 v[108:111], v[216:219], a[168:171], v[108:111]
    s_add_u32 s68, s68, 3072
    v_xor_b32 v244, 128, v241
    buffer_load_dwordx4 v244, s[16:19], s68 offen offset:1024 nt lds
    v_mfma_f32_16x16x32_bf16 v[116:119], v[216:219], a[184:187], v[116:119]
    v_mfma_f32_16x16x32_bf16 v[100:103], v[220:223], a[156:159], v[100:103]
    v_mfma_f32_16x16x32_bf16 v[108:111], v[220:223], a[172:175], v[108:111]
    v_mfma_f32_16x16x32_bf16 v[116:119], v[220:223], a[188:191], v[116:119]
    s_add_u32 s68, s68, 3072
    buffer_load_dwordx4 v241, s[16:19], s68 offen offset:2048 nt lds
    s_waitcnt lgkmcnt(4)
    v_mfma_f32_16x16x32_bf16 v[120:123], v[192:195], a[144:147], 0
    v_max3_f32 v232, v232, v96, v97
    v_max3_f32 v233, v233, v104, v105
    v_mfma_f32_16x16x32_bf16 v[128:131], v[192:195], a[160:163], 0
    ds_read_b128 v[212:215], v225 offset:4096
    v_max3_f32 v234, v234, v112, v113
    v_mfma_f32_16x16x32_bf16 v[136:139], v[192:195], a[176:179], 0
    v_max3_f32 v232, v232, v98, v99
    s_add_u32 s68, s68, 3072
    buffer_load_dwordx4 v244, s[16:19], s68 offen offset:3072 nt lds
    v_max3_f32 v233, v233, v106, v107
    s_waitcnt lgkmcnt(4)
    v_mfma_f32_16x16x32_bf16 v[120:123], v[196:199], a[148:151], v[120:123]
    v_max3_f32 v234, v234, v114, v115
    v_max3_f32 v232, v232, v100, v101
    v_mfma_f32_16x16x32_bf16 v[128:131], v[196:199], a[164:167], v[128:131]
    ds_read_b128 v[216:219], v226 offset:4096
    v_max3_f32 v233, v233, v108, v109
    v_mfma_f32_16x16x32_bf16 v[136:139], v[196:199], a[180:183], v[136:139]
    v_max3_f32 v234, v234, v116, v117
    v_max3_f32 v232, v232, v102, v103
    s_waitcnt lgkmcnt(4)
    v_mfma_f32_16x16x32_bf16 v[120:123], v[200:203], a[152:155], v[120:123]
    v_max3_f32 v233, v233, v110, v111
    v_max3_f32 v234, v234, v118, v119
    v_mfma_f32_16x16x32_bf16 v[128:131], v[200:203], a[168:171], v[128:131]
    ds_read_b128 v[220:223], v227 offset:4096
    v_mfma_f32_16x16x32_bf16 v[136:139], v[200:203], a[184:187], v[136:139]
    s_waitcnt lgkmcnt(4)
    v_mfma_f32_16x16x32_bf16 v[120:123], v[204:207], a[156:159], v[120:123]
    v_add_u32 v224, 32768, v246
    v_xor_b32 v225, 64, v224
    v_mfma_f32_16x16x32_bf16 v[128:131], v[204:207], a[172:175], v[128:131]
    v_xor_b32 v226, 128, v224
    v_xor_b32 v227, 192, v224
    v_mfma_f32_16x16x32_bf16 v[136:139], v[204:207], a[188:191], v[136:139]
    s_waitcnt lgkmcnt(3)
    v_mfma_f32_16x16x32_bf16 v[124:127], v[208:211], a[144:147], 0
    v_mfma_f32_16x16x32_bf16 v[132:135], v[208:211], a[160:163], 0
    v_mfma_f32_16x16x32_bf16 v[140:143], v[208:211], a[176:179], 0
    s_waitcnt vmcnt(8) lgkmcnt(0)
    s_barrier
    s_lshl_b32 s48, s40, 28
    s_add_u32 s48, s48, s47
    v_lshlrev_b32 v238, 24, v248
    v_lshrrev_b32 v239, 8, v248
    v_lshl_or_b32 v238, v239, 28, v238
    v_or_b32 v238, s48, v238
    v_mov_b32 v239, s71
    buffer_store_dword v239, v238, s[32:35], 0 offen offset:0 sc1
    v_mfma_f32_16x16x32_bf16 v[124:127], v[212:215], a[148:151], v[124:127]
    ds_read_b128 v[192:195], v224 offset:0
    ds_read_b128 v[196:199], v225 offset:0
    s_add_u32 m0, s59, 0
    s_add_u32 s68, s46, 147456
    buffer_load_dwordx4 v241, s[16:19], s68 offen offset:0 nt lds
    v_mfma_f32_16x16x32_bf16 v[132:135], v[212:215], a[164:167], v[132:135]
    ds_read_b128 v[200:203], v226 offset:0
    ds_read_b128 v[204:207], v227 offset:0
    v_mfma_f32_16x16x32_bf16 v[140:143], v[212:215], a[180:183], v[140:143]
    ds_read_b128 v[208:211], v224 offset:4096
    v_mfma_f32_16x16x32_bf16 v[124:127], v[216:219], a[152:155], v[124:127]
    v_mfma_f32_16x16x32_bf16 v[132:135], v[216:219], a[168:171], v[132:135]
    s_add_u32 s68, s68, 3072
    v_xor_b32 v244, 128, v241
    buffer_load_dwordx4 v244, s[16:19], s68 offen offset:1024 nt lds
    v_mfma_f32_16x16x32_bf16 v[140:143], v[216:219], a[184:187], v[140:143]
    v_mfma_f32_16x16x32_bf16 v[124:127], v[220:223], a[156:159], v[124:127]
    v_mfma_f32_16x16x32_bf16 v[132:135], v[220:223], a[172:175], v[132:135]
    v_mfma_f32_16x16x32_bf16 v[140:143], v[220:223], a[188:191], v[140:143]
    s_add_u32 s68, s68, 3072
    buffer_load_dwordx4 v241, s[16:19], s68 offen offset:2048 nt lds
    s_waitcnt lgkmcnt(4)
    v_mfma_f32_16x16x32_bf16 v[144:147], v[192:195], a[144:147], 0
    v_max3_f32 v232, v232, v120, v121
    v_max3_f32 v233, v233, v128, v129
    v_mfma_f32_16x16x32_bf16 v[152:155], v[192:195], a[160:163], 0
    ds_read_b128 v[212:215], v225 offset:4096
    v_max3_f32 v234, v234, v136, v137
    v_mfma_f32_16x16x32_bf16 v[160:163], v[192:195], a[176:179], 0
    v_max3_f32 v232, v232, v122, v123
    s_add_u32 s68, s68, 3072
    buffer_load_dwordx4 v244, s[16:19], s68 offen offset:3072 nt lds
    v_max3_f32 v233, v233, v130, v131
    s_waitcnt lgkmcnt(4)
    v_mfma_f32_16x16x32_bf16 v[144:147], v[196:199], a[148:151], v[144:147]
    v_max3_f32 v234, v234, v138, v139
    v_max3_f32 v232, v232, v124, v125
    v_mfma_f32_16x16x32_bf16 v[152:155], v[196:199], a[164:167], v[152:155]
    ds_read_b128 v[216:219], v226 offset:4096
    v_max3_f32 v233, v233, v132, v133
    v_mfma_f32_16x16x32_bf16 v[160:163], v[196:199], a[180:183], v[160:163]
    v_max3_f32 v234, v234, v140, v141
    v_max3_f32 v232, v232, v126, v127
    s_waitcnt lgkmcnt(4)
    v_mfma_f32_16x16x32_bf16 v[144:147], v[200:203], a[152:155], v[144:147]
    v_max3_f32 v233, v233, v134, v135
    v_max3_f32 v234, v234, v142, v143
    v_mfma_f32_16x16x32_bf16 v[152:155], v[200:203], a[168:171], v[152:155]
    ds_read_b128 v[220:223], v227 offset:4096
    v_mfma_f32_16x16x32_bf16 v[160:163], v[200:203], a[184:187], v[160:163]
    s_waitcnt lgkmcnt(4)
    v_mfma_f32_16x16x32_bf16 v[144:147], v[204:207], a[156:159], v[144:147]
    v_add_u32 v224, 98304, v246
    v_xor_b32 v225, 64, v224
    v_mfma_f32_16x16x32_bf16 v[152:155], v[204:207], a[172:175], v[152:155]
    v_xor_b32 v226, 128, v224
    v_xor_b32 v227, 192, v224
    v_mfma_f32_16x16x32_bf16 v[160:163], v[204:207], a[188:191], v[160:163]
    s_waitcnt lgkmcnt(3)
    v_mfma_f32_16x16x32_bf16 v[148:151], v[208:211], a[144:147], 0
    v_mfma_f32_16x16x32_bf16 v[156:159], v[208:211], a[160:163], 0
    v_mfma_f32_16x16x32_bf16 v[164:167], v[208:211], a[176:179], 0
    s_waitcnt vmcnt(9) lgkmcnt(0)
    s_barrier
    v_mfma_f32_16x16x32_bf16 v[148:151], v[212:215], a[148:151], v[148:151]
    ds_read_b128 v[192:195], v224 offset:0
    ds_read_b128 v[196:199], v225 offset:0
    s_add_u32 m0, s59, 49152
    s_add_u32 s68, s46, 163840
    buffer_load_dwordx4 v241, s[16:19], s68 offen offset:0 nt lds
    v_mfma_f32_16x16x32_bf16 v[156:159], v[212:215], a[164:167], v[156:159]
    ds_read_b128 v[200:203], v226 offset:0
    ds_read_b128 v[204:207], v227 offset:0
    v_mfma_f32_16x16x32_bf16 v[164:167], v[212:215], a[180:183], v[164:167]
    ds_read_b128 v[208:211], v224 offset:4096
    v_mfma_f32_16x16x32_bf16 v[148:151], v[216:219], a[152:155], v[148:151]
    v_mfma_f32_16x16x32_bf16 v[156:159], v[216:219], a[168:171], v[156:159]
    s_add_u32 s68, s68, 3072
    v_xor_b32 v244, 128, v241
    buffer_load_dwordx4 v244, s[16:19], s68 offen offset:1024 nt lds
    v_mfma_f32_16x16x32_bf16 v[164:167], v[216:219], a[184:187], v[164:167]
    v_mfma_f32_16x16x32_bf16 v[148:151], v[220:223], a[156:159], v[148:151]
    v_mfma_f32_16x16x32_bf16 v[156:159], v[220:223], a[172:175], v[156:159]
    v_mfma_f32_16x16x32_bf16 v[164:167], v[220:223], a[188:191], v[164:167]
    s_add_u32 s68, s68, 3072
    buffer_load_dwordx4 v241, s[16:19], s68 offen offset:2048 nt lds
    s_waitcnt lgkmcnt(4)
    v_mfma_f32_16x16x32_bf16 v[168:171], v[192:195], a[144:147], 0
    v_max3_f32 v232, v232, v144, v145
    v_max3_f32 v233, v233, v152, v153
    v_mfma_f32_16x16x32_bf16 v[176:179], v[192:195], a[160:163], 0
    ds_read_b128 v[212:215], v225 offset:4096
    v_max3_f32 v234, v234, v160, v161
    v_mfma_f32_16x16x32_bf16 v[184:187], v[192:195], a[176:179], 0
    v_max3_f32 v232, v232, v146, v147
    s_add_u32 s68, s68, 3072
    buffer_load_dwordx4 v244, s[16:19], s68 offen offset:3072 nt lds
    v_max3_f32 v233, v233, v154, v155
    s_waitcnt lgkmcnt(4)
    v_mfma_f32_16x16x32_bf16 v[168:171], v[196:199], a[148:151], v[168:171]
    v_max3_f32 v234, v234, v162, v163
    v_max3_f32 v232, v232, v148, v149
    v_mfma_f32_16x16x32_bf16 v[176:179], v[196:199], a[164:167], v[176:179]
    ds_read_b128 v[216:219], v226 offset:4096
    v_max3_f32 v233, v233, v156, v157
    v_mfma_f32_16x16x32_bf16 v[184:187], v[196:199], a[180:183], v[184:187]
    v_max3_f32 v234, v234, v164, v165
    v_max3_f32 v232, v232, v150, v151
    s_waitcnt lgkmcnt(4)
    v_mfma_f32_16x16x32_bf16 v[168:171], v[200:203], a[152:155], v[168:171]
    v_max3_f32 v233, v233, v158, v159
    v_max3_f32 v234, v234, v166, v167
    v_mfma_f32_16x16x32_bf16 v[176:179], v[200:203], a[168:171], v[176:179]
    ds_read_b128 v[220:223], v227 offset:4096
    v_mfma_f32_16x16x32_bf16 v[184:187], v[200:203], a[184:187], v[184:187]
    s_waitcnt lgkmcnt(4)
    v_mfma_f32_16x16x32_bf16 v[168:171], v[204:207], a[156:159], v[168:171]
    v_mfma_f32_16x16x32_bf16 v[176:179], v[204:207], a[172:175], v[176:179]
    v_mfma_f32_16x16x32_bf16 v[184:187], v[204:207], a[188:191], v[184:187]
    s_waitcnt lgkmcnt(3)
    v_mfma_f32_16x16x32_bf16 v[172:175], v[208:211], a[144:147], 0
    v_mfma_f32_16x16x32_bf16 v[180:183], v[208:211], a[160:163], 0
    v_mfma_f32_16x16x32_bf16 v[188:191], v[208:211], a[176:179], 0
    s_waitcnt lgkmcnt(2)
    v_mfma_f32_16x16x32_bf16 v[172:175], v[212:215], a[148:151], v[172:175]
    v_mfma_f32_16x16x32_bf16 v[180:183], v[212:215], a[164:167], v[180:183]
    v_mfma_f32_16x16x32_bf16 v[188:191], v[212:215], a[180:183], v[188:191]
    s_waitcnt lgkmcnt(1)
    v_mfma_f32_16x16x32_bf16 v[172:175], v[216:219], a[152:155], v[172:175]
    v_mfma_f32_16x16x32_bf16 v[180:183], v[216:219], a[168:171], v[180:183]
    v_mfma_f32_16x16x32_bf16 v[188:191], v[216:219], a[184:187], v[188:191]
    s_waitcnt lgkmcnt(0)
    v_mfma_f32_16x16x32_bf16 v[172:175], v[220:223], a[156:159], v[172:175]
    v_mfma_f32_16x16x32_bf16 v[180:183], v[220:223], a[172:175], v[180:183]
    v_mfma_f32_16x16x32_bf16 v[188:191], v[220:223], a[188:191], v[188:191]
    s_lshl_b32 s48, s42, 13
    s_lshl_b32 s49, s57, 5
    v_subrev_u32 v246, s48, v247
    v_xor_b32 v246, s49, v246
    v_max3_f32 v232, v232, v168, v169
    s_add_u32 m0, s59, 16384
    s_add_u32 s68, s46, 180224
    buffer_load_dwordx4 v241, s[16:19], s68 offen offset:0 nt lds
    v_max3_f32 v233, v233, v176, v177
    v_max3_f32 v234, v234, v184, v185
    v_max3_f32 v232, v232, v170, v171
    v_max3_f32 v233, v233, v178, v179
    v_max3_f32 v234, v234, v186, v187
    v_max3_f32 v232, v232, v172, v173
    v_max3_f32 v233, v233, v180, v181
    v_max3_f32 v234, v234, v188, v189
    v_max3_f32 v232, v232, v174, v175
    v_max3_f32 v233, v233, v182, v183
    v_max3_f32 v234, v234, v190, v191
    v_mov_b32 v228, v232
    v_mov_b32 v229, v233
    v_mov_b32 v230, v234
    v_permlane32_swap_b32 v228, v232
    v_permlane32_swap_b32 v229, v233
    v_permlane32_swap_b32 v230, v234
    v_max_f32 v232, v228, v232
    v_max_f32 v233, v229, v233
    v_max_f32 v234, v230, v234
    v_mov_b32 v228, v232
    v_mov_b32 v229, v233
    v_mov_b32 v230, v234
    v_permlane16_swap_b32 v228, v232
    v_permlane16_swap_b32 v229, v233
    v_permlane16_swap_b32 v230, v234
    v_max_f32 v232, v228, v232
    v_max_f32 v233, v229, v233
    v_max_f32 v234, v230, v234
    v_mul_f32 v232, s52, v232
    v_mul_f32 v233, s52, v233
    v_mul_f32 v234, s52, v234
    v_mov_b32 v230, v233
    v_pk_fma_f32 v[0:1], v[0:1], s[52:53], v[232:233] op_sel_hi:[1,0,0] neg_lo:[0,0,1] neg_hi:[0,0,1]
    v_pk_fma_f32 v[2:3], v[2:3], s[52:53], v[232:233] op_sel_hi:[1,0,0] neg_lo:[0,0,1] neg_hi:[0,0,1]
    v_pk_fma_f32 v[4:5], v[4:5], s[52:53], v[232:233] op_sel_hi:[1,0,0] neg_lo:[0,0,1] neg_hi:[0,0,1]
    v_pk_fma_f32 v[6:7], v[6:7], s[52:53], v[232:233] op_sel_hi:[1,0,0] neg_lo:[0,0,1] neg_hi:[0,0,1]
    v_exp_f32 v0, v0
    v_exp_f32 v1, v1
    v_exp_f32 v2, v2
    v_exp_f32 v3, v3
    v_exp_f32 v4, v4
    v_exp_f32 v5, v5
    v_exp_f32 v6, v6
    s_add_u32 s68, s68, 3072
    v_xor_b32 v244, 128, v241
    buffer_load_dwordx4 v244, s[16:19], s68 offen offset:1024 nt lds
    v_exp_f32 v7, v7
    v_pk_add_f32 v[250:251], v[0:1], v[2:3]
    v_pk_add_f32 v[250:251], v[250:251], v[4:5]
    v_pk_add_f32 v[250:251], v[250:251], v[6:7]
    v_cvt_pk_bf16_f32 v0, v0, v1
    v_cvt_pk_bf16_f32 v1, v2, v3
    v_cvt_pk_bf16_f32 v2, v4, v5
    v_cvt_pk_bf16_f32 v3, v6, v7
    v_pk_fma_f32 v[8:9], v[8:9], s[52:53], v[230:231] op_sel_hi:[1,0,0] neg_lo:[0,0,1] neg_hi:[0,0,1]
    v_pk_fma_f32 v[10:11], v[10:11], s[52:53], v[230:231] op_sel_hi:[1,0,0] neg_lo:[0,0,1] neg_hi:[0,0,1]
    v_pk_fma_f32 v[12:13], v[12:13], s[52:53], v[230:231] op_sel_hi:[1,0,0] neg_lo:[0,0,1] neg_hi:[0,0,1]
    v_pk_fma_f32 v[14:15], v[14:15], s[52:53], v[230:231] op_sel_hi:[1,0,0] neg_lo:[0,0,1] neg_hi:[0,0,1]
    v_exp_f32 v8, v8
    v_exp_f32 v9, v9
    v_exp_f32 v10, v10
    v_exp_f32 v11, v11
    v_exp_f32 v12, v12
    v_exp_f32 v13, v13
    v_exp_f32 v14, v14
    v_exp_f32 v15, v15
    v_pk_add_f32 v[252:253], v[8:9], v[10:11]
    v_pk_add_f32 v[252:253], v[252:253], v[12:13]
    v_pk_add_f32 v[252:253], v[252:253], v[14:15]
    v_cvt_pk_bf16_f32 v4, v8, v9
    v_cvt_pk_bf16_f32 v5, v10, v11
    v_cvt_pk_bf16_f32 v6, v12, v13
    v_cvt_pk_bf16_f32 v7, v14, v15
    v_pk_fma_f32 v[16:17], v[16:17], s[52:53], v[234:235] op_sel_hi:[1,0,0] neg_lo:[0,0,1] neg_hi:[0,0,1]
    v_pk_fma_f32 v[18:19], v[18:19], s[52:53], v[234:235] op_sel_hi:[1,0,0] neg_lo:[0,0,1] neg_hi:[0,0,1]
    v_pk_fma_f32 v[20:21], v[20:21], s[52:53], v[234:235] op_sel_hi:[1,0,0] neg_lo:[0,0,1] neg_hi:[0,0,1]
    v_pk_fma_f32 v[22:23], v[22:23], s[52:53], v[234:235] op_sel_hi:[1,0,0] neg_lo:[0,0,1] neg_hi:[0,0,1]
    v_exp_f32 v16, v16
    v_exp_f32 v17, v17
    v_exp_f32 v18, v18
    v_exp_f32 v19, v19
    v_exp_f32 v20, v20
    s_add_u32 s68, s68, 3072
    buffer_load_dwordx4 v241, s[16:19], s68 offen offset:2048 nt lds
    v_exp_f32 v21, v21
    v_exp_f32 v22, v22
    v_exp_f32 v23, v23
    v_pk_add_f32 v[238:239], v[16:17], v[18:19]
    v_pk_add_f32 v[238:239], v[238:239], v[20:21]
    v_pk_add_f32 v[238:239], v[238:239], v[22:23]
    v_cvt_pk_bf16_f32 v8, v16, v17
    v_cvt_pk_bf16_f32 v9, v18, v19
    v_cvt_pk_bf16_f32 v10, v20, v21
    v_cvt_pk_bf16_f32 v11, v22, v23
    v_pk_fma_f32 v[24:25], v[24:25], s[52:53], v[232:233] op_sel_hi:[1,0,0] neg_lo:[0,0,1] neg_hi:[0,0,1]
    v_pk_fma_f32 v[26:27], v[26:27], s[52:53], v[232:233] op_sel_hi:[1,0,0] neg_lo:[0,0,1] neg_hi:[0,0,1]
    v_pk_fma_f32 v[28:29], v[28:29], s[52:53], v[232:233] op_sel_hi:[1,0,0] neg_lo:[0,0,1] neg_hi:[0,0,1]
    v_pk_fma_f32 v[30:31], v[30:31], s[52:53], v[232:233] op_sel_hi:[1,0,0] neg_lo:[0,0,1] neg_hi:[0,0,1]
    v_exp_f32 v24, v24
    v_exp_f32 v25, v25
    v_exp_f32 v26, v26
    v_exp_f32 v27, v27
    v_exp_f32 v28, v28
    v_exp_f32 v29, v29
    v_exp_f32 v30, v30
    v_exp_f32 v31, v31
    v_pk_add_f32 v[250:251], v[250:251], v[24:25]
    v_pk_add_f32 v[250:251], v[250:251], v[26:27]
    v_pk_add_f32 v[250:251], v[250:251], v[28:29]
    v_pk_add_f32 v[250:251], v[250:251], v[30:31]
    v_cvt_pk_bf16_f32 v12, v24, v25
    v_cvt_pk_bf16_f32 v13, v26, v27
    v_cvt_pk_bf16_f32 v14, v28, v29
    v_cvt_pk_bf16_f32 v15, v30, v31
    v_pk_fma_f32 v[32:33], v[32:33], s[52:53], v[230:231] op_sel_hi:[1,0,0] neg_lo:[0,0,1] neg_hi:[0,0,1]
    v_pk_fma_f32 v[34:35], v[34:35], s[52:53], v[230:231] op_sel_hi:[1,0,0] neg_lo:[0,0,1] neg_hi:[0,0,1]
    v_pk_fma_f32 v[36:37], v[36:37], s[52:53], v[230:231] op_sel_hi:[1,0,0] neg_lo:[0,0,1] neg_hi:[0,0,1]
    v_pk_fma_f32 v[38:39], v[38:39], s[52:53], v[230:231] op_sel_hi:[1,0,0] neg_lo:[0,0,1] neg_hi:[0,0,1]
    v_exp_f32 v32, v32
    v_exp_f32 v33, v33
    v_exp_f32 v34, v34
    s_add_u32 s68, s68, 3072
    buffer_load_dwordx4 v244, s[16:19], s68 offen offset:3072 nt lds
    v_exp_f32 v35, v35
    v_exp_f32 v36, v36
    v_exp_f32 v37, v37
    v_exp_f32 v38, v38
    v_exp_f32 v39, v39
    v_pk_add_f32 v[252:253], v[252:253], v[32:33]
    v_pk_add_f32 v[252:253], v[252:253], v[34:35]
    v_pk_add_f32 v[252:253], v[252:253], v[36:37]
    v_pk_add_f32 v[252:253], v[252:253], v[38:39]
    v_cvt_pk_bf16_f32 v16, v32, v33
    v_cvt_pk_bf16_f32 v17, v34, v35
    v_cvt_pk_bf16_f32 v18, v36, v37
    v_cvt_pk_bf16_f32 v19, v38, v39
    v_pk_fma_f32 v[40:41], v[40:41], s[52:53], v[234:235] op_sel_hi:[1,0,0] neg_lo:[0,0,1] neg_hi:[0,0,1]
    v_pk_fma_f32 v[42:43], v[42:43], s[52:53], v[234:235] op_sel_hi:[1,0,0] neg_lo:[0,0,1] neg_hi:[0,0,1]
    v_pk_fma_f32 v[44:45], v[44:45], s[52:53], v[234:235] op_sel_hi:[1,0,0] neg_lo:[0,0,1] neg_hi:[0,0,1]
    v_pk_fma_f32 v[46:47], v[46:47], s[52:53], v[234:235] op_sel_hi:[1,0,0] neg_lo:[0,0,1] neg_hi:[0,0,1]
    v_exp_f32 v40, v40
    v_exp_f32 v41, v41
    v_exp_f32 v42, v42
    v_exp_f32 v43, v43
    v_exp_f32 v44, v44
    v_exp_f32 v45, v45
    v_exp_f32 v46, v46
    v_exp_f32 v47, v47
    v_pk_add_f32 v[238:239], v[238:239], v[40:41]
    v_pk_add_f32 v[238:239], v[238:239], v[42:43]
    v_pk_add_f32 v[238:239], v[238:239], v[44:45]
    v_pk_add_f32 v[238:239], v[238:239], v[46:47]
    v_cvt_pk_bf16_f32 v20, v40, v41
    v_cvt_pk_bf16_f32 v21, v42, v43
    v_cvt_pk_bf16_f32 v22, v44, v45
    v_cvt_pk_bf16_f32 v23, v46, v47
    v_pk_fma_f32 v[48:49], v[48:49], s[52:53], v[232:233] op_sel_hi:[1,0,0] neg_lo:[0,0,1] neg_hi:[0,0,1]
    v_pk_fma_f32 v[50:51], v[50:51], s[52:53], v[232:233] op_sel_hi:[1,0,0] neg_lo:[0,0,1] neg_hi:[0,0,1]
    v_pk_fma_f32 v[52:53], v[52:53], s[52:53], v[232:233] op_sel_hi:[1,0,0] neg_lo:[0,0,1] neg_hi:[0,0,1]
    v_pk_fma_f32 v[54:55], v[54:55], s[52:53], v[232:233] op_sel_hi:[1,0,0] neg_lo:[0,0,1] neg_hi:[0,0,1]
    s_add_u32 m0, s59, 81920
    s_add_u32 s68, s46, 196608
    buffer_load_dwordx4 v241, s[16:19], s68 offen offset:0 nt lds
    v_exp_f32 v48, v48
    v_exp_f32 v49, v49
    v_exp_f32 v50, v50
    v_exp_f32 v51, v51
    v_exp_f32 v52, v52
    v_exp_f32 v53, v53
    v_exp_f32 v54, v54
    v_exp_f32 v55, v55
    v_pk_add_f32 v[250:251], v[250:251], v[48:49]
    v_pk_add_f32 v[250:251], v[250:251], v[50:51]
    v_pk_add_f32 v[250:251], v[250:251], v[52:53]
    v_pk_add_f32 v[250:251], v[250:251], v[54:55]
    v_cvt_pk_bf16_f32 v24, v48, v49
    v_cvt_pk_bf16_f32 v25, v50, v51
    v_cvt_pk_bf16_f32 v26, v52, v53
    v_cvt_pk_bf16_f32 v27, v54, v55
    v_pk_fma_f32 v[56:57], v[56:57], s[52:53], v[230:231] op_sel_hi:[1,0,0] neg_lo:[0,0,1] neg_hi:[0,0,1]
    v_pk_fma_f32 v[58:59], v[58:59], s[52:53], v[230:231] op_sel_hi:[1,0,0] neg_lo:[0,0,1] neg_hi:[0,0,1]
    v_pk_fma_f32 v[60:61], v[60:61], s[52:53], v[230:231] op_sel_hi:[1,0,0] neg_lo:[0,0,1] neg_hi:[0,0,1]
    v_pk_fma_f32 v[62:63], v[62:63], s[52:53], v[230:231] op_sel_hi:[1,0,0] neg_lo:[0,0,1] neg_hi:[0,0,1]
    v_exp_f32 v56, v56
    v_exp_f32 v57, v57
    v_exp_f32 v58, v58
    v_exp_f32 v59, v59
    v_exp_f32 v60, v60
    v_exp_f32 v61, v61
    v_exp_f32 v62, v62
    v_exp_f32 v63, v63
    v_pk_add_f32 v[252:253], v[252:253], v[56:57]
    v_pk_add_f32 v[252:253], v[252:253], v[58:59]
    v_pk_add_f32 v[252:253], v[252:253], v[60:61]
    v_pk_add_f32 v[252:253], v[252:253], v[62:63]
    v_cvt_pk_bf16_f32 v28, v56, v57
    v_cvt_pk_bf16_f32 v29, v58, v59
    s_add_u32 s68, s68, 3072
    v_xor_b32 v244, 128, v241
    buffer_load_dwordx4 v244, s[16:19], s68 offen offset:1024 nt lds
    v_cvt_pk_bf16_f32 v30, v60, v61
    v_cvt_pk_bf16_f32 v31, v62, v63
    v_pk_fma_f32 v[64:65], v[64:65], s[52:53], v[234:235] op_sel_hi:[1,0,0] neg_lo:[0,0,1] neg_hi:[0,0,1]
    v_pk_fma_f32 v[66:67], v[66:67], s[52:53], v[234:235] op_sel_hi:[1,0,0] neg_lo:[0,0,1] neg_hi:[0,0,1]
    v_pk_fma_f32 v[68:69], v[68:69], s[52:53], v[234:235] op_sel_hi:[1,0,0] neg_lo:[0,0,1] neg_hi:[0,0,1]
    v_pk_fma_f32 v[70:71], v[70:71], s[52:53], v[234:235] op_sel_hi:[1,0,0] neg_lo:[0,0,1] neg_hi:[0,0,1]
    v_exp_f32 v64, v64
    v_exp_f32 v65, v65
    v_exp_f32 v66, v66
    v_exp_f32 v67, v67
    v_exp_f32 v68, v68
    v_exp_f32 v69, v69
    v_exp_f32 v70, v70
    v_exp_f32 v71, v71
    v_pk_add_f32 v[238:239], v[238:239], v[64:65]
    v_pk_add_f32 v[238:239], v[238:239], v[66:67]
    v_pk_add_f32 v[238:239], v[238:239], v[68:69]
    v_pk_add_f32 v[238:239], v[238:239], v[70:71]
    v_cvt_pk_bf16_f32 v32, v64, v65
    v_cvt_pk_bf16_f32 v33, v66, v67
    v_cvt_pk_bf16_f32 v34, v68, v69
    v_cvt_pk_bf16_f32 v35, v70, v71
    v_pk_fma_f32 v[72:73], v[72:73], s[52:53], v[232:233] op_sel_hi:[1,0,0] neg_lo:[0,0,1] neg_hi:[0,0,1]
    v_pk_fma_f32 v[74:75], v[74:75], s[52:53], v[232:233] op_sel_hi:[1,0,0] neg_lo:[0,0,1] neg_hi:[0,0,1]
    v_pk_fma_f32 v[76:77], v[76:77], s[52:53], v[232:233] op_sel_hi:[1,0,0] neg_lo:[0,0,1] neg_hi:[0,0,1]
    v_pk_fma_f32 v[78:79], v[78:79], s[52:53], v[232:233] op_sel_hi:[1,0,0] neg_lo:[0,0,1] neg_hi:[0,0,1]
    v_exp_f32 v72, v72
    v_exp_f32 v73, v73
    v_exp_f32 v74, v74
    v_exp_f32 v75, v75
    v_exp_f32 v76, v76
    v_exp_f32 v77, v77
    v_exp_f32 v78, v78
    v_exp_f32 v79, v79
    s_add_u32 s68, s68, 3072
    buffer_load_dwordx4 v241, s[16:19], s68 offen offset:2048 nt lds
    v_pk_add_f32 v[250:251], v[250:251], v[72:73]
    v_pk_add_f32 v[250:251], v[250:251], v[74:75]
    v_pk_add_f32 v[250:251], v[250:251], v[76:77]
    v_pk_add_f32 v[250:251], v[250:251], v[78:79]
    v_cvt_pk_bf16_f32 v36, v72, v73
    v_cvt_pk_bf16_f32 v37, v74, v75
    v_cvt_pk_bf16_f32 v38, v76, v77
    v_cvt_pk_bf16_f32 v39, v78, v79
    v_pk_fma_f32 v[80:81], v[80:81], s[52:53], v[230:231] op_sel_hi:[1,0,0] neg_lo:[0,0,1] neg_hi:[0,0,1]
    v_pk_fma_f32 v[82:83], v[82:83], s[52:53], v[230:231] op_sel_hi:[1,0,0] neg_lo:[0,0,1] neg_hi:[0,0,1]
    v_pk_fma_f32 v[84:85], v[84:85], s[52:53], v[230:231] op_sel_hi:[1,0,0] neg_lo:[0,0,1] neg_hi:[0,0,1]
    v_pk_fma_f32 v[86:87], v[86:87], s[52:53], v[230:231] op_sel_hi:[1,0,0] neg_lo:[0,0,1] neg_hi:[0,0,1]
    v_exp_f32 v80, v80
    v_exp_f32 v81, v81
    v_exp_f32 v82, v82
    v_exp_f32 v83, v83
    v_exp_f32 v84, v84
    v_exp_f32 v85, v85
    v_exp_f32 v86, v86
    v_exp_f32 v87, v87
    v_pk_add_f32 v[252:253], v[252:253], v[80:81]
    v_pk_add_f32 v[252:253], v[252:253], v[82:83]
    v_pk_add_f32 v[252:253], v[252:253], v[84:85]
    v_pk_add_f32 v[252:253], v[252:253], v[86:87]
    v_cvt_pk_bf16_f32 v40, v80, v81
    v_cvt_pk_bf16_f32 v41, v82, v83
    v_cvt_pk_bf16_f32 v42, v84, v85
    v_cvt_pk_bf16_f32 v43, v86, v87
    v_pk_fma_f32 v[88:89], v[88:89], s[52:53], v[234:235] op_sel_hi:[1,0,0] neg_lo:[0,0,1] neg_hi:[0,0,1]
    v_pk_fma_f32 v[90:91], v[90:91], s[52:53], v[234:235] op_sel_hi:[1,0,0] neg_lo:[0,0,1] neg_hi:[0,0,1]
    v_pk_fma_f32 v[92:93], v[92:93], s[52:53], v[234:235] op_sel_hi:[1,0,0] neg_lo:[0,0,1] neg_hi:[0,0,1]
    v_pk_fma_f32 v[94:95], v[94:95], s[52:53], v[234:235] op_sel_hi:[1,0,0] neg_lo:[0,0,1] neg_hi:[0,0,1]
    v_exp_f32 v88, v88
    v_exp_f32 v89, v89
    v_exp_f32 v90, v90
    v_exp_f32 v91, v91
    v_exp_f32 v92, v92
    s_add_u32 s68, s68, 3072
    buffer_load_dwordx4 v244, s[16:19], s68 offen offset:3072 nt lds
    v_exp_f32 v93, v93
    v_exp_f32 v94, v94
    v_exp_f32 v95, v95
    v_pk_add_f32 v[238:239], v[238:239], v[88:89]
    v_pk_add_f32 v[238:239], v[238:239], v[90:91]
    v_pk_add_f32 v[238:239], v[238:239], v[92:93]
    v_pk_add_f32 v[238:239], v[238:239], v[94:95]
    v_cvt_pk_bf16_f32 v44, v88, v89
    v_cvt_pk_bf16_f32 v45, v90, v91
    v_cvt_pk_bf16_f32 v46, v92, v93
    v_cvt_pk_bf16_f32 v47, v94, v95
    v_pk_fma_f32 v[96:97], v[96:97], s[52:53], v[232:233] op_sel_hi:[1,0,0] neg_lo:[0,0,1] neg_hi:[0,0,1]
    v_pk_fma_f32 v[98:99], v[98:99], s[52:53], v[232:233] op_sel_hi:[1,0,0] neg_lo:[0,0,1] neg_hi:[0,0,1]
    v_pk_fma_f32 v[100:101], v[100:101], s[52:53], v[232:233] op_sel_hi:[1,0,0] neg_lo:[0,0,1] neg_hi:[0,0,1]
    v_pk_fma_f32 v[102:103], v[102:103], s[52:53], v[232:233] op_sel_hi:[1,0,0] neg_lo:[0,0,1] neg_hi:[0,0,1]
    v_exp_f32 v96, v96
    v_exp_f32 v97, v97
    v_exp_f32 v98, v98
    v_exp_f32 v99, v99
    v_exp_f32 v100, v100
    v_exp_f32 v101, v101
    v_exp_f32 v102, v102
    v_exp_f32 v103, v103
    v_pk_add_f32 v[250:251], v[250:251], v[96:97]
    v_pk_add_f32 v[250:251], v[250:251], v[98:99]
    v_pk_add_f32 v[250:251], v[250:251], v[100:101]
    v_pk_add_f32 v[250:251], v[250:251], v[102:103]
    v_cvt_pk_bf16_f32 v48, v96, v97
    v_cvt_pk_bf16_f32 v49, v98, v99
    v_cvt_pk_bf16_f32 v50, v100, v101
    v_cvt_pk_bf16_f32 v51, v102, v103
    v_pk_fma_f32 v[104:105], v[104:105], s[52:53], v[230:231] op_sel_hi:[1,0,0] neg_lo:[0,0,1] neg_hi:[0,0,1]
    v_pk_fma_f32 v[106:107], v[106:107], s[52:53], v[230:231] op_sel_hi:[1,0,0] neg_lo:[0,0,1] neg_hi:[0,0,1]
    v_pk_fma_f32 v[108:109], v[108:109], s[52:53], v[230:231] op_sel_hi:[1,0,0] neg_lo:[0,0,1] neg_hi:[0,0,1]
    v_pk_fma_f32 v[110:111], v[110:111], s[52:53], v[230:231] op_sel_hi:[1,0,0] neg_lo:[0,0,1] neg_hi:[0,0,1]
    v_exp_f32 v104, v104
    v_exp_f32 v105, v105
    s_add_u32 m0, s59, 32768
    s_add_u32 s68, s46, 212992
    buffer_load_dwordx4 v241, s[16:19], s68 offen offset:0 nt lds
    v_exp_f32 v106, v106
    v_exp_f32 v107, v107
    v_exp_f32 v108, v108
    v_exp_f32 v109, v109
    v_exp_f32 v110, v110
    v_exp_f32 v111, v111
    v_pk_add_f32 v[252:253], v[252:253], v[104:105]
    v_pk_add_f32 v[252:253], v[252:253], v[106:107]
    v_pk_add_f32 v[252:253], v[252:253], v[108:109]
    v_pk_add_f32 v[252:253], v[252:253], v[110:111]
    v_cvt_pk_bf16_f32 v52, v104, v105
    v_cvt_pk_bf16_f32 v53, v106, v107
    v_cvt_pk_bf16_f32 v54, v108, v109
    v_cvt_pk_bf16_f32 v55, v110, v111
    v_pk_fma_f32 v[112:113], v[112:113], s[52:53], v[234:235] op_sel_hi:[1,0,0] neg_lo:[0,0,1] neg_hi:[0,0,1]
    v_pk_fma_f32 v[114:115], v[114:115], s[52:53], v[234:235] op_sel_hi:[1,0,0] neg_lo:[0,0,1] neg_hi:[0,0,1]
    v_pk_fma_f32 v[116:117], v[116:117], s[52:53], v[234:235] op_sel_hi:[1,0,0] neg_lo:[0,0,1] neg_hi:[0,0,1]
    v_pk_fma_f32 v[118:119], v[118:119], s[52:53], v[234:235] op_sel_hi:[1,0,0] neg_lo:[0,0,1] neg_hi:[0,0,1]
    v_exp_f32 v112, v112
    v_exp_f32 v113, v113
    v_exp_f32 v114, v114
    v_exp_f32 v115, v115
    v_exp_f32 v116, v116
    v_exp_f32 v117, v117
    v_exp_f32 v118, v118
    v_exp_f32 v119, v119
    v_pk_add_f32 v[238:239], v[238:239], v[112:113]
    v_pk_add_f32 v[238:239], v[238:239], v[114:115]
    v_pk_add_f32 v[238:239], v[238:239], v[116:117]
    v_pk_add_f32 v[238:239], v[238:239], v[118:119]
    v_cvt_pk_bf16_f32 v56, v112, v113
    v_cvt_pk_bf16_f32 v57, v114, v115
    v_cvt_pk_bf16_f32 v58, v116, v117
    v_cvt_pk_bf16_f32 v59, v118, v119
    v_pk_fma_f32 v[120:121], v[120:121], s[52:53], v[232:233] op_sel_hi:[1,0,0] neg_lo:[0,0,1] neg_hi:[0,0,1]
    v_pk_fma_f32 v[122:123], v[122:123], s[52:53], v[232:233] op_sel_hi:[1,0,0] neg_lo:[0,0,1] neg_hi:[0,0,1]
    s_add_u32 s68, s68, 3072
    v_xor_b32 v244, 128, v241
    buffer_load_dwordx4 v244, s[16:19], s68 offen offset:1024 nt lds
    v_pk_fma_f32 v[124:125], v[124:125], s[52:53], v[232:233] op_sel_hi:[1,0,0] neg_lo:[0,0,1] neg_hi:[0,0,1]
    v_pk_fma_f32 v[126:127], v[126:127], s[52:53], v[232:233] op_sel_hi:[1,0,0] neg_lo:[0,0,1] neg_hi:[0,0,1]
    v_exp_f32 v120, v120
    v_exp_f32 v121, v121
    v_exp_f32 v122, v122
    v_exp_f32 v123, v123
    v_exp_f32 v124, v124
    v_exp_f32 v125, v125
    v_exp_f32 v126, v126
    v_exp_f32 v127, v127
    v_pk_add_f32 v[250:251], v[250:251], v[120:121]
    v_pk_add_f32 v[250:251], v[250:251], v[122:123]
    v_pk_add_f32 v[250:251], v[250:251], v[124:125]
    v_pk_add_f32 v[250:251], v[250:251], v[126:127]
    v_cvt_pk_bf16_f32 v60, v120, v121
    v_cvt_pk_bf16_f32 v61, v122, v123
    v_cvt_pk_bf16_f32 v62, v124, v125
    v_cvt_pk_bf16_f32 v63, v126, v127
    v_pk_fma_f32 v[128:129], v[128:129], s[52:53], v[230:231] op_sel_hi:[1,0,0] neg_lo:[0,0,1] neg_hi:[0,0,1]
    v_pk_fma_f32 v[130:131], v[130:131], s[52:53], v[230:231] op_sel_hi:[1,0,0] neg_lo:[0,0,1] neg_hi:[0,0,1]
    v_pk_fma_f32 v[132:133], v[132:133], s[52:53], v[230:231] op_sel_hi:[1,0,0] neg_lo:[0,0,1] neg_hi:[0,0,1]
    v_pk_fma_f32 v[134:135], v[134:135], s[52:53], v[230:231] op_sel_hi:[1,0,0] neg_lo:[0,0,1] neg_hi:[0,0,1]
    v_exp_f32 v128, v128
    v_exp_f32 v129, v129
    v_exp_f32 v130, v130
    v_exp_f32 v131, v131
    v_exp_f32 v132, v132
    v_exp_f32 v133, v133
    v_exp_f32 v134, v134
    v_exp_f32 v135, v135
    v_pk_add_f32 v[252:253], v[252:253], v[128:129]
    v_pk_add_f32 v[252:253], v[252:253], v[130:131]
    v_pk_add_f32 v[252:253], v[252:253], v[132:133]
    v_pk_add_f32 v[252:253], v[252:253], v[134:135]
    s_add_u32 s68, s68, 3072
    buffer_load_dwordx4 v241, s[16:19], s68 offen offset:2048 nt lds
    v_cvt_pk_bf16_f32 v64, v128, v129
    v_cvt_pk_bf16_f32 v65, v130, v131
    v_cvt_pk_bf16_f32 v66, v132, v133
    v_cvt_pk_bf16_f32 v67, v134, v135
    v_pk_fma_f32 v[136:137], v[136:137], s[52:53], v[234:235] op_sel_hi:[1,0,0] neg_lo:[0,0,1] neg_hi:[0,0,1]
    v_pk_fma_f32 v[138:139], v[138:139], s[52:53], v[234:235] op_sel_hi:[1,0,0] neg_lo:[0,0,1] neg_hi:[0,0,1]
    v_pk_fma_f32 v[140:141], v[140:141], s[52:53], v[234:235] op_sel_hi:[1,0,0] neg_lo:[0,0,1] neg_hi:[0,0,1]
    v_pk_fma_f32 v[142:143], v[142:143], s[52:53], v[234:235] op_sel_hi:[1,0,0] neg_lo:[0,0,1] neg_hi:[0,0,1]
    v_exp_f32 v136, v136
    v_exp_f32 v137, v137
    v_exp_f32 v138, v138
    v_exp_f32 v139, v139
    v_exp_f32 v140, v140
    v_exp_f32 v141, v141
    v_exp_f32 v142, v142
    v_exp_f32 v143, v143
    v_pk_add_f32 v[238:239], v[238:239], v[136:137]
    v_pk_add_f32 v[238:239], v[238:239], v[138:139]
    v_pk_add_f32 v[238:239], v[238:239], v[140:141]
    v_pk_add_f32 v[238:239], v[238:239], v[142:143]
    v_cvt_pk_bf16_f32 v68, v136, v137
    v_cvt_pk_bf16_f32 v69, v138, v139
    v_cvt_pk_bf16_f32 v70, v140, v141
    v_cvt_pk_bf16_f32 v71, v142, v143
    v_pk_fma_f32 v[144:145], v[144:145], s[52:53], v[232:233] op_sel_hi:[1,0,0] neg_lo:[0,0,1] neg_hi:[0,0,1]
    v_pk_fma_f32 v[146:147], v[146:147], s[52:53], v[232:233] op_sel_hi:[1,0,0] neg_lo:[0,0,1] neg_hi:[0,0,1]
    v_pk_fma_f32 v[148:149], v[148:149], s[52:53], v[232:233] op_sel_hi:[1,0,0] neg_lo:[0,0,1] neg_hi:[0,0,1]
    v_pk_fma_f32 v[150:151], v[150:151], s[52:53], v[232:233] op_sel_hi:[1,0,0] neg_lo:[0,0,1] neg_hi:[0,0,1]
    v_exp_f32 v144, v144
    v_exp_f32 v145, v145
    v_exp_f32 v146, v146
    v_exp_f32 v147, v147
    v_exp_f32 v148, v148
    v_exp_f32 v149, v149
    v_exp_f32 v150, v150
    s_add_u32 s68, s68, 3072
    buffer_load_dwordx4 v244, s[16:19], s68 offen offset:3072 nt lds
    v_exp_f32 v151, v151
    v_pk_add_f32 v[250:251], v[250:251], v[144:145]
    v_pk_add_f32 v[250:251], v[250:251], v[146:147]
    v_pk_add_f32 v[250:251], v[250:251], v[148:149]
    v_pk_add_f32 v[250:251], v[250:251], v[150:151]
    v_cvt_pk_bf16_f32 v72, v144, v145
    v_cvt_pk_bf16_f32 v73, v146, v147
    v_cvt_pk_bf16_f32 v74, v148, v149
    v_cvt_pk_bf16_f32 v75, v150, v151
    v_pk_fma_f32 v[152:153], v[152:153], s[52:53], v[230:231] op_sel_hi:[1,0,0] neg_lo:[0,0,1] neg_hi:[0,0,1]
    v_pk_fma_f32 v[154:155], v[154:155], s[52:53], v[230:231] op_sel_hi:[1,0,0] neg_lo:[0,0,1] neg_hi:[0,0,1]
    v_pk_fma_f32 v[156:157], v[156:157], s[52:53], v[230:231] op_sel_hi:[1,0,0] neg_lo:[0,0,1] neg_hi:[0,0,1]
    v_pk_fma_f32 v[158:159], v[158:159], s[52:53], v[230:231] op_sel_hi:[1,0,0] neg_lo:[0,0,1] neg_hi:[0,0,1]
    v_exp_f32 v152, v152
    v_exp_f32 v153, v153
    v_exp_f32 v154, v154
    v_exp_f32 v155, v155
    v_exp_f32 v156, v156
    v_exp_f32 v157, v157
    v_exp_f32 v158, v158
    v_exp_f32 v159, v159
    v_pk_add_f32 v[252:253], v[252:253], v[152:153]
    v_pk_add_f32 v[252:253], v[252:253], v[154:155]
    v_pk_add_f32 v[252:253], v[252:253], v[156:157]
    v_pk_add_f32 v[252:253], v[252:253], v[158:159]
    v_cvt_pk_bf16_f32 v76, v152, v153
    v_cvt_pk_bf16_f32 v77, v154, v155
    v_cvt_pk_bf16_f32 v78, v156, v157
    v_cvt_pk_bf16_f32 v79, v158, v159
    v_pk_fma_f32 v[160:161], v[160:161], s[52:53], v[234:235] op_sel_hi:[1,0,0] neg_lo:[0,0,1] neg_hi:[0,0,1]
    v_pk_fma_f32 v[162:163], v[162:163], s[52:53], v[234:235] op_sel_hi:[1,0,0] neg_lo:[0,0,1] neg_hi:[0,0,1]
    v_pk_fma_f32 v[164:165], v[164:165], s[52:53], v[234:235] op_sel_hi:[1,0,0] neg_lo:[0,0,1] neg_hi:[0,0,1]
    v_pk_fma_f32 v[166:167], v[166:167], s[52:53], v[234:235] op_sel_hi:[1,0,0] neg_lo:[0,0,1] neg_hi:[0,0,1]
    v_exp_f32 v160, v160
    v_exp_f32 v161, v161
    v_exp_f32 v162, v162
    v_exp_f32 v163, v163
    v_exp_f32 v164, v164
    v_exp_f32 v165, v165
    v_exp_f32 v166, v166
    v_exp_f32 v167, v167
    v_pk_add_f32 v[238:239], v[238:239], v[160:161]
    v_pk_add_f32 v[238:239], v[238:239], v[162:163]
    v_pk_add_f32 v[238:239], v[238:239], v[164:165]
    v_pk_add_f32 v[238:239], v[238:239], v[166:167]
    v_cvt_pk_bf16_f32 v80, v160, v161
    v_cvt_pk_bf16_f32 v81, v162, v163
    v_cvt_pk_bf16_f32 v82, v164, v165
    v_cvt_pk_bf16_f32 v83, v166, v167
    v_pk_fma_f32 v[168:169], v[168:169], s[52:53], v[232:233] op_sel_hi:[1,0,0] neg_lo:[0,0,1] neg_hi:[0,0,1]
    v_pk_fma_f32 v[170:171], v[170:171], s[52:53], v[232:233] op_sel_hi:[1,0,0] neg_lo:[0,0,1] neg_hi:[0,0,1]
    v_pk_fma_f32 v[172:173], v[172:173], s[52:53], v[232:233] op_sel_hi:[1,0,0] neg_lo:[0,0,1] neg_hi:[0,0,1]
    v_pk_fma_f32 v[174:175], v[174:175], s[52:53], v[232:233] op_sel_hi:[1,0,0] neg_lo:[0,0,1] neg_hi:[0,0,1]
    v_exp_f32 v168, v168
    v_exp_f32 v169, v169
    v_exp_f32 v170, v170
    v_exp_f32 v171, v171
    v_exp_f32 v172, v172
    v_exp_f32 v173, v173
    v_exp_f32 v174, v174
    v_exp_f32 v175, v175
    v_pk_add_f32 v[250:251], v[250:251], v[168:169]
    v_pk_add_f32 v[250:251], v[250:251], v[170:171]
    v_pk_add_f32 v[250:251], v[250:251], v[172:173]
    v_pk_add_f32 v[250:251], v[250:251], v[174:175]
    v_cvt_pk_bf16_f32 v84, v168, v169
    v_cvt_pk_bf16_f32 v85, v170, v171
    v_cvt_pk_bf16_f32 v86, v172, v173
    v_cvt_pk_bf16_f32 v87, v174, v175
    v_pk_fma_f32 v[176:177], v[176:177], s[52:53], v[230:231] op_sel_hi:[1,0,0] neg_lo:[0,0,1] neg_hi:[0,0,1]
    v_pk_fma_f32 v[178:179], v[178:179], s[52:53], v[230:231] op_sel_hi:[1,0,0] neg_lo:[0,0,1] neg_hi:[0,0,1]
    v_pk_fma_f32 v[180:181], v[180:181], s[52:53], v[230:231] op_sel_hi:[1,0,0] neg_lo:[0,0,1] neg_hi:[0,0,1]
    v_pk_fma_f32 v[182:183], v[182:183], s[52:53], v[230:231] op_sel_hi:[1,0,0] neg_lo:[0,0,1] neg_hi:[0,0,1]
    v_exp_f32 v176, v176
    v_exp_f32 v177, v177
    v_exp_f32 v178, v178
    v_exp_f32 v179, v179
    v_exp_f32 v180, v180
    v_exp_f32 v181, v181
    v_exp_f32 v182, v182
    v_exp_f32 v183, v183
    v_pk_add_f32 v[252:253], v[252:253], v[176:177]
    v_pk_add_f32 v[252:253], v[252:253], v[178:179]
    v_pk_add_f32 v[252:253], v[252:253], v[180:181]
    v_pk_add_f32 v[252:253], v[252:253], v[182:183]
    v_cvt_pk_bf16_f32 v88, v176, v177
    v_cvt_pk_bf16_f32 v89, v178, v179
    v_cvt_pk_bf16_f32 v90, v180, v181
    v_cvt_pk_bf16_f32 v91, v182, v183
    v_pk_fma_f32 v[184:185], v[184:185], s[52:53], v[234:235] op_sel_hi:[1,0,0] neg_lo:[0,0,1] neg_hi:[0,0,1]
    v_pk_fma_f32 v[186:187], v[186:187], s[52:53], v[234:235] op_sel_hi:[1,0,0] neg_lo:[0,0,1] neg_hi:[0,0,1]
    v_pk_fma_f32 v[188:189], v[188:189], s[52:53], v[234:235] op_sel_hi:[1,0,0] neg_lo:[0,0,1] neg_hi:[0,0,1]
    v_pk_fma_f32 v[190:191], v[190:191], s[52:53], v[234:235] op_sel_hi:[1,0,0] neg_lo:[0,0,1] neg_hi:[0,0,1]
    v_exp_f32 v184, v184
    v_exp_f32 v185, v185
    v_exp_f32 v186, v186
    v_exp_f32 v187, v187
    v_exp_f32 v188, v188
    v_exp_f32 v189, v189
    v_exp_f32 v190, v190
    v_exp_f32 v191, v191
    v_pk_add_f32 v[238:239], v[238:239], v[184:185]
    v_pk_add_f32 v[238:239], v[238:239], v[186:187]
    v_pk_add_f32 v[238:239], v[238:239], v[188:189]
    v_pk_add_f32 v[238:239], v[238:239], v[190:191]
    v_cvt_pk_bf16_f32 v92, v184, v185
    v_cvt_pk_bf16_f32 v93, v186, v187
    v_cvt_pk_bf16_f32 v94, v188, v189
    v_cvt_pk_bf16_f32 v95, v190, v191
    v_add_f32 v235, v250, v251
    v_add_f32 v236, v252, v253
    v_add_f32 v237, v238, v239
    v_mov_b32 v228, v235
    v_mov_b32 v229, v236
    v_mov_b32 v230, v237
    v_permlane32_swap_b32 v228, v235
    v_permlane32_swap_b32 v229, v236
    v_permlane32_swap_b32 v230, v237
    v_add_f32 v235, v228, v235
    v_add_f32 v236, v229, v236
    v_add_f32 v237, v230, v237
    v_mov_b32 v228, v235
    v_mov_b32 v229, v236
    v_mov_b32 v230, v237
    v_permlane16_swap_b32 v228, v235
    v_permlane16_swap_b32 v229, v236
    v_permlane16_swap_b32 v230, v237
    v_add_f32 v235, v228, v235
    v_add_f32 v236, v229, v236
    v_add_f32 v237, v230, v237
    s_lshl_b32 s48, s40, 11
    s_add_u32 s48, s48, 114688
    v_add_u32 v228, s48, v248
    v_xor_b32 v238, 4096, v228
    ds_write_b128 v228, v[232:235]
    ds_write_b64 v228, v[236:237] offset:1024
    v_add_u32 v224, 65536, v247
    v_xor_b32 v225, 32, v224
    v_xor_b32 v226, 64, v224
    v_xor_b32 v227, 96, v224
    v_xor_b32 v228, 128, v224
    v_xor_b32 v229, 160, v224
    v_xor_b32 v230, 192, v224
    v_xor_b32 v231, 224, v224
    s_waitcnt vmcnt(21) lgkmcnt(0)
    s_barrier
    ds_read_b64_tr_b16 v[192:193], v224 offset:0
    ds_read_b64_tr_b16 v[194:195], v224 offset:4096
    ds_read_b128 a[240:243], v238
    ds_read_b64 a[244:245], v238 offset:1024
    ds_read_b64_tr_b16 v[196:197], v225 offset:0
    ds_read_b64_tr_b16 v[198:199], v225 offset:4096
    ds_read_b64_tr_b16 v[200:201], v226 offset:0
    ds_read_b64_tr_b16 v[202:203], v226 offset:4096
    ds_read_b64_tr_b16 v[204:205], v227 offset:0
    ds_read_b64_tr_b16 v[206:207], v227 offset:4096
    ds_read_b64_tr_b16 v[208:209], v228 offset:0
    ds_read_b64_tr_b16 v[210:211], v228 offset:4096
    s_waitcnt lgkmcnt(8)
    v_mfma_f32_16x16x32_bf16 v[96:99], v[192:195], v[0:3], 0
    v_mfma_f32_16x16x32_bf16 v[100:103], v[192:195], v[4:7], 0
    ds_read_b64_tr_b16 v[212:213], v229 offset:0
    ds_read_b64_tr_b16 v[214:215], v229 offset:4096
    v_mfma_f32_16x16x32_bf16 v[104:107], v[192:195], v[8:11], 0
    s_waitcnt lgkmcnt(8)
    v_mfma_f32_16x16x32_bf16 v[108:111], v[196:199], v[0:3], 0
    v_mfma_f32_16x16x32_bf16 v[112:115], v[196:199], v[4:7], 0
    ds_read_b64_tr_b16 v[216:217], v230 offset:0
    ds_read_b64_tr_b16 v[218:219], v230 offset:4096
    v_mfma_f32_16x16x32_bf16 v[116:119], v[196:199], v[8:11], 0
    s_waitcnt lgkmcnt(8)
    v_mfma_f32_16x16x32_bf16 v[120:123], v[200:203], v[0:3], 0
    v_mfma_f32_16x16x32_bf16 v[124:127], v[200:203], v[4:7], 0
    ds_read_b64_tr_b16 v[220:221], v231 offset:0
    ds_read_b64_tr_b16 v[222:223], v231 offset:4096
    v_mfma_f32_16x16x32_bf16 v[128:131], v[200:203], v[8:11], 0
    s_waitcnt lgkmcnt(8)
    v_mfma_f32_16x16x32_bf16 v[132:135], v[204:207], v[0:3], 0
    v_add_u32 v224, 0, v247
    v_xor_b32 v225, 32, v224
    v_mfma_f32_16x16x32_bf16 v[136:139], v[204:207], v[4:7], 0
    v_xor_b32 v226, 64, v224
    v_xor_b32 v227, 96, v224
    v_mfma_f32_16x16x32_bf16 v[140:143], v[204:207], v[8:11], 0
    v_xor_b32 v228, 128, v224
    v_xor_b32 v229, 160, v224
    s_waitcnt lgkmcnt(6)
    v_mfma_f32_16x16x32_bf16 v[144:147], v[208:211], v[0:3], 0
    v_xor_b32 v230, 192, v224
    v_xor_b32 v231, 224, v224
    v_mfma_f32_16x16x32_bf16 v[148:151], v[208:211], v[4:7], 0
    v_mfma_f32_16x16x32_bf16 v[152:155], v[208:211], v[8:11], 0
    s_waitcnt vmcnt(16) lgkmcnt(0)
    s_barrier
    v_mfma_f32_16x16x32_bf16 v[156:159], v[212:215], v[0:3], 0
    ds_read_b64_tr_b16 v[192:193], v224 offset:0
    ds_read_b64_tr_b16 v[194:195], v224 offset:4096
    v_mfma_f32_16x16x32_bf16 v[160:163], v[212:215], v[4:7], 0
    ds_read_b64_tr_b16 v[196:197], v225 offset:0
    ds_read_b64_tr_b16 v[198:199], v225 offset:4096
    v_mfma_f32_16x16x32_bf16 v[164:167], v[212:215], v[8:11], 0
    ds_read_b64_tr_b16 v[200:201], v226 offset:0
    ds_read_b64_tr_b16 v[202:203], v226 offset:4096
    v_mfma_f32_16x16x32_bf16 v[168:171], v[216:219], v[0:3], 0
    ds_read_b64_tr_b16 v[204:205], v227 offset:0
    ds_read_b64_tr_b16 v[206:207], v227 offset:4096
    v_mfma_f32_16x16x32_bf16 v[172:175], v[216:219], v[4:7], 0
    ds_read_b64_tr_b16 v[208:209], v228 offset:0
    ds_read_b64_tr_b16 v[210:211], v228 offset:4096
    v_mfma_f32_16x16x32_bf16 v[176:179], v[216:219], v[8:11], 0
    v_mfma_f32_16x16x32_bf16 v[180:183], v[220:223], v[0:3], 0
    v_mfma_f32_16x16x32_bf16 v[184:187], v[220:223], v[4:7], 0
    v_mfma_f32_16x16x32_bf16 v[188:191], v[220:223], v[8:11], 0
    v_accvgpr_read_b32 v238, a240
    v_accvgpr_read_b32 v239, a243
    v_max_f32 v249, v238, v232
    v_sub_f32 v252, v238, v249
    v_sub_f32 v249, v232, v249
    v_exp_f32 v252, v252
    v_exp_f32 v249, v249
    v_mul_f32 v239, v239, v252
    v_fma_f32 v239, v235, v249, v239
    v_rcp_f32 v239, v239
    s_nop 0
    v_mul_f32 v249, v249, v239
    v_mul_f32 v252, v252, v239
    v_accvgpr_read_b32 v238, a241
    v_accvgpr_read_b32 v239, a244
    v_max_f32 v250, v238, v233
    v_sub_f32 v253, v238, v250
    v_sub_f32 v250, v233, v250
    v_exp_f32 v253, v253
    v_exp_f32 v250, v250
    v_mul_f32 v239, v239, v253
    v_fma_f32 v239, v236, v250, v239
    v_rcp_f32 v239, v239
    s_nop 0
    v_mul_f32 v250, v250, v239
    v_mul_f32 v253, v253, v239
    v_accvgpr_read_b32 v238, a242
    v_accvgpr_read_b32 v239, a245
    v_max_f32 v251, v238, v234
    v_sub_f32 v254, v238, v251
    v_sub_f32 v251, v234, v251
    v_exp_f32 v254, v254
    v_exp_f32 v251, v251
    v_mul_f32 v239, v239, v254
    v_fma_f32 v239, v237, v251, v239
    v_rcp_f32 v239, v239
    s_nop 0
    v_mul_f32 v251, v251, v239
    v_mul_f32 v254, v254, v239
    s_waitcnt lgkmcnt(8)
    v_mfma_f32_16x16x32_bf16 v[96:99], v[192:195], v[12:15], v[96:99]
    v_mfma_f32_16x16x32_bf16 v[100:103], v[192:195], v[16:19], v[100:103]
    ds_read_b64_tr_b16 v[212:213], v229 offset:0
    ds_read_b64_tr_b16 v[214:215], v229 offset:4096
    v_mfma_f32_16x16x32_bf16 v[104:107], v[192:195], v[20:23], v[104:107]
    s_waitcnt lgkmcnt(8)
    v_mfma_f32_16x16x32_bf16 v[108:111], v[196:199], v[12:15], v[108:111]
    v_mfma_f32_16x16x32_bf16 v[112:115], v[196:199], v[16:19], v[112:115]
    ds_read_b64_tr_b16 v[216:217], v230 offset:0
    ds_read_b64_tr_b16 v[218:219], v230 offset:4096
    v_mfma_f32_16x16x32_bf16 v[116:119], v[196:199], v[20:23], v[116:119]
    s_waitcnt lgkmcnt(8)
    v_mfma_f32_16x16x32_bf16 v[120:123], v[200:203], v[12:15], v[120:123]
    v_mfma_f32_16x16x32_bf16 v[124:127], v[200:203], v[16:19], v[124:127]
    ds_read_b64_tr_b16 v[220:221], v231 offset:0
    ds_read_b64_tr_b16 v[222:223], v231 offset:4096
    v_mfma_f32_16x16x32_bf16 v[128:131], v[200:203], v[20:23], v[128:131]
    s_waitcnt lgkmcnt(8)
    v_mfma_f32_16x16x32_bf16 v[132:135], v[204:207], v[12:15], v[132:135]
    v_add_u32 v224, 49152, v247
    v_xor_b32 v225, 32, v224
    v_mfma_f32_16x16x32_bf16 v[136:139], v[204:207], v[16:19], v[136:139]
    v_xor_b32 v226, 64, v224
    v_xor_b32 v227, 96, v224
    v_mfma_f32_16x16x32_bf16 v[140:143], v[204:207], v[20:23], v[140:143]
    v_xor_b32 v228, 128, v224
    v_xor_b32 v229, 160, v224
    s_waitcnt lgkmcnt(6)
    v_mfma_f32_16x16x32_bf16 v[144:147], v[208:211], v[12:15], v[144:147]
    v_xor_b32 v230, 192, v224
    v_xor_b32 v231, 224, v224
    v_mfma_f32_16x16x32_bf16 v[148:151], v[208:211], v[16:19], v[148:151]
    v_mfma_f32_16x16x32_bf16 v[152:155], v[208:211], v[20:23], v[152:155]
    s_waitcnt vmcnt(12) lgkmcnt(0)
    s_barrier
    v_bfe_u32 v238, v248, 4, 2
    v_lshl_add_u32 v238, v238, 2, s63
    buffer_load_dword v237, v238, s[32:35], 0 offen offset:0 sc1
    v_mfma_f32_16x16x32_bf16 v[156:159], v[212:215], v[12:15], v[156:159]
    ds_read_b64_tr_b16 v[192:193], v224 offset:0
    ds_read_b64_tr_b16 v[194:195], v224 offset:4096
    v_mfma_f32_16x16x32_bf16 v[160:163], v[212:215], v[16:19], v[160:163]
    ds_read_b64_tr_b16 v[196:197], v225 offset:0
    ds_read_b64_tr_b16 v[198:199], v225 offset:4096
    v_mfma_f32_16x16x32_bf16 v[164:167], v[212:215], v[20:23], v[164:167]
    ds_read_b64_tr_b16 v[200:201], v226 offset:0
    ds_read_b64_tr_b16 v[202:203], v226 offset:4096
    v_mfma_f32_16x16x32_bf16 v[168:171], v[216:219], v[12:15], v[168:171]
    ds_read_b64_tr_b16 v[204:205], v227 offset:0
    ds_read_b64_tr_b16 v[206:207], v227 offset:4096
    v_mfma_f32_16x16x32_bf16 v[172:175], v[216:219], v[16:19], v[172:175]
    ds_read_b64_tr_b16 v[208:209], v228 offset:0
    ds_read_b64_tr_b16 v[210:211], v228 offset:4096
    v_mfma_f32_16x16x32_bf16 v[176:179], v[216:219], v[20:23], v[176:179]
    v_mfma_f32_16x16x32_bf16 v[180:183], v[220:223], v[12:15], v[180:183]
    v_mfma_f32_16x16x32_bf16 v[184:187], v[220:223], v[16:19], v[184:187]
    v_mfma_f32_16x16x32_bf16 v[188:191], v[220:223], v[20:23], v[188:191]
    s_waitcnt lgkmcnt(8)
    v_mfma_f32_16x16x32_bf16 v[96:99], v[192:195], v[24:27], v[96:99]
    v_mfma_f32_16x16x32_bf16 v[100:103], v[192:195], v[28:31], v[100:103]
    ds_read_b64_tr_b16 v[212:213], v229 offset:0
    ds_read_b64_tr_b16 v[214:215], v229 offset:4096
    v_mfma_f32_16x16x32_bf16 v[104:107], v[192:195], v[32:35], v[104:107]
    s_waitcnt lgkmcnt(8)
    v_mfma_f32_16x16x32_bf16 v[108:111], v[196:199], v[24:27], v[108:111]
    v_mfma_f32_16x16x32_bf16 v[112:115], v[196:199], v[28:31], v[112:115]
    ds_read_b64_tr_b16 v[216:217], v230 offset:0
    ds_read_b64_tr_b16 v[218:219], v230 offset:4096
    v_mfma_f32_16x16x32_bf16 v[116:119], v[196:199], v[32:35], v[116:119]
    s_waitcnt lgkmcnt(8)
    v_mfma_f32_16x16x32_bf16 v[120:123], v[200:203], v[24:27], v[120:123]
    v_mfma_f32_16x16x32_bf16 v[124:127], v[200:203], v[28:31], v[124:127]
    ds_read_b64_tr_b16 v[220:221], v231 offset:0
    ds_read_b64_tr_b16 v[222:223], v231 offset:4096
    v_mfma_f32_16x16x32_bf16 v[128:131], v[200:203], v[32:35], v[128:131]
    s_waitcnt lgkmcnt(8)
    v_mfma_f32_16x16x32_bf16 v[132:135], v[204:207], v[24:27], v[132:135]
    v_add_u32 v224, 16384, v247
    v_xor_b32 v225, 32, v224
    v_mfma_f32_16x16x32_bf16 v[136:139], v[204:207], v[28:31], v[136:139]
    v_xor_b32 v226, 64, v224
    v_xor_b32 v227, 96, v224
    v_mfma_f32_16x16x32_bf16 v[140:143], v[204:207], v[32:35], v[140:143]
    v_xor_b32 v228, 128, v224
    v_xor_b32 v229, 160, v224
    s_waitcnt lgkmcnt(6)
    v_mfma_f32_16x16x32_bf16 v[144:147], v[208:211], v[24:27], v[144:147]
    v_xor_b32 v230, 192, v224
    v_xor_b32 v231, 224, v224
    v_mfma_f32_16x16x32_bf16 v[148:151], v[208:211], v[28:31], v[148:151]
    v_mfma_f32_16x16x32_bf16 v[152:155], v[208:211], v[32:35], v[152:155]
    s_waitcnt vmcnt(9) lgkmcnt(0)
    s_barrier
    v_mfma_f32_16x16x32_bf16 v[156:159], v[212:215], v[24:27], v[156:159]
    ds_read_b64_tr_b16 v[192:193], v224 offset:0
    ds_read_b64_tr_b16 v[194:195], v224 offset:4096
    s_add_u32 m0, s59, 98304
    s_add_u32 s68, s46, 229376
    buffer_load_dwordx4 v241, s[16:19], s68 offen offset:0 nt lds
    v_mfma_f32_16x16x32_bf16 v[160:163], v[212:215], v[28:31], v[160:163]
    ds_read_b64_tr_b16 v[196:197], v225 offset:0
    ds_read_b64_tr_b16 v[198:199], v225 offset:4096
    v_mfma_f32_16x16x32_bf16 v[164:167], v[212:215], v[32:35], v[164:167]
    ds_read_b64_tr_b16 v[200:201], v226 offset:0
    ds_read_b64_tr_b16 v[202:203], v226 offset:4096
    v_mfma_f32_16x16x32_bf16 v[168:171], v[216:219], v[24:27], v[168:171]
    ds_read_b64_tr_b16 v[204:205], v227 offset:0
    ds_read_b64_tr_b16 v[206:207], v227 offset:4096
    v_mfma_f32_16x16x32_bf16 v[172:175], v[216:219], v[28:31], v[172:175]
    ds_read_b64_tr_b16 v[208:209], v228 offset:0
    ds_read_b64_tr_b16 v[210:211], v228 offset:4096
    s_add_u32 s68, s68, 3072
    v_xor_b32 v244, 128, v241
    buffer_load_dwordx4 v244, s[16:19], s68 offen offset:1024 nt lds
    v_mfma_f32_16x16x32_bf16 v[176:179], v[216:219], v[32:35], v[176:179]
    v_mfma_f32_16x16x32_bf16 v[180:183], v[220:223], v[24:27], v[180:183]
    v_mfma_f32_16x16x32_bf16 v[184:187], v[220:223], v[28:31], v[184:187]
    v_mfma_f32_16x16x32_bf16 v[188:191], v[220:223], v[32:35], v[188:191]
    s_add_u32 s68, s68, 3072
    buffer_load_dwordx4 v241, s[16:19], s68 offen offset:2048 nt lds
    s_waitcnt lgkmcnt(8)
    v_mfma_f32_16x16x32_bf16 v[96:99], v[192:195], v[36:39], v[96:99]
    v_mfma_f32_16x16x32_bf16 v[100:103], v[192:195], v[40:43], v[100:103]
    ds_read_b64_tr_b16 v[212:213], v229 offset:0
    ds_read_b64_tr_b16 v[214:215], v229 offset:4096
    v_mfma_f32_16x16x32_bf16 v[104:107], v[192:195], v[44:47], v[104:107]
    s_waitcnt lgkmcnt(8)
    v_mfma_f32_16x16x32_bf16 v[108:111], v[196:199], v[36:39], v[108:111]
    s_add_u32 s68, s68, 3072
    buffer_load_dwordx4 v244, s[16:19], s68 offen offset:3072 nt lds
    v_mfma_f32_16x16x32_bf16 v[112:115], v[196:199], v[40:43], v[112:115]
    ds_read_b64_tr_b16 v[216:217], v230 offset:0
    ds_read_b64_tr_b16 v[218:219], v230 offset:4096
    v_mfma_f32_16x16x32_bf16 v[116:119], v[196:199], v[44:47], v[116:119]
    s_waitcnt lgkmcnt(8)
    v_mfma_f32_16x16x32_bf16 v[120:123], v[200:203], v[36:39], v[120:123]
    v_mfma_f32_16x16x32_bf16 v[124:127], v[200:203], v[40:43], v[124:127]
    ds_read_b64_tr_b16 v[220:221], v231 offset:0
    ds_read_b64_tr_b16 v[222:223], v231 offset:4096
    v_mfma_f32_16x16x32_bf16 v[128:131], v[200:203], v[44:47], v[128:131]
    s_waitcnt lgkmcnt(8)
    v_mfma_f32_16x16x32_bf16 v[132:135], v[204:207], v[36:39], v[132:135]
    v_add_u32 v224, 81920, v247
    v_xor_b32 v225, 32, v224
    v_mfma_f32_16x16x32_bf16 v[136:139], v[204:207], v[40:43], v[136:139]
    v_xor_b32 v226, 64, v224
    v_xor_b32 v227, 96, v224
    v_mfma_f32_16x16x32_bf16 v[140:143], v[204:207], v[44:47], v[140:143]
    v_xor_b32 v228, 128, v224
    v_xor_b32 v229, 160, v224
    s_waitcnt lgkmcnt(6)
    v_mfma_f32_16x16x32_bf16 v[144:147], v[208:211], v[36:39], v[144:147]
    v_xor_b32 v230, 192, v224
    v_xor_b32 v231, 224, v224
    v_mfma_f32_16x16x32_bf16 v[148:151], v[208:211], v[40:43], v[148:151]
    v_mfma_f32_16x16x32_bf16 v[152:155], v[208:211], v[44:47], v[152:155]
    s_waitcnt vmcnt(9) lgkmcnt(0)
    s_barrier
    v_mfma_f32_16x16x32_bf16 v[156:159], v[212:215], v[36:39], v[156:159]
    ds_read_b64_tr_b16 v[192:193], v224 offset:0
    ds_read_b64_tr_b16 v[194:195], v224 offset:4096
    s_add_u32 m0, s59, 65536
    s_add_u32 s68, s46, 245760
    buffer_load_dwordx4 v241, s[16:19], s68 offen offset:0 nt lds
    v_mfma_f32_16x16x32_bf16 v[160:163], v[212:215], v[40:43], v[160:163]
    ds_read_b64_tr_b16 v[196:197], v225 offset:0
    ds_read_b64_tr_b16 v[198:199], v225 offset:4096
    v_mfma_f32_16x16x32_bf16 v[164:167], v[212:215], v[44:47], v[164:167]
    ds_read_b64_tr_b16 v[200:201], v226 offset:0
    ds_read_b64_tr_b16 v[202:203], v226 offset:4096
    v_mfma_f32_16x16x32_bf16 v[168:171], v[216:219], v[36:39], v[168:171]
    ds_read_b64_tr_b16 v[204:205], v227 offset:0
    ds_read_b64_tr_b16 v[206:207], v227 offset:4096
    v_mfma_f32_16x16x32_bf16 v[172:175], v[216:219], v[40:43], v[172:175]
    ds_read_b64_tr_b16 v[208:209], v228 offset:0
    ds_read_b64_tr_b16 v[210:211], v228 offset:4096
    s_add_u32 s68, s68, 3072
    v_xor_b32 v244, 128, v241
    buffer_load_dwordx4 v244, s[16:19], s68 offen offset:1024 nt lds
    v_mfma_f32_16x16x32_bf16 v[176:179], v[216:219], v[44:47], v[176:179]
    v_mfma_f32_16x16x32_bf16 v[180:183], v[220:223], v[36:39], v[180:183]
    v_mfma_f32_16x16x32_bf16 v[184:187], v[220:223], v[40:43], v[184:187]
    v_mfma_f32_16x16x32_bf16 v[188:191], v[220:223], v[44:47], v[188:191]
    s_add_u32 s68, s68, 3072
    buffer_load_dwordx4 v241, s[16:19], s68 offen offset:2048 nt lds
    s_waitcnt lgkmcnt(8)
    v_mfma_f32_16x16x32_bf16 v[96:99], v[192:195], v[48:51], v[96:99]
    v_mfma_f32_16x16x32_bf16 v[100:103], v[192:195], v[52:55], v[100:103]
    ds_read_b64_tr_b16 v[212:213], v229 offset:0
    ds_read_b64_tr_b16 v[214:215], v229 offset:4096
    v_mfma_f32_16x16x32_bf16 v[104:107], v[192:195], v[56:59], v[104:107]
    s_waitcnt lgkmcnt(8)
    v_mfma_f32_16x16x32_bf16 v[108:111], v[196:199], v[48:51], v[108:111]
    s_add_u32 s68, s68, 3072
    buffer_load_dwordx4 v244, s[16:19], s68 offen offset:3072 nt lds
    v_mfma_f32_16x16x32_bf16 v[112:115], v[196:199], v[52:55], v[112:115]
    ds_read_b64_tr_b16 v[216:217], v230 offset:0
    ds_read_b64_tr_b16 v[218:219], v230 offset:4096
    v_mfma_f32_16x16x32_bf16 v[116:119], v[196:199], v[56:59], v[116:119]
    s_waitcnt lgkmcnt(8)
    v_mfma_f32_16x16x32_bf16 v[120:123], v[200:203], v[48:51], v[120:123]
    v_mfma_f32_16x16x32_bf16 v[124:127], v[200:203], v[52:55], v[124:127]
    ds_read_b64_tr_b16 v[220:221], v231 offset:0
    ds_read_b64_tr_b16 v[222:223], v231 offset:4096
    v_mfma_f32_16x16x32_bf16 v[128:131], v[200:203], v[56:59], v[128:131]
    s_waitcnt lgkmcnt(8)
    v_mfma_f32_16x16x32_bf16 v[132:135], v[204:207], v[48:51], v[132:135]
    v_add_u32 v224, 32768, v247
    v_xor_b32 v225, 32, v224
    v_mfma_f32_16x16x32_bf16 v[136:139], v[204:207], v[52:55], v[136:139]
    v_xor_b32 v226, 64, v224
    v_xor_b32 v227, 96, v224
    v_mfma_f32_16x16x32_bf16 v[140:143], v[204:207], v[56:59], v[140:143]
    v_xor_b32 v228, 128, v224
    v_xor_b32 v229, 160, v224
    s_waitcnt lgkmcnt(6)
    v_mfma_f32_16x16x32_bf16 v[144:147], v[208:211], v[48:51], v[144:147]
    v_xor_b32 v230, 192, v224
    v_xor_b32 v231, 224, v224
    v_mfma_f32_16x16x32_bf16 v[148:151], v[208:211], v[52:55], v[148:151]
    v_mfma_f32_16x16x32_bf16 v[152:155], v[208:211], v[56:59], v[152:155]
    s_waitcnt vmcnt(9) lgkmcnt(0)
    s_barrier
    v_mfma_f32_16x16x32_bf16 v[156:159], v[212:215], v[48:51], v[156:159]
    ds_read_b64_tr_b16 v[192:193], v224 offset:0
    ds_read_b64_tr_b16 v[194:195], v224 offset:4096
    v_mfma_f32_16x16x32_bf16 v[160:163], v[212:215], v[52:55], v[160:163]
    ds_read_b64_tr_b16 v[196:197], v225 offset:0
    ds_read_b64_tr_b16 v[198:199], v225 offset:4096
    v_mfma_f32_16x16x32_bf16 v[164:167], v[212:215], v[56:59], v[164:167]
    ds_read_b64_tr_b16 v[200:201], v226 offset:0
    ds_read_b64_tr_b16 v[202:203], v226 offset:4096
    v_mfma_f32_16x16x32_bf16 v[168:171], v[216:219], v[48:51], v[168:171]
    ds_read_b64_tr_b16 v[204:205], v227 offset:0
    ds_read_b64_tr_b16 v[206:207], v227 offset:4096
    v_mfma_f32_16x16x32_bf16 v[172:175], v[216:219], v[52:55], v[172:175]
    ds_read_b64_tr_b16 v[208:209], v228 offset:0
    ds_read_b64_tr_b16 v[210:211], v228 offset:4096
    v_mfma_f32_16x16x32_bf16 v[176:179], v[216:219], v[56:59], v[176:179]
    v_mfma_f32_16x16x32_bf16 v[180:183], v[220:223], v[48:51], v[180:183]
    v_mfma_f32_16x16x32_bf16 v[184:187], v[220:223], v[52:55], v[184:187]
    v_mfma_f32_16x16x32_bf16 v[188:191], v[220:223], v[56:59], v[188:191]
    s_waitcnt lgkmcnt(8)
    v_mfma_f32_16x16x32_bf16 v[96:99], v[192:195], v[60:63], v[96:99]
    v_mfma_f32_16x16x32_bf16 v[100:103], v[192:195], v[64:67], v[100:103]
    ds_read_b64_tr_b16 v[212:213], v229 offset:0
    ds_read_b64_tr_b16 v[214:215], v229 offset:4096
    v_mfma_f32_16x16x32_bf16 v[104:107], v[192:195], v[68:71], v[104:107]
    s_waitcnt lgkmcnt(8)
    v_mfma_f32_16x16x32_bf16 v[108:111], v[196:199], v[60:63], v[108:111]
    v_mfma_f32_16x16x32_bf16 v[112:115], v[196:199], v[64:67], v[112:115]
    ds_read_b64_tr_b16 v[216:217], v230 offset:0
    ds_read_b64_tr_b16 v[218:219], v230 offset:4096
    v_mfma_f32_16x16x32_bf16 v[116:119], v[196:199], v[68:71], v[116:119]
    s_waitcnt lgkmcnt(8)
    v_mfma_f32_16x16x32_bf16 v[120:123], v[200:203], v[60:63], v[120:123]
    v_mfma_f32_16x16x32_bf16 v[124:127], v[200:203], v[64:67], v[124:127]
    ds_read_b64_tr_b16 v[220:221], v231 offset:0
    ds_read_b64_tr_b16 v[222:223], v231 offset:4096
    v_mfma_f32_16x16x32_bf16 v[128:131], v[200:203], v[68:71], v[128:131]
    s_waitcnt lgkmcnt(8)
    v_mfma_f32_16x16x32_bf16 v[132:135], v[204:207], v[60:63], v[132:135]
    v_add_u32 v224, 98304, v247
    v_xor_b32 v225, 32, v224
    v_mfma_f32_16x16x32_bf16 v[136:139], v[204:207], v[64:67], v[136:139]
    v_xor_b32 v226, 64, v224
    v_xor_b32 v227, 96, v224
    v_mfma_f32_16x16x32_bf16 v[140:143], v[204:207], v[68:71], v[140:143]
    v_xor_b32 v228, 128, v224
    v_xor_b32 v229, 160, v224
    s_waitcnt lgkmcnt(6)
    v_mfma_f32_16x16x32_bf16 v[144:147], v[208:211], v[60:63], v[144:147]
    v_xor_b32 v230, 192, v224
    v_xor_b32 v231, 224, v224
    v_mfma_f32_16x16x32_bf16 v[148:151], v[208:211], v[64:67], v[148:151]
    v_mfma_f32_16x16x32_bf16 v[152:155], v[208:211], v[68:71], v[152:155]
    s_waitcnt vmcnt(4) lgkmcnt(0)
    s_barrier
    v_mfma_f32_16x16x32_bf16 v[156:159], v[212:215], v[60:63], v[156:159]
    ds_read_b64_tr_b16 v[192:193], v224 offset:0
    ds_read_b64_tr_b16 v[194:195], v224 offset:4096
    v_mfma_f32_16x16x32_bf16 v[160:163], v[212:215], v[64:67], v[160:163]
    ds_read_b64_tr_b16 v[196:197], v225 offset:0
    ds_read_b64_tr_b16 v[198:199], v225 offset:4096
    v_mfma_f32_16x16x32_bf16 v[164:167], v[212:215], v[68:71], v[164:167]
    ds_read_b64_tr_b16 v[200:201], v226 offset:0
    ds_read_b64_tr_b16 v[202:203], v226 offset:4096
    v_mfma_f32_16x16x32_bf16 v[168:171], v[216:219], v[60:63], v[168:171]
    ds_read_b64_tr_b16 v[204:205], v227 offset:0
    ds_read_b64_tr_b16 v[206:207], v227 offset:4096
    v_mfma_f32_16x16x32_bf16 v[172:175], v[216:219], v[64:67], v[172:175]
    ds_read_b64_tr_b16 v[208:209], v228 offset:0
    ds_read_b64_tr_b16 v[210:211], v228 offset:4096
    v_mfma_f32_16x16x32_bf16 v[176:179], v[216:219], v[68:71], v[176:179]
    v_mfma_f32_16x16x32_bf16 v[180:183], v[220:223], v[60:63], v[180:183]
    v_mfma_f32_16x16x32_bf16 v[184:187], v[220:223], v[64:67], v[184:187]
    v_mfma_f32_16x16x32_bf16 v[188:191], v[220:223], v[68:71], v[188:191]
    s_waitcnt lgkmcnt(8)
    v_mfma_f32_16x16x32_bf16 v[96:99], v[192:195], v[72:75], v[96:99]
    v_mfma_f32_16x16x32_bf16 v[100:103], v[192:195], v[76:79], v[100:103]
    ds_read_b64_tr_b16 v[212:213], v229 offset:0
    ds_read_b64_tr_b16 v[214:215], v229 offset:4096
    v_mfma_f32_16x16x32_bf16 v[104:107], v[192:195], v[80:83], v[104:107]
    s_waitcnt lgkmcnt(8)
    v_mfma_f32_16x16x32_bf16 v[108:111], v[196:199], v[72:75], v[108:111]
    v_mfma_f32_16x16x32_bf16 v[112:115], v[196:199], v[76:79], v[112:115]
    ds_read_b64_tr_b16 v[216:217], v230 offset:0
    ds_read_b64_tr_b16 v[218:219], v230 offset:4096
    v_mfma_f32_16x16x32_bf16 v[116:119], v[196:199], v[80:83], v[116:119]
    s_waitcnt lgkmcnt(8)
    v_mfma_f32_16x16x32_bf16 v[120:123], v[200:203], v[72:75], v[120:123]
    v_mfma_f32_16x16x32_bf16 v[124:127], v[200:203], v[76:79], v[124:127]
    ds_read_b64_tr_b16 v[220:221], v231 offset:0
    ds_read_b64_tr_b16 v[222:223], v231 offset:4096
    v_mfma_f32_16x16x32_bf16 v[128:131], v[200:203], v[80:83], v[128:131]
    s_waitcnt lgkmcnt(8)
    v_mfma_f32_16x16x32_bf16 v[132:135], v[204:207], v[72:75], v[132:135]
    v_add_u32 v224, 65536, v247
    v_xor_b32 v225, 32, v224
    v_mfma_f32_16x16x32_bf16 v[136:139], v[204:207], v[76:79], v[136:139]
    v_xor_b32 v226, 64, v224
    v_xor_b32 v227, 96, v224
    v_mfma_f32_16x16x32_bf16 v[140:143], v[204:207], v[80:83], v[140:143]
    v_xor_b32 v228, 128, v224
    v_xor_b32 v229, 160, v224
    s_waitcnt lgkmcnt(6)
    v_mfma_f32_16x16x32_bf16 v[144:147], v[208:211], v[72:75], v[144:147]
    v_xor_b32 v230, 192, v224
    v_xor_b32 v231, 224, v224
    v_mfma_f32_16x16x32_bf16 v[148:151], v[208:211], v[76:79], v[148:151]
    v_mfma_f32_16x16x32_bf16 v[152:155], v[208:211], v[80:83], v[152:155]
    s_waitcnt vmcnt(0) lgkmcnt(0)
    s_barrier
    v_bfe_u32 v238, v248, 4, 2
    v_lshl_add_u32 v238, v238, 2, s63
    s_mov_b32 s70, 0
L_p0_Y:
    v_cmp_eq_u32 vcc, s71, v237
    s_nop 0
    s_cmp_eq_u64 vcc, -1
    s_cbranch_scc1 L_p0ok_Y
    s_add_u32 s70, s70, 1
    s_cmp_gt_u32 s70, 20000
    s_cbranch_scc1 L_p0ok_Y
    s_sleep 1
    buffer_load_dword v237, v238, s[32:35], 0 offen offset:0 sc1
    s_waitcnt vmcnt(0)
    s_branch L_p0_Y
L_p0ok_Y:
    s_mul_i32 s48, s42, 49152
    s_add_u32 s48, s48, s60
    s_add_u32 s48, s48, 0
    v_add_u32 v239, s48, v248
    v_mfma_f32_16x16x32_bf16 v[156:159], v[212:215], v[72:75], v[156:159]
    ds_read_b64_tr_b16 v[192:193], v224 offset:0
    ds_read_b64_tr_b16 v[194:195], v224 offset:4096
    s_add_u32 m0, s59, 16384
    s_add_u32 s68, s72, 0
    buffer_load_dwordx4 v243, s[24:27], s68 offen offset:0  lds
    v_mfma_f32_16x16x32_bf16 v[160:163], v[212:215], v[76:79], v[160:163]
    ds_read_b64_tr_b16 v[196:197], v225 offset:0
    ds_read_b64_tr_b16 v[198:199], v225 offset:4096
    v_mfma_f32_16x16x32_bf16 v[164:167], v[212:215], v[80:83], v[164:167]
    ds_read_b64_tr_b16 v[200:201], v226 offset:0
    ds_read_b64_tr_b16 v[202:203], v226 offset:4096
    v_mfma_f32_16x16x32_bf16 v[168:171], v[216:219], v[72:75], v[168:171]
    ds_read_b64_tr_b16 v[204:205], v227 offset:0
    ds_read_b64_tr_b16 v[206:207], v227 offset:4096
    s_add_u32 s68, s68, 3072
    v_xor_b32 v244, 128, v243
    buffer_load_dwordx4 v244, s[24:27], s68 offen offset:1024  lds
    v_mfma_f32_16x16x32_bf16 v[172:175], v[216:219], v[76:79], v[172:175]
    ds_read_b64_tr_b16 v[208:209], v228 offset:0
    ds_read_b64_tr_b16 v[210:211], v228 offset:4096
    v_mfma_f32_16x16x32_bf16 v[176:179], v[216:219], v[80:83], v[176:179]
    ds_write_b128 v239, a[48:51] offset:0
    ds_write_b128 v239, a[52:55] offset:2048
    v_mfma_f32_16x16x32_bf16 v[180:183], v[220:223], v[72:75], v[180:183]
    ds_write_b128 v239, a[56:59] offset:4096
    ds_write_b128 v239, a[60:63] offset:1024
    s_add_u32 s68, s68, 3072
    buffer_load_dwordx4 v243, s[24:27], s68 offen offset:2048  lds
    v_mfma_f32_16x16x32_bf16 v[184:187], v[220:223], v[76:79], v[184:187]
    ds_write_b128 v239, a[64:67] offset:3072
    ds_write_b128 v239, a[68:71] offset:5120
    v_mfma_f32_16x16x32_bf16 v[188:191], v[220:223], v[80:83], v[188:191]
    s_waitcnt lgkmcnt(14)
    v_mfma_f32_16x16x32_bf16 v[96:99], v[192:195], v[84:87], v[96:99]
    s_add_u32 s68, s68, 3072
    buffer_load_dwordx4 v244, s[24:27], s68 offen offset:3072  lds
    v_mfma_f32_16x16x32_bf16 v[100:103], v[192:195], v[88:91], v[100:103]
    ds_read_b64_tr_b16 v[212:213], v229 offset:0
    ds_read_b64_tr_b16 v[214:215], v229 offset:4096
    v_mfma_f32_16x16x32_bf16 v[104:107], v[192:195], v[92:95], v[104:107]
    s_waitcnt lgkmcnt(14)
    v_mfma_f32_16x16x32_bf16 v[108:111], v[196:199], v[84:87], v[108:111]
    s_add_u32 m0, s59, 81920
    s_add_u32 s68, s72, 65536
    buffer_load_dwordx4 v243, s[24:27], s68 offen offset:0  lds
    v_mfma_f32_16x16x32_bf16 v[112:115], v[196:199], v[88:91], v[112:115]
    ds_read_b64_tr_b16 v[216:217], v230 offset:0
    ds_read_b64_tr_b16 v[218:219], v230 offset:4096
    v_mfma_f32_16x16x32_bf16 v[116:119], v[196:199], v[92:95], v[116:119]
    s_waitcnt lgkmcnt(14)
    v_mfma_f32_16x16x32_bf16 v[120:123], v[200:203], v[84:87], v[120:123]
    s_add_u32 s68, s68, 3072
    v_xor_b32 v244, 128, v243
    buffer_load_dwordx4 v244, s[24:27], s68 offen offset:1024  lds
    v_mfma_f32_16x16x32_bf16 v[124:127], v[200:203], v[88:91], v[124:127]
    ds_read_b64_tr_b16 v[220:221], v231 offset:0
    ds_read_b64_tr_b16 v[222:223], v231 offset:4096
    v_mfma_f32_16x16x32_bf16 v[128:131], v[200:203], v[92:95], v[128:131]
    s_waitcnt lgkmcnt(14)
    v_mfma_f32_16x16x32_bf16 v[132:135], v[204:207], v[84:87], v[132:135]
    s_add_u32 s68, s68, 3072
    buffer_load_dwordx4 v243, s[24:27], s68 offen offset:2048  lds
    v_mfma_f32_16x16x32_bf16 v[136:139], v[204:207], v[88:91], v[136:139]
    v_mfma_f32_16x16x32_bf16 v[140:143], v[204:207], v[92:95], v[140:143]
    s_waitcnt lgkmcnt(12)
    v_mfma_f32_16x16x32_bf16 v[144:147], v[208:211], v[84:87], v[144:147]
    v_mfma_f32_16x16x32_bf16 v[148:151], v[208:211], v[88:91], v[148:151]
    s_add_u32 s68, s68, 3072
    buffer_load_dwordx4 v244, s[24:27], s68 offen offset:3072  lds
    v_mfma_f32_16x16x32_bf16 v[152:155], v[208:211], v[92:95], v[152:155]
    s_waitcnt lgkmcnt(4)
    v_mfma_f32_16x16x32_bf16 v[156:159], v[212:215], v[84:87], v[156:159]
    v_mfma_f32_16x16x32_bf16 v[160:163], v[212:215], v[88:91], v[160:163]
    v_mfma_f32_16x16x32_bf16 v[164:167], v[212:215], v[92:95], v[164:167]
    s_add_u32 m0, s59, 32768
    s_add_u32 s68, s72, 131072
    buffer_load_dwordx4 v243, s[24:27], s68 offen offset:0  lds
    s_waitcnt lgkmcnt(2)
    v_mfma_f32_16x16x32_bf16 v[168:171], v[216:219], v[84:87], v[168:171]
    v_mfma_f32_16x16x32_bf16 v[172:175], v[216:219], v[88:91], v[172:175]
    v_mfma_f32_16x16x32_bf16 v[176:179], v[216:219], v[92:95], v[176:179]
    s_waitcnt lgkmcnt(0)
    v_mfma_f32_16x16x32_bf16 v[180:183], v[220:223], v[84:87], v[180:183]
    s_add_u32 s68, s68, 3072
    v_xor_b32 v244, 128, v243
    buffer_load_dwordx4 v244, s[24:27], s68 offen offset:1024  lds
    v_mfma_f32_16x16x32_bf16 v[184:187], v[220:223], v[88:91], v[184:187]
    v_mfma_f32_16x16x32_bf16 v[188:191], v[220:223], v[92:95], v[188:191]
    s_mul_i32 s48, s40, 12288
    s_add_u32 s48, s48, 114688
    v_add_u32 v192, s48, v248
    s_xor_b32 s49, s40, 2
    s_mul_i32 s49, s49, 12288
    s_add_u32 s49, s49, 114688
    v_add_u32 v193, s49, v248
    s_add_u32 s68, s68, 3072
    buffer_load_dwordx4 v243, s[24:27], s68 offen offset:2048  lds
    ds_write_b128 v192, v[144:147] offset:0
    v_mul_f32 v96, v96, v249
    v_mul_f32 v97, v97, v249
    v_mul_f32 v98, v98, v249
    v_mul_f32 v99, v99, v249
    ds_write_b128 v192, v[148:151] offset:1024
    v_mul_f32 v100, v100, v250
    v_mul_f32 v101, v101, v250
    v_mul_f32 v102, v102, v250
    v_mul_f32 v103, v103, v250
    ds_write_b128 v192, v[152:155] offset:2048
    v_mul_f32 v104, v104, v251
    v_mul_f32 v105, v105, v251
    s_add_u32 s68, s68, 3072
    buffer_load_dwordx4 v244, s[24:27], s68 offen offset:3072  lds
    v_mul_f32 v106, v106, v251
    v_mul_f32 v107, v107, v251
    ds_write_b128 v192, v[156:159] offset:3072
    v_mul_f32 v108, v108, v249
    v_mul_f32 v109, v109, v249
    v_mul_f32 v110, v110, v249
    v_mul_f32 v111, v111, v249
    ds_write_b128 v192, v[160:163] offset:4096
    v_mul_f32 v112, v112, v250
    v_mul_f32 v113, v113, v250
    v_mul_f32 v114, v114, v250
    v_mul_f32 v115, v115, v250
    ds_write_b128 v192, v[164:167] offset:5120
    v_mul_f32 v116, v116, v251
    v_mul_f32 v117, v117, v251
    v_mul_f32 v118, v118, v251
    v_mul_f32 v119, v119, v251
    ds_write_b128 v192, v[168:171] offset:6144
    v_mul_f32 v120, v120, v249
    v_mul_f32 v121, v121, v249
    v_mul_f32 v122, v122, v249
    v_mul_f32 v123, v123, v249
    ds_write_b128 v192, v[172:175] offset:7168
    v_mul_f32 v124, v124, v250
    v_mul_f32 v125, v125, v250
    v_mul_f32 v126, v126, v250
    v_mul_f32 v127, v127, v250
    ds_write_b128 v192, v[176:179] offset:8192
    v_mul_f32 v128, v128, v251
    v_mul_f32 v129, v129, v251
    v_mul_f32 v130, v130, v251
    v_mul_f32 v131, v131, v251
    ds_write_b128 v192, v[180:183] offset:9216
    v_mul_f32 v132, v132, v249
    v_mul_f32 v133, v133, v249
    v_mul_f32 v134, v134, v249
    v_mul_f32 v135, v135, v249
    ds_write_b128 v192, v[184:187] offset:10240
    v_mul_f32 v136, v136, v250
    v_mul_f32 v137, v137, v250
    v_mul_f32 v138, v138, v250
    v_mul_f32 v139, v139, v250
    ds_write_b128 v192, v[188:191] offset:11264
    v_mul_f32 v140, v140, v251
    v_mul_f32 v141, v141, v251
    v_mul_f32 v142, v142, v251
    v_mul_f32 v143, v143, v251
    s_waitcnt lgkmcnt(0)
    s_barrier
    ds_read_b128 v[0:3], v193 offset:0
    ds_read_b128 v[12:15], v193 offset:3072
    ds_read_b128 v[4:7], v193 offset:1024
    ds_read_b128 v[16:19], v193 offset:4096
    ds_read_b128 v[8:11], v193 offset:2048
    ds_read_b128 v[20:23], v193 offset:5120
    ds_read_b128 v[24:27], v193 offset:6144
    ds_read_b128 v[36:39], v193 offset:9216
    ds_read_b128 v[28:31], v193 offset:7168
    ds_read_b128 v[40:43], v193 offset:10240
    ds_read_b128 v[32:35], v193 offset:8192
    ds_read_b128 v[44:47], v193 offset:11264
    s_mul_i32 s48, s42, -32768
    s_add_u32 s48, s48, s60
    s_add_u32 s48, s48, 98304
    v_add_u32 v194, s48, v248
    s_add_u32 s48, s62, 24576
    s_add_u32 s49, s48, 2048
    s_add_u32 s50, s48, 4096
    s_waitcnt lgkmcnt(11)
    v_fma_f32 v96, v0, v252, v96
    v_fma_f32 v97, v1, v252, v97
    v_fma_f32 v98, v2, v252, v98
    v_fma_f32 v99, v3, v252, v99
    v_cvt_pk_bf16_f32 v48, v96, v97
    v_cvt_pk_bf16_f32 v49, v98, v99
    s_waitcnt lgkmcnt(10)
    v_fma_f32 v108, v12, v252, v108
    v_fma_f32 v109, v13, v252, v109
    v_fma_f32 v110, v14, v252, v110
    v_fma_f32 v111, v15, v252, v111
    v_cvt_pk_bf16_f32 v50, v108, v109
    v_cvt_pk_bf16_f32 v51, v110, v111
    buffer_store_dwordx4 v[48:51], v248, s[32:35], s48 offen offset:0 sc1
    ds_write_b128 v194, v[48:51] offset:0
    s_waitcnt lgkmcnt(10)
    v_fma_f32 v100, v4, v253, v100
    v_fma_f32 v101, v5, v253, v101
    v_fma_f32 v102, v6, v253, v102
    v_fma_f32 v103, v7, v253, v103
    v_cvt_pk_bf16_f32 v52, v100, v101
    v_cvt_pk_bf16_f32 v53, v102, v103
    s_waitcnt lgkmcnt(9)
    v_fma_f32 v112, v16, v253, v112
    v_fma_f32 v113, v17, v253, v113
    v_fma_f32 v114, v18, v253, v114
    v_fma_f32 v115, v19, v253, v115
    v_cvt_pk_bf16_f32 v54, v112, v113
    v_cvt_pk_bf16_f32 v55, v114, v115
    buffer_store_dwordx4 v[52:55], v248, s[32:35], s49 offen offset:0 sc1
    ds_write_b128 v194, v[52:55] offset:2048
    s_waitcnt lgkmcnt(9)
    v_fma_f32 v104, v8, v254, v104
    v_fma_f32 v105, v9, v254, v105
    v_fma_f32 v106, v10, v254, v106
    v_fma_f32 v107, v11, v254, v107
    v_cvt_pk_bf16_f32 v56, v104, v105
    v_cvt_pk_bf16_f32 v57, v106, v107
    s_waitcnt lgkmcnt(8)
    v_fma_f32 v116, v20, v254, v116
    v_fma_f32 v117, v21, v254, v117
    v_fma_f32 v118, v22, v254, v118
    v_fma_f32 v119, v23, v254, v119
    v_cvt_pk_bf16_f32 v58, v116, v117
    v_cvt_pk_bf16_f32 v59, v118, v119
    buffer_store_dwordx4 v[56:59], v248, s[32:35], s50 offen offset:0 sc1
    ds_write_b128 v194, v[56:59] offset:4096
    s_waitcnt lgkmcnt(8)
    v_fma_f32 v120, v24, v252, v120
    v_fma_f32 v121, v25, v252, v121
    v_fma_f32 v122, v26, v252, v122
    v_fma_f32 v123, v27, v252, v123
    v_cvt_pk_bf16_f32 v60, v120, v121
    v_cvt_pk_bf16_f32 v61, v122, v123
    s_waitcnt lgkmcnt(7)
    v_fma_f32 v132, v36, v252, v132
    v_fma_f32 v133, v37, v252, v133
    v_fma_f32 v134, v38, v252, v134
    v_fma_f32 v135, v39, v252, v135
    v_cvt_pk_bf16_f32 v62, v132, v133
    v_cvt_pk_bf16_f32 v63, v134, v135
    buffer_store_dwordx4 v[60:63], v248, s[32:35], s48 offen offset:1024 sc1
    ds_write_b128 v194, v[60:63] offset:1024
    s_waitcnt lgkmcnt(7)
    v_fma_f32 v124, v28, v253, v124
    v_fma_f32 v125, v29, v253, v125
    v_fma_f32 v126, v30, v253, v126
    v_fma_f32 v127, v31, v253, v127
    v_cvt_pk_bf16_f32 v64, v124, v125
    v_cvt_pk_bf16_f32 v65, v126, v127
    s_waitcnt lgkmcnt(6)
    v_fma_f32 v136, v40, v253, v136
    v_fma_f32 v137, v41, v253, v137
    v_fma_f32 v138, v42, v253, v138
    v_fma_f32 v139, v43, v253, v139
    v_cvt_pk_bf16_f32 v66, v136, v137
    v_cvt_pk_bf16_f32 v67, v138, v139
    buffer_store_dwordx4 v[64:67], v248, s[32:35], s49 offen offset:1024 sc1
    ds_write_b128 v194, v[64:67] offset:3072
    s_waitcnt lgkmcnt(6)
    v_fma_f32 v128, v32, v254, v128
    v_fma_f32 v129, v33, v254, v129
    v_fma_f32 v130, v34, v254, v130
    v_fma_f32 v131, v35, v254, v131
    v_cvt_pk_bf16_f32 v68, v128, v129
    v_cvt_pk_bf16_f32 v69, v130, v131
    s_waitcnt lgkmcnt(5)
    v_fma_f32 v140, v44, v254, v140
    v_fma_f32 v141, v45, v254, v141
    v_fma_f32 v142, v46, v254, v142
    v_fma_f32 v143, v47, v254, v143
    v_cvt_pk_bf16_f32 v70, v140, v141
    v_cvt_pk_bf16_f32 v71, v142, v143
    buffer_store_dwordx4 v[68:71], v248, s[32:35], s50 offen offset:1024 sc1
    ds_write_b128 v194, v[68:71] offset:5120
    s_add_u32 s48, s60, 0
    v_add_u32 v245, s48, v248
    v_add_u32 v224, 16384, v246
    v_xor_b32 v225, 32, v224
    v_xor_b32 v226, 64, v224
    v_xor_b32 v227, 96, v224
    s_waitcnt vmcnt(14) lgkmcnt(0)
    s_barrier
    s_add_u32 m0, s59, 114688
    s_add_u32 s68, s72, 196608
    buffer_load_dwordx4 v243, s[24:27], s68 offen offset:0  lds
    ds_read_b64_tr_b16 v[192:193], v224 offset:0
    ds_read_b64_tr_b16 v[194:195], v224 offset:4096
    ds_read_b128 a[0:3], v245 offset:0
    ds_read_b128 a[4:7], v245 offset:2048
    ds_read_b128 a[8:11], v245 offset:4096
    ds_read_b64_tr_b16 v[196:197], v225 offset:0
    ds_read_b64_tr_b16 v[198:199], v225 offset:4096
    ds_read_b64_tr_b16 v[200:201], v226 offset:0
    ds_read_b64_tr_b16 v[202:203], v226 offset:4096
    ds_read_b128 a[12:15], v245 offset:1024
    ds_read_b128 a[16:19], v245 offset:3072
    ds_read_b128 a[20:23], v245 offset:5120
    ds_read_b64_tr_b16 v[204:205], v227 offset:0
    ds_read_b64_tr_b16 v[206:207], v227 offset:4096
    ds_read_b64_tr_b16 v[208:209], v224 offset:8192
    ds_read_b64_tr_b16 v[210:211], v224 offset:12288
    s_waitcnt lgkmcnt(11)
    v_mfma_f32_16x16x32_bf16 a[192:195], v[192:195], a[0:3], 0
    s_add_u32 s68, s68, 3072
    v_xor_b32 v244, 128, v243
    buffer_load_dwordx4 v244, s[24:27], s68 offen offset:1024  lds
    v_mfma_f32_16x16x32_bf16 a[196:199], v[192:195], a[4:7], 0
    ds_read_b64_tr_b16 v[212:213], v225 offset:8192
    ds_read_b64_tr_b16 v[214:215], v225 offset:12288
    v_mfma_f32_16x16x32_bf16 a[200:203], v[192:195], a[8:11], 0
    s_waitcnt lgkmcnt(11)
    v_mfma_f32_16x16x32_bf16 a[204:207], v[196:199], a[0:3], 0
    s_add_u32 s68, s68, 3072
    buffer_load_dwordx4 v243, s[24:27], s68 offen offset:2048  lds
    v_mfma_f32_16x16x32_bf16 a[208:211], v[196:199], a[4:7], 0
    ds_read_b64_tr_b16 v[216:217], v226 offset:8192
    ds_read_b64_tr_b16 v[218:219], v226 offset:12288
    v_mfma_f32_16x16x32_bf16 a[212:215], v[196:199], a[8:11], 0
    s_waitcnt lgkmcnt(11)
    v_mfma_f32_16x16x32_bf16 a[216:219], v[200:203], a[0:3], 0
    s_add_u32 s68, s68, 3072
    buffer_load_dwordx4 v244, s[24:27], s68 offen offset:3072  lds
    v_mfma_f32_16x16x32_bf16 a[220:223], v[200:203], a[4:7], 0
    ds_read_b64_tr_b16 v[220:221], v227 offset:8192
    ds_read_b64_tr_b16 v[222:223], v227 offset:12288
    v_mfma_f32_16x16x32_bf16 a[224:227], v[200:203], a[8:11], 0
    s_add_u32 s48, s60, 49152
    v_add_u32 v245, s48, v248
    s_waitcnt lgkmcnt(8)
    v_mfma_f32_16x16x32_bf16 a[228:231], v[204:207], a[0:3], 0
    v_add_u32 v224, 81920, v246
    s_add_u32 m0, s59, 131072
    s_add_u32 s68, s73, 0
    buffer_load_dwordx4 v243, s[24:27], s68 offen offset:0  lds
    v_xor_b32 v225, 32, v224
    v_mfma_f32_16x16x32_bf16 a[232:235], v[204:207], a[4:7], 0
    v_xor_b32 v226, 64, v224
    v_xor_b32 v227, 96, v224
    v_mfma_f32_16x16x32_bf16 a[236:239], v[204:207], a[8:11], 0
    s_waitcnt lgkmcnt(6)
    v_mfma_f32_16x16x32_bf16 a[192:195], v[208:211], a[12:15], a[192:195]
    s_add_u32 s68, s68, 3072
    v_xor_b32 v244, 128, v243
    buffer_load_dwordx4 v244, s[24:27], s68 offen offset:1024  lds
    v_mfma_f32_16x16x32_bf16 a[196:199], v[208:211], a[16:19], a[196:199]
    v_mfma_f32_16x16x32_bf16 a[200:203], v[208:211], a[20:23], a[200:203]
    s_waitcnt vmcnt(6) lgkmcnt(0)
    s_barrier
    s_lshl_b32 s48, s40, 28
    s_add_u32 s48, s48, s47
    v_lshlrev_b32 v238, 24, v248
    s_add_u32 s68, s68, 3072
    buffer_load_dwordx4 v243, s[24:27], s68 offen offset:2048  lds
    v_lshrrev_b32 v239, 8, v248
    v_lshl_or_b32 v238, v239, 28, v238
    v_or_b32 v238, s48, v238
    v_mov_b32 v239, s71
    buffer_store_dword v239, v238, s[32:35], 0 offen offset:2048 sc1
    v_mfma_f32_16x16x32_bf16 a[204:207], v[212:215], a[12:15], a[204:207]
    ds_read_b64_tr_b16 v[192:193], v224 offset:0
    ds_read_b64_tr_b16 v[194:195], v224 offset:4096
    v_mfma_f32_16x16x32_bf16 a[208:211], v[212:215], a[16:19], a[208:211]
    ds_read_b128 a[24:27], v245 offset:0
    ds_read_b128 a[28:31], v245 offset:2048
    s_add_u32 s68, s68, 3072
    buffer_load_dwordx4 v244, s[24:27], s68 offen offset:3072  lds
    v_mfma_f32_16x16x32_bf16 a[212:215], v[212:215], a[20:23], a[212:215]
    ds_read_b128 a[32:35], v245 offset:4096
    ds_read_b64_tr_b16 v[196:197], v225 offset:0
    v_mfma_f32_16x16x32_bf16 a[216:219], v[216:219], a[12:15], a[216:219]
    ds_read_b64_tr_b16 v[198:199], v225 offset:4096
    ds_read_b64_tr_b16 v[200:201], v226 offset:0
    v_mfma_f32_16x16x32_bf16 a[220:223], v[216:219], a[16:19], a[220:223]
    ds_read_b64_tr_b16 v[202:203], v226 offset:4096
    ds_read_b128 a[36:39], v245 offset:1024
    s_add_u32 m0, s61, 147456
    s_add_u32 s68, s81, 0
    buffer_load_dwordx4 v248, s[32:35], s68 offen offset:0 sc1 lds
    v_mfma_f32_16x16x32_bf16 a[224:227], v[216:219], a[20:23], a[224:227]
    ds_read_b128 a[40:43], v245 offset:3072
    ds_read_b128 a[44:47], v245 offset:5120
    v_mfma_f32_16x16x32_bf16 a[228:231], v[220:223], a[12:15], a[228:231]
    ds_read_b64_tr_b16 v[204:205], v227 offset:0
    ds_read_b64_tr_b16 v[206:207], v227 offset:4096
    v_mfma_f32_16x16x32_bf16 a[232:235], v[220:223], a[16:19], a[232:235]
    ds_read_b64_tr_b16 v[208:209], v224 offset:8192
    ds_read_b64_tr_b16 v[210:211], v224 offset:12288
    buffer_load_dwordx4 v248, s[32:35], s68 offen offset:1024 sc1 lds
    v_mfma_f32_16x16x32_bf16 a[236:239], v[220:223], a[20:23], a[236:239]
    s_waitcnt lgkmcnt(11)
    v_mfma_f32_16x16x32_bf16 a[192:195], v[192:195], a[24:27], a[192:195]
    v_mfma_f32_16x16x32_bf16 a[196:199], v[192:195], a[28:31], a[196:199]
    ds_read_b64_tr_b16 v[212:213], v225 offset:8192
    ds_read_b64_tr_b16 v[214:215], v225 offset:12288
    buffer_load_dwordx4 v248, s[32:35], s68 offen offset:2048 sc1 lds
    v_mfma_f32_16x16x32_bf16 a[200:203], v[192:195], a[32:35], a[200:203]
    s_waitcnt lgkmcnt(11)
    v_mfma_f32_16x16x32_bf16 a[204:207], v[196:199], a[24:27], a[204:207]
    v_mfma_f32_16x16x32_bf16 a[208:211], v[196:199], a[28:31], a[208:211]
    ds_read_b64_tr_b16 v[216:217], v226 offset:8192
    ds_read_b64_tr_b16 v[218:219], v226 offset:12288
    s_add_u32 m0, s59, 16384
    s_add_u32 s68, s73, 65536
    buffer_load_dwordx4 v243, s[24:27], s68 offen offset:0  lds
    v_mfma_f32_16x16x32_bf16 a[212:215], v[196:199], a[32:35], a[212:215]
    s_waitcnt lgkmcnt(11)
    v_mfma_f32_16x16x32_bf16 a[216:219], v[200:203], a[24:27], a[216:219]
    v_mfma_f32_16x16x32_bf16 a[220:223], v[200:203], a[28:31], a[220:223]
    ds_read_b64_tr_b16 v[220:221], v227 offset:8192
    ds_read_b64_tr_b16 v[222:223], v227 offset:12288
    s_add_u32 s68, s68, 3072
    v_xor_b32 v244, 128, v243
    buffer_load_dwordx4 v244, s[24:27], s68 offen offset:1024  lds
    v_mfma_f32_16x16x32_bf16 a[224:227], v[200:203], a[32:35], a[224:227]
    s_add_u32 s48, s60, 98304
    v_add_u32 v245, s48, v248
    s_waitcnt lgkmcnt(8)
    v_mfma_f32_16x16x32_bf16 a[228:231], v[204:207], a[24:27], a[228:231]
    v_add_u32 v224, 32768, v246
    v_xor_b32 v225, 32, v224
    v_mfma_f32_16x16x32_bf16 a[232:235], v[204:207], a[28:31], a[232:235]
    v_xor_b32 v226, 64, v224
    s_add_u32 s68, s68, 3072
    buffer_load_dwordx4 v243, s[24:27], s68 offen offset:2048  lds
    v_xor_b32 v227, 96, v224
    v_mfma_f32_16x16x32_bf16 a[236:239], v[204:207], a[32:35], a[236:239]
    s_waitcnt lgkmcnt(6)
    v_mfma_f32_16x16x32_bf16 a[192:195], v[208:211], a[36:39], a[192:195]
    v_mfma_f32_16x16x32_bf16 a[196:199], v[208:211], a[40:43], a[196:199]
    s_add_u32 s68, s68, 3072
    buffer_load_dwordx4 v244, s[24:27], s68 offen offset:3072  lds
    v_mfma_f32_16x16x32_bf16 a[200:203], v[208:211], a[44:47], a[200:203]
    s_waitcnt lgkmcnt(0)
    s_barrier
    v_mfma_f32_16x16x32_bf16 a[204:207], v[212:215], a[36:39], a[204:207]
    ds_read_b64_tr_b16 v[192:193], v224 offset:0
    ds_read_b64_tr_b16 v[194:195], v224 offset:4096
    s_add_u32 m0, s61, 0
    s_add_u32 s68, s81, 12288
    buffer_load_dwordx4 v248, s[32:35], s68 offen offset:0 sc1 lds
    v_mfma_f32_16x16x32_bf16 a[208:211], v[212:215], a[40:43], a[208:211]
    ds_read_b128 a[0:3], v245 offset:0
    ds_read_b128 a[4:7], v245 offset:2048
    v_mfma_f32_16x16x32_bf16 a[212:215], v[212:215], a[44:47], a[212:215]
    ds_read_b128 a[8:11], v245 offset:4096
    ds_read_b64_tr_b16 v[196:197], v225 offset:0
    v_mfma_f32_16x16x32_bf16 a[216:219], v[216:219], a[36:39], a[216:219]
    ds_read_b64_tr_b16 v[198:199], v225 offset:4096
    ds_read_b64_tr_b16 v[200:201], v226 offset:0
    buffer_load_dwordx4 v248, s[32:35], s68 offen offset:1024 sc1 lds
    v_mfma_f32_16x16x32_bf16 a[220:223], v[216:219], a[40:43], a[220:223]
    ds_read_b64_tr_b16 v[202:203], v226 offset:4096
    ds_read_b128 a[12:15], v245 offset:1024
    v_mfma_f32_16x16x32_bf16 a[224:227], v[216:219], a[44:47], a[224:227]
    ds_read_b128 a[16:19], v245 offset:3072
    ds_read_b128 a[20:23], v245 offset:5120
    v_mfma_f32_16x16x32_bf16 a[228:231], v[220:223], a[36:39], a[228:231]
    ds_read_b64_tr_b16 v[204:205], v227 offset:0
    ds_read_b64_tr_b16 v[206:207], v227 offset:4096
    buffer_load_dwordx4 v248, s[32:35], s68 offen offset:2048 sc1 lds
    v_mfma_f32_16x16x32_bf16 a[232:235], v[220:223], a[40:43], a[232:235]
    ds_read_b64_tr_b16 v[208:209], v224 offset:8192
    ds_read_b64_tr_b16 v[210:211], v224 offset:12288
    v_mfma_f32_16x16x32_bf16 a[236:239], v[220:223], a[44:47], a[236:239]
    s_waitcnt lgkmcnt(11)
    v_mfma_f32_16x16x32_bf16 a[192:195], v[192:195], a[0:3], a[192:195]
    s_add_u32 m0, s59, 81920
    s_add_u32 s68, s74, 0
    buffer_load_dwordx4 v243, s[24:27], s68 offen offset:0  lds
    v_mfma_f32_16x16x32_bf16 a[196:199], v[192:195], a[4:7], a[196:199]
    ds_read_b64_tr_b16 v[212:213], v225 offset:8192
    ds_read_b64_tr_b16 v[214:215], v225 offset:12288
    v_mfma_f32_16x16x32_bf16 a[200:203], v[192:195], a[8:11], a[200:203]
    s_waitcnt lgkmcnt(11)
    v_mfma_f32_16x16x32_bf16 a[204:207], v[196:199], a[0:3], a[204:207]
    s_add_u32 s68, s68, 3072
    v_xor_b32 v244, 128, v243
    buffer_load_dwordx4 v244, s[24:27], s68 offen offset:1024  lds
    v_mfma_f32_16x16x32_bf16 a[208:211], v[196:199], a[4:7], a[208:211]
    ds_read_b64_tr_b16 v[216:217], v226 offset:8192
    ds_read_b64_tr_b16 v[218:219], v226 offset:12288
    v_mfma_f32_16x16x32_bf16 a[212:215], v[196:199], a[8:11], a[212:215]
    s_waitcnt lgkmcnt(11)
    v_mfma_f32_16x16x32_bf16 a[216:219], v[200:203], a[0:3], a[216:219]
    s_add_u32 s68, s68, 3072
    buffer_load_dwordx4 v243, s[24:27], s68 offen offset:2048  lds
    v_mfma_f32_16x16x32_bf16 a[220:223], v[200:203], a[4:7], a[220:223]
    ds_read_b64_tr_b16 v[220:221], v227 offset:8192
    ds_read_b64_tr_b16 v[222:223], v227 offset:12288
    v_mfma_f32_16x16x32_bf16 a[224:227], v[200:203], a[8:11], a[224:227]
    s_add_u32 s48, s60, 65536
    v_add_u32 v245, s48, v248
    s_waitcnt lgkmcnt(8)
    v_mfma_f32_16x16x32_bf16 a[228:231], v[204:207], a[0:3], a[228:231]
    v_add_u32 v224, 114688, v246
    s_add_u32 s68, s68, 3072
    buffer_load_dwordx4 v244, s[24:27], s68 offen offset:3072  lds
    v_xor_b32 v225, 32, v224
    v_mfma_f32_16x16x32_bf16 a[232:235], v[204:207], a[4:7], a[232:235]
    v_xor_b32 v226, 64, v224
    v_xor_b32 v227, 96, v224
    v_mfma_f32_16x16x32_bf16 a[236:239], v[204:207], a[8:11], a[236:239]
    s_waitcnt lgkmcnt(6)
    v_mfma_f32_16x16x32_bf16 a[192:195], v[208:211], a[12:15], a[192:195]
    s_add_u32 m0, s61, 49152
    s_add_u32 s68, s82, 0
    buffer_load_dwordx4 v248, s[32:35], s68 offen offset:0 sc1 lds
    v_mfma_f32_16x16x32_bf16 a[196:199], v[208:211], a[16:19], a[196:199]
    v_mfma_f32_16x16x32_bf16 a[200:203], v[208:211], a[20:23], a[200:203]
    s_waitcnt vmcnt(20) lgkmcnt(0)
    s_barrier
    v_mfma_f32_16x16x32_bf16 a[204:207], v[212:215], a[12:15], a[204:207]
    ds_read_b64_tr_b16 v[192:193], v224 offset:0
    ds_read_b64_tr_b16 v[194:195], v224 offset:4096
    buffer_load_dwordx4 v248, s[32:35], s68 offen offset:1024 sc1 lds
    v_mfma_f32_16x16x32_bf16 a[208:211], v[212:215], a[16:19], a[208:211]
    ds_read_b128 a[24:27], v245 offset:0
    ds_read_b128 a[28:31], v245 offset:2048
    v_mfma_f32_16x16x32_bf16 a[212:215], v[212:215], a[20:23], a[212:215]
    ds_read_b128 a[32:35], v245 offset:4096
    ds_read_b64_tr_b16 v[196:197], v225 offset:0
    v_mfma_f32_16x16x32_bf16 a[216:219], v[216:219], a[12:15], a[216:219]
    ds_read_b64_tr_b16 v[198:199], v225 offset:4096
    ds_read_b64_tr_b16 v[200:201], v226 offset:0
    buffer_load_dwordx4 v248, s[32:35], s68 offen offset:2048 sc1 lds
    v_mfma_f32_16x16x32_bf16 a[220:223], v[216:219], a[16:19], a[220:223]
    ds_read_b64_tr_b16 v[202:203], v226 offset:4096
    ds_read_b128 a[36:39], v245 offset:1024
    v_mfma_f32_16x16x32_bf16 a[224:227], v[216:219], a[20:23], a[224:227]
    ds_read_b128 a[40:43], v245 offset:3072
    ds_read_b128 a[44:47], v245 offset:5120
    v_mfma_f32_16x16x32_bf16 a[228:231], v[220:223], a[12:15], a[228:231]
    ds_read_b64_tr_b16 v[204:205], v227 offset:0
    ds_read_b64_tr_b16 v[206:207], v227 offset:4096
    s_add_u32 m0, s59, 32768
    s_add_u32 s68, s74, 65536
    buffer_load_dwordx4 v243, s[24:27], s68 offen offset:0  lds
    v_mfma_f32_16x16x32_bf16 a[232:235], v[220:223], a[16:19], a[232:235]
    ds_read_b64_tr_b16 v[208:209], v224 offset:8192
    ds_read_b64_tr_b16 v[210:211], v224 offset:12288
    v_mfma_f32_16x16x32_bf16 a[236:239], v[220:223], a[20:23], a[236:239]
    s_waitcnt lgkmcnt(11)
    v_mfma_f32_16x16x32_bf16 a[192:195], v[192:195], a[24:27], a[192:195]
    s_add_u32 s68, s68, 3072
    v_xor_b32 v244, 128, v243
    buffer_load_dwordx4 v244, s[24:27], s68 offen offset:1024  lds
    v_mfma_f32_16x16x32_bf16 a[196:199], v[192:195], a[28:31], a[196:199]
    ds_read_b64_tr_b16 v[212:213], v225 offset:8192
    ds_read_b64_tr_b16 v[214:215], v225 offset:12288
    v_mfma_f32_16x16x32_bf16 a[200:203], v[192:195], a[32:35], a[200:203]
    s_waitcnt lgkmcnt(11)
    v_mfma_f32_16x16x32_bf16 a[204:207], v[196:199], a[24:27], a[204:207]
    s_add_u32 s68, s68, 3072
    buffer_load_dwordx4 v243, s[24:27], s68 offen offset:2048  lds
    v_mfma_f32_16x16x32_bf16 a[208:211], v[196:199], a[28:31], a[208:211]
    ds_read_b64_tr_b16 v[216:217], v226 offset:8192
    ds_read_b64_tr_b16 v[218:219], v226 offset:12288
    v_mfma_f32_16x16x32_bf16 a[212:215], v[196:199], a[32:35], a[212:215]
    s_waitcnt lgkmcnt(11)
    v_mfma_f32_16x16x32_bf16 a[216:219], v[200:203], a[24:27], a[216:219]
    s_add_u32 s68, s68, 3072
    buffer_load_dwordx4 v244, s[24:27], s68 offen offset:3072  lds
    v_mfma_f32_16x16x32_bf16 a[220:223], v[200:203], a[28:31], a[220:223]
    ds_read_b64_tr_b16 v[220:221], v227 offset:8192
    ds_read_b64_tr_b16 v[222:223], v227 offset:12288
    v_mfma_f32_16x16x32_bf16 a[224:227], v[200:203], a[32:35], a[224:227]
    s_add_u32 s48, s60, 147456
    v_add_u32 v245, s48, v248
    s_waitcnt lgkmcnt(8)
    v_mfma_f32_16x16x32_bf16 a[228:231], v[204:207], a[24:27], a[228:231]
    v_add_u32 v224, 131072, v246
    v_xor_b32 v225, 32, v224
    v_mfma_f32_16x16x32_bf16 a[232:235], v[204:207], a[28:31], a[232:235]
    v_xor_b32 v226, 64, v224
    v_xor_b32 v227, 96, v224
    v_mfma_f32_16x16x32_bf16 a[236:239], v[204:207], a[32:35], a[236:239]
    s_waitcnt lgkmcnt(6)
    v_mfma_f32_16x16x32_bf16 a[192:195], v[208:211], a[36:39], a[192:195]
    v_mfma_f32_16x16x32_bf16 a[196:199], v[208:211], a[40:43], a[196:199]
    v_mfma_f32_16x16x32_bf16 a[200:203], v[208:211], a[44:47], a[200:203]
    s_waitcnt vmcnt(18) lgkmcnt(0)
    s_barrier
    v_mfma_f32_16x16x32_bf16 a[204:207], v[212:215], a[36:39], a[204:207]
    ds_read_b64_tr_b16 v[192:193], v224 offset:0
    ds_read_b64_tr_b16 v[194:195], v224 offset:4096
    s_add_u32 m0, s61, 114688
    s_add_u32 s68, s82, 12288
    buffer_load_dwordx4 v248, s[32:35], s68 offen offset:0 sc1 lds
    v_mfma_f32_16x16x32_bf16 a[208:211], v[212:215], a[40:43], a[208:211]
    ds_read_b128 a[0:3], v245 offset:0
    ds_read_b128 a[4:7], v245 offset:2048
    v_mfma_f32_16x16x32_bf16 a[212:215], v[212:215], a[44:47], a[212:215]
    ds_read_b128 a[8:11], v245 offset:4096
    ds_read_b64_tr_b16 v[196:197], v225 offset:0
    v_mfma_f32_16x16x32_bf16 a[216:219], v[216:219], a[36:39], a[216:219]
    ds_read_b64_tr_b16 v[198:199], v225 offset:4096
    ds_read_b64_tr_b16 v[200:201], v226 offset:0
    buffer_load_dwordx4 v248, s[32:35], s68 offen offset:1024 sc1 lds
    v_mfma_f32_16x16x32_bf16 a[220:223], v[216:219], a[40:43], a[220:223]
    ds_read_b64_tr_b16 v[202:203], v226 offset:4096
    ds_read_b128 a[12:15], v245 offset:1024
    v_mfma_f32_16x16x32_bf16 a[224:227], v[216:219], a[44:47], a[224:227]
    ds_read_b128 a[16:19], v245 offset:3072
    ds_read_b128 a[20:23], v245 offset:5120
    v_mfma_f32_16x16x32_bf16 a[228:231], v[220:223], a[36:39], a[228:231]
    ds_read_b64_tr_b16 v[204:205], v227 offset:0
    ds_read_b64_tr_b16 v[206:207], v227 offset:4096
    buffer_load_dwordx4 v248, s[32:35], s68 offen offset:2048 sc1 lds
    v_mfma_f32_16x16x32_bf16 a[232:235], v[220:223], a[40:43], a[232:235]
    ds_read_b64_tr_b16 v[208:209], v224 offset:8192
    ds_read_b64_tr_b16 v[210:211], v224 offset:12288
    v_mfma_f32_16x16x32_bf16 a[236:239], v[220:223], a[44:47], a[236:239]
    s_waitcnt lgkmcnt(11)
    v_mfma_f32_16x16x32_bf16 a[192:195], v[192:195], a[0:3], a[192:195]
    s_add_u32 m0, s59, 98304
    s_add_u32 s68, s75, 0
    buffer_load_dwordx4 v243, s[24:27], s68 offen offset:0  lds
    v_mfma_f32_16x16x32_bf16 a[196:199], v[192:195], a[4:7], a[196:199]
    ds_read_b64_tr_b16 v[212:213], v225 offset:8192
    ds_read_b64_tr_b16 v[214:215], v225 offset:12288
    v_mfma_f32_16x16x32_bf16 a[200:203], v[192:195], a[8:11], a[200:203]
    s_waitcnt lgkmcnt(11)
    v_mfma_f32_16x16x32_bf16 a[204:207], v[196:199], a[0:3], a[204:207]
    s_add_u32 s68, s68, 3072
    v_xor_b32 v244, 128, v243
    buffer_load_dwordx4 v244, s[24:27], s68 offen offset:1024  lds
    v_mfma_f32_16x16x32_bf16 a[208:211], v[196:199], a[4:7], a[208:211]
    ds_read_b64_tr_b16 v[216:217], v226 offset:8192
    ds_read_b64_tr_b16 v[218:219], v226 offset:12288
    v_mfma_f32_16x16x32_bf16 a[212:215], v[196:199], a[8:11], a[212:215]
    s_waitcnt lgkmcnt(11)
    v_mfma_f32_16x16x32_bf16 a[216:219], v[200:203], a[0:3], a[216:219]
    s_add_u32 s68, s68, 3072
    buffer_load_dwordx4 v243, s[24:27], s68 offen offset:2048  lds
    v_mfma_f32_16x16x32_bf16 a[220:223], v[200:203], a[4:7], a[220:223]
    ds_read_b64_tr_b16 v[220:221], v227 offset:8192
    ds_read_b64_tr_b16 v[222:223], v227 offset:12288
    v_mfma_f32_16x16x32_bf16 a[224:227], v[200:203], a[8:11], a[224:227]
    s_add_u32 s48, s60, 0
    v_add_u32 v245, s48, v248
    s_waitcnt lgkmcnt(8)
    v_mfma_f32_16x16x32_bf16 a[228:231], v[204:207], a[0:3], a[228:231]
    v_add_u32 v224, 16384, v246
    s_add_u32 s68, s68, 3072
    buffer_load_dwordx4 v244, s[24:27], s68 offen offset:3072  lds
    v_xor_b32 v225, 32, v224
    v_mfma_f32_16x16x32_bf16 a[232:235], v[204:207], a[4:7], a[232:235]
    v_xor_b32 v226, 64, v224
    v_xor_b32 v227, 96, v224
    v_mfma_f32_16x16x32_bf16 a[236:239], v[204:207], a[8:11], a[236:239]
    s_waitcnt lgkmcnt(6)
    v_mfma_f32_16x16x32_bf16 a[192:195], v[208:211], a[12:15], a[192:195]
    v_mfma_f32_16x16x32_bf16 a[196:199], v[208:211], a[16:19], a[196:199]
    v_mfma_f32_16x16x32_bf16 a[200:203], v[208:211], a[20:23], a[200:203]
    s_waitcnt vmcnt(18) lgkmcnt(0)
    s_barrier
    v_mfma_f32_16x16x32_bf16 a[204:207], v[212:215], a[12:15], a[204:207]
    ds_read_b64_tr_b16 v[192:193], v224 offset:0
    ds_read_b64_tr_b16 v[194:195], v224 offset:4096
    s_add_u32 m0, s61, 131072
    s_add_u32 s68, s83, 0
    buffer_load_dwordx4 v248, s[32:35], s68 offen offset:0 sc1 lds
    v_mfma_f32_16x16x32_bf16 a[208:211], v[212:215], a[16:19], a[208:211]
    ds_read_b128 a[24:27], v245 offset:0
    ds_read_b128 a[28:31], v245 offset:2048
    v_mfma_f32_16x16x32_bf16 a[212:215], v[212:215], a[20:23], a[212:215]
    ds_read_b128 a[32:35], v245 offset:4096
    ds_read_b64_tr_b16 v[196:197], v225 offset:0
    v_mfma_f32_16x16x32_bf16 a[216:219], v[216:219], a[12:15], a[216:219]
    ds_read_b64_tr_b16 v[198:199], v225 offset:4096
    ds_read_b64_tr_b16 v[200:201], v226 offset:0
    buffer_load_dwordx4 v248, s[32:35], s68 offen offset:1024 sc1 lds
    v_mfma_f32_16x16x32_bf16 a[220:223], v[216:219], a[16:19], a[220:223]
    ds_read_b64_tr_b16 v[202:203], v226 offset:4096
    ds_read_b128 a[36:39], v245 offset:1024
    v_mfma_f32_16x16x32_bf16 a[224:227], v[216:219], a[20:23], a[224:227]
    ds_read_b128 a[40:43], v245 offset:3072
    ds_read_b128 a[44:47], v245 offset:5120
    v_mfma_f32_16x16x32_bf16 a[228:231], v[220:223], a[12:15], a[228:231]
    ds_read_b64_tr_b16 v[204:205], v227 offset:0
    ds_read_b64_tr_b16 v[206:207], v227 offset:4096
    buffer_load_dwordx4 v248, s[32:35], s68 offen offset:2048 sc1 lds
    v_mfma_f32_16x16x32_bf16 a[232:235], v[220:223], a[16:19], a[232:235]
    ds_read_b64_tr_b16 v[208:209], v224 offset:8192
    ds_read_b64_tr_b16 v[210:211], v224 offset:12288
    v_mfma_f32_16x16x32_bf16 a[236:239], v[220:223], a[20:23], a[236:239]
    s_waitcnt lgkmcnt(11)
    v_mfma_f32_16x16x32_bf16 a[192:195], v[192:195], a[24:27], a[192:195]
    s_add_u32 m0, s59, 147456
    s_add_u32 s68, s75, 65536
    buffer_load_dwordx4 v243, s[24:27], s68 offen offset:0  lds
    v_mfma_f32_16x16x32_bf16 a[196:199], v[192:195], a[28:31], a[196:199]
    ds_read_b64_tr_b16 v[212:213], v225 offset:8192
    ds_read_b64_tr_b16 v[214:215], v225 offset:12288
    v_mfma_f32_16x16x32_bf16 a[200:203], v[192:195], a[32:35], a[200:203]
    s_waitcnt lgkmcnt(11)
    v_mfma_f32_16x16x32_bf16 a[204:207], v[196:199], a[24:27], a[204:207]
    s_add_u32 s68, s68, 3072
    v_xor_b32 v244, 128, v243
    buffer_load_dwordx4 v244, s[24:27], s68 offen offset:1024  lds
    v_mfma_f32_16x16x32_bf16 a[208:211], v[196:199], a[28:31], a[208:211]
    ds_read_b64_tr_b16 v[216:217], v226 offset:8192
    ds_read_b64_tr_b16 v[218:219], v226 offset:12288
    v_mfma_f32_16x16x32_bf16 a[212:215], v[196:199], a[32:35], a[212:215]
    s_waitcnt lgkmcnt(11)
    v_mfma_f32_16x16x32_bf16 a[216:219], v[200:203], a[24:27], a[216:219]
    s_add_u32 s68, s68, 3072
    buffer_load_dwordx4 v243, s[24:27], s68 offen offset:2048  lds
    v_mfma_f32_16x16x32_bf16 a[220:223], v[200:203], a[28:31], a[220:223]
    ds_read_b64_tr_b16 v[220:221], v227 offset:8192
    ds_read_b64_tr_b16 v[222:223], v227 offset:12288
    v_mfma_f32_16x16x32_bf16 a[224:227], v[200:203], a[32:35], a[224:227]
    s_add_u32 s48, s60, 49152
    v_add_u32 v245, s48, v248
    s_waitcnt lgkmcnt(8)
    v_mfma_f32_16x16x32_bf16 a[228:231], v[204:207], a[24:27], a[228:231]
    v_add_u32 v224, 81920, v246
    s_add_u32 s68, s68, 3072
    buffer_load_dwordx4 v244, s[24:27], s68 offen offset:3072  lds
    v_xor_b32 v225, 32, v224
    v_mfma_f32_16x16x32_bf16 a[232:235], v[204:207], a[28:31], a[232:235]
    v_xor_b32 v226, 64, v224
    v_xor_b32 v227, 96, v224
    v_mfma_f32_16x16x32_bf16 a[236:239], v[204:207], a[32:35], a[236:239]
    s_waitcnt lgkmcnt(6)
    v_mfma_f32_16x16x32_bf16 a[192:195], v[208:211], a[36:39], a[192:195]
    v_mfma_f32_16x16x32_bf16 a[196:199], v[208:211], a[40:43], a[196:199]
    v_mfma_f32_16x16x32_bf16 a[200:203], v[208:211], a[44:47], a[200:203]
    s_waitcnt vmcnt(18) lgkmcnt(0)
    s_barrier
    v_bfe_u32 v238, v248, 4, 2
    v_lshl_add_u32 v238, v238, 2, s63
    buffer_load_dword v232, v238, s[32:35], 0 offen offset:2048 sc1
    v_mfma_f32_16x16x32_bf16 a[204:207], v[212:215], a[36:39], a[204:207]
    ds_read_b64_tr_b16 v[192:193], v224 offset:0
    ds_read_b64_tr_b16 v[194:195], v224 offset:4096
    s_add_u32 m0, s61, 65536
    s_add_u32 s68, s83, 12288
    buffer_load_dwordx4 v248, s[32:35], s68 offen offset:0 sc1 lds
    v_mfma_f32_16x16x32_bf16 a[208:211], v[212:215], a[40:43], a[208:211]
    ds_read_b128 a[0:3], v245 offset:0
    ds_read_b128 a[4:7], v245 offset:2048
    v_mfma_f32_16x16x32_bf16 a[212:215], v[212:215], a[44:47], a[212:215]
    ds_read_b128 a[8:11], v245 offset:4096
    ds_read_b64_tr_b16 v[196:197], v225 offset:0
    v_mfma_f32_16x16x32_bf16 a[216:219], v[216:219], a[36:39], a[216:219]
    ds_read_b64_tr_b16 v[198:199], v225 offset:4096
    ds_read_b64_tr_b16 v[200:201], v226 offset:0
    buffer_load_dwordx4 v248, s[32:35], s68 offen offset:1024 sc1 lds
    v_mfma_f32_16x16x32_bf16 a[220:223], v[216:219], a[40:43], a[220:223]
    ds_read_b64_tr_b16 v[202:203], v226 offset:4096
    ds_read_b128 a[12:15], v245 offset:1024
    v_mfma_f32_16x16x32_bf16 a[224:227], v[216:219], a[44:47], a[224:227]
    ds_read_b128 a[16:19], v245 offset:3072
    ds_read_b128 a[20:23], v245 offset:5120
    v_mfma_f32_16x16x32_bf16 a[228:231], v[220:223], a[36:39], a[228:231]
    ds_read_b64_tr_b16 v[204:205], v227 offset:0
    ds_read_b64_tr_b16 v[206:207], v227 offset:4096
    buffer_load_dwordx4 v248, s[32:35], s68 offen offset:2048 sc1 lds
    v_mfma_f32_16x16x32_bf16 a[232:235], v[220:223], a[40:43], a[232:235]
    ds_read_b64_tr_b16 v[208:209], v224 offset:8192
    ds_read_b64_tr_b16 v[210:211], v224 offset:12288
    v_mfma_f32_16x16x32_bf16 a[236:239], v[220:223], a[44:47], a[236:239]
    s_waitcnt lgkmcnt(11)
    v_mfma_f32_16x16x32_bf16 a[192:195], v[192:195], a[0:3], a[192:195]
    s_add_u32 m0, s59, 16384
    s_add_u32 s68, s73, 131072
    buffer_load_dwordx4 v243, s[24:27], s68 offen offset:0  lds
    v_mfma_f32_16x16x32_bf16 a[196:199], v[192:195], a[4:7], a[196:199]
    ds_read_b64_tr_b16 v[212:213], v225 offset:8192
    ds_read_b64_tr_b16 v[214:215], v225 offset:12288
    v_mfma_f32_16x16x32_bf16 a[200:203], v[192:195], a[8:11], a[200:203]
    s_waitcnt lgkmcnt(11)
    v_mfma_f32_16x16x32_bf16 a[204:207], v[196:199], a[0:3], a[204:207]
    s_add_u32 s68, s68, 3072
    v_xor_b32 v244, 128, v243
    buffer_load_dwordx4 v244, s[24:27], s68 offen offset:1024  lds
    v_mfma_f32_16x16x32_bf16 a[208:211], v[196:199], a[4:7], a[208:211]
    ds_read_b64_tr_b16 v[216:217], v226 offset:8192
    ds_read_b64_tr_b16 v[218:219], v226 offset:12288
    v_mfma_f32_16x16x32_bf16 a[212:215], v[196:199], a[8:11], a[212:215]
    s_waitcnt lgkmcnt(11)
    v_mfma_f32_16x16x32_bf16 a[216:219], v[200:203], a[0:3], a[216:219]
    s_add_u32 s68, s68, 3072
    buffer_load_dwordx4 v243, s[24:27], s68 offen offset:2048  lds
    v_mfma_f32_16x16x32_bf16 a[220:223], v[200:203], a[4:7], a[220:223]
    ds_read_b64_tr_b16 v[220:221], v227 offset:8192
    ds_read_b64_tr_b16 v[222:223], v227 offset:12288
    v_mfma_f32_16x16x32_bf16 a[224:227], v[200:203], a[8:11], a[224:227]
    s_add_u32 s48, s60, 114688
    v_add_u32 v245, s48, v248
    s_waitcnt lgkmcnt(8)
    v_mfma_f32_16x16x32_bf16 a[228:231], v[204:207], a[0:3], a[228:231]
    v_add_u32 v224, 32768, v246
    s_add_u32 s68, s68, 3072
    buffer_load_dwordx4 v244, s[24:27], s68 offen offset:3072  lds
    v_xor_b32 v225, 32, v224
    v_mfma_f32_16x16x32_bf16 a[232:235], v[204:207], a[4:7], a[232:235]
    v_xor_b32 v226, 64, v224
    v_xor_b32 v227, 96, v224
    v_mfma_f32_16x16x32_bf16 a[236:239], v[204:207], a[8:11], a[236:239]
    s_waitcnt lgkmcnt(6)
    v_mfma_f32_16x16x32_bf16 a[192:195], v[208:211], a[12:15], a[192:195]
    v_mfma_f32_16x16x32_bf16 a[196:199], v[208:211], a[16:19], a[196:199]
    v_mfma_f32_16x16x32_bf16 a[200:203], v[208:211], a[20:23], a[200:203]
    s_waitcnt vmcnt(19) lgkmcnt(0)
    s_barrier
    v_mfma_f32_16x16x32_bf16 a[204:207], v[212:215], a[12:15], a[204:207]
    ds_read_b64_tr_b16 v[192:193], v224 offset:0
    ds_read_b64_tr_b16 v[194:195], v224 offset:4096
    s_add_u32 m0, s59, 0
    s_add_u32 s68, s73, 196608
    buffer_load_dwordx4 v243, s[24:27], s68 offen offset:0  lds
    v_mfma_f32_16x16x32_bf16 a[208:211], v[212:215], a[16:19], a[208:211]
    ds_read_b128 a[24:27], v245 offset:0
    ds_read_b128 a[28:31], v245 offset:2048
    v_mfma_f32_16x16x32_bf16 a[212:215], v[212:215], a[20:23], a[212:215]
    ds_read_b128 a[32:35], v245 offset:4096
    ds_read_b64_tr_b16 v[196:197], v225 offset:0
    v_mfma_f32_16x16x32_bf16 a[216:219], v[216:219], a[12:15], a[216:219]
    ds_read_b64_tr_b16 v[198:199], v225 offset:4096
    ds_read_b64_tr_b16 v[200:201], v226 offset:0
    s_add_u32 s68, s68, 3072
    v_xor_b32 v244, 128, v243
    buffer_load_dwordx4 v244, s[24:27], s68 offen offset:1024  lds
    v_mfma_f32_16x16x32_bf16 a[220:223], v[216:219], a[16:19], a[220:223]
    ds_read_b64_tr_b16 v[202:203], v226 offset:4096
    ds_read_b128 a[36:39], v245 offset:1024
    v_mfma_f32_16x16x32_bf16 a[224:227], v[216:219], a[20:23], a[224:227]
    ds_read_b128 a[40:43], v245 offset:3072
    ds_read_b128 a[44:47], v245 offset:5120
    v_mfma_f32_16x16x32_bf16 a[228:231], v[220:223], a[12:15], a[228:231]
    ds_read_b64_tr_b16 v[204:205], v227 offset:0
    ds_read_b64_tr_b16 v[206:207], v227 offset:4096
    s_add_u32 s68, s68, 3072
    buffer_load_dwordx4 v243, s[24:27], s68 offen offset:2048  lds
    v_mfma_f32_16x16x32_bf16 a[232:235], v[220:223], a[16:19], a[232:235]
    ds_read_b64_tr_b16 v[208:209], v224 offset:8192
    ds_read_b64_tr_b16 v[210:211], v224 offset:12288
    v_mfma_f32_16x16x32_bf16 a[236:239], v[220:223], a[20:23], a[236:239]
    s_waitcnt lgkmcnt(11)
    v_mfma_f32_16x16x32_bf16 a[192:195], v[192:195], a[24:27], a[192:195]
    s_add_u32 s68, s68, 3072
    buffer_load_dwordx4 v244, s[24:27], s68 offen offset:3072  lds
    v_mfma_f32_16x16x32_bf16 a[196:199], v[192:195], a[28:31], a[196:199]
    ds_read_b64_tr_b16 v[212:213], v225 offset:8192
    ds_read_b64_tr_b16 v[214:215], v225 offset:12288
    v_mfma_f32_16x16x32_bf16 a[200:203], v[192:195], a[32:35], a[200:203]
    s_waitcnt lgkmcnt(11)
    v_mfma_f32_16x16x32_bf16 a[204:207], v[196:199], a[24:27], a[204:207]
    v_mfma_f32_16x16x32_bf16 a[208:211], v[196:199], a[28:31], a[208:211]
    ds_read_b64_tr_b16 v[216:217], v226 offset:8192
    ds_read_b64_tr_b16 v[218:219], v226 offset:12288
    v_mfma_f32_16x16x32_bf16 a[212:215], v[196:199], a[32:35], a[212:215]
    s_waitcnt lgkmcnt(11)
    v_mfma_f32_16x16x32_bf16 a[216:219], v[200:203], a[24:27], a[216:219]
    v_mfma_f32_16x16x32_bf16 a[220:223], v[200:203], a[28:31], a[220:223]
    ds_read_b64_tr_b16 v[220:221], v227 offset:8192
    ds_read_b64_tr_b16 v[222:223], v227 offset:12288
    v_mfma_f32_16x16x32_bf16 a[224:227], v[200:203], a[32:35], a[224:227]
    s_add_u32 s48, s60, 131072
    v_add_u32 v245, s48, v248
    s_waitcnt lgkmcnt(8)
    v_mfma_f32_16x16x32_bf16 a[228:231], v[204:207], a[24:27], a[228:231]
    v_add_u32 v224, 98304, v246
    v_xor_b32 v225, 32, v224
    v_mfma_f32_16x16x32_bf16 a[232:235], v[204:207], a[28:31], a[232:235]
    v_xor_b32 v226, 64, v224
    v_xor_b32 v227, 96, v224
    v_mfma_f32_16x16x32_bf16 a[236:239], v[204:207], a[32:35], a[236:239]
    s_waitcnt lgkmcnt(6)
    v_mfma_f32_16x16x32_bf16 a[192:195], v[208:211], a[36:39], a[192:195]
    v_mfma_f32_16x16x32_bf16 a[196:199], v[208:211], a[40:43], a[196:199]
    v_mfma_f32_16x16x32_bf16 a[200:203], v[208:211], a[44:47], a[200:203]
    s_waitcnt vmcnt(16) lgkmcnt(0)
    s_barrier
    v_bfe_u32 v238, v248, 4, 2
    v_lshl_add_u32 v238, v238, 2, s63
    buffer_load_dword v233, v238, s[32:35], 0 offen offset:2048 sc1
    v_bfe_u32 v238, v248, 4, 2
    v_lshl_add_u32 v238, v238, 2, s63
    s_add_u32 s49, s56, 1
    s_and_b32 s49, s49, 3
    s_waitcnt vmcnt(12)
    s_mov_b32 s70, 0
L_p110_Y:
    v_cmp_eq_u32 vcc, s71, v232
    s_nop 0
    s_bitcmp1_b32 vcc_lo, s49
    s_cbranch_scc1 L_p110ok_Y
    s_add_u32 s70, s70, 1
    s_cmp_gt_u32 s70, 20000
    s_cbranch_scc1 L_p110ok_Y
    s_sleep 1
    buffer_load_dword v232, v238, s[32:35], 0 offen offset:2048 sc1
    s_waitcnt vmcnt(0)
    s_branch L_p110_Y
L_p110ok_Y:
    v_mfma_f32_16x16x32_bf16 a[204:207], v[212:215], a[36:39], a[204:207]
    ds_read_b64_tr_b16 v[192:193], v224 offset:0
    ds_read_b64_tr_b16 v[194:195], v224 offset:4096
    s_add_u32 m0, s61, 114688
    s_add_u32 s68, s81, 24576
    buffer_load_dwordx4 v248, s[32:35], s68 offen offset:0 sc1 lds
    v_mfma_f32_16x16x32_bf16 a[208:211], v[212:215], a[40:43], a[208:211]
    ds_read_b128 a[0:3], v245 offset:0
    ds_read_b128 a[4:7], v245 offset:2048
    v_mfma_f32_16x16x32_bf16 a[212:215], v[212:215], a[44:47], a[212:215]
    ds_read_b128 a[8:11], v245 offset:4096
    ds_read_b64_tr_b16 v[196:197], v225 offset:0
    v_mfma_f32_16x16x32_bf16 a[216:219], v[216:219], a[36:39], a[216:219]
    ds_read_b64_tr_b16 v[198:199], v225 offset:4096
    ds_read_b64_tr_b16 v[200:201], v226 offset:0
    buffer_load_dwordx4 v248, s[32:35], s68 offen offset:1024 sc1 lds
    v_mfma_f32_16x16x32_bf16 a[220:223], v[216:219], a[40:43], a[220:223]
    ds_read_b64_tr_b16 v[202:203], v226 offset:4096
    ds_read_b128 a[12:15], v245 offset:1024
    v_mfma_f32_16x16x32_bf16 a[224:227], v[216:219], a[44:47], a[224:227]
    ds_read_b128 a[16:19], v245 offset:3072
    ds_read_b128 a[20:23], v245 offset:5120
    v_mfma_f32_16x16x32_bf16 a[228:231], v[220:223], a[36:39], a[228:231]
    ds_read_b64_tr_b16 v[204:205], v227 offset:0
    ds_read_b64_tr_b16 v[206:207], v227 offset:4096
    buffer_load_dwordx4 v248, s[32:35], s68 offen offset:2048 sc1 lds
    v_mfma_f32_16x16x32_bf16 a[232:235], v[220:223], a[40:43], a[232:235]
    ds_read_b64_tr_b16 v[208:209], v224 offset:8192
    ds_read_b64_tr_b16 v[210:211], v224 offset:12288
    v_mfma_f32_16x16x32_bf16 a[236:239], v[220:223], a[44:47], a[236:239]
    s_waitcnt lgkmcnt(11)
    v_mfma_f32_16x16x32_bf16 a[192:195], v[192:195], a[0:3], a[192:195]
    s_add_u32 m0, s61, 81920
    s_add_u32 s68, s81, 36864
    buffer_load_dwordx4 v248, s[32:35], s68 offen offset:0 sc1 lds
    v_mfma_f32_16x16x32_bf16 a[196:199], v[192:195], a[4:7], a[196:199]
    ds_read_b64_tr_b16 v[212:213], v225 offset:8192
    ds_read_b64_tr_b16 v[214:215], v225 offset:12288
    v_mfma_f32_16x16x32_bf16 a[200:203], v[192:195], a[8:11], a[200:203]
    s_waitcnt lgkmcnt(11)
    v_mfma_f32_16x16x32_bf16 a[204:207], v[196:199], a[0:3], a[204:207]
    buffer_load_dwordx4 v248, s[32:35], s68 offen offset:1024 sc1 lds
    v_mfma_f32_16x16x32_bf16 a[208:211], v[196:199], a[4:7], a[208:211]
    ds_read_b64_tr_b16 v[216:217], v226 offset:8192
    ds_read_b64_tr_b16 v[218:219], v226 offset:12288
    v_mfma_f32_16x16x32_bf16 a[212:215], v[196:199], a[8:11], a[212:215]
    s_waitcnt lgkmcnt(11)
    v_mfma_f32_16x16x32_bf16 a[216:219], v[200:203], a[0:3], a[216:219]
    buffer_load_dwordx4 v248, s[32:35], s68 offen offset:2048 sc1 lds
    v_mfma_f32_16x16x32_bf16 a[220:223], v[200:203], a[4:7], a[220:223]
    ds_read_b64_tr_b16 v[220:221], v227 offset:8192
    ds_read_b64_tr_b16 v[222:223], v227 offset:12288
    v_mfma_f32_16x16x32_bf16 a[224:227], v[200:203], a[8:11], a[224:227]
    s_add_u32 s48, s60, 65536
    v_add_u32 v245, s48, v248
    s_waitcnt lgkmcnt(8)
    v_mfma_f32_16x16x32_bf16 a[228:231], v[204:207], a[0:3], a[228:231]
    v_add_u32 v224, 147456, v246
    s_add_u32 m0, s59, 49152
    s_add_u32 s68, s74, 131072
    buffer_load_dwordx4 v243, s[24:27], s68 offen offset:0  lds
    v_xor_b32 v225, 32, v224
    v_mfma_f32_16x16x32_bf16 a[232:235], v[204:207], a[4:7], a[232:235]
    v_xor_b32 v226, 64, v224
    v_xor_b32 v227, 96, v224
    v_mfma_f32_16x16x32_bf16 a[236:239], v[204:207], a[8:11], a[236:239]
    s_waitcnt lgkmcnt(6)
    v_mfma_f32_16x16x32_bf16 a[192:195], v[208:211], a[12:15], a[192:195]
    s_add_u32 s68, s68, 3072
    v_xor_b32 v244, 128, v243
    buffer_load_dwordx4 v244, s[24:27], s68 offen offset:1024  lds
    v_mfma_f32_16x16x32_bf16 a[196:199], v[208:211], a[16:19], a[196:199]
    v_mfma_f32_16x16x32_bf16 a[200:203], v[208:211], a[20:23], a[200:203]
    s_waitcnt vmcnt(17) lgkmcnt(0)
    s_barrier
    v_mfma_f32_16x16x32_bf16 a[204:207], v[212:215], a[12:15], a[204:207]
    ds_read_b64_tr_b16 v[192:193], v224 offset:0
    ds_read_b64_tr_b16 v[194:195], v224 offset:4096
    s_add_u32 s68, s68, 3072
    buffer_load_dwordx4 v243, s[24:27], s68 offen offset:2048  lds
    v_mfma_f32_16x16x32_bf16 a[208:211], v[212:215], a[16:19], a[208:211]
    ds_read_b128 a[24:27], v245 offset:0
    ds_read_b128 a[28:31], v245 offset:2048
    v_mfma_f32_16x16x32_bf16 a[212:215], v[212:215], a[20:23], a[212:215]
    ds_read_b128 a[32:35], v245 offset:4096
    ds_read_b64_tr_b16 v[196:197], v225 offset:0
    v_mfma_f32_16x16x32_bf16 a[216:219], v[216:219], a[12:15], a[216:219]
    ds_read_b64_tr_b16 v[198:199], v225 offset:4096
    ds_read_b64_tr_b16 v[200:201], v226 offset:0
    s_add_u32 s68, s68, 3072
    buffer_load_dwordx4 v244, s[24:27], s68 offen offset:3072  lds
    v_mfma_f32_16x16x32_bf16 a[220:223], v[216:219], a[16:19], a[220:223]
    ds_read_b64_tr_b16 v[202:203], v226 offset:4096
    ds_read_b128 a[36:39], v245 offset:1024
    v_mfma_f32_16x16x32_bf16 a[224:227], v[216:219], a[20:23], a[224:227]
    ds_read_b128 a[40:43], v245 offset:3072
    ds_read_b128 a[44:47], v245 offset:5120
    v_mfma_f32_16x16x32_bf16 a[228:231], v[220:223], a[12:15], a[228:231]
    ds_read_b64_tr_b16 v[204:205], v227 offset:0
    ds_read_b64_tr_b16 v[206:207], v227 offset:4096
    s_add_u32 m0, s59, 131072
    s_add_u32 s68, s74, 196608
    buffer_load_dwordx4 v243, s[24:27], s68 offen offset:0  lds
    v_mfma_f32_16x16x32_bf16 a[232:235], v[220:223], a[16:19], a[232:235]
    ds_read_b64_tr_b16 v[208:209], v224 offset:8192
    ds_read_b64_tr_b16 v[210:211], v224 offset:12288
    v_mfma_f32_16x16x32_bf16 a[236:239], v[220:223], a[20:23], a[236:239]
    s_waitcnt lgkmcnt(11)
    v_mfma_f32_16x16x32_bf16 a[192:195], v[192:195], a[24:27], a[192:195]
    s_add_u32 s68, s68, 3072
    v_xor_b32 v244, 128, v243
    buffer_load_dwordx4 v244, s[24:27], s68 offen offset:1024  lds
    v_mfma_f32_16x16x32_bf16 a[196:199], v[192:195], a[28:31], a[196:199]
    ds_read_b64_tr_b16 v[212:213], v225 offset:8192
    ds_read_b64_tr_b16 v[214:215], v225 offset:12288
    v_mfma_f32_16x16x32_bf16 a[200:203], v[192:195], a[32:35], a[200:203]
    s_waitcnt lgkmcnt(11)
    v_mfma_f32_16x16x32_bf16 a[204:207], v[196:199], a[24:27], a[204:207]
    s_add_u32 s68, s68, 3072
    buffer_load_dwordx4 v243, s[24:27], s68 offen offset:2048  lds
    v_mfma_f32_16x16x32_bf16 a[208:211], v[196:199], a[28:31], a[208:211]
    ds_read_b64_tr_b16 v[216:217], v226 offset:8192
    ds_read_b64_tr_b16 v[218:219], v226 offset:12288
    v_mfma_f32_16x16x32_bf16 a[212:215], v[196:199], a[32:35], a[212:215]
    s_waitcnt lgkmcnt(11)
    v_mfma_f32_16x16x32_bf16 a[216:219], v[200:203], a[24:27], a[216:219]
    s_add_u32 s68, s68, 3072
    buffer_load_dwordx4 v244, s[24:27], s68 offen offset:3072  lds
    v_mfma_f32_16x16x32_bf16 a[220:223], v[200:203], a[28:31], a[220:223]
    ds_read_b64_tr_b16 v[220:221], v227 offset:8192
    ds_read_b64_tr_b16 v[222:223], v227 offset:12288
    v_mfma_f32_16x16x32_bf16 a[224:227], v[200:203], a[32:35], a[224:227]
    s_add_u32 s48, s60, 114688
    v_add_u32 v245, s48, v248
    s_waitcnt lgkmcnt(8)
    v_mfma_f32_16x16x32_bf16 a[228:231], v[204:207], a[24:27], a[228:231]
    v_add_u32 v224, 16384, v246
    v_xor_b32 v225, 32, v224
    v_mfma_f32_16x16x32_bf16 a[232:235], v[204:207], a[28:31], a[232:235]
    v_xor_b32 v226, 64, v224
    v_xor_b32 v227, 96, v224
    v_mfma_f32_16x16x32_bf16 a[236:239], v[204:207], a[32:35], a[236:239]
    s_waitcnt lgkmcnt(6)
    v_mfma_f32_16x16x32_bf16 a[192:195], v[208:211], a[36:39], a[192:195]
    v_mfma_f32_16x16x32_bf16 a[196:199], v[208:211], a[40:43], a[196:199]
    v_mfma_f32_16x16x32_bf16 a[200:203], v[208:211], a[44:47], a[200:203]
    s_waitcnt vmcnt(11) lgkmcnt(0)
    s_barrier
    v_bfe_u32 v238, v248, 4, 2
    v_lshl_add_u32 v238, v238, 2, s63
    buffer_load_dword v234, v238, s[32:35], 0 offen offset:2048 sc1
    v_bfe_u32 v238, v248, 4, 2
    v_lshl_add_u32 v238, v238, 2, s63
    s_add_u32 s49, s56, 2
    s_and_b32 s49, s49, 3
    s_mov_b32 s70, 0
L_p112_Y:
    v_cmp_eq_u32 vcc, s71, v233
    s_nop 0
    s_bitcmp1_b32 vcc_lo, s49
    s_cbranch_scc1 L_p112ok_Y
    s_add_u32 s70, s70, 1
    s_cmp_gt_u32 s70, 20000
    s_cbranch_scc1 L_p112ok_Y
    s_sleep 1
    buffer_load_dword v233, v238, s[32:35], 0 offen offset:2048 sc1
    s_waitcnt vmcnt(0)
    s_branch L_p112_Y
L_p112ok_Y:
    v_mfma_f32_16x16x32_bf16 a[204:207], v[212:215], a[36:39], a[204:207]
    ds_read_b64_tr_b16 v[192:193], v224 offset:0
    ds_read_b64_tr_b16 v[194:195], v224 offset:4096
    s_add_u32 m0, s61, 147456
    s_add_u32 s68, s82, 24576
    buffer_load_dwordx4 v248, s[32:35], s68 offen offset:0 sc1 lds
    v_mfma_f32_16x16x32_bf16 a[208:211], v[212:215], a[40:43], a[208:211]
    ds_read_b128 a[0:3], v245 offset:0
    ds_read_b128 a[4:7], v245 offset:2048
    v_mfma_f32_16x16x32_bf16 a[212:215], v[212:215], a[44:47], a[212:215]
    ds_read_b128 a[8:11], v245 offset:4096
    ds_read_b64_tr_b16 v[196:197], v225 offset:0
    v_mfma_f32_16x16x32_bf16 a[216:219], v[216:219], a[36:39], a[216:219]
    ds_read_b64_tr_b16 v[198:199], v225 offset:4096
    ds_read_b64_tr_b16 v[200:201], v226 offset:0
    buffer_load_dwordx4 v248, s[32:35], s68 offen offset:1024 sc1 lds
    v_mfma_f32_16x16x32_bf16 a[220:223], v[216:219], a[40:43], a[220:223]
    ds_read_b64_tr_b16 v[202:203], v226 offset:4096
    ds_read_b128 a[12:15], v245 offset:1024
    v_mfma_f32_16x16x32_bf16 a[224:227], v[216:219], a[44:47], a[224:227]
    ds_read_b128 a[16:19], v245 offset:3072
    ds_read_b128 a[20:23], v245 offset:5120
    v_mfma_f32_16x16x32_bf16 a[228:231], v[220:223], a[36:39], a[228:231]
    ds_read_b64_tr_b16 v[204:205], v227 offset:0
    ds_read_b64_tr_b16 v[206:207], v227 offset:4096
    buffer_load_dwordx4 v248, s[32:35], s68 offen offset:2048 sc1 lds
    v_mfma_f32_16x16x32_bf16 a[232:235], v[220:223], a[40:43], a[232:235]
    ds_read_b64_tr_b16 v[208:209], v224 offset:8192
    ds_read_b64_tr_b16 v[210:211], v224 offset:12288
    v_mfma_f32_16x16x32_bf16 a[236:239], v[220:223], a[44:47], a[236:239]
    s_waitcnt lgkmcnt(11)
    v_mfma_f32_16x16x32_bf16 a[192:195], v[192:195], a[0:3], a[192:195]
    s_add_u32 m0, s61, 32768
    s_add_u32 s68, s82, 36864
    buffer_load_dwordx4 v248, s[32:35], s68 offen offset:0 sc1 lds
    v_mfma_f32_16x16x32_bf16 a[196:199], v[192:195], a[4:7], a[196:199]
    ds_read_b64_tr_b16 v[212:213], v225 offset:8192
    ds_read_b64_tr_b16 v[214:215], v225 offset:12288
    v_mfma_f32_16x16x32_bf16 a[200:203], v[192:195], a[8:11], a[200:203]
    s_waitcnt lgkmcnt(11)
    v_mfma_f32_16x16x32_bf16 a[204:207], v[196:199], a[0:3], a[204:207]
    buffer_load_dwordx4 v248, s[32:35], s68 offen offset:1024 sc1 lds
    v_mfma_f32_16x16x32_bf16 a[208:211], v[196:199], a[4:7], a[208:211]
    ds_read_b64_tr_b16 v[216:217], v226 offset:8192
    ds_read_b64_tr_b16 v[218:219], v226 offset:12288
    v_mfma_f32_16x16x32_bf16 a[212:215], v[196:199], a[8:11], a[212:215]
    s_waitcnt lgkmcnt(11)
    v_mfma_f32_16x16x32_bf16 a[216:219], v[200:203], a[0:3], a[216:219]
    buffer_load_dwordx4 v248, s[32:35], s68 offen offset:2048 sc1 lds
    v_mfma_f32_16x16x32_bf16 a[220:223], v[200:203], a[4:7], a[220:223]
    ds_read_b64_tr_b16 v[220:221], v227 offset:8192
    ds_read_b64_tr_b16 v[222:223], v227 offset:12288
    v_mfma_f32_16x16x32_bf16 a[224:227], v[200:203], a[8:11], a[224:227]
    s_add_u32 s48, s60, 81920
    v_add_u32 v245, s48, v248
    s_waitcnt lgkmcnt(8)
    v_mfma_f32_16x16x32_bf16 a[228:231], v[204:207], a[0:3], a[228:231]
    v_add_u32 v224, 0, v246
    s_add_u32 m0, s59, 98304
    s_add_u32 s68, s75, 131072
    buffer_load_dwordx4 v243, s[24:27], s68 offen offset:0  lds
    v_xor_b32 v225, 32, v224
    v_mfma_f32_16x16x32_bf16 a[232:235], v[204:207], a[4:7], a[232:235]
    v_xor_b32 v226, 64, v224
    v_xor_b32 v227, 96, v224
    v_mfma_f32_16x16x32_bf16 a[236:239], v[204:207], a[8:11], a[236:239]
    s_waitcnt lgkmcnt(6)
    v_mfma_f32_16x16x32_bf16 a[192:195], v[208:211], a[12:15], a[192:195]
    s_add_u32 s68, s68, 3072
    v_xor_b32 v244, 128, v243
    buffer_load_dwordx4 v244, s[24:27], s68 offen offset:1024  lds
    v_mfma_f32_16x16x32_bf16 a[196:199], v[208:211], a[16:19], a[196:199]
    v_mfma_f32_16x16x32_bf16 a[200:203], v[208:211], a[20:23], a[200:203]
    s_waitcnt vmcnt(17) lgkmcnt(0)
    s_barrier
    v_mfma_f32_16x16x32_bf16 a[204:207], v[212:215], a[12:15], a[204:207]
    ds_read_b64_tr_b16 v[192:193], v224 offset:0
    ds_read_b64_tr_b16 v[194:195], v224 offset:4096
    s_add_u32 s68, s68, 3072
    buffer_load_dwordx4 v243, s[24:27], s68 offen offset:2048  lds
    v_mfma_f32_16x16x32_bf16 a[208:211], v[212:215], a[16:19], a[208:211]
    ds_read_b128 a[24:27], v245 offset:0
    ds_read_b128 a[28:31], v245 offset:2048
    v_mfma_f32_16x16x32_bf16 a[212:215], v[212:215], a[20:23], a[212:215]
    ds_read_b128 a[32:35], v245 offset:4096
    ds_read_b64_tr_b16 v[196:197], v225 offset:0
    v_mfma_f32_16x16x32_bf16 a[216:219], v[216:219], a[12:15], a[216:219]
    ds_read_b64_tr_b16 v[198:199], v225 offset:4096
    ds_read_b64_tr_b16 v[200:201], v226 offset:0
    s_add_u32 s68, s68, 3072
    buffer_load_dwordx4 v244, s[24:27], s68 offen offset:3072  lds
    v_mfma_f32_16x16x32_bf16 a[220:223], v[216:219], a[16:19], a[220:223]
    ds_read_b64_tr_b16 v[202:203], v226 offset:4096
    ds_read_b128 a[36:39], v245 offset:1024
    v_mfma_f32_16x16x32_bf16 a[224:227], v[216:219], a[20:23], a[224:227]
    ds_read_b128 a[40:43], v245 offset:3072
    ds_read_b128 a[44:47], v245 offset:5120
    v_mfma_f32_16x16x32_bf16 a[228:231], v[220:223], a[12:15], a[228:231]
    ds_read_b64_tr_b16 v[204:205], v227 offset:0
    ds_read_b64_tr_b16 v[206:207], v227 offset:4096
    s_add_u32 m0, s59, 114688
    s_add_u32 s68, s75, 196608
    buffer_load_dwordx4 v243, s[24:27], s68 offen offset:0  lds
    v_mfma_f32_16x16x32_bf16 a[232:235], v[220:223], a[16:19], a[232:235]
    ds_read_b64_tr_b16 v[208:209], v224 offset:8192
    ds_read_b64_tr_b16 v[210:211], v224 offset:12288
    v_mfma_f32_16x16x32_bf16 a[236:239], v[220:223], a[20:23], a[236:239]
    s_waitcnt lgkmcnt(11)
    v_mfma_f32_16x16x32_bf16 a[192:195], v[192:195], a[24:27], a[192:195]
    s_add_u32 s68, s68, 3072
    v_xor_b32 v244, 128, v243
    buffer_load_dwordx4 v244, s[24:27], s68 offen offset:1024  lds
    v_mfma_f32_16x16x32_bf16 a[196:199], v[192:195], a[28:31], a[196:199]
    ds_read_b64_tr_b16 v[212:213], v225 offset:8192
    ds_read_b64_tr_b16 v[214:215], v225 offset:12288
    v_mfma_f32_16x16x32_bf16 a[200:203], v[192:195], a[32:35], a[200:203]
    s_waitcnt lgkmcnt(11)
    v_mfma_f32_16x16x32_bf16 a[204:207], v[196:199], a[24:27], a[204:207]
    s_add_u32 s68, s68, 3072
    buffer_load_dwordx4 v243, s[24:27], s68 offen offset:2048  lds
    v_mfma_f32_16x16x32_bf16 a[208:211], v[196:199], a[28:31], a[208:211]
    ds_read_b64_tr_b16 v[216:217], v226 offset:8192
    ds_read_b64_tr_b16 v[218:219], v226 offset:12288
    v_mfma_f32_16x16x32_bf16 a[212:215], v[196:199], a[32:35], a[212:215]
    s_waitcnt lgkmcnt(11)
    v_mfma_f32_16x16x32_bf16 a[216:219], v[200:203], a[24:27], a[216:219]
    s_add_u32 s68, s68, 3072
    buffer_load_dwordx4 v244, s[24:27], s68 offen offset:3072  lds
    v_mfma_f32_16x16x32_bf16 a[220:223], v[200:203], a[28:31], a[220:223]
    ds_read_b64_tr_b16 v[220:221], v227 offset:8192
    ds_read_b64_tr_b16 v[222:223], v227 offset:12288
    v_mfma_f32_16x16x32_bf16 a[224:227], v[200:203], a[32:35], a[224:227]
    s_add_u32 s48, s60, 147456
    v_add_u32 v245, s48, v248
    s_waitcnt lgkmcnt(8)
    v_mfma_f32_16x16x32_bf16 a[228:231], v[204:207], a[24:27], a[228:231]
    v_add_u32 v224, 49152, v246
    v_xor_b32 v225, 32, v224
    v_mfma_f32_16x16x32_bf16 a[232:235], v[204:207], a[28:31], a[232:235]
    v_xor_b32 v226, 64, v224
    v_xor_b32 v227, 96, v224
    v_mfma_f32_16x16x32_bf16 a[236:239], v[204:207], a[32:35], a[236:239]
    s_waitcnt lgkmcnt(6)
    v_mfma_f32_16x16x32_bf16 a[192:195], v[208:211], a[36:39], a[192:195]
    v_mfma_f32_16x16x32_bf16 a[196:199], v[208:211], a[40:43], a[196:199]
    v_mfma_f32_16x16x32_bf16 a[200:203], v[208:211], a[44:47], a[200:203]
    s_waitcnt vmcnt(11) lgkmcnt(0)
    s_barrier
    v_bfe_u32 v238, v248, 4, 2
    v_lshl_add_u32 v238, v238, 2, s63
    s_add_u32 s49, s56, 3
    s_and_b32 s49, s49, 3
    s_mov_b32 s70, 0
L_p114_Y:
    v_cmp_eq_u32 vcc, s71, v234
    s_nop 0
    s_bitcmp1_b32 vcc_lo, s49
    s_cbranch_scc1 L_p114ok_Y
    s_add_u32 s70, s70, 1
    s_cmp_gt_u32 s70, 20000
    s_cbranch_scc1 L_p114ok_Y
    s_sleep 1
    buffer_load_dword v234, v238, s[32:35], 0 offen offset:2048 sc1
    s_waitcnt vmcnt(0)
    s_branch L_p114_Y
L_p114ok_Y:
    v_mfma_f32_16x16x32_bf16 a[204:207], v[212:215], a[36:39], a[204:207]
    ds_read_b64_tr_b16 v[192:193], v224 offset:0
    ds_read_b64_tr_b16 v[194:195], v224 offset:4096
    s_add_u32 m0, s61, 65536
    s_add_u32 s68, s83, 24576
    buffer_load_dwordx4 v248, s[32:35], s68 offen offset:0 sc1 lds
    v_mfma_f32_16x16x32_bf16 a[208:211], v[212:215], a[40:43], a[208:211]
    ds_read_b128 a[0:3], v245 offset:0
    ds_read_b128 a[4:7], v245 offset:2048
    v_mfma_f32_16x16x32_bf16 a[212:215], v[212:215], a[44:47], a[212:215]
    ds_read_b128 a[8:11], v245 offset:4096
    ds_read_b64_tr_b16 v[196:197], v225 offset:0
    v_mfma_f32_16x16x32_bf16 a[216:219], v[216:219], a[36:39], a[216:219]
    ds_read_b64_tr_b16 v[198:199], v225 offset:4096
    ds_read_b64_tr_b16 v[200:201], v226 offset:0
    buffer_load_dwordx4 v248, s[32:35], s68 offen offset:1024 sc1 lds
    v_mfma_f32_16x16x32_bf16 a[220:223], v[216:219], a[40:43], a[220:223]
    ds_read_b64_tr_b16 v[202:203], v226 offset:4096
    ds_read_b128 a[12:15], v245 offset:1024
    v_mfma_f32_16x16x32_bf16 a[224:227], v[216:219], a[44:47], a[224:227]
    ds_read_b128 a[16:19], v245 offset:3072
    ds_read_b128 a[20:23], v245 offset:5120
    v_mfma_f32_16x16x32_bf16 a[228:231], v[220:223], a[36:39], a[228:231]
    ds_read_b64_tr_b16 v[204:205], v227 offset:0
    ds_read_b64_tr_b16 v[206:207], v227 offset:4096
    buffer_load_dwordx4 v248, s[32:35], s68 offen offset:2048 sc1 lds
    v_mfma_f32_16x16x32_bf16 a[232:235], v[220:223], a[40:43], a[232:235]
    ds_read_b64_tr_b16 v[208:209], v224 offset:8192
    ds_read_b64_tr_b16 v[210:211], v224 offset:12288
    v_mfma_f32_16x16x32_bf16 a[236:239], v[220:223], a[44:47], a[236:239]
    s_waitcnt lgkmcnt(11)
    v_mfma_f32_16x16x32_bf16 a[192:195], v[192:195], a[0:3], a[192:195]
    s_add_u32 m0, s61, 16384
    s_add_u32 s68, s83, 36864
    buffer_load_dwordx4 v248, s[32:35], s68 offen offset:0 sc1 lds
    v_mfma_f32_16x16x32_bf16 a[196:199], v[192:195], a[4:7], a[196:199]
    ds_read_b64_tr_b16 v[212:213], v225 offset:8192
    ds_read_b64_tr_b16 v[214:215], v225 offset:12288
    v_mfma_f32_16x16x32_bf16 a[200:203], v[192:195], a[8:11], a[200:203]
    s_waitcnt lgkmcnt(11)
    v_mfma_f32_16x16x32_bf16 a[204:207], v[196:199], a[0:3], a[204:207]
    buffer_load_dwordx4 v248, s[32:35], s68 offen offset:1024 sc1 lds
    v_mfma_f32_16x16x32_bf16 a[208:211], v[196:199], a[4:7], a[208:211]
    ds_read_b64_tr_b16 v[216:217], v226 offset:8192
    ds_read_b64_tr_b16 v[218:219], v226 offset:12288
    v_mfma_f32_16x16x32_bf16 a[212:215], v[196:199], a[8:11], a[212:215]
    s_waitcnt lgkmcnt(11)
    v_mfma_f32_16x16x32_bf16 a[216:219], v[200:203], a[0:3], a[216:219]
    buffer_load_dwordx4 v248, s[32:35], s68 offen offset:2048 sc1 lds
    v_mfma_f32_16x16x32_bf16 a[220:223], v[200:203], a[4:7], a[220:223]
    ds_read_b64_tr_b16 v[220:221], v227 offset:8192
    ds_read_b64_tr_b16 v[222:223], v227 offset:12288
    v_mfma_f32_16x16x32_bf16 a[224:227], v[200:203], a[8:11], a[224:227]
    s_add_u32 s48, s60, 32768
    v_add_u32 v245, s48, v248
    s_waitcnt lgkmcnt(8)
    v_mfma_f32_16x16x32_bf16 a[228:231], v[204:207], a[0:3], a[228:231]
    v_add_u32 v224, 131072, v246
    v_xor_b32 v225, 32, v224
    v_mfma_f32_16x16x32_bf16 a[232:235], v[204:207], a[4:7], a[232:235]
    v_xor_b32 v226, 64, v224
    v_xor_b32 v227, 96, v224
    v_mfma_f32_16x16x32_bf16 a[236:239], v[204:207], a[8:11], a[236:239]
    s_waitcnt lgkmcnt(6)
    v_mfma_f32_16x16x32_bf16 a[192:195], v[208:211], a[12:15], a[192:195]
    v_mfma_f32_16x16x32_bf16 a[196:199], v[208:211], a[16:19], a[196:199]
    v_mfma_f32_16x16x32_bf16 a[200:203], v[208:211], a[20:23], a[200:203]
    s_waitcnt vmcnt(14) lgkmcnt(0)
    s_barrier
    s_mul_i32 s76, s58, 147456
    s_mul_i32 s48, s40, 3072
    s_add_u32 s76, s76, s48
    s_add_u32 s76, s76, 20971520
    s_xor_b32 s48, s57, 1
    s_mul_i32 s48, s48, 36864
    s_add_u32 s48, s48, s76
    s_add_u32 s84, s48, 0
    s_xor_b32 s48, s57, 2
    s_mul_i32 s48, s48, 36864
    s_add_u32 s48, s48, s76
    s_add_u32 s85, s48, 12288
    s_xor_b32 s48, s57, 3
    s_mul_i32 s48, s48, 36864
    s_add_u32 s48, s48, s76
    s_add_u32 s86, s48, 24576
    s_mul_i32 s50, s57, 36864
    s_add_u32 s76, s76, s50
    v_bfe_u32 v50, v248, 4, 4
    v_lshrrev_b32 v51, 8, v248
    v_lshlrev_b32 v50, 11, v50
    v_lshl_add_u32 v50, v51, 3, v50
    s_mul_i32 s77, s44, 196608
    s_mul_i32 s49, s41, 98304
    s_add_u32 s77, s77, s49
    s_lshl_b32 s49, s43, 10
    s_add_u32 s77, s77, s49
    s_lshl_b32 s49, s90, 8
    s_add_u32 s77, s77, s49
    s_lshl_b32 s49, s42, 7
    s_add_u32 s77, s77, s49
    s_lshl_b32 s49, s57, 5
    s_add_u32 s77, s77, s49
    v_mfma_f32_16x16x32_bf16 a[204:207], v[212:215], a[12:15], a[204:207]
    ds_read_b64_tr_b16 v[192:193], v224 offset:0
    ds_read_b64_tr_b16 v[194:195], v224 offset:4096
    v_mfma_f32_16x16x32_bf16 a[208:211], v[212:215], a[16:19], a[208:211]
    ds_read_b128 a[24:27], v245 offset:0
    ds_read_b128 a[28:31], v245 offset:2048
    v_mfma_f32_16x16x32_bf16 a[212:215], v[212:215], a[20:23], a[212:215]
    ds_read_b128 a[32:35], v245 offset:4096
    ds_read_b64_tr_b16 v[196:197], v225 offset:0
    v_mfma_f32_16x16x32_bf16 a[216:219], v[216:219], a[12:15], a[216:219]
    ds_read_b64_tr_b16 v[198:199], v225 offset:4096
    ds_read_b64_tr_b16 v[200:201], v226 offset:0
    v_mfma_f32_16x16x32_bf16 a[220:223], v[216:219], a[16:19], a[220:223]
    ds_read_b64_tr_b16 v[202:203], v226 offset:4096
    ds_read_b128 a[36:39], v245 offset:1024
    v_mfma_f32_16x16x32_bf16 a[224:227], v[216:219], a[20:23], a[224:227]
    ds_read_b128 a[40:43], v245 offset:3072
    ds_read_b128 a[44:47], v245 offset:5120
    v_mfma_f32_16x16x32_bf16 a[228:231], v[220:223], a[12:15], a[228:231]
    ds_read_b64_tr_b16 v[204:205], v227 offset:0
    ds_read_b64_tr_b16 v[206:207], v227 offset:4096
    v_mfma_f32_16x16x32_bf16 a[232:235], v[220:223], a[16:19], a[232:235]
    ds_read_b64_tr_b16 v[208:209], v224 offset:8192
    ds_read_b64_tr_b16 v[210:211], v224 offset:12288
    v_mfma_f32_16x16x32_bf16 a[236:239], v[220:223], a[20:23], a[236:239]
    s_waitcnt lgkmcnt(11)
    v_mfma_f32_16x16x32_bf16 a[192:195], v[192:195], a[24:27], a[192:195]
    v_mfma_f32_16x16x32_bf16 a[196:199], v[192:195], a[28:31], a[196:199]
    ds_read_b64_tr_b16 v[212:213], v225 offset:8192
    ds_read_b64_tr_b16 v[214:215], v225 offset:12288
    v_mfma_f32_16x16x32_bf16 a[200:203], v[192:195], a[32:35], a[200:203]
    s_waitcnt lgkmcnt(11)
    v_mfma_f32_16x16x32_bf16 a[204:207], v[196:199], a[24:27], a[204:207]
    v_mfma_f32_16x16x32_bf16 a[208:211], v[196:199], a[28:31], a[208:211]
    ds_read_b64_tr_b16 v[216:217], v226 offset:8192
    ds_read_b64_tr_b16 v[218:219], v226 offset:12288
    v_mfma_f32_16x16x32_bf16 a[212:215], v[196:199], a[32:35], a[212:215]
    s_waitcnt lgkmcnt(11)
    v_mfma_f32_16x16x32_bf16 a[216:219], v[200:203], a[24:27], a[216:219]
    v_mfma_f32_16x16x32_bf16 a[220:223], v[200:203], a[28:31], a[220:223]
    ds_read_b64_tr_b16 v[220:221], v227 offset:8192
    ds_read_b64_tr_b16 v[222:223], v227 offset:12288
    v_mfma_f32_16x16x32_bf16 a[224:227], v[200:203], a[32:35], a[224:227]
    s_add_u32 s48, s60, 65536
    v_add_u32 v245, s48, v248
    s_waitcnt lgkmcnt(8)
    v_mfma_f32_16x16x32_bf16 a[228:231], v[204:207], a[24:27], a[228:231]
    v_add_u32 v224, 98304, v246
    v_xor_b32 v225, 32, v224
    v_mfma_f32_16x16x32_bf16 a[232:235], v[204:207], a[28:31], a[232:235]
    v_xor_b32 v226, 64, v224
    v_xor_b32 v227, 96, v224
    v_mfma_f32_16x16x32_bf16 a[236:239], v[204:207], a[32:35], a[236:239]
    s_waitcnt lgkmcnt(6)
    v_mfma_f32_16x16x32_bf16 a[192:195], v[208:211], a[36:39], a[192:195]
    v_mfma_f32_16x16x32_bf16 a[196:199], v[208:211], a[40:43], a[196:199]
    v_mfma_f32_16x16x32_bf16 a[200:203], v[208:211], a[44:47], a[200:203]
    s_waitcnt vmcnt(3) lgkmcnt(0)
    s_barrier
    v_mfma_f32_16x16x32_bf16 a[204:207], v[212:215], a[36:39], a[204:207]
    ds_read_b64_tr_b16 v[192:193], v224 offset:0
    ds_read_b64_tr_b16 v[194:195], v224 offset:4096
    v_mfma_f32_16x16x32_bf16 a[208:211], v[212:215], a[40:43], a[208:211]
    ds_read_b128 a[0:3], v245 offset:0
    ds_read_b128 a[4:7], v245 offset:2048
    v_mfma_f32_16x16x32_bf16 a[212:215], v[212:215], a[44:47], a[212:215]
    ds_read_b128 a[8:11], v245 offset:4096
    ds_read_b64_tr_b16 v[196:197], v225 offset:0
    v_mfma_f32_16x16x32_bf16 a[216:219], v[216:219], a[36:39], a[216:219]
    ds_read_b64_tr_b16 v[198:199], v225 offset:4096
    ds_read_b64_tr_b16 v[200:201], v226 offset:0
    v_mfma_f32_16x16x32_bf16 a[220:223], v[216:219], a[40:43], a[220:223]
    ds_read_b64_tr_b16 v[202:203], v226 offset:4096
    ds_read_b128 a[12:15], v245 offset:1024
    v_mfma_f32_16x16x32_bf16 a[224:227], v[216:219], a[44:47], a[224:227]
    ds_read_b128 a[16:19], v245 offset:3072
    ds_read_b128 a[20:23], v245 offset:5120
    v_mfma_f32_16x16x32_bf16 a[228:231], v[220:223], a[36:39], a[228:231]
    ds_read_b64_tr_b16 v[204:205], v227 offset:0
    ds_read_b64_tr_b16 v[206:207], v227 offset:4096
    v_mfma_f32_16x16x32_bf16 a[232:235], v[220:223], a[40:43], a[232:235]
    ds_read_b64_tr_b16 v[208:209], v224 offset:8192
    ds_read_b64_tr_b16 v[210:211], v224 offset:12288
    v_mfma_f32_16x16x32_bf16 a[236:239], v[220:223], a[44:47], a[236:239]
    s_waitcnt lgkmcnt(11)
    v_mfma_f32_16x16x32_bf16 a[192:195], v[192:195], a[0:3], a[192:195]
    v_mfma_f32_16x16x32_bf16 a[196:199], v[192:195], a[4:7], a[196:199]
    ds_read_b64_tr_b16 v[212:213], v225 offset:8192
    ds_read_b64_tr_b16 v[214:215], v225 offset:12288
    v_mfma_f32_16x16x32_bf16 a[200:203], v[192:195], a[8:11], a[200:203]
    s_waitcnt lgkmcnt(11)
    v_mfma_f32_16x16x32_bf16 a[204:207], v[196:199], a[0:3], a[204:207]
    v_mfma_f32_16x16x32_bf16 a[208:211], v[196:199], a[4:7], a[208:211]
    ds_read_b64_tr_b16 v[216:217], v226 offset:8192
    ds_read_b64_tr_b16 v[218:219], v226 offset:12288
    v_mfma_f32_16x16x32_bf16 a[212:215], v[196:199], a[8:11], a[212:215]
    s_waitcnt lgkmcnt(11)
    v_mfma_f32_16x16x32_bf16 a[216:219], v[200:203], a[0:3], a[216:219]
    v_mfma_f32_16x16x32_bf16 a[220:223], v[200:203], a[4:7], a[220:223]
    ds_read_b64_tr_b16 v[220:221], v227 offset:8192
    ds_read_b64_tr_b16 v[222:223], v227 offset:12288
    v_mfma_f32_16x16x32_bf16 a[224:227], v[200:203], a[8:11], a[224:227]
    s_add_u32 s48, s60, 16384
    v_add_u32 v245, s48, v248
    s_waitcnt lgkmcnt(8)
    v_mfma_f32_16x16x32_bf16 a[228:231], v[204:207], a[0:3], a[228:231]
    v_add_u32 v224, 114688, v246
    v_xor_b32 v225, 32, v224
    v_mfma_f32_16x16x32_bf16 a[232:235], v[204:207], a[4:7], a[232:235]
    v_xor_b32 v226, 64, v224
    v_xor_b32 v227, 96, v224
    v_mfma_f32_16x16x32_bf16 a[236:239], v[204:207], a[8:11], a[236:239]
    s_waitcnt lgkmcnt(6)
    v_mfma_f32_16x16x32_bf16 a[192:195], v[208:211], a[12:15], a[192:195]
    v_mfma_f32_16x16x32_bf16 a[196:199], v[208:211], a[16:19], a[196:199]
    v_mfma_f32_16x16x32_bf16 a[200:203], v[208:211], a[20:23], a[200:203]
    s_waitcnt vmcnt(0) lgkmcnt(0)
    s_barrier
    v_mfma_f32_16x16x32_bf16 a[204:207], v[212:215], a[12:15], a[204:207]
    ds_read_b64_tr_b16 v[192:193], v224 offset:0
    ds_read_b64_tr_b16 v[194:195], v224 offset:4096
    v_mfma_f32_16x16x32_bf16 a[208:211], v[212:215], a[16:19], a[208:211]
    ds_read_b128 a[24:27], v245 offset:0
    ds_read_b128 a[28:31], v245 offset:2048
    v_mfma_f32_16x16x32_bf16 a[212:215], v[212:215], a[20:23], a[212:215]
    ds_read_b128 a[32:35], v245 offset:4096
    ds_read_b64_tr_b16 v[196:197], v225 offset:0
    v_mfma_f32_16x16x32_bf16 a[216:219], v[216:219], a[12:15], a[216:219]
    ds_read_b64_tr_b16 v[198:199], v225 offset:4096
    ds_read_b64_tr_b16 v[200:201], v226 offset:0
    v_mfma_f32_16x16x32_bf16 a[220:223], v[216:219], a[16:19], a[220:223]
    ds_read_b64_tr_b16 v[202:203], v226 offset:4096
    ds_read_b128 a[36:39], v245 offset:1024
    v_mfma_f32_16x16x32_bf16 a[224:227], v[216:219], a[20:23], a[224:227]
    ds_read_b128 a[40:43], v245 offset:3072
    ds_read_b128 a[44:47], v245 offset:5120
    v_mfma_f32_16x16x32_bf16 a[228:231], v[220:223], a[12:15], a[228:231]
    ds_read_b64_tr_b16 v[204:205], v227 offset:0
    ds_read_b64_tr_b16 v[206:207], v227 offset:4096
    v_mfma_f32_16x16x32_bf16 a[232:235], v[220:223], a[16:19], a[232:235]
    ds_read_b64_tr_b16 v[208:209], v224 offset:8192
    ds_read_b64_tr_b16 v[210:211], v224 offset:12288
    v_mfma_f32_16x16x32_bf16 a[236:239], v[220:223], a[20:23], a[236:239]
    s_waitcnt lgkmcnt(11)
    v_mfma_f32_16x16x32_bf16 a[192:195], v[192:195], a[24:27], a[192:195]
    v_mfma_f32_16x16x32_bf16 a[196:199], v[192:195], a[28:31], a[196:199]
    ds_read_b64_tr_b16 v[212:213], v225 offset:8192
    ds_read_b64_tr_b16 v[214:215], v225 offset:12288
    v_mfma_f32_16x16x32_bf16 a[200:203], v[192:195], a[32:35], a[200:203]
    s_waitcnt lgkmcnt(11)
    v_mfma_f32_16x16x32_bf16 a[204:207], v[196:199], a[24:27], a[204:207]
    v_mfma_f32_16x16x32_bf16 a[208:211], v[196:199], a[28:31], a[208:211]
    ds_read_b64_tr_b16 v[216:217], v226 offset:8192
    ds_read_b64_tr_b16 v[218:219], v226 offset:12288
    v_mfma_f32_16x16x32_bf16 a[212:215], v[196:199], a[32:35], a[212:215]
    s_waitcnt lgkmcnt(11)
    v_mfma_f32_16x16x32_bf16 a[216:219], v[200:203], a[24:27], a[216:219]
    v_mfma_f32_16x16x32_bf16 a[220:223], v[200:203], a[28:31], a[220:223]
    ds_read_b64_tr_b16 v[220:221], v227 offset:8192
    ds_read_b64_tr_b16 v[222:223], v227 offset:12288
    v_mfma_f32_16x16x32_bf16 a[224:227], v[200:203], a[32:35], a[224:227]
    s_waitcnt lgkmcnt(8)
    v_mfma_f32_16x16x32_bf16 a[228:231], v[204:207], a[24:27], a[228:231]
    v_mfma_f32_16x16x32_bf16 a[232:235], v[204:207], a[28:31], a[232:235]
    v_mfma_f32_16x16x32_bf16 a[236:239], v[204:207], a[32:35], a[236:239]
    s_waitcnt lgkmcnt(6)
    v_mfma_f32_16x16x32_bf16 a[192:195], v[208:211], a[36:39], a[192:195]
    v_mfma_f32_16x16x32_bf16 a[196:199], v[208:211], a[40:43], a[196:199]
    v_mfma_f32_16x16x32_bf16 a[200:203], v[208:211], a[44:47], a[200:203]
    s_waitcnt lgkmcnt(4)
    v_mfma_f32_16x16x32_bf16 a[204:207], v[212:215], a[36:39], a[204:207]
    v_mfma_f32_16x16x32_bf16 a[208:211], v[212:215], a[40:43], a[208:211]
    v_mfma_f32_16x16x32_bf16 a[212:215], v[212:215], a[44:47], a[212:215]
    s_waitcnt lgkmcnt(2)
    v_mfma_f32_16x16x32_bf16 a[216:219], v[216:219], a[36:39], a[216:219]
    v_mfma_f32_16x16x32_bf16 a[220:223], v[216:219], a[40:43], a[220:223]
    v_mfma_f32_16x16x32_bf16 a[224:227], v[216:219], a[44:47], a[224:227]
    s_waitcnt lgkmcnt(0)
    v_mfma_f32_16x16x32_bf16 a[228:231], v[220:223], a[36:39], a[228:231]
    v_mfma_f32_16x16x32_bf16 a[232:235], v[220:223], a[40:43], a[232:235]
    v_mfma_f32_16x16x32_bf16 a[236:239], v[220:223], a[44:47], a[236:239]
    buffer_store_dwordx4 a[204:207], v248, s[32:35], s84 offen offset:0 sc1
    buffer_store_dwordx4 a[208:211], v248, s[32:35], s84 offen offset:1024 sc1
    buffer_store_dwordx4 a[212:215], v248, s[32:35], s84 offen offset:2048 sc1
    buffer_store_dwordx4 a[216:219], v248, s[32:35], s85 offen offset:0 sc1
    buffer_store_dwordx4 a[220:223], v248, s[32:35], s85 offen offset:1024 sc1
    buffer_store_dwordx4 a[224:227], v248, s[32:35], s85 offen offset:2048 sc1
    buffer_store_dwordx4 a[228:231], v248, s[32:35], s86 offen offset:0 sc1
    buffer_store_dwordx4 a[232:235], v248, s[32:35], s86 offen offset:1024 sc1
    buffer_store_dwordx4 a[236:239], v248, s[32:35], s86 offen offset:2048 sc1
    s_lshl_b32 s63, s58, 6
    s_add_u32 s63, s63, 16785408
    s_lshl_b32 s49, s57, 2
    s_add_u32 s47, s63, s49
    v_accvgpr_read_b32 v96, a192
    v_accvgpr_read_b32 v97, a193
    v_accvgpr_read_b32 v98, a194
    v_accvgpr_read_b32 v99, a195
    v_accvgpr_read_b32 v100, a196
    v_accvgpr_read_b32 v101, a197
    v_accvgpr_read_b32 v102, a198
    v_accvgpr_read_b32 v103, a199
    v_accvgpr_read_b32 v104, a200
    v_accvgpr_read_b32 v105, a201
    v_accvgpr_read_b32 v106, a202
    v_accvgpr_read_b32 v107, a203
    s_waitcnt vmcnt(0)
    s_barrier
    s_lshl_b32 s48, s40, 28
    s_add_u32 s48, s48, s47
    v_lshlrev_b32 v52, 24, v248
    v_lshrrev_b32 v53, 8, v248
    v_lshl_or_b32 v52, v53, 28, v52
    v_or_b32 v52, s48, v52
    v_mov_b32 v53, s71
    buffer_store_dword v53, v52, s[32:35], 0 offen offset:0 sc1
    v_bfe_u32 v54, v248, 4, 2
    v_lshl_add_u32 v54, v54, 2, s63
    buffer_load_dword v55, v54, s[32:35], 0 offen offset:0 sc1
    v_bfe_u32 v54, v248, 4, 2
    v_lshl_add_u32 v54, v54, 2, s63
    s_waitcnt vmcnt(0)
    s_mov_b32 s70, 0
L_p2_Y:
    v_cmp_eq_u32 vcc, s71, v55
    s_nop 0
    s_cmp_eq_u64 vcc, -1
    s_cbranch_scc1 L_p2ok_Y
    s_add_u32 s70, s70, 1
    s_cmp_gt_u32 s70, 20000
    s_cbranch_scc1 L_p2ok_Y
    s_sleep 1
    buffer_load_dword v55, v54, s[32:35], 0 offen offset:0 sc1
    s_waitcnt vmcnt(0)
    s_branch L_p2_Y
L_p2ok_Y:
    buffer_load_dwordx4 v[0:3], v248, s[32:35], s76 offen offset:0 sc1
    buffer_load_dwordx4 v[4:7], v248, s[32:35], s76 offen offset:1024 sc1
    buffer_load_dwordx4 v[8:11], v248, s[32:35], s76 offen offset:2048 sc1
    s_add_u32 s76, s76, 12288
    buffer_load_dwordx4 v[12:15], v248, s[32:35], s76 offen offset:0 sc1
    buffer_load_dwordx4 v[16:19], v248, s[32:35], s76 offen offset:1024 sc1
    buffer_load_dwordx4 v[20:23], v248, s[32:35], s76 offen offset:2048 sc1
    s_add_u32 s76, s76, 12288
    buffer_load_dwordx4 v[24:27], v248, s[32:35], s76 offen offset:0 sc1
    buffer_load_dwordx4 v[28:31], v248, s[32:35], s76 offen offset:1024 sc1
    buffer_load_dwordx4 v[32:35], v248, s[32:35], s76 offen offset:2048 sc1
    s_waitcnt vmcnt(0)
    v_add_f32 v96, v96, v0
    v_add_f32 v12, v12, v24
    v_add_f32 v96, v96, v12
    v_add_f32 v97, v97, v1
    v_add_f32 v13, v13, v25
    v_add_f32 v97, v97, v13
    v_add_f32 v98, v98, v2
    v_add_f32 v14, v14, v26
    v_add_f32 v98, v98, v14
    v_add_f32 v99, v99, v3
    v_add_f32 v15, v15, v27
    v_add_f32 v99, v99, v15
    v_cvt_pk_bf16_f32 v56, v96, v97
    v_cvt_pk_bf16_f32 v57, v98, v99
    buffer_store_dwordx2 v[56:57], v50, s[28:31], s77 offen
    v_add_f32 v100, v100, v4
    v_add_f32 v16, v16, v28
    v_add_f32 v100, v100, v16
    v_add_f32 v101, v101, v5
    v_add_f32 v17, v17, v29
    v_add_f32 v101, v101, v17
    v_add_f32 v102, v102, v6
    v_add_f32 v18, v18, v30
    v_add_f32 v102, v102, v18
    v_add_f32 v103, v103, v7
    v_add_f32 v19, v19, v31
    v_add_f32 v103, v103, v19
    v_cvt_pk_bf16_f32 v58, v100, v101
    v_cvt_pk_bf16_f32 v59, v102, v103
    s_add_u32 s77, s77, 32768
    buffer_store_dwordx2 v[58:59], v50, s[28:31], s77 offen
    v_add_f32 v104, v104, v8
    v_add_f32 v20, v20, v32
    v_add_f32 v104, v104, v20
    v_add_f32 v105, v105, v9
    v_add_f32 v21, v21, v33
    v_add_f32 v105, v105, v21
    v_add_f32 v106, v106, v10
    v_add_f32 v22, v22, v34
    v_add_f32 v106, v106, v22
    v_add_f32 v107, v107, v11
    v_add_f32 v23, v23, v35
    v_add_f32 v107, v107, v23
    v_cvt_pk_bf16_f32 v60, v104, v105
    v_cvt_pk_bf16_f32 v61, v106, v107
    s_add_u32 s77, s77, 32768
    buffer_store_dwordx2 v[60:61], v50, s[28:31], s77 offen
    s_waitcnt vmcnt(0)
    s_endpgm
.section .rodata,"a"
.p2align 6
.amdhsa_kernel concat_heads__gqa_block_cached__mha_block_cached__near_ridge_kernel
  .amdhsa_next_free_vgpr 512
  .amdhsa_next_free_sgpr 102
  .amdhsa_accum_offset 256
  .amdhsa_group_segment_fixed_size 0
  .amdhsa_kernarg_size 104
  .amdhsa_user_sgpr_count 2
  .amdhsa_user_sgpr_kernarg_segment_ptr 1
  .amdhsa_system_sgpr_workgroup_id_x 1
.end_amdhsa_kernel
.text
```
